```python
import torch

def _softmax(x, axis=-1):
    return torch.softmax(x, dim=axis)
def _gelu(x):
    return torch.nn.functional.gelu(x, approximate="tanh")
def _silu(x):
    return torch.nn.functional.silu(x)
def _sigmoid(x):
    return torch.sigmoid(x)
def _layernorm(x, axis=-1, eps=1e-5):
    m = x.mean(dim=axis, keepdim=True)
    v = x.var(dim=axis, keepdim=True, unbiased=False)
    return (x - m) / torch.sqrt(v + eps)
def _scatter_add(tgt, idx, src, axis=0):
    return tgt.clone().index_add_(axis, idx, src)
def _segment_sum(src, seg, n):
    out = torch.zeros((n,) + src.shape[1:], dtype=src.dtype)
    return out.index_add_(0, seg, src)
def _pad(x, pw):
    flat = tuple(v for pair in reversed(pw) for v in pair)
    return torch.nn.functional.pad(x, flat)

kernel_name = 'recurrent_scan__sliding_block_cached__mixer_s_mlp__prompt'

def setup_inputs():

    _w = (lambda a: (lambda t: t.to(torch.bfloat16) if t.is_floating_point() else t)(torch.as_tensor(a)))
    def _A_setup():
        B, Sq, D = 1, 2048, 576
        Hq, Hkv, Sk, Dh = 32, 16, 2048, 128
        assert Hq % Hkv == 0, (Hq, Hkv)
        return {
            "x": _w((lambda *s: torch.randn(*s, dtype=torch.bfloat16) * 0.05)(B, Sq, D)),
            "k_cache": _w((lambda *s: torch.randn(*s, dtype=torch.bfloat16) * 0.8)(B, Hkv, Sk, Dh)),
            "v_cache": _w((lambda *s: torch.randn(*s, dtype=torch.bfloat16) * 0.8)(B, Hkv, Sk, Dh)),
            "wq": _w((lambda *s: torch.randn(*s, dtype=torch.bfloat16) * 0.8)(D, Hq * Dh) * (D ** -0.5)),
            "wo": _w((lambda *s: torch.randn(*s, dtype=torch.bfloat16) * 0.8)(Hq * Dh, D) * ((Hq * Dh) ** -0.5)),
        }
    _A_in = _A_setup()

    def _B_setup():
        B, S, D, F = 1, 2048, 576, 4608
        return {
            "x":  _w((lambda *s: torch.randn(*s, dtype=torch.bfloat16) * 0.05)(B, S, D)),
            "w1": _w((lambda *s: torch.randn(*s, dtype=torch.bfloat16) * 3.2)(D, D) * (D ** -0.5)),
            "w2": _w((lambda *s: torch.randn(*s, dtype=torch.bfloat16) * 3.2)(D, D) * (D ** -0.5)),
            "w3": _w((lambda *s: torch.randn(*s, dtype=torch.bfloat16) * 3.2)(D, F) * (D ** -0.5)),
            "w4": _w((lambda *s: torch.randn(*s, dtype=torch.bfloat16) * 3.2)(F, D) * (F ** -0.5)),
        }
    _B_in = _B_setup()

    return {
        "A_x": _A_in["x"],
        "A_k_cache": _A_in["k_cache"],
        "A_v_cache": _A_in["v_cache"],
        "A_wq": _A_in["wq"],
        "A_wo": _A_in["wo"],
        "B_x": _B_in["x"],
        "B_w1": _B_in["w1"],
        "B_w2": _B_in["w2"],
        "B_w3": _B_in["w3"],
        "B_w4": _B_in["w4"],
    }

def reference(A_x, A_k_cache, A_v_cache, A_wq, A_wo, B_x, B_w1, B_w2, B_w3, B_w4):
    def _A_ref(x, k_cache, v_cache, wq, wo):
        B, Sq, D = x.shape
        Hq, Dh = 32, 128
        Hkv, Sk = k_cache.shape[1], k_cache.shape[2]
        W = min(4096, max(256, Sk // 4))
        rep = Hq // Hkv
        q = (lambda x, *d: x.permute(*d))((x @ wq).reshape(B, Sq, Hq, Dh), 0, 2, 1, 3)
        k = (lambda x, n, axis: torch.repeat_interleave(x, n, dim=axis))(k_cache[:, :, Sk - W:, :], rep, axis=1)
        v = (lambda x, n, axis: torch.repeat_interleave(x, n, dim=axis))(v_cache[:, :, Sk - W:, :], rep, axis=1)
        scores = torch.einsum("bhqd,bhkd->bhqk", q, k) * (Dh ** -0.5)
        p = _softmax(scores, axis=-1)
        o = torch.einsum("bhqk,bhkd->bhqd", p, v)
        return (lambda x, *d: x.permute(*d))(o, 0, 2, 1, 3).reshape(B, Sq, Hq * Dh) @ wo

    def _B_ref(x, w1, w2, w3, w4):
        B, S, D = x.shape
        h = _gelu(_layernorm(x, axis=-1) @ w1)
        c = D // 4
        g0 = _pad(h[:, :, 0*c:1*c], ((0, 0), (1, 0), (0, 0)))[:, :S, :]
        g1 = _pad(h[:, :, 1*c:2*c], ((0, 0), (0, 1), (0, 0)))[:, 1:, :]
        g2 = _pad(h[:, :, 2*c:3*c], ((0, 0), (2, 0), (0, 0)))[:, :S, :]
        g3 = _pad(h[:, :, 3*c:   ], ((0, 0), (0, 2), (0, 0)))[:, 2:, :]
        hs = torch.concatenate([g0, g1, g2, g3], axis=-1) @ w2
        x1 = x + hs
        h2 = _gelu(_layernorm(x1, axis=-1) @ w3) @ w4
        return x1 + h2

    x = A_x
    xn = _layernorm(x, axis=-1)
    s = _A_ref(xn, A_k_cache, A_v_cache, A_wq, A_wo)
    g = _silu(_B_ref(xn, B_w1, B_w2, B_w3, B_w4))
    return x + s * g
```

```asm
; @launch grid=(256,1,1) block=(256,1,1) lds=163840
.amdgcn_target "amdgcn-amd-amdhsa--gfx950"
.macro R d, a, o
ds_read_b64_tr_b16 v[\d:\d+1], v\a offset:\o
.endm
.macro NV d, a, b
v_mfma_f32_16x16x32_bf16 v[\d:\d+3], v[\a:\a+3], v[\b:\b+3], v[\d:\d+3]
.endm
.macro NA d, a, b
v_mfma_f32_16x16x32_bf16 v[\d:\d+3], v[\a:\a+3], a[\b:\b+3], v[\d:\d+3]
.endm
.macro MA d, a, b
v_mfma_f32_32x32x16_bf16 a[\d:\d+15], v[\a:\a+3], v[\b:\b+3], a[\d:\d+15]
.endm
.macro MS d, a, b
v_mfma_f32_32x32x16_bf16 v[\d:\d+15], v[\a:\a+3], a[\b:\b+3], v[\d:\d+15]
.endm
.macro NC d, a, b
v_mfma_f32_16x16x32_bf16 a[\d:\d+3], v[\a:\a+3], v[\b:\b+3], a[\d:\d+3]
.endm
.macro MV d, a, b
v_mfma_f32_32x32x16_bf16 v[\d:\d+15], v[\a:\a+3], v[\b:\b+3], v[\d:\d+15]
.endm
.macro CV d, a, b
v_cvt_pk_bf16_f32 v\d, v\a, v\b
.endm
.text
.globl recurrent_scan__sliding_block_cached__mixer_s_mlp__prompt_kernel
.p2align 12
.type recurrent_scan__sliding_block_cached__mixer_s_mlp__prompt_kernel,@function
recurrent_scan__sliding_block_cached__mixer_s_mlp__prompt_kernel:
s_cmp_ge_u32 s2, 256
s_cbranch_scc1 LM_end
s_load_dwordx2 s[4:5], s[0:1], 0
s_load_dwordx2 s[24:25], s[0:1], 48
s_load_dwordx2 s[16:17], s[0:1], 24
s_load_dwordx2 s[8:9], s[0:1], 8
s_load_dwordx2 s[12:13], s[0:1], 16
s_load_dwordx2 s[20:21], s[0:1], 32
s_load_dwordx2 s[28:29], s[0:1], 56
s_load_dwordx2 s[32:33], s[0:1], 64
s_load_dwordx2 s[36:37], s[0:1], 72
s_load_dwordx2 s[40:41], s[0:1], 80
s_load_dwordx2 s[44:45], s[0:1], 88
s_load_dwordx2 s[48:49], s[0:1], 96
v_lshrrev_b32 v40, 6, v0
v_and_b32 v1, 63, v0
v_readfirstlane_b32 s52, v40
s_getpc_b64 s[100:101]
s_bfe_u32 s71, s2, 0x30003
s_lshl_b32 s71, s71, 15
v_lshlrev_b32 v41, 7, v0
v_add_u32 v41, s71, v41
v_min_u32 v41, LA_end-recurrent_scan__sliding_block_cached__mixer_s_mlp__prompt_kernel-256, v41
global_load_dword v42, v41, s[100:101]
s_bfe_u32 s57, s2, 0x10000
s_bfe_u32 s56, s2, 0x10003
s_bfe_u32 s71, s2, 0x10001
s_lshl_b32 s71, s71, 1
s_or_b32 s56, s56, s71
s_bfe_u32 s71, s2, 0x10002
s_lshl_b32 s71, s71, 2
s_or_b32 s56, s56, s71
s_bfe_u32 s54, s2, 0x10004
s_bfe_u32 s71, s2, 0x10005
s_lshl_b32 s71, s71, 1
s_or_b32 s54, s54, s71
s_bfe_u32 s71, s2, 0x10006
s_lshl_b32 s71, s71, 2
s_or_b32 s54, s54, s71
s_bfe_u32 s71, s2, 0x10007
s_lshl_b32 s71, s71, 3
s_or_b32 s54, s54, s71
s_lshl_b32 s53, s57, 3
s_add_u32 s53, s53, s56
s_lshl_b32 s55, s54, 2
s_add_u32 s55, s55, s52
s_mul_i32 s82, s55, 36864
s_lshl_b32 s66, s52, 13
s_mul_i32 s76, s52, 12288
v_lshrrev_b32 v21, 3, v1
v_mul_u32_u24 v19, 1152, v21
v_lshrrev_b32 v21, 1, v21
v_and_b32 v22, 7, v1
v_xor_b32 v22, v21, v22
v_lshlrev_b32 v22, 4, v22
v_xor_b32 v21, 64, v22
v_add_u32 v20, v19, v21
v_add_u32 v19, v19, v22
v_add_u32 v20, 8192, v20
v_add_u32 v21, 16384, v19
v_add_u32 v22, 16384, v20
s_mov_b32 s6, 2359296
s_mov_b32 s7, 0x20000
s_mov_b32 s10, 8388608
s_mov_b32 s11, 0x20000
s_mov_b32 s14, 8388608
s_mov_b32 s15, 0x20000
s_mov_b32 s18, 4718592
s_mov_b32 s19, 0x20000
s_mov_b32 s22, 4718592
s_mov_b32 s23, 0x20000
s_mov_b32 s26, 663552
s_mov_b32 s27, 0x20000
s_mov_b32 s30, 663552
s_mov_b32 s31, 0x20000
s_mov_b32 s34, 5308416
s_mov_b32 s35, 0x20000
s_mov_b32 s38, 5308416
s_mov_b32 s39, 0x20000
s_mov_b32 s42, 2359296
s_mov_b32 s43, 0x20000
s_mov_b32 s46, 256
s_mov_b32 s47, 0x20000
s_mov_b32 s50, 43778048
s_mov_b32 s51, 0x20000
v_min_u32 v46, 17, v1
v_lshlrev_b32 v46, 7, v46
s_mul_i32 s71, s53, 2304
s_add_u32 s71, s71, s82
s_waitcnt lgkmcnt(0)
buffer_load_dword v0, v46, s[4:7], s71 offen
s_add_u32 m0, s76, 110592
s_add_u32 s75, s82, 0
buffer_load_dwordx4 v19, s[4:7], s75 offen offset:0 lds
buffer_load_dwordx4 v20, s[4:7], s75 offen offset:1024 lds
buffer_load_dwordx4 v21, s[4:7], s75 offen offset:2048 lds
buffer_load_dwordx4 v22, s[4:7], s75 offen offset:3072 lds
s_add_u32 m0, s76, 114688
s_add_u32 s75, s82, 128
buffer_load_dwordx4 v19, s[4:7], s75 offen offset:0 lds
buffer_load_dwordx4 v20, s[4:7], s75 offen offset:1024 lds
buffer_load_dwordx4 v21, s[4:7], s75 offen offset:2048 lds
buffer_load_dwordx4 v22, s[4:7], s75 offen offset:3072 lds
v_and_b32 v46, 31, v1
v_lshrrev_b32 v47, 1, v46
v_and_b32 v47, 7, v47
v_lshrrev_b32 v56, 5, v1
v_xor_b32 v47, v47, v56
v_lshlrev_b32 v47, 4, v47
v_lshl_add_u32 v56, v46, 7, v47
v_xor_b32 v57, 32, v56
v_xor_b32 v58, 64, v56
v_xor_b32 v59, 96, v56
s_add_u32 s71, s76, 110592
v_add_u32 v48, s71, v56
v_add_u32 v52, s66, v56
v_add_u32 v56, 73728, v52
v_add_u32 v49, s71, v57
v_add_u32 v53, s66, v57
v_add_u32 v57, 73728, v53
v_add_u32 v50, s71, v58
v_add_u32 v54, s66, v58
v_add_u32 v58, 73728, v54
v_add_u32 v51, s71, v59
v_add_u32 v55, s66, v59
v_add_u32 v59, 73728, v55
s_mul_i32 s67, s52, 9216
s_mul_i32 s69, s52, 3072
s_lshl_b32 s68, s52, 12
v_lshrrev_b32 v16, 3, v1
v_and_b32 v17, 7, v1
v_lshlrev_b32 v17, 4, v17
v_mul_u32_u24 v15, 8192, v16
v_lshlrev_b32 v16, 5, v16
v_and_b32 v16, 64, v16
v_xor_b32 v17, v16, v17
v_add_u32 v15, v15, v17
v_add_u32 v16, 64512, v15
v_add_u32 v17, 129024, v15
v_add_u32 v18, 193536, v15
s_lshl_b32 s80, s55, 7
s_lshl_b32 s72, s53, 2
s_add_u32 s80, s80, s72
s_add_u32 s80, s80, 42598400
s_lshl_b32 s71, s54, 3
s_add_u32 s71, s71, s56
s_lshl_b32 s71, s71, 2
s_add_u32 s71, s71, s52
s_mul_i32 s78, s71, 36864
v_mov_b32 v44, 2147483648
v_cmp_eq_u32 vcc, 0, v1
s_nop 1
v_cndmask_b32 v30, v44, 0, vcc
v_lshlrev_b32 v23, 4, v1
v_and_b32 v44, 1, v1
v_lshlrev_b32 v44, 4, v44
v_and_b32 v45, 2, v1
v_lshl_add_u32 v44, v45, 2, v44
v_and_b32 v45, 16, v1
v_lshl_add_u32 v44, v45, 1, v44
v_and_b32 v45, 12, v1
v_lshl_add_u32 v46, v45, 5, v44
v_and_b32 v45, 8, v1
v_lshl_add_u32 v46, v45, 3, v46
v_and_b32 v45, 32, v1
v_lshl_add_u32 v2, v45, 5, v46
v_xor_b32 v5, 64, v2
v_add_u32 v3, 0x10000, v2
v_add_u32 v4, 0x20000, v2
v_add_u32 v6, 0x10000, v5
v_add_u32 v7, 0x20000, v5
s_mov_b32 s83, 0x3f803f80
s_mov_b32 s77, 0x40000
v_mov_b32 v32, 0
v_mov_b32 v33, 0
v_mov_b32 v34, 0
v_mov_b32 v35, 0
v_mov_b32 v36, 0
v_mov_b32 v37, 0
v_mov_b32 v38, 0
v_mov_b32 v39, 0
s_add_u32 m0, s76, 118784
s_add_u32 s75, s82, 256
buffer_load_dwordx4 v19, s[4:7], s75 offen offset:0 lds
buffer_load_dwordx4 v20, s[4:7], s75 offen offset:1024 lds
buffer_load_dwordx4 v21, s[4:7], s75 offen offset:2048 lds
buffer_load_dwordx4 v22, s[4:7], s75 offen offset:3072 lds
s_add_u32 m0, s66, 0
s_add_u32 s75, s82, 384
buffer_load_dwordx4 v19, s[4:7], s75 offen offset:0 lds
buffer_load_dwordx4 v20, s[4:7], s75 offen offset:1024 lds
buffer_load_dwordx4 v21, s[4:7], s75 offen offset:2048 lds
buffer_load_dwordx4 v22, s[4:7], s75 offen offset:3072 lds
s_waitcnt vmcnt(17)
s_cmp_eq_u32 s57, 1
s_cbranch_scc1 LA_start
LM_start:
s_mov_b64 exec, 0
s_cmp_eq_u32 s52, 0
s_cbranch_scc1 LM_pad1
s_cmp_eq_u32 s52, 1
s_cbranch_scc1 LM_pad2
s_cmp_eq_u32 s52, 2
s_cbranch_scc1 LM_pad3
s_branch LM_pad4
.p2align 12
LM_ret:
s_mov_b64 exec, -1
s_getpc_b64 s[100:101]
s_and_b32 s100, s100, 0xfffff000
s_lshl_b32 s71, s52, 10
s_add_u32 s100, s100, s71
s_addc_u32 s101, s101, 0
s_mul_i32 s70, s52, 6144
s_mul_i32 s71, s52, 55296
s_lshl_b32 s85, s56, 7
s_add_u32 s58, s71, s85
s_lshl_b32 s72, s56, 6
s_add_u32 s59, s71, s72
s_add_u32 s59, s59, 1024
s_cmp_lt_u32 s56, 2
s_cselect_b32 s79, 0, 2147483648
s_mul_i32 s60, s52, 196608
s_lshl_b32 s73, s56, 10
s_add_u32 s60, s60, s73
s_add_u32 s60, s60, 640
s_mul_i32 s61, s52, 663552
s_mul_i32 s73, s56, 1152
s_add_u32 s61, s61, s73
s_mul_i32 s62, s52, 82944
s_mul_i32 s73, s56, 663552
s_add_u32 s62, s62, s73
v_lshrrev_b32 v12, 3, v1
v_and_b32 v13, 7, v1
v_lshlrev_b32 v13, 4, v13
v_mul_u32_u24 v11, 1152, v12
v_lshlrev_b32 v12, 5, v12
v_and_b32 v12, 64, v12
v_xor_b32 v13, v12, v13
v_add_u32 v11, v11, v13
v_add_u32 v12, 8192, v11
v_add_u32 v13, 16384, v11
v_add_u32 v14, 24576, v11
v_lshrrev_b32 v44, 2, v1
v_mul_u32_u24 v44, 1152, v44
v_and_b32 v45, 3, v1
v_lshl_add_u32 v44, v45, 4, v44
v_or_b32 v108, s79, v44
v_add_u32 v109, 17408, v108
v_add_u32 v110, 34816, v108
v_and_b32 v44, 56, v2
v_and_b32 v45, 12, v1
v_lshl_add_u32 v44, v45, 4, v44
v_and_b32 v45, 32, v1
v_lshl_add_u32 v8, v45, 4, v44
v_add_u32 v9, 0x10000, v8
s_or_b32 s73, s56, s52
s_cmp_eq_u32 s73, 0
s_cselect_b32 s73, 0, 2147483648
v_and_b32 v44, 3, v1
v_lshlrev_b32 v60, 4, v44
v_and_b32 v44, 12, v1
v_lshl_add_u32 v60, v44, 5, v60
v_and_b32 v44, 48, v1
v_lshl_add_u32 v60, v44, 9, v60
v_or_b32 v60, s73, v60
v_or_b32 v31, s73, v30
v_mov_b32 v64, 0
v_mov_b32 v65, 0
v_mov_b32 v66, 0
v_mov_b32 v67, 0
s_mul_i32 s0, s55, 10368
s_mul_i32 s74, s56, 128
s_add_u32 s0, s0, s74
v_lshrrev_b32 v44, 2, v1
v_min_u32 v44, 8, v44
v_mul_u32_u24 v44, 1152, v44
s_add_u32 s0, s0, 0
buffer_load_dword v0, v44, s[24:27], s0 offen
buffer_store_dwordx4 v[64:67], v60, s[48:51], s80 offen sc1
s_add_u32 s71, s80, 32768
buffer_store_dwordx4 v[64:67], v60, s[48:51], s71 offen sc1
s_add_u32 s71, s71, 32768
buffer_store_dwordx4 v[64:67], v60, s[48:51], s71 offen sc1
s_add_u32 m0, s66, 4096
s_add_u32 s75, s82, 512
buffer_load_dwordx4 v19, s[4:7], s75 offen offset:0 lds
buffer_load_dwordx4 v20, s[4:7], s75 offen offset:1024 lds
buffer_load_dwordx4 v21, s[4:7], s75 offen offset:2048 lds
buffer_load_dwordx4 v22, s[4:7], s75 offen offset:3072 lds
s_waitcnt vmcnt(20)
ds_read_b128 v[112:115], v48 offset:0
ds_read_b128 v[116:119], v49 offset:0
ds_read_b128 v[120:123], v50 offset:0
ds_read_b128 v[124:127], v51 offset:0
s_add_u32 m0, s66, 36864
s_add_u32 s75, s82, 640
buffer_load_dwordx4 v19, s[4:7], s75 offen offset:0 lds
buffer_load_dwordx4 v20, s[4:7], s75 offen offset:1024 lds
buffer_load_dwordx4 v21, s[4:7], s75 offen offset:2048 lds
buffer_load_dwordx4 v22, s[4:7], s75 offen offset:3072 lds
s_waitcnt vmcnt(20)
ds_read_b128 v[128:131], v48 offset:4096
ds_read_b128 v[132:135], v49 offset:4096
ds_read_b128 v[136:139], v50 offset:4096
ds_read_b128 v[140:143], v51 offset:4096
s_waitcnt lgkmcnt(7)
v_dot2c_f32_bf16 v32, s83, v112
v_dot2c_f32_bf16 v36, v112, v112
v_dot2c_f32_bf16 v33, s83, v113
v_dot2c_f32_bf16 v37, v113, v113
v_dot2c_f32_bf16 v34, s83, v114
v_dot2c_f32_bf16 v38, v114, v114
v_dot2c_f32_bf16 v35, s83, v115
v_dot2c_f32_bf16 v39, v115, v115
s_waitcnt lgkmcnt(6)
v_dot2c_f32_bf16 v32, s83, v116
v_dot2c_f32_bf16 v36, v116, v116
v_dot2c_f32_bf16 v33, s83, v117
v_dot2c_f32_bf16 v37, v117, v117
v_dot2c_f32_bf16 v34, s83, v118
v_dot2c_f32_bf16 v38, v118, v118
v_dot2c_f32_bf16 v35, s83, v119
v_dot2c_f32_bf16 v39, v119, v119
s_waitcnt lgkmcnt(5)
v_dot2c_f32_bf16 v32, s83, v120
v_dot2c_f32_bf16 v36, v120, v120
v_dot2c_f32_bf16 v33, s83, v121
v_dot2c_f32_bf16 v37, v121, v121
v_dot2c_f32_bf16 v34, s83, v122
v_dot2c_f32_bf16 v38, v122, v122
v_dot2c_f32_bf16 v35, s83, v123
v_dot2c_f32_bf16 v39, v123, v123
s_waitcnt lgkmcnt(4)
v_dot2c_f32_bf16 v32, s83, v124
v_dot2c_f32_bf16 v36, v124, v124
v_dot2c_f32_bf16 v33, s83, v125
v_dot2c_f32_bf16 v37, v125, v125
v_dot2c_f32_bf16 v34, s83, v126
v_dot2c_f32_bf16 v38, v126, v126
v_dot2c_f32_bf16 v35, s83, v127
v_dot2c_f32_bf16 v39, v127, v127
s_add_u32 m0, s66, 40960
s_add_u32 s75, s82, 768
buffer_load_dwordx4 v19, s[4:7], s75 offen offset:0 lds
buffer_load_dwordx4 v20, s[4:7], s75 offen offset:1024 lds
buffer_load_dwordx4 v21, s[4:7], s75 offen offset:2048 lds
buffer_load_dwordx4 v22, s[4:7], s75 offen offset:3072 lds
s_waitcnt vmcnt(20)
ds_read_b128 v[144:147], v48 offset:8192
ds_read_b128 v[148:151], v49 offset:8192
ds_read_b128 v[152:155], v50 offset:8192
ds_read_b128 v[156:159], v51 offset:8192
s_waitcnt lgkmcnt(4)
v_dot2c_f32_bf16 v32, s83, v128
v_dot2c_f32_bf16 v36, v128, v128
v_dot2c_f32_bf16 v33, s83, v129
v_dot2c_f32_bf16 v37, v129, v129
v_dot2c_f32_bf16 v34, s83, v130
v_dot2c_f32_bf16 v38, v130, v130
v_dot2c_f32_bf16 v35, s83, v131
v_dot2c_f32_bf16 v39, v131, v131
v_dot2c_f32_bf16 v32, s83, v132
v_dot2c_f32_bf16 v36, v132, v132
v_dot2c_f32_bf16 v33, s83, v133
v_dot2c_f32_bf16 v37, v133, v133
v_dot2c_f32_bf16 v34, s83, v134
v_dot2c_f32_bf16 v38, v134, v134
v_dot2c_f32_bf16 v35, s83, v135
v_dot2c_f32_bf16 v39, v135, v135
v_dot2c_f32_bf16 v32, s83, v136
v_dot2c_f32_bf16 v36, v136, v136
v_dot2c_f32_bf16 v33, s83, v137
v_dot2c_f32_bf16 v37, v137, v137
v_dot2c_f32_bf16 v34, s83, v138
v_dot2c_f32_bf16 v38, v138, v138
v_dot2c_f32_bf16 v35, s83, v139
v_dot2c_f32_bf16 v39, v139, v139
v_dot2c_f32_bf16 v32, s83, v140
v_dot2c_f32_bf16 v36, v140, v140
v_dot2c_f32_bf16 v33, s83, v141
v_dot2c_f32_bf16 v37, v141, v141
v_dot2c_f32_bf16 v34, s83, v142
v_dot2c_f32_bf16 v38, v142, v142
v_dot2c_f32_bf16 v35, s83, v143
v_dot2c_f32_bf16 v39, v143, v143
s_add_u32 m0, s66, 73728
s_add_u32 s75, s82, 896
buffer_load_dwordx4 v19, s[4:7], s75 offen offset:0 lds
buffer_load_dwordx4 v20, s[4:7], s75 offen offset:1024 lds
buffer_load_dwordx4 v21, s[4:7], s75 offen offset:2048 lds
buffer_load_dwordx4 v22, s[4:7], s75 offen offset:3072 lds
s_waitcnt vmcnt(20)
ds_read_b128 v[160:163], v52 offset:0
ds_read_b128 v[164:167], v53 offset:0
ds_read_b128 v[168:171], v54 offset:0
ds_read_b128 v[172:175], v55 offset:0
s_waitcnt lgkmcnt(4)
v_dot2c_f32_bf16 v32, s83, v144
v_dot2c_f32_bf16 v36, v144, v144
v_dot2c_f32_bf16 v33, s83, v145
v_dot2c_f32_bf16 v37, v145, v145
v_dot2c_f32_bf16 v34, s83, v146
v_dot2c_f32_bf16 v38, v146, v146
v_dot2c_f32_bf16 v35, s83, v147
v_dot2c_f32_bf16 v39, v147, v147
v_dot2c_f32_bf16 v32, s83, v148
v_dot2c_f32_bf16 v36, v148, v148
v_dot2c_f32_bf16 v33, s83, v149
v_dot2c_f32_bf16 v37, v149, v149
v_dot2c_f32_bf16 v34, s83, v150
v_dot2c_f32_bf16 v38, v150, v150
v_dot2c_f32_bf16 v35, s83, v151
v_dot2c_f32_bf16 v39, v151, v151
v_dot2c_f32_bf16 v32, s83, v152
v_dot2c_f32_bf16 v36, v152, v152
v_dot2c_f32_bf16 v33, s83, v153
v_dot2c_f32_bf16 v37, v153, v153
v_dot2c_f32_bf16 v34, s83, v154
v_dot2c_f32_bf16 v38, v154, v154
v_dot2c_f32_bf16 v35, s83, v155
v_dot2c_f32_bf16 v39, v155, v155
v_dot2c_f32_bf16 v32, s83, v156
v_dot2c_f32_bf16 v36, v156, v156
v_dot2c_f32_bf16 v33, s83, v157
v_dot2c_f32_bf16 v37, v157, v157
v_dot2c_f32_bf16 v34, s83, v158
v_dot2c_f32_bf16 v38, v158, v158
v_dot2c_f32_bf16 v35, s83, v159
v_dot2c_f32_bf16 v39, v159, v159
s_add_u32 m0, s66, 77824
s_add_u32 s75, s82, 1024
buffer_load_dwordx4 v19, s[4:7], s75 offen offset:0 lds
buffer_load_dwordx4 v20, s[4:7], s75 offen offset:1024 lds
buffer_load_dwordx4 v21, s[4:7], s75 offen offset:2048 lds
buffer_load_dwordx4 v22, s[4:7], s75 offen offset:3072 lds
s_waitcnt vmcnt(16)
ds_read_b128 v[176:179], v52 offset:4096
ds_read_b128 v[180:183], v53 offset:4096
ds_read_b128 v[184:187], v54 offset:4096
ds_read_b128 v[188:191], v55 offset:4096
s_waitcnt lgkmcnt(4)
v_dot2c_f32_bf16 v32, s83, v160
v_dot2c_f32_bf16 v36, v160, v160
v_dot2c_f32_bf16 v33, s83, v161
v_dot2c_f32_bf16 v37, v161, v161
v_dot2c_f32_bf16 v34, s83, v162
v_dot2c_f32_bf16 v38, v162, v162
v_dot2c_f32_bf16 v35, s83, v163
v_dot2c_f32_bf16 v39, v163, v163
v_dot2c_f32_bf16 v32, s83, v164
v_dot2c_f32_bf16 v36, v164, v164
v_dot2c_f32_bf16 v33, s83, v165
v_dot2c_f32_bf16 v37, v165, v165
v_dot2c_f32_bf16 v34, s83, v166
v_dot2c_f32_bf16 v38, v166, v166
v_dot2c_f32_bf16 v35, s83, v167
v_dot2c_f32_bf16 v39, v167, v167
v_dot2c_f32_bf16 v32, s83, v168
v_dot2c_f32_bf16 v36, v168, v168
v_dot2c_f32_bf16 v33, s83, v169
v_dot2c_f32_bf16 v37, v169, v169
v_dot2c_f32_bf16 v34, s83, v170
v_dot2c_f32_bf16 v38, v170, v170
v_dot2c_f32_bf16 v35, s83, v171
v_dot2c_f32_bf16 v39, v171, v171
v_dot2c_f32_bf16 v32, s83, v172
v_dot2c_f32_bf16 v36, v172, v172
v_dot2c_f32_bf16 v33, s83, v173
v_dot2c_f32_bf16 v37, v173, v173
v_dot2c_f32_bf16 v34, s83, v174
v_dot2c_f32_bf16 v38, v174, v174
v_dot2c_f32_bf16 v35, s83, v175
v_dot2c_f32_bf16 v39, v175, v175
s_waitcnt vmcnt(12)
ds_read_b128 v[192:195], v52 offset:36864
ds_read_b128 v[196:199], v53 offset:36864
ds_read_b128 v[200:203], v54 offset:36864
ds_read_b128 v[204:207], v55 offset:36864
s_waitcnt lgkmcnt(4)
s_barrier
s_add_u32 m0, s69, 110592
s_add_u32 s75, s59, 0
buffer_load_dwordx4 v108, s[24:27], s75 offen offset:0 lds
buffer_load_dwordx4 v109, s[24:27], s75 offen offset:1024 lds
buffer_load_dwordx4 v110, s[24:27], s75 offen offset:2048 lds
s_add_u32 m0, s70, 122880
s_add_u32 s75, s58, 0
buffer_load_dwordx4 v11, s[24:27], s75 offen offset:0 lds
buffer_load_dwordx4 v12, s[24:27], s75 offen offset:1024 lds
buffer_load_dwordx4 v13, s[24:27], s75 offen offset:2048 lds
v_dot2c_f32_bf16 v32, s83, v176
v_dot2c_f32_bf16 v36, v176, v176
v_dot2c_f32_bf16 v33, s83, v177
v_dot2c_f32_bf16 v37, v177, v177
v_dot2c_f32_bf16 v34, s83, v178
v_dot2c_f32_bf16 v38, v178, v178
v_dot2c_f32_bf16 v35, s83, v179
v_dot2c_f32_bf16 v39, v179, v179
v_dot2c_f32_bf16 v32, s83, v180
v_dot2c_f32_bf16 v36, v180, v180
v_dot2c_f32_bf16 v33, s83, v181
v_dot2c_f32_bf16 v37, v181, v181
v_dot2c_f32_bf16 v34, s83, v182
v_dot2c_f32_bf16 v38, v182, v182
v_dot2c_f32_bf16 v35, s83, v183
v_dot2c_f32_bf16 v39, v183, v183
v_dot2c_f32_bf16 v32, s83, v184
v_dot2c_f32_bf16 v36, v184, v184
v_dot2c_f32_bf16 v33, s83, v185
v_dot2c_f32_bf16 v37, v185, v185
v_dot2c_f32_bf16 v34, s83, v186
v_dot2c_f32_bf16 v38, v186, v186
v_dot2c_f32_bf16 v35, s83, v187
v_dot2c_f32_bf16 v39, v187, v187
v_dot2c_f32_bf16 v32, s83, v188
v_dot2c_f32_bf16 v36, v188, v188
v_dot2c_f32_bf16 v33, s83, v189
v_dot2c_f32_bf16 v37, v189, v189
v_dot2c_f32_bf16 v34, s83, v190
v_dot2c_f32_bf16 v38, v190, v190
v_dot2c_f32_bf16 v35, s83, v191
v_dot2c_f32_bf16 v39, v191, v191
s_waitcnt vmcnt(14)
ds_read_b128 v[208:211], v52 offset:40960
ds_read_b128 v[212:215], v53 offset:40960
ds_read_b128 v[216:219], v54 offset:40960
ds_read_b128 v[220:223], v55 offset:40960
s_add_u32 m0, s70, 125952
s_add_u32 s75, s58, 27648
buffer_load_dwordx4 v11, s[24:27], s75 offen offset:0 lds
buffer_load_dwordx4 v12, s[24:27], s75 offen offset:1024 lds
buffer_load_dwordx4 v13, s[24:27], s75 offen offset:2048 lds
s_waitcnt lgkmcnt(4)
v_dot2c_f32_bf16 v32, s83, v192
v_dot2c_f32_bf16 v36, v192, v192
v_dot2c_f32_bf16 v33, s83, v193
v_dot2c_f32_bf16 v37, v193, v193
v_dot2c_f32_bf16 v34, s83, v194
v_dot2c_f32_bf16 v38, v194, v194
v_dot2c_f32_bf16 v35, s83, v195
v_dot2c_f32_bf16 v39, v195, v195
v_dot2c_f32_bf16 v32, s83, v196
v_dot2c_f32_bf16 v36, v196, v196
v_dot2c_f32_bf16 v33, s83, v197
v_dot2c_f32_bf16 v37, v197, v197
v_dot2c_f32_bf16 v34, s83, v198
v_dot2c_f32_bf16 v38, v198, v198
v_dot2c_f32_bf16 v35, s83, v199
v_dot2c_f32_bf16 v39, v199, v199
v_dot2c_f32_bf16 v32, s83, v200
v_dot2c_f32_bf16 v36, v200, v200
v_dot2c_f32_bf16 v33, s83, v201
v_dot2c_f32_bf16 v37, v201, v201
v_dot2c_f32_bf16 v34, s83, v202
v_dot2c_f32_bf16 v38, v202, v202
v_dot2c_f32_bf16 v35, s83, v203
v_dot2c_f32_bf16 v39, v203, v203
v_dot2c_f32_bf16 v32, s83, v204
v_dot2c_f32_bf16 v36, v204, v204
v_dot2c_f32_bf16 v33, s83, v205
v_dot2c_f32_bf16 v37, v205, v205
v_dot2c_f32_bf16 v34, s83, v206
v_dot2c_f32_bf16 v38, v206, v206
v_dot2c_f32_bf16 v35, s83, v207
v_dot2c_f32_bf16 v39, v207, v207
s_waitcnt vmcnt(13)
ds_read_b128 v[224:227], v56 offset:0
ds_read_b128 v[228:231], v57 offset:0
ds_read_b128 v[232:235], v58 offset:0
ds_read_b128 v[236:239], v59 offset:0
s_add_u32 m0, s69, 0
s_add_u32 s75, s59, 221184
buffer_load_dwordx4 v108, s[24:27], s75 offen offset:0 lds
buffer_load_dwordx4 v109, s[24:27], s75 offen offset:1024 lds
buffer_load_dwordx4 v110, s[24:27], s75 offen offset:2048 lds
s_waitcnt lgkmcnt(4)
v_dot2c_f32_bf16 v32, s83, v208
v_dot2c_f32_bf16 v36, v208, v208
v_dot2c_f32_bf16 v33, s83, v209
v_dot2c_f32_bf16 v37, v209, v209
v_dot2c_f32_bf16 v34, s83, v210
v_dot2c_f32_bf16 v38, v210, v210
v_dot2c_f32_bf16 v35, s83, v211
v_dot2c_f32_bf16 v39, v211, v211
v_dot2c_f32_bf16 v32, s83, v212
v_dot2c_f32_bf16 v36, v212, v212
v_dot2c_f32_bf16 v33, s83, v213
v_dot2c_f32_bf16 v37, v213, v213
v_dot2c_f32_bf16 v34, s83, v214
v_dot2c_f32_bf16 v38, v214, v214
v_dot2c_f32_bf16 v35, s83, v215
v_dot2c_f32_bf16 v39, v215, v215
v_dot2c_f32_bf16 v32, s83, v216
v_dot2c_f32_bf16 v36, v216, v216
v_dot2c_f32_bf16 v33, s83, v217
v_dot2c_f32_bf16 v37, v217, v217
v_dot2c_f32_bf16 v34, s83, v218
v_dot2c_f32_bf16 v38, v218, v218
v_dot2c_f32_bf16 v35, s83, v219
v_dot2c_f32_bf16 v39, v219, v219
v_dot2c_f32_bf16 v32, s83, v220
v_dot2c_f32_bf16 v36, v220, v220
v_dot2c_f32_bf16 v33, s83, v221
v_dot2c_f32_bf16 v37, v221, v221
v_dot2c_f32_bf16 v34, s83, v222
v_dot2c_f32_bf16 v38, v222, v222
v_dot2c_f32_bf16 v35, s83, v223
v_dot2c_f32_bf16 v39, v223, v223
s_waitcnt vmcnt(12)
ds_read_b128 v[240:243], v56 offset:4096
ds_read_b128 v[244:247], v57 offset:4096
ds_read_b128 v[248:251], v58 offset:4096
ds_read_b128 v[252:255], v59 offset:4096
s_add_u32 m0, s70, 12288
s_add_u32 s75, s58, 221184
buffer_load_dwordx4 v11, s[24:27], s75 offen offset:0 lds
buffer_load_dwordx4 v12, s[24:27], s75 offen offset:1024 lds
buffer_load_dwordx4 v13, s[24:27], s75 offen offset:2048 lds
s_waitcnt lgkmcnt(4)
v_dot2c_f32_bf16 v32, s83, v224
v_dot2c_f32_bf16 v36, v224, v224
v_dot2c_f32_bf16 v33, s83, v225
v_dot2c_f32_bf16 v37, v225, v225
v_dot2c_f32_bf16 v34, s83, v226
v_dot2c_f32_bf16 v38, v226, v226
v_dot2c_f32_bf16 v35, s83, v227
v_dot2c_f32_bf16 v39, v227, v227
v_dot2c_f32_bf16 v32, s83, v228
v_dot2c_f32_bf16 v36, v228, v228
v_dot2c_f32_bf16 v33, s83, v229
v_dot2c_f32_bf16 v37, v229, v229
v_dot2c_f32_bf16 v34, s83, v230
v_dot2c_f32_bf16 v38, v230, v230
v_dot2c_f32_bf16 v35, s83, v231
v_dot2c_f32_bf16 v39, v231, v231
v_dot2c_f32_bf16 v32, s83, v232
v_dot2c_f32_bf16 v36, v232, v232
v_dot2c_f32_bf16 v33, s83, v233
v_dot2c_f32_bf16 v37, v233, v233
v_dot2c_f32_bf16 v34, s83, v234
v_dot2c_f32_bf16 v38, v234, v234
v_dot2c_f32_bf16 v35, s83, v235
v_dot2c_f32_bf16 v39, v235, v235
v_dot2c_f32_bf16 v32, s83, v236
v_dot2c_f32_bf16 v36, v236, v236
v_dot2c_f32_bf16 v33, s83, v237
v_dot2c_f32_bf16 v37, v237, v237
v_dot2c_f32_bf16 v34, s83, v238
v_dot2c_f32_bf16 v38, v238, v238
v_dot2c_f32_bf16 v35, s83, v239
v_dot2c_f32_bf16 v39, v239, v239
s_add_u32 m0, s70, 15360
s_add_u32 s75, s58, 248832
buffer_load_dwordx4 v11, s[24:27], s75 offen offset:0 lds
buffer_load_dwordx4 v12, s[24:27], s75 offen offset:1024 lds
buffer_load_dwordx4 v13, s[24:27], s75 offen offset:2048 lds
s_waitcnt lgkmcnt(0)
v_dot2c_f32_bf16 v32, s83, v240
v_dot2c_f32_bf16 v36, v240, v240
v_dot2c_f32_bf16 v33, s83, v241
v_dot2c_f32_bf16 v37, v241, v241
v_dot2c_f32_bf16 v34, s83, v242
v_dot2c_f32_bf16 v38, v242, v242
v_dot2c_f32_bf16 v35, s83, v243
v_dot2c_f32_bf16 v39, v243, v243
v_dot2c_f32_bf16 v32, s83, v244
v_dot2c_f32_bf16 v36, v244, v244
v_dot2c_f32_bf16 v33, s83, v245
v_dot2c_f32_bf16 v37, v245, v245
v_dot2c_f32_bf16 v34, s83, v246
v_dot2c_f32_bf16 v38, v246, v246
v_dot2c_f32_bf16 v35, s83, v247
v_dot2c_f32_bf16 v39, v247, v247
v_dot2c_f32_bf16 v32, s83, v248
v_dot2c_f32_bf16 v36, v248, v248
v_dot2c_f32_bf16 v33, s83, v249
v_dot2c_f32_bf16 v37, v249, v249
v_dot2c_f32_bf16 v34, s83, v250
v_dot2c_f32_bf16 v38, v250, v250
v_dot2c_f32_bf16 v35, s83, v251
v_dot2c_f32_bf16 v39, v251, v251
v_dot2c_f32_bf16 v32, s83, v252
v_dot2c_f32_bf16 v36, v252, v252
v_dot2c_f32_bf16 v33, s83, v253
v_dot2c_f32_bf16 v37, v253, v253
v_dot2c_f32_bf16 v34, s83, v254
v_dot2c_f32_bf16 v38, v254, v254
v_dot2c_f32_bf16 v35, s83, v255
v_dot2c_f32_bf16 v39, v255, v255
v_add_f32 v32, v32, v33
s_nop 0
v_add_f32 v34, v34, v35
v_add_f32 v36, v36, v37
v_add_f32 v38, v38, v39
v_add_f32 v32, v32, v34
v_add_f32 v36, v36, v38
v_mov_b32 v33, v32
v_mov_b32 v37, v36
s_nop 0
v_permlane32_swap_b32 v32, v33
v_permlane32_swap_b32 v36, v37
v_add_f32 v32, v32, v33
v_add_f32 v36, v36, v37
v_mul_f32 v24, 0xbae38e39, v32
v_mul_f32 v36, 0x3ae38e39, v36
v_fma_f32 v36, -v24, v24, v36
v_max_f32 v27, 0, v36
v_add_f32 v37, 0x3727c5ac, v27
v_rsq_f32 v25, v37
s_nop 0
v_mul_f32 v26, 0x3e0293ee, v25
v_mul_f32 v29, v24, v26
v_cvt_pk_bf16_f32 v28, v26, 0
v_lshlrev_b32 v26, 16, v28
v_mul_f32 v29, v24, v26
v_dot2_f32_bf16 v96, v112, v28, v29
v_dot2_f32_bf16 v97, v112, v26, v29
v_dot2_f32_bf16 v98, v113, v28, v29
v_dot2_f32_bf16 v99, v113, v26, v29
v_dot2_f32_bf16 v100, v114, v28, v29
v_dot2_f32_bf16 v101, v114, v26, v29
v_dot2_f32_bf16 v102, v115, v28, v29
v_dot2_f32_bf16 v103, v115, v26, v29
CV 112,96,97
CV 113,98,99
CV 114,100,101
CV 115,102,103
v_dot2_f32_bf16 v96, v116, v28, v29
v_dot2_f32_bf16 v97, v116, v26, v29
v_dot2_f32_bf16 v98, v117, v28, v29
v_dot2_f32_bf16 v99, v117, v26, v29
v_dot2_f32_bf16 v100, v118, v28, v29
v_dot2_f32_bf16 v101, v118, v26, v29
v_dot2_f32_bf16 v102, v119, v28, v29
v_dot2_f32_bf16 v103, v119, v26, v29
s_waitcnt vmcnt(9)
s_barrier
R 32,3,57344
R 34,3,57856
R 36,6,57344
R 38,6,57856
R 40,9,45056
R 42,9,45312
R 44,3,59392
R 46,3,59904
R 48,6,59392
R 50,6,59904
R 52,9,46080
R 54,9,46336
R 56,3,61440
R 58,3,61952
s_waitcnt lgkmcnt(12)
v_mfma_f32_32x32x16_bf16 v[64:79], v[32:35], v[112:115], 0
R 60,6,61440
R 62,6,61952
CV 116,96,97
CV 117,98,99
s_add_u32 m0, s69, 36864
s_add_u32 s75, s59, 442368
s_waitcnt lgkmcnt(12)
v_mfma_f32_32x32x16_bf16 v[80:95], v[36:39], v[112:115], 0
R 32,9,47104
R 34,9,47360
buffer_load_dwordx4 v108, s[24:27], s75 offen offset:0 lds
CV 118,100,101
CV 119,102,103
s_waitcnt lgkmcnt(7)
v_mfma_f32_32x32x16_bf16 a[144:159], v[40:43], v[112:115], 0
R 36,3,63488
R 38,3,64000
v_dot2_f32_bf16 v96, v120, v28, v29
v_dot2_f32_bf16 v97, v120, v26, v29
v_dot2_f32_bf16 v98, v121, v28, v29
v_dot2_f32_bf16 v99, v121, v26, v29
v_dot2_f32_bf16 v100, v122, v28, v29
v_dot2_f32_bf16 v101, v122, v26, v29
v_dot2_f32_bf16 v102, v123, v28, v29
v_dot2_f32_bf16 v103, v123, v26, v29
MV 64,44,116
R 40,6,63488
R 42,6,64000
CV 120,96,97
CV 121,98,99
CV 122,100,101
MV 80,48,116
R 44,9,48128
R 46,9,48384
buffer_load_dwordx4 v109, s[24:27], s75 offen offset:1024 lds
CV 123,102,103
s_waitcnt lgkmcnt(5)
MA 144,52,116
R 48,4,0
R 50,4,512
buffer_load_dwordx4 v110, s[24:27], s75 offen offset:2048 lds
v_dot2_f32_bf16 v96, v124, v28, v29
v_dot2_f32_bf16 v97, v124, v26, v29
v_dot2_f32_bf16 v98, v125, v28, v29
v_dot2_f32_bf16 v99, v125, v26, v29
v_dot2_f32_bf16 v100, v126, v28, v29
v_dot2_f32_bf16 v101, v126, v26, v29
v_dot2_f32_bf16 v102, v127, v28, v29
v_dot2_f32_bf16 v103, v127, v26, v29
MV 64,56,120
R 52,7,0
R 54,7,512
CV 124,96,97
CV 125,98,99
s_add_u32 m0, s70, 49152
s_add_u32 s75, s58, 442368
MV 80,60,120
R 56,9,49152
R 58,9,49408
buffer_load_dwordx4 v11, s[24:27], s75 offen offset:0 lds
CV 126,100,101
CV 127,102,103
MA 144,32,120
R 60,4,2048
R 62,4,2560
v_dot2_f32_bf16 v96, v128, v28, v29
v_dot2_f32_bf16 v97, v128, v26, v29
v_dot2_f32_bf16 v98, v129, v28, v29
v_dot2_f32_bf16 v99, v129, v26, v29
v_dot2_f32_bf16 v100, v130, v28, v29
v_dot2_f32_bf16 v101, v130, v26, v29
v_dot2_f32_bf16 v102, v131, v28, v29
v_dot2_f32_bf16 v103, v131, v26, v29
s_waitcnt lgkmcnt(4)
MV 64,36,124
R 32,7,2048
R 34,7,2560
CV 128,96,97
CV 129,98,99
CV 130,100,101
MV 80,40,124
R 36,9,50176
R 38,9,50432
buffer_load_dwordx4 v12, s[24:27], s75 offen offset:1024 lds
CV 131,102,103
MA 144,44,124
R 40,4,4096
R 42,4,4608
buffer_load_dwordx4 v13, s[24:27], s75 offen offset:2048 lds
v_dot2_f32_bf16 v96, v132, v28, v29
v_dot2_f32_bf16 v97, v132, v26, v29
v_dot2_f32_bf16 v98, v133, v28, v29
v_dot2_f32_bf16 v99, v133, v26, v29
v_dot2_f32_bf16 v100, v134, v28, v29
v_dot2_f32_bf16 v101, v134, v26, v29
v_dot2_f32_bf16 v102, v135, v28, v29
v_dot2_f32_bf16 v103, v135, v26, v29
MV 64,48,128
R 44,7,4096
R 46,7,4608
CV 132,96,97
CV 133,98,99
s_add_u32 m0, s70, 52224
s_add_u32 s75, s58, 470016
MV 80,52,128
R 48,9,51200
R 50,9,51456
buffer_load_dwordx4 v11, s[24:27], s75 offen offset:0 lds
CV 134,100,101
CV 135,102,103
s_waitcnt lgkmcnt(4)
MA 144,56,128
R 52,4,6144
R 54,4,6656
v_dot2_f32_bf16 v96, v136, v28, v29
v_dot2_f32_bf16 v97, v136, v26, v29
v_dot2_f32_bf16 v98, v137, v28, v29
v_dot2_f32_bf16 v99, v137, v26, v29
v_dot2_f32_bf16 v100, v138, v28, v29
v_dot2_f32_bf16 v101, v138, v26, v29
v_dot2_f32_bf16 v102, v139, v28, v29
v_dot2_f32_bf16 v103, v139, v26, v29
MV 64,60,132
R 56,7,6144
R 58,7,6656
CV 136,96,97
CV 137,98,99
CV 138,100,101
MV 80,32,132
R 60,9,52224
R 62,9,52480
buffer_load_dwordx4 v12, s[24:27], s75 offen offset:1024 lds
CV 139,102,103
MA 144,36,132
R 32,4,8192
R 34,4,8704
buffer_load_dwordx4 v13, s[24:27], s75 offen offset:2048 lds
v_dot2_f32_bf16 v96, v140, v28, v29
v_dot2_f32_bf16 v97, v140, v26, v29
v_dot2_f32_bf16 v98, v141, v28, v29
v_dot2_f32_bf16 v99, v141, v26, v29
v_dot2_f32_bf16 v100, v142, v28, v29
v_dot2_f32_bf16 v101, v142, v26, v29
v_dot2_f32_bf16 v102, v143, v28, v29
v_dot2_f32_bf16 v103, v143, v26, v29
MV 64,40,136
R 36,7,8192
R 38,7,8704
CV 140,96,97
CV 141,98,99
CV 142,100,101
s_waitcnt lgkmcnt(4)
MV 80,44,136
R 40,9,53248
R 42,9,53504
CV 143,102,103
s_add_u32 m0, s69, 73728
s_add_u32 s75, s60, 0
LM_pad1:
s_cbranch_execz LM_pad5
MA 144,48,136
R 44,4,10240
R 46,4,10752
buffer_load_dwordx4 v15, s[16:19], s75 offen offset:0 lds
v_dot2_f32_bf16 v96, v144, v28, v29
v_dot2_f32_bf16 v97, v144, v26, v29
v_dot2_f32_bf16 v98, v145, v28, v29
v_dot2_f32_bf16 v99, v145, v26, v29
v_dot2_f32_bf16 v100, v146, v28, v29
v_dot2_f32_bf16 v101, v146, v26, v29
v_dot2_f32_bf16 v102, v147, v28, v29
v_dot2_f32_bf16 v103, v147, v26, v29
MV 64,52,140
R 48,7,10240
R 50,7,10752
CV 144,96,97
CV 145,98,99
MV 80,56,140
R 52,9,54272
R 54,9,54528
CV 146,100,101
CV 147,102,103
MA 144,60,140
R 56,4,12288
R 58,4,12800
v_dot2_f32_bf16 v96, v148, v28, v29
v_dot2_f32_bf16 v97, v148, v26, v29
v_dot2_f32_bf16 v98, v149, v28, v29
v_dot2_f32_bf16 v99, v149, v26, v29
v_dot2_f32_bf16 v100, v150, v28, v29
v_dot2_f32_bf16 v101, v150, v26, v29
v_dot2_f32_bf16 v102, v151, v28, v29
v_dot2_f32_bf16 v103, v151, v26, v29
s_waitcnt lgkmcnt(6)
MV 64,32,144
R 60,7,12288
R 62,7,12800
buffer_load_dwordx4 v16, s[16:19], s75 offen offset:1024 lds
CV 148,96,97
CV 149,98,99
CV 150,100,101
MV 80,36,144
R 32,9,55296
R 34,9,55552
buffer_load_dwordx4 v17, s[16:19], s75 offen offset:2048 lds
CV 151,102,103
s_add_u32 m0, s69, 86016
s_add_u32 s75, s60, 128
MA 144,40,144
s_waitcnt vmcnt(12)
s_barrier
R 36,4,14336
R 38,4,14848
buffer_load_dwordx4 v15, s[16:19], s75 offen offset:0 lds
v_dot2_f32_bf16 v96, v152, v28, v29
v_dot2_f32_bf16 v97, v152, v26, v29
v_dot2_f32_bf16 v98, v153, v28, v29
v_dot2_f32_bf16 v99, v153, v26, v29
v_dot2_f32_bf16 v100, v154, v28, v29
v_dot2_f32_bf16 v101, v154, v26, v29
v_dot2_f32_bf16 v102, v155, v28, v29
v_dot2_f32_bf16 v103, v155, v26, v29
MV 64,44,148
R 40,7,14336
R 42,7,14848
CV 152,96,97
CV 153,98,99
s_waitcnt lgkmcnt(4)
MV 80,48,148
R 44,9,56320
R 46,9,56576
CV 154,100,101
CV 155,102,103
MA 144,52,148
R 48,2,12288
R 50,2,12800
v_dot2_f32_bf16 v96, v156, v28, v29
v_dot2_f32_bf16 v97, v156, v26, v29
v_dot2_f32_bf16 v98, v157, v28, v29
v_dot2_f32_bf16 v99, v157, v26, v29
v_dot2_f32_bf16 v100, v158, v28, v29
v_dot2_f32_bf16 v101, v158, v26, v29
v_dot2_f32_bf16 v102, v159, v28, v29
v_dot2_f32_bf16 v103, v159, v26, v29
s_lshl_b32 s71, s54, 2
MV 64,56,152
R 52,5,12288
R 54,5,12800
buffer_store_dword v3, v31, s[44:47], s71 offen sc1
MV 80,60,152
R 56,8,0
R 58,8,256
buffer_load_dwordx4 v16, s[16:19], s75 offen offset:1024 lds
CV 156,96,97
CV 157,98,99
CV 158,100,101
CV 159,102,103
MA 144,32,152
R 60,2,14336
R 62,2,14848
buffer_load_dwordx4 v17, s[16:19], s75 offen offset:2048 lds
v_dot2_f32_bf16 v96, v160, v28, v29
v_dot2_f32_bf16 v97, v160, v26, v29
v_dot2_f32_bf16 v98, v161, v28, v29
v_dot2_f32_bf16 v99, v161, v26, v29
v_dot2_f32_bf16 v100, v162, v28, v29
v_dot2_f32_bf16 v101, v162, v26, v29
v_dot2_f32_bf16 v102, v163, v28, v29
v_dot2_f32_bf16 v103, v163, v26, v29
s_add_u32 m0, s69, 98304
s_add_u32 s75, s60, 256
s_waitcnt lgkmcnt(4)
MV 64,36,156
R 32,5,14336
R 34,5,14848
buffer_load_dwordx4 v15, s[16:19], s75 offen offset:0 lds
CV 160,96,97
CV 161,98,99
MV 80,40,156
R 36,8,1024
R 38,8,1280
CV 162,100,101
CV 163,102,103
MA 144,44,156
R 40,2,16384
R 42,2,16896
v_dot2_f32_bf16 v96, v164, v28, v29
v_dot2_f32_bf16 v97, v164, v26, v29
v_dot2_f32_bf16 v98, v165, v28, v29
v_dot2_f32_bf16 v99, v165, v26, v29
v_dot2_f32_bf16 v100, v166, v28, v29
v_dot2_f32_bf16 v101, v166, v26, v29
v_dot2_f32_bf16 v102, v167, v28, v29
v_dot2_f32_bf16 v103, v167, v26, v29
MV 64,48,160
R 44,5,16384
R 46,5,16896
CV 164,96,97
CV 165,98,99
CV 166,100,101
MV 80,52,160
R 48,8,2048
R 50,8,2304
buffer_load_dwordx4 v16, s[16:19], s75 offen offset:1024 lds
CV 167,102,103
s_waitcnt lgkmcnt(5)
MA 144,56,160
R 52,2,18432
R 54,2,18944
v_dot2_f32_bf16 v96, v168, v28, v29
v_dot2_f32_bf16 v97, v168, v26, v29
v_dot2_f32_bf16 v98, v169, v28, v29
v_dot2_f32_bf16 v99, v169, v26, v29
v_dot2_f32_bf16 v100, v170, v28, v29
v_dot2_f32_bf16 v101, v170, v26, v29
v_dot2_f32_bf16 v102, v171, v28, v29
v_dot2_f32_bf16 v103, v171, v26, v29
MV 64,60,164
R 56,5,18432
R 58,5,18944
buffer_load_dwordx4 v17, s[16:19], s75 offen offset:2048 lds
CV 168,96,97
CV 169,98,99
s_add_u32 m0, s68, 147456
s_add_u32 s75, s82, s85
MV 80,32,164
R 60,8,3072
R 62,8,3328
buffer_load_dwordx4 v19, s[4:7], s75 offen offset:0 lds
CV 170,100,101
CV 171,102,103
MA 144,36,164
R 32,2,20480
R 34,2,20992
v_dot2_f32_bf16 v96, v172, v28, v29
v_dot2_f32_bf16 v97, v172, v26, v29
v_dot2_f32_bf16 v98, v173, v28, v29
v_dot2_f32_bf16 v99, v173, v26, v29
v_dot2_f32_bf16 v100, v174, v28, v29
v_dot2_f32_bf16 v101, v174, v26, v29
v_dot2_f32_bf16 v102, v175, v28, v29
v_dot2_f32_bf16 v103, v175, v26, v29
s_waitcnt lgkmcnt(4)
MV 64,40,168
R 36,5,20480
R 38,5,20992
CV 172,96,97
CV 173,98,99
MV 80,44,168
R 40,8,4096
R 42,8,4352
CV 174,100,101
CV 175,102,103
MA 144,48,168
R 44,2,22528
R 46,2,23040
buffer_load_dwordx4 v20, s[4:7], s75 offen offset:1024 lds
v_dot2_f32_bf16 v96, v176, v28, v29
v_dot2_f32_bf16 v97, v176, v26, v29
v_dot2_f32_bf16 v98, v177, v28, v29
v_dot2_f32_bf16 v99, v177, v26, v29
v_dot2_f32_bf16 v100, v178, v28, v29
v_dot2_f32_bf16 v101, v178, v26, v29
v_dot2_f32_bf16 v102, v179, v28, v29
v_dot2_f32_bf16 v103, v179, v26, v29
MV 64,52,172
R 48,5,22528
R 50,5,23040
CV 176,96,97
CV 177,98,99
CV 178,100,101
MV 80,56,172
R 52,8,5120
R 54,8,5376
buffer_load_dwordx4 v21, s[4:7], s75 offen offset:2048 lds
CV 179,102,103
s_waitcnt lgkmcnt(4)
MA 144,60,172
R 56,2,24576
R 58,2,25088
buffer_load_dwordx4 v22, s[4:7], s75 offen offset:3072 lds
v_dot2_f32_bf16 v96, v180, v28, v29
v_dot2_f32_bf16 v97, v180, v26, v29
v_dot2_f32_bf16 v98, v181, v28, v29
v_dot2_f32_bf16 v99, v181, v26, v29
v_dot2_f32_bf16 v100, v182, v28, v29
v_dot2_f32_bf16 v101, v182, v26, v29
v_dot2_f32_bf16 v102, v183, v28, v29
v_dot2_f32_bf16 v103, v183, v26, v29
MV 64,32,176
R 60,5,24576
R 62,5,25088
CV 180,96,97
CV 181,98,99
CV 182,100,101
CV 183,102,103
MV 80,36,176
s_waitcnt vmcnt(14)
s_barrier
R 32,8,6144
R 34,8,6400
MA 144,40,176
R 36,2,26624
R 38,2,27136
v_dot2_f32_bf16 v96, v184, v28, v29
v_dot2_f32_bf16 v97, v184, v26, v29
v_dot2_f32_bf16 v98, v185, v28, v29
v_dot2_f32_bf16 v99, v185, v26, v29
v_dot2_f32_bf16 v100, v186, v28, v29
v_dot2_f32_bf16 v101, v186, v26, v29
v_dot2_f32_bf16 v102, v187, v28, v29
v_dot2_f32_bf16 v103, v187, v26, v29
s_add_u32 m0, s69, 110592
s_add_u32 s75, s60, 786432
MV 64,44,180
R 40,5,26624
R 42,5,27136
buffer_load_dwordx4 v15, s[16:19], s75 offen offset:0 lds
CV 184,96,97
CV 185,98,99
s_waitcnt lgkmcnt(5)
MV 80,48,180
R 44,8,7168
R 46,8,7424
CV 186,100,101
CV 187,102,103
MA 144,52,180
R 48,2,28672
R 50,2,29184
v_dot2_f32_bf16 v96, v188, v28, v29
v_dot2_f32_bf16 v97, v188, v26, v29
v_dot2_f32_bf16 v98, v189, v28, v29
v_dot2_f32_bf16 v99, v189, v26, v29
v_dot2_f32_bf16 v100, v190, v28, v29
v_dot2_f32_bf16 v101, v190, v26, v29
v_dot2_f32_bf16 v102, v191, v28, v29
v_dot2_f32_bf16 v103, v191, v26, v29
MV 64,56,184
R 52,5,28672
R 54,5,29184
CV 188,96,97
CV 189,98,99
MV 80,60,184
R 56,8,8192
R 58,8,8448
CV 190,100,101
CV 191,102,103
s_waitcnt lgkmcnt(6)
MA 144,32,184
R 60,2,30720
R 62,2,31232
v_dot2_f32_bf16 v96, v192, v28, v29
v_dot2_f32_bf16 v97, v192, v26, v29
v_dot2_f32_bf16 v98, v193, v28, v29
v_dot2_f32_bf16 v99, v193, v26, v29
v_dot2_f32_bf16 v100, v194, v28, v29
v_dot2_f32_bf16 v101, v194, v26, v29
v_dot2_f32_bf16 v102, v195, v28, v29
v_dot2_f32_bf16 v103, v195, v26, v29
MV 64,36,188
R 32,5,30720
R 34,5,31232
buffer_load_dwordx4 v16, s[16:19], s75 offen offset:1024 lds
CV 192,96,97
CV 193,98,99
MV 80,40,188
R 36,8,9216
R 38,8,9472
CV 194,100,101
CV 195,102,103
MA 144,44,188
R 40,2,32768
R 42,2,33280
v_dot2_f32_bf16 v96, v196, v28, v29
v_dot2_f32_bf16 v97, v196, v26, v29
v_dot2_f32_bf16 v98, v197, v28, v29
v_dot2_f32_bf16 v99, v197, v26, v29
v_dot2_f32_bf16 v100, v198, v28, v29
v_dot2_f32_bf16 v101, v198, v26, v29
v_dot2_f32_bf16 v102, v199, v28, v29
v_dot2_f32_bf16 v103, v199, v26, v29
s_waitcnt lgkmcnt(5)
MV 64,48,192
R 44,5,32768
R 46,5,33280
buffer_load_dwordx4 v17, s[16:19], s75 offen offset:2048 lds
CV 196,96,97
CV 197,98,99
CV 198,100,101
MV 80,52,192
R 48,8,10240
R 50,8,10496
CV 199,102,103
s_add_u32 m0, s69, 122880
s_add_u32 s75, s60, 786560
MA 144,56,192
R 52,2,34816
R 54,2,35328
buffer_load_dwordx4 v15, s[16:19], s75 offen offset:0 lds
v_dot2_f32_bf16 v96, v200, v28, v29
v_dot2_f32_bf16 v97, v200, v26, v29
v_dot2_f32_bf16 v98, v201, v28, v29
v_dot2_f32_bf16 v99, v201, v26, v29
v_dot2_f32_bf16 v100, v202, v28, v29
v_dot2_f32_bf16 v101, v202, v26, v29
v_dot2_f32_bf16 v102, v203, v28, v29
v_dot2_f32_bf16 v103, v203, v26, v29
MV 64,60,196
R 56,5,34816
R 58,5,35328
CV 200,96,97
CV 201,98,99
s_waitcnt lgkmcnt(4)
MV 80,32,196
R 60,8,11264
R 62,8,11520
CV 202,100,101
CV 203,102,103
MA 144,36,196
R 32,2,49152
R 34,2,49664
v_dot2_f32_bf16 v96, v204, v28, v29
v_dot2_f32_bf16 v97, v204, v26, v29
v_dot2_f32_bf16 v98, v205, v28, v29
v_dot2_f32_bf16 v99, v205, v26, v29
v_dot2_f32_bf16 v100, v206, v28, v29
v_dot2_f32_bf16 v101, v206, v26, v29
v_dot2_f32_bf16 v102, v207, v28, v29
v_dot2_f32_bf16 v103, v207, v26, v29
MV 64,40,200
R 36,5,49152
R 38,5,49664
CV 204,96,97
v_min_u32 v111, 2, v1
CV 205,98,99
MV 80,44,200
R 40,8,36864
R 42,8,37120
CV 206,100,101
CV 207,102,103
MA 144,48,200
R 44,2,51200
R 46,2,51712
v_add_u32 v111, s54, v111
v_subrev_u32 v111, 1, v111
v_max_i32 v111, 0, v111
v_dot2_f32_bf16 v96, v208, v28, v29
v_dot2_f32_bf16 v97, v208, v26, v29
v_dot2_f32_bf16 v98, v209, v28, v29
v_dot2_f32_bf16 v99, v209, v26, v29
v_dot2_f32_bf16 v100, v210, v28, v29
v_dot2_f32_bf16 v101, v210, v26, v29
v_dot2_f32_bf16 v102, v211, v28, v29
v_dot2_f32_bf16 v103, v211, v26, v29
s_waitcnt lgkmcnt(4)
MV 64,52,204
R 48,5,51200
R 50,5,51712
buffer_load_dwordx4 v16, s[16:19], s75 offen offset:1024 lds
CV 208,96,97
CV 209,98,99
MV 80,56,204
R 52,8,37888
R 54,8,38144
CV 210,100,101
CV 211,102,103
v_min_i32 v111, 15, v111
MA 144,60,204
R 56,2,53248
R 58,2,53760
buffer_load_dwordx4 v17, s[16:19], s75 offen offset:2048 lds
v_lshlrev_b32 v111, 2, v111
v_dot2_f32_bf16 v96, v212, v28, v29
v_dot2_f32_bf16 v97, v212, v26, v29
v_dot2_f32_bf16 v98, v213, v28, v29
v_dot2_f32_bf16 v99, v213, v26, v29
v_dot2_f32_bf16 v100, v214, v28, v29
v_dot2_f32_bf16 v101, v214, v26, v29
v_dot2_f32_bf16 v102, v215, v28, v29
v_dot2_f32_bf16 v103, v215, v26, v29
MV 64,32,208
R 60,5,53248
R 62,5,53760
CV 212,96,97
CV 213,98,99
s_add_u32 m0, s69, 135168
s_add_u32 s75, s60, 786688
MV 80,36,208
R 32,8,38912
R 34,8,39168
buffer_load_dwordx4 v15, s[16:19], s75 offen offset:0 lds
CV 214,100,101
CV 215,102,103
s_waitcnt lgkmcnt(4)
MA 144,40,208
R 36,2,55296
R 38,2,55808
buffer_load_dword v31, v111, s[44:47], 0 offen sc1
v_dot2_f32_bf16 v96, v216, v28, v29
v_dot2_f32_bf16 v97, v216, v26, v29
v_dot2_f32_bf16 v98, v217, v28, v29
v_dot2_f32_bf16 v99, v217, v26, v29
v_dot2_f32_bf16 v100, v218, v28, v29
v_dot2_f32_bf16 v101, v218, v26, v29
v_dot2_f32_bf16 v102, v219, v28, v29
v_dot2_f32_bf16 v103, v219, v26, v29
MV 64,44,212
R 40,5,55296
R 42,5,55808
CV 216,96,97
CV 217,98,99
MV 80,48,212
R 44,8,39936
R 46,8,40192
CV 218,100,101
CV 219,102,103
MA 144,52,212
R 48,2,57344
R 50,2,57856
v_dot2_f32_bf16 v96, v220, v28, v29
v_dot2_f32_bf16 v97, v220, v26, v29
v_dot2_f32_bf16 v98, v221, v28, v29
v_dot2_f32_bf16 v99, v221, v26, v29
v_dot2_f32_bf16 v100, v222, v28, v29
v_dot2_f32_bf16 v101, v222, v26, v29
v_dot2_f32_bf16 v102, v223, v28, v29
v_dot2_f32_bf16 v103, v223, v26, v29
MV 64,56,216
R 52,5,57344
R 54,5,57856
CV 220,96,97
CV 221,98,99
s_waitcnt lgkmcnt(6)
MV 80,60,216
R 56,8,40960
R 58,8,41216
CV 222,100,101
CV 223,102,103
MA 144,32,216
R 60,2,59392
R 62,2,59904
buffer_load_dwordx4 v16, s[16:19], s75 offen offset:1024 lds
v_dot2_f32_bf16 v96, v224, v28, v29
v_dot2_f32_bf16 v97, v224, v26, v29
v_dot2_f32_bf16 v98, v225, v28, v29
v_dot2_f32_bf16 v99, v225, v26, v29
v_dot2_f32_bf16 v100, v226, v28, v29
v_dot2_f32_bf16 v101, v226, v26, v29
v_dot2_f32_bf16 v102, v227, v28, v29
v_dot2_f32_bf16 v103, v227, v26, v29
MV 64,36,220
R 32,5,59392
R 34,5,59904
CV 224,96,97
CV 225,98,99
CV 226,100,101
MV 80,40,220
R 36,8,41984
R 38,8,42240
buffer_load_dwordx4 v17, s[16:19], s75 offen offset:2048 lds
CV 227,102,103
s_waitcnt lgkmcnt(4)
MA 144,44,220
R 40,2,61440
R 42,2,61952
v_dot2_f32_bf16 v96, v228, v28, v29
v_dot2_f32_bf16 v97, v228, v26, v29
v_dot2_f32_bf16 v98, v229, v28, v29
v_dot2_f32_bf16 v99, v229, v26, v29
v_dot2_f32_bf16 v100, v230, v28, v29
v_dot2_f32_bf16 v101, v230, v26, v29
v_dot2_f32_bf16 v102, v231, v28, v29
v_dot2_f32_bf16 v103, v231, v26, v29
MV 64,48,224
R 44,5,61440
R 46,5,61952
CV 228,96,97
CV 229,98,99
CV 230,100,101
CV 231,102,103
MV 80,52,224
s_waitcnt vmcnt(14)
s_barrier
R 48,8,43008
R 50,8,43264
MA 144,56,224
LM_pad2:
s_cbranch_execz LM_pad6
R 52,2,63488
R 54,2,64000
v_dot2_f32_bf16 v96, v232, v28, v29
v_dot2_f32_bf16 v97, v232, v26, v29
v_dot2_f32_bf16 v98, v233, v28, v29
v_dot2_f32_bf16 v99, v233, v26, v29
v_dot2_f32_bf16 v100, v234, v28, v29
v_dot2_f32_bf16 v101, v234, v26, v29
v_dot2_f32_bf16 v102, v235, v28, v29
v_dot2_f32_bf16 v103, v235, v26, v29
s_add_u32 m0, s69, 0
s_add_u32 s75, s60, 1572864
MV 64,60,228
R 56,5,63488
R 58,5,64000
buffer_load_dwordx4 v15, s[16:19], s75 offen offset:0 lds
CV 232,96,97
CV 233,98,99
s_waitcnt lgkmcnt(5)
MV 80,32,228
R 60,8,44032
R 62,8,44288
CV 234,100,101
CV 235,102,103
MA 144,36,228
R 32,3,0
R 34,3,512
v_dot2_f32_bf16 v96, v236, v28, v29
v_dot2_f32_bf16 v97, v236, v26, v29
v_dot2_f32_bf16 v98, v237, v28, v29
v_dot2_f32_bf16 v99, v237, v26, v29
v_dot2_f32_bf16 v100, v238, v28, v29
v_dot2_f32_bf16 v101, v238, v26, v29
v_dot2_f32_bf16 v102, v239, v28, v29
v_dot2_f32_bf16 v103, v239, v26, v29
MV 64,40,232
R 36,6,0
R 38,6,512
CV 236,96,97
CV 237,98,99
MV 80,44,232
R 40,8,45056
R 42,8,45312
CV 238,100,101
CV 239,102,103
s_add_u32 s100, s100, 28672
s_addc_u32 s101, s101, 0
s_waitcnt lgkmcnt(4)
MA 144,48,232
R 44,3,2048
R 46,3,2560
global_load_dword v0, v23, s[100:101]
v_dot2_f32_bf16 v96, v240, v28, v29
v_dot2_f32_bf16 v97, v240, v26, v29
v_dot2_f32_bf16 v98, v241, v28, v29
v_dot2_f32_bf16 v99, v241, v26, v29
v_dot2_f32_bf16 v100, v242, v28, v29
v_dot2_f32_bf16 v101, v242, v26, v29
v_dot2_f32_bf16 v102, v243, v28, v29
v_dot2_f32_bf16 v103, v243, v26, v29
MV 64,52,236
R 48,6,2048
R 50,6,2560
buffer_load_dwordx4 v16, s[16:19], s75 offen offset:1024 lds
CV 240,96,97
CV 241,98,99
MV 80,56,236
R 52,8,46080
R 54,8,46336
CV 242,100,101
CV 243,102,103
MA 144,60,236
R 56,3,4096
R 58,3,4608
v_dot2_f32_bf16 v96, v244, v28, v29
v_dot2_f32_bf16 v97, v244, v26, v29
v_dot2_f32_bf16 v98, v245, v28, v29
v_dot2_f32_bf16 v99, v245, v26, v29
v_dot2_f32_bf16 v100, v246, v28, v29
v_dot2_f32_bf16 v101, v246, v26, v29
v_dot2_f32_bf16 v102, v247, v28, v29
v_dot2_f32_bf16 v103, v247, v26, v29
MV 64,32,240
R 60,6,4096
R 62,6,4608
buffer_load_dwordx4 v17, s[16:19], s75 offen offset:2048 lds
CV 244,96,97
s_waitcnt vmcnt(6)
v_cmp_ne_u32 vcc, 0x10000, v31
s_nop 1
s_cbranch_vccnz LM_poll0
LM_ok0:
s_waitcnt lgkmcnt(4)
MV 80,36,240
R 32,8,47104
R 34,8,47360
CV 245,98,99
CV 246,100,101
CV 247,102,103
s_add_u32 m0, s69, 12288
s_add_u32 s75, s60, 1572992
MA 144,40,240
R 36,3,6144
R 38,3,6656
buffer_load_dwordx4 v15, s[16:19], s75 offen offset:0 lds
v_dot2_f32_bf16 v96, v248, v28, v29
v_dot2_f32_bf16 v97, v248, v26, v29
v_dot2_f32_bf16 v98, v249, v28, v29
v_dot2_f32_bf16 v99, v249, v26, v29
v_dot2_f32_bf16 v100, v250, v28, v29
v_dot2_f32_bf16 v101, v250, v26, v29
v_dot2_f32_bf16 v102, v251, v28, v29
v_dot2_f32_bf16 v103, v251, v26, v29
MV 64,44,244
R 40,6,6144
R 42,6,6656
CV 248,96,97
CV 249,98,99
MV 80,48,244
R 44,8,48128
R 46,8,48384
CV 250,100,101
CV 251,102,103
MA 144,52,244
R 48,3,8192
R 50,3,8704
v_dot2_f32_bf16 v96, v252, v28, v29
v_dot2_f32_bf16 v97, v252, v26, v29
v_dot2_f32_bf16 v98, v253, v28, v29
v_dot2_f32_bf16 v99, v253, v26, v29
v_dot2_f32_bf16 v100, v254, v28, v29
v_dot2_f32_bf16 v101, v254, v26, v29
v_dot2_f32_bf16 v102, v255, v28, v29
v_dot2_f32_bf16 v103, v255, v26, v29
s_waitcnt lgkmcnt(6)
MV 64,56,248
R 52,6,8192
R 54,6,8704
CV 252,96,97
CV 253,98,99
MV 80,60,248
R 56,3,20480
R 58,3,20992
CV 254,100,101
CV 255,102,103
MA 144,32,248
R 60,6,20480
R 62,6,20992
MV 64,36,252
R 32,3,32768
R 34,3,33280
buffer_load_dwordx4 v16, s[16:19], s75 offen offset:1024 lds
s_waitcnt lgkmcnt(6)
MV 80,40,252
R 36,6,32768
R 38,6,33280
MA 144,44,252
R 40,3,10240
R 42,3,10752
buffer_load_dwordx4 v17, s[16:19], s75 offen offset:2048 lds
v_mfma_f32_32x32x16_bf16 a[160:175], v[48:51], v[112:115], 0
R 44,6,10240
R 46,6,10752
s_add_u32 m0, s69, 24576
s_add_u32 s75, s60, 1573120
v_mfma_f32_32x32x16_bf16 a[176:191], v[52:55], v[112:115], 0
R 48,3,22528
R 50,3,23040
buffer_load_dwordx4 v15, s[16:19], s75 offen offset:0 lds
v_mul_f32 v96, v25, v25
v_mul_f32 v96, v96, v27
v_add_f32 v96, 0x3727c5ac, v96
v_rsq_f32 v96, v96
v_rcp_f32 v97, v26
v_mul_f32 v96, v96, v25
v_mul_f32 v96, v96, v97
v_rcp_f32 v29, v96
v_mul_f32 v27, 0xc0135761, v96
v_mul_f32 v97, v96, v96
v_mul_f32 v97, v97, v96
v_mul_f32 v28, 0xbdd2d3e8, v97
s_lshl_b32 s71, s55, 5
v_and_b32 v26, 31, v1
v_add_u32 v26, s71, v26
v_and_b32 v98, 512, v23
v_mov_b32 v99, 2147483648
s_lshl_b32 s71, s56, 2
s_add_u32 s71, s71, 0
s_cmp_lt_u32 s71, 27
s_cselect_b32 s72, 2, -2
s_cmp_lt_u32 s71, 18
s_cselect_b32 s72, -1, s72
s_cmp_lt_u32 s71, 9
s_cselect_b32 s72, 1, s72
v_add_u32 v96, s72, v26
s_waitcnt lgkmcnt(2)
v_mfma_f32_32x32x16_bf16 a[192:207], v[56:59], v[112:115], 0
R 52,6,22528
R 54,6,23040
v_lshrrev_b32 v97, 5, v96
v_mul_u32_u24 v97, 36864, v97
v_and_b32 v100, 31, v96
v_lshl_add_u32 v97, v100, 4, v97
v_add_u32 v97, v97, v98
v_cmp_gt_u32 vcc, 0x800, v96
s_nop 1
v_cndmask_b32 v100, v99, v97, vcc
s_lshl_b32 s71, s56, 2
s_add_u32 s71, s71, 1
s_cmp_lt_u32 s71, 27
s_cselect_b32 s72, 2, -2
s_cmp_lt_u32 s71, 18
s_cselect_b32 s72, -1, s72
s_cmp_lt_u32 s71, 9
s_cselect_b32 s72, 1, s72
v_add_u32 v96, s72, v26
v_lshrrev_b32 v97, 5, v96
v_mfma_f32_32x32x16_bf16 a[208:223], v[60:63], v[112:115], 0
R 56,3,34816
R 58,3,35328
v_mul_u32_u24 v97, 36864, v97
v_and_b32 v101, 31, v96
v_lshl_add_u32 v97, v101, 4, v97
v_add_u32 v97, v97, v98
v_cmp_gt_u32 vcc, 0x800, v96
s_nop 1
v_cndmask_b32 v101, v99, v97, vcc
s_lshl_b32 s71, s56, 2
s_add_u32 s71, s71, 2
s_cmp_lt_u32 s71, 27
s_cselect_b32 s72, 2, -2
s_cmp_lt_u32 s71, 18
s_cselect_b32 s72, -1, s72
s_cmp_lt_u32 s71, 9
s_cselect_b32 s72, 1, s72
v_add_u32 v96, s72, v26
v_lshrrev_b32 v97, 5, v96
v_mul_u32_u24 v97, 36864, v97
v_and_b32 v102, 31, v96
v_lshl_add_u32 v97, v102, 4, v97
v_add_u32 v97, v97, v98
v_cmp_gt_u32 vcc, 0x800, v96
s_nop 1
v_cndmask_b32 v102, v99, v97, vcc
s_lshl_b32 s71, s56, 2
s_add_u32 s71, s71, 3
s_cmp_lt_u32 s71, 27
s_cselect_b32 s72, 2, -2
s_cmp_lt_u32 s71, 18
s_cselect_b32 s72, -1, s72
s_cmp_lt_u32 s71, 9
s_cselect_b32 s72, 1, s72
v_add_u32 v96, s72, v26
v_mfma_f32_32x32x16_bf16 a[224:239], v[32:35], v[112:115], 0
R 60,6,34816
R 62,6,35328
v_lshrrev_b32 v97, 5, v96
v_mul_u32_u24 v97, 36864, v97
v_and_b32 v103, 31, v96
v_lshl_add_u32 v97, v103, 4, v97
v_add_u32 v97, v97, v98
v_cmp_gt_u32 vcc, 0x800, v96
s_nop 1
v_cndmask_b32 v103, v99, v97, vcc
v_add_u32 v96, -2, v26
v_or_b32 v98, s79, v98
v_lshrrev_b32 v97, 5, v96
v_mul_u32_u24 v97, 36864, v97
v_and_b32 v104, 31, v96
v_lshl_add_u32 v97, v104, 4, v97
v_add_u32 v97, v97, v98
v_cmp_gt_u32 vcc, 0x800, v96
s_nop 1
v_cndmask_b32 v104, v99, v97, vcc
v_mfma_f32_32x32x16_bf16 a[240:255], v[36:39], v[112:115], 0
R 32,3,12288
R 34,3,12800
v_mul_f32 v96, v64, v64
v_mul_f32 v97, v65, v65
v_mul_f32 v98, v66, v66
v_mul_f32 v99, v67, v67
v_fma_f32 v96, v96, v28, v27
v_fma_f32 v97, v97, v28, v27
v_fma_f32 v98, v98, v28, v27
v_fma_f32 v99, v99, v28, v27
v_mul_f32 v96, v96, v64
v_mul_f32 v97, v97, v65
v_mul_f32 v98, v98, v66
v_mul_f32 v99, v99, v67
v_exp_f32 v96, v96
v_exp_f32 v97, v97
v_exp_f32 v98, v98
v_exp_f32 v99, v99
MA 160,40,116
R 36,6,12288
R 38,6,12800
v_fma_f32 v96, v96, v29, v29
v_fma_f32 v97, v97, v29, v29
v_fma_f32 v98, v98, v29, v29
v_fma_f32 v99, v99, v29, v29
v_rcp_f32 v96, v96
v_rcp_f32 v97, v97
v_rcp_f32 v98, v98
v_rcp_f32 v99, v99
v_mul_f32 v64, v64, v96
v_mul_f32 v65, v65, v97
v_mul_f32 v66, v66, v98
v_mul_f32 v67, v67, v99
CV 64,64,65
CV 65,66,67
v_mul_f32 v96, v68, v68
v_mul_f32 v97, v69, v69
v_mul_f32 v98, v70, v70
MA 176,44,116
R 40,3,24576
R 42,3,25088
v_mul_f32 v99, v71, v71
v_fma_f32 v96, v96, v28, v27
v_fma_f32 v97, v97, v28, v27
v_fma_f32 v98, v98, v28, v27
v_fma_f32 v99, v99, v28, v27
v_mul_f32 v96, v96, v68
v_mul_f32 v97, v97, v69
v_mul_f32 v98, v98, v70
v_mul_f32 v99, v99, v71
v_exp_f32 v96, v96
v_exp_f32 v97, v97
v_exp_f32 v98, v98
v_exp_f32 v99, v99
v_fma_f32 v96, v96, v29, v29
v_fma_f32 v97, v97, v29, v29
v_fma_f32 v98, v98, v29, v29
v_fma_f32 v99, v99, v29, v29
v_rcp_f32 v96, v96
s_waitcnt lgkmcnt(2)
MA 192,48,116
R 44,6,24576
R 46,6,25088
buffer_load_dwordx4 v16, s[16:19], s75 offen offset:1024 lds
v_rcp_f32 v97, v97
v_rcp_f32 v98, v98
v_rcp_f32 v99, v99
v_mul_f32 v68, v68, v96
v_mul_f32 v69, v69, v97
v_mul_f32 v70, v70, v98
v_mul_f32 v71, v71, v99
CV 66,68,69
CV 67,70,71
s_lshl_b32 s71, s56, 12
MA 208,52,116
R 48,3,36864
R 50,3,37376
buffer_store_dwordx4 v[64:67], v100, s[48:51], s71 offen offset:0 sc1
v_mul_f32 v96, v72, v72
v_mul_f32 v97, v73, v73
v_mul_f32 v98, v74, v74
v_mul_f32 v99, v75, v75
v_fma_f32 v96, v96, v28, v27
v_fma_f32 v97, v97, v28, v27
v_fma_f32 v98, v98, v28, v27
v_fma_f32 v99, v99, v28, v27
v_mul_f32 v96, v96, v72
v_mul_f32 v97, v97, v73
v_mul_f32 v98, v98, v74
v_mul_f32 v99, v99, v75
v_exp_f32 v96, v96
v_exp_f32 v97, v97
v_exp_f32 v98, v98
v_exp_f32 v99, v99
v_fma_f32 v96, v96, v29, v29
v_fma_f32 v97, v97, v29, v29
MA 224,56,116
R 52,6,36864
R 54,6,37376
buffer_load_dwordx4 v17, s[16:19], s75 offen offset:2048 lds
v_fma_f32 v98, v98, v29, v29
v_fma_f32 v99, v99, v29, v29
v_rcp_f32 v96, v96
v_rcp_f32 v97, v97
v_rcp_f32 v98, v98
v_rcp_f32 v99, v99
v_mul_f32 v72, v72, v96
v_mul_f32 v73, v73, v97
v_mul_f32 v74, v74, v98
v_mul_f32 v75, v75, v99
CV 68,72,73
CV 69,74,75
v_mul_f32 v96, v76, v76
v_mul_f32 v97, v77, v77
v_mul_f32 v98, v78, v78
v_mul_f32 v99, v79, v79
MA 240,60,116
R 56,3,14336
R 58,3,14848
v_fma_f32 v96, v96, v28, v27
v_fma_f32 v97, v97, v28, v27
v_fma_f32 v98, v98, v28, v27
v_fma_f32 v99, v99, v28, v27
v_mul_f32 v96, v96, v76
v_mul_f32 v97, v97, v77
v_mul_f32 v98, v98, v78
v_mul_f32 v99, v99, v79
v_exp_f32 v96, v96
v_exp_f32 v97, v97
v_exp_f32 v98, v98
v_exp_f32 v99, v99
v_fma_f32 v96, v96, v29, v29
v_fma_f32 v97, v97, v29, v29
v_fma_f32 v98, v98, v29, v29
v_fma_f32 v99, v99, v29, v29
v_rcp_f32 v96, v96
MA 160,32,120
R 60,6,14336
R 62,6,14848
v_rcp_f32 v97, v97
v_rcp_f32 v98, v98
v_rcp_f32 v99, v99
v_mul_f32 v76, v76, v96
v_mul_f32 v77, v77, v97
v_mul_f32 v78, v78, v98
v_mul_f32 v79, v79, v99
CV 70,76,77
CV 71,78,79
v_mul_f32 v96, v80, v80
v_mul_f32 v97, v81, v81
s_lshl_b32 s71, s56, 12
MA 176,36,120
s_waitcnt vmcnt(11)
s_barrier
R 32,3,26624
R 34,3,27136
buffer_store_dwordx4 v[68:71], v101, s[48:51], s71 offen offset:1024 sc1
v_mul_f32 v98, v82, v82
v_mul_f32 v99, v83, v83
v_fma_f32 v96, v96, v28, v27
v_fma_f32 v97, v97, v28, v27
v_fma_f32 v98, v98, v28, v27
v_fma_f32 v99, v99, v28, v27
v_mul_f32 v96, v96, v80
v_mul_f32 v97, v97, v81
v_mul_f32 v98, v98, v82
v_mul_f32 v99, v99, v83
v_exp_f32 v96, v96
v_exp_f32 v97, v97
s_waitcnt lgkmcnt(2)
MA 192,40,120
R 36,6,26624
R 38,6,27136
v_exp_f32 v98, v98
v_exp_f32 v99, v99
v_fma_f32 v96, v96, v29, v29
v_fma_f32 v97, v97, v29, v29
v_fma_f32 v98, v98, v29, v29
v_fma_f32 v99, v99, v29, v29
v_rcp_f32 v96, v96
v_rcp_f32 v97, v97
v_rcp_f32 v98, v98
v_rcp_f32 v99, v99
v_mul_f32 v80, v80, v96
v_mul_f32 v81, v81, v97
v_mul_f32 v82, v82, v98
s_add_u32 m0, s69, 36864
s_add_u32 s75, s59, 0
MA 208,44,120
R 40,3,38912
R 42,3,39424
buffer_load_dwordx4 v108, s[28:31], s75 offen offset:0 lds
v_mul_f32 v83, v83, v99
CV 72,80,81
CV 73,82,83
v_mul_f32 v96, v84, v84
v_mul_f32 v97, v85, v85
v_mul_f32 v98, v86, v86
v_mul_f32 v99, v87, v87
v_fma_f32 v96, v96, v28, v27
v_fma_f32 v97, v97, v28, v27
v_fma_f32 v98, v98, v28, v27
v_fma_f32 v99, v99, v28, v27
v_mul_f32 v96, v96, v84
v_mul_f32 v97, v97, v85
v_mul_f32 v98, v98, v86
v_mul_f32 v99, v99, v87
v_exp_f32 v96, v96
v_exp_f32 v97, v97
v_exp_f32 v98, v98
MA 224,48,120
R 44,6,38912
R 46,6,39424
v_exp_f32 v99, v99
v_fma_f32 v96, v96, v29, v29
v_fma_f32 v97, v97, v29, v29
v_fma_f32 v98, v98, v29, v29
v_fma_f32 v99, v99, v29, v29
v_rcp_f32 v96, v96
v_rcp_f32 v97, v97
v_rcp_f32 v98, v98
v_rcp_f32 v99, v99
v_mul_f32 v84, v84, v96
v_mul_f32 v85, v85, v97
v_mul_f32 v86, v86, v98
v_mul_f32 v87, v87, v99
CV 74,84,85
CV 75,86,87
MA 240,52,120
R 48,3,16384
R 50,3,16896
v_mul_f32 v96, v88, v88
v_mul_f32 v97, v89, v89
v_mul_f32 v98, v90, v90
v_mul_f32 v99, v91, v91
v_fma_f32 v96, v96, v28, v27
v_fma_f32 v97, v97, v28, v27
v_fma_f32 v98, v98, v28, v27
v_fma_f32 v99, v99, v28, v27
v_mul_f32 v96, v96, v88
v_mul_f32 v97, v97, v89
v_mul_f32 v98, v98, v90
v_mul_f32 v99, v99, v91
v_exp_f32 v96, v96
v_exp_f32 v97, v97
s_lshl_b32 s71, s56, 12
MA 160,56,124
R 52,6,16384
R 54,6,16896
buffer_store_dwordx4 v[72:75], v102, s[48:51], s71 offen offset:2048 sc1
v_exp_f32 v98, v98
v_exp_f32 v99, v99
v_fma_f32 v96, v96, v29, v29
v_fma_f32 v97, v97, v29, v29
v_fma_f32 v98, v98, v29, v29
v_fma_f32 v99, v99, v29, v29
v_rcp_f32 v96, v96
v_rcp_f32 v97, v97
v_rcp_f32 v98, v98
v_rcp_f32 v99, v99
v_mul_f32 v88, v88, v96
v_mul_f32 v89, v89, v97
v_mul_f32 v90, v90, v98
v_mul_f32 v91, v91, v99
MA 176,60,124
R 56,3,28672
R 58,3,29184
CV 76,88,89
CV 77,90,91
v_mul_f32 v96, v92, v92
v_mul_f32 v97, v93, v93
v_mul_f32 v98, v94, v94
v_mul_f32 v99, v95, v95
v_fma_f32 v96, v96, v28, v27
v_fma_f32 v97, v97, v28, v27
v_fma_f32 v98, v98, v28, v27
v_fma_f32 v99, v99, v28, v27
v_mul_f32 v96, v96, v92
v_mul_f32 v97, v97, v93
v_mul_f32 v98, v98, v94
v_mul_f32 v99, v99, v95
v_exp_f32 v96, v96
v_exp_f32 v97, v97
v_exp_f32 v98, v98
v_exp_f32 v99, v99
s_waitcnt lgkmcnt(2)
MA 192,32,124
R 60,6,28672
R 62,6,29184
v_fma_f32 v96, v96, v29, v29
v_fma_f32 v97, v97, v29, v29
v_fma_f32 v98, v98, v29, v29
v_fma_f32 v99, v99, v29, v29
v_rcp_f32 v96, v96
v_rcp_f32 v97, v97
v_rcp_f32 v98, v98
v_rcp_f32 v99, v99
v_mul_f32 v92, v92, v96
v_mul_f32 v93, v93, v97
v_mul_f32 v94, v94, v98
v_mul_f32 v95, v95, v99
CV 78,92,93
CV 79,94,95
s_lshl_b32 s71, s56, 12
MA 208,36,124
R 32,3,40960
R 34,3,41472
buffer_load_dwordx4 v109, s[28:31], s75 offen offset:1024 lds
buffer_store_dwordx4 v[76:79], v103, s[48:51], s71 offen offset:3072 sc1
v_accvgpr_read_b32 v80, a144
v_accvgpr_read_b32 v81, a145
v_accvgpr_read_b32 v82, a146
v_accvgpr_read_b32 v83, a147
v_accvgpr_read_b32 v84, a148
v_accvgpr_read_b32 v85, a149
v_accvgpr_read_b32 v86, a150
v_accvgpr_read_b32 v87, a151
v_accvgpr_read_b32 v88, a152
v_accvgpr_read_b32 v89, a153
v_accvgpr_read_b32 v90, a154
v_accvgpr_read_b32 v91, a155
v_accvgpr_read_b32 v92, a156
v_accvgpr_read_b32 v93, a157
v_accvgpr_read_b32 v94, a158
v_accvgpr_read_b32 v95, a159
v_mul_f32 v96, v80, v80
MA 224,40,124
R 36,6,40960
R 38,6,41472
v_mul_f32 v97, v81, v81
v_mul_f32 v98, v82, v82
v_mul_f32 v99, v83, v83
v_fma_f32 v96, v96, v28, v27
v_fma_f32 v97, v97, v28, v27
v_fma_f32 v98, v98, v28, v27
v_fma_f32 v99, v99, v28, v27
v_mul_f32 v96, v96, v80
v_mul_f32 v97, v97, v81
v_mul_f32 v98, v98, v82
v_mul_f32 v99, v99, v83
v_exp_f32 v96, v96
v_exp_f32 v97, v97
v_exp_f32 v98, v98
v_exp_f32 v99, v99
v_fma_f32 v96, v96, v29, v29
v_fma_f32 v97, v97, v29, v29
MA 240,44,124
R 40,3,18432
R 42,3,18944
v_fma_f32 v98, v98, v29, v29
v_fma_f32 v99, v99, v29, v29
v_rcp_f32 v96, v96
v_rcp_f32 v97, v97
v_rcp_f32 v98, v98
v_rcp_f32 v99, v99
v_mul_f32 v80, v80, v96
v_mul_f32 v81, v81, v97
v_mul_f32 v82, v82, v98
v_mul_f32 v83, v83, v99
CV 80,80,81
CV 81,82,83
v_mul_f32 v96, v84, v84
v_mul_f32 v97, v85, v85
v_mul_f32 v98, v86, v86
v_mul_f32 v99, v87, v87
v_fma_f32 v96, v96, v28, v27
MA 160,48,128
R 44,6,18432
R 46,6,18944
buffer_load_dwordx4 v110, s[28:31], s75 offen offset:2048 lds
v_fma_f32 v97, v97, v28, v27
v_fma_f32 v98, v98, v28, v27
v_fma_f32 v99, v99, v28, v27
v_mul_f32 v96, v96, v84
v_mul_f32 v97, v97, v85
v_mul_f32 v98, v98, v86
v_mul_f32 v99, v99, v87
v_exp_f32 v96, v96
v_exp_f32 v97, v97
v_exp_f32 v98, v98
v_exp_f32 v99, v99
LM_pad3:
s_cbranch_execz LM_pad7
v_fma_f32 v96, v96, v29, v29
v_fma_f32 v97, v97, v29, v29
v_fma_f32 v98, v98, v29, v29
v_fma_f32 v99, v99, v29, v29
v_rcp_f32 v96, v96
MA 176,52,128
R 48,3,30720
R 50,3,31232
v_rcp_f32 v97, v97
v_rcp_f32 v98, v98
v_rcp_f32 v99, v99
v_mul_f32 v84, v84, v96
v_mul_f32 v85, v85, v97
v_mul_f32 v86, v86, v98
v_mul_f32 v87, v87, v99
CV 82,84,85
CV 83,86,87
s_add_u32 m0, s70, 49152
s_add_u32 s75, s58, 0
s_lshl_b32 s71, s56, 11
s_add_u32 s71, s71, 32768
s_waitcnt lgkmcnt(2)
MA 192,56,128
R 52,6,30720
R 54,6,31232
buffer_load_dwordx4 v11, s[28:31], s75 offen offset:0 lds
buffer_store_dwordx4 v[80:83], v104, s[48:51], s71 offen offset:0 sc1
v_mul_f32 v96, v88, v88
v_mul_f32 v97, v89, v89
v_mul_f32 v98, v90, v90
v_mul_f32 v99, v91, v91
v_fma_f32 v96, v96, v28, v27
v_fma_f32 v97, v97, v28, v27
v_fma_f32 v98, v98, v28, v27
v_fma_f32 v99, v99, v28, v27
v_mul_f32 v96, v96, v88
v_mul_f32 v97, v97, v89
v_mul_f32 v98, v98, v90
v_mul_f32 v99, v99, v91
v_exp_f32 v96, v96
v_exp_f32 v97, v97
v_exp_f32 v98, v98
v_exp_f32 v99, v99
MA 208,60,128
R 56,3,43008
R 58,3,43520
v_fma_f32 v96, v96, v29, v29
v_fma_f32 v97, v97, v29, v29
v_fma_f32 v98, v98, v29, v29
v_fma_f32 v99, v99, v29, v29
v_rcp_f32 v96, v96
v_rcp_f32 v97, v97
v_rcp_f32 v98, v98
v_rcp_f32 v99, v99
v_mul_f32 v88, v88, v96
v_mul_f32 v89, v89, v97
v_mul_f32 v90, v90, v98
v_mul_f32 v91, v91, v99
CV 84,88,89
CV 85,90,91
v_mul_f32 v96, v92, v92
v_mul_f32 v97, v93, v93
v_mul_f32 v98, v94, v94
MA 224,32,128
R 60,6,43008
R 62,6,43520
v_mul_f32 v99, v95, v95
v_fma_f32 v96, v96, v28, v27
v_fma_f32 v97, v97, v28, v27
v_fma_f32 v98, v98, v28, v27
v_fma_f32 v99, v99, v28, v27
v_mul_f32 v96, v96, v92
v_mul_f32 v97, v97, v93
v_mul_f32 v98, v98, v94
v_mul_f32 v99, v99, v95
v_exp_f32 v96, v96
v_exp_f32 v97, v97
v_exp_f32 v98, v98
v_exp_f32 v99, v99
v_fma_f32 v96, v96, v29, v29
v_fma_f32 v97, v97, v29, v29
v_fma_f32 v98, v98, v29, v29
v_fma_f32 v99, v99, v29, v29
MA 240,36,128
R 32,3,45056
R 34,3,45568
v_rcp_f32 v96, v96
v_rcp_f32 v97, v97
v_rcp_f32 v98, v98
v_rcp_f32 v99, v99
v_mul_f32 v92, v92, v96
v_mul_f32 v93, v93, v97
v_mul_f32 v94, v94, v98
v_mul_f32 v95, v95, v99
CV 86,92,93
CV 87,94,95
s_lshl_b32 s71, s56, 11
s_add_u32 s71, s71, 32768
s_add_u32 s100, s100, 4096
s_addc_u32 s101, s101, 0
MA 160,40,132
R 36,6,45056
R 38,6,45568
global_load_dword v0, v23, s[100:101]
buffer_store_dwordx4 v[84:87], v104, s[48:51], s71 offen offset:1024 sc1
MA 176,44,132
R 40,3,57344
R 42,3,57856
s_waitcnt lgkmcnt(4)
MA 192,48,132
R 44,6,57344
R 46,6,57856
MA 208,52,132
R 48,4,4096
R 50,4,4608
buffer_load_dwordx4 v12, s[28:31], s75 offen offset:1024 lds
v_lshrrev_b32 v105, 4, v1
MA 224,56,132
R 52,7,4096
R 54,7,4608
v_min_u32 v105, 2, v105
v_add_u32 v105, s55, v105
MA 240,60,132
R 56,3,47104
R 58,3,47616
buffer_load_dwordx4 v13, s[28:31], s75 offen offset:2048 lds
v_subrev_u32 v105, 1, v105
MA 160,32,136
R 60,6,47104
R 62,6,47616
v_max_i32 v105, 0, v105
s_add_u32 m0, s70, 52224
s_add_u32 s75, s58, 27648
s_waitcnt lgkmcnt(6)
MA 176,36,136
R 32,3,59392
R 34,3,59904
buffer_load_dwordx4 v11, s[28:31], s75 offen offset:0 lds
v_min_i32 v105, 63, v105
MA 192,40,136
R 36,6,59392
R 38,6,59904
v_lshlrev_b32 v105, 7, v105
v_and_b32 v106, 7, v1
MA 208,44,136
R 40,4,6144
R 42,4,6656
v_lshl_add_u32 v105, v106, 2, v105
s_lshl_b32 s71, s55, 7
v_lshl_add_u32 v107, v106, 2, s71
MA 224,48,136
R 44,7,6144
R 46,7,6656
v_mov_b32 v99, 2147483648
s_waitcnt lgkmcnt(6)
MA 240,52,136
R 48,3,49152
R 50,3,49664
v_add_u32 v100, -1, v26
v_cmp_gt_u32 vcc, 0x800, v100
s_nop 1
v_cndmask_b32 v100, v99, v23, vcc
MA 160,56,140
R 52,6,49152
R 54,6,49664
v_add_u32 v101, 1, v26
MA 176,60,140
R 56,3,61440
R 58,3,61952
v_cmp_gt_u32 vcc, 0x800, v101
s_nop 1
v_cndmask_b32 v101, v99, v23, vcc
MA 192,32,140
R 60,6,61440
R 62,6,61952
buffer_load_dwordx4 v12, s[28:31], s75 offen offset:1024 lds
v_add_u32 v102, -2, v26
s_waitcnt lgkmcnt(6)
MA 208,36,140
R 32,4,8192
R 34,4,8704
v_cmp_gt_u32 vcc, 0x800, v102
s_nop 1
v_cndmask_b32 v102, v99, v23, vcc
MA 224,40,140
R 36,7,8192
R 38,7,8704
buffer_load_dwordx4 v13, s[28:31], s75 offen offset:2048 lds
v_add_u32 v103, 2, v26
MA 240,44,140
R 40,3,51200
R 42,3,51712
v_cmp_gt_u32 vcc, 0x800, v103
s_nop 1
v_cndmask_b32 v103, v99, v23, vcc
s_add_u32 s74, s80, 0
s_waitcnt vmcnt(5)
MA 160,48,144
R 44,6,51200
R 46,6,51712
buffer_store_dword v3, v30, s[48:51], s74 offen sc1
s_waitcnt lgkmcnt(6)
MA 176,52,144
s_barrier
R 48,3,63488
R 50,3,64000
MA 192,56,144
R 52,6,63488
R 54,6,64000
s_add_u32 m0, s69, 73728
s_add_u32 s75, s59, 221184
MA 208,60,144
R 56,4,10240
R 58,4,10752
buffer_load_dwordx4 v108, s[28:31], s75 offen offset:0 lds
MA 224,32,144
R 60,7,10240
R 62,7,10752
s_waitcnt lgkmcnt(6)
MA 240,36,144
R 32,3,53248
R 34,3,53760
MA 160,40,148
R 36,6,53248
R 38,6,53760
MA 176,44,148
R 40,4,0
R 42,4,512
MA 192,48,148
R 44,7,0
R 46,7,512
s_waitcnt lgkmcnt(8)
MA 208,52,148
R 48,4,12288
R 50,4,12800
buffer_load_dwordx4 v109, s[28:31], s75 offen offset:1024 lds
MA 224,56,148
R 52,7,12288
R 54,7,12800
MA 240,60,148
R 56,3,55296
R 58,3,55808
s_waitcnt lgkmcnt(6)
MA 160,32,152
R 60,6,55296
R 62,6,55808
buffer_load_dwordx4 v110, s[28:31], s75 offen offset:2048 lds
MA 176,36,152
R 32,4,2048
R 34,4,2560
s_add_u32 m0, s70, 86016
s_add_u32 s75, s58, 221184
MA 192,40,152
R 36,7,2048
R 38,7,2560
buffer_load_dwordx4 v11, s[28:31], s75 offen offset:0 lds
MA 208,44,152
R 40,4,14336
R 42,4,14848
s_waitcnt lgkmcnt(6)
MA 224,48,152
R 44,7,14336
R 46,7,14848
MA 240,52,152
R 48,2,0
R 50,2,512
MA 160,56,156
R 52,5,0
R 54,5,512
MA 176,60,156
R 56,2,12288
R 58,2,12800
s_waitcnt lgkmcnt(8)
MA 192,32,156
R 60,5,12288
R 62,5,12800
MA 208,36,156
R 32,2,24576
R 34,2,25088
buffer_load_dwordx4 v12, s[28:31], s75 offen offset:1024 lds
MA 224,40,156
R 36,5,24576
R 38,5,25088
s_waitcnt lgkmcnt(6)
MA 240,44,156
R 40,2,2048
R 42,2,2560
buffer_load_dwordx4 v13, s[28:31], s75 offen offset:2048 lds
s_mov_b32 s81, 42598400
MA 160,48,160
R 44,5,2048
R 46,5,2560
buffer_load_dword v31, v105, s[48:51], s81 offen sc1
s_add_u32 m0, s70, 89088
s_add_u32 s75, s58, 248832
MA 176,52,160
R 48,2,14336
R 50,2,14848
buffer_load_dwordx4 v11, s[28:31], s75 offen offset:0 lds
MA 192,56,160
R 52,5,14336
R 54,5,14848
s_waitcnt lgkmcnt(6)
MA 208,60,160
R 56,2,26624
R 58,2,27136
MA 224,32,160
R 60,5,26624
R 62,5,27136
MA 240,36,160
R 32,2,4096
R 34,2,4608
MA 160,40,164
R 36,5,4096
R 38,5,4608
s_waitcnt lgkmcnt(8)
MA 176,44,164
R 40,2,16384
R 42,2,16896
MA 192,48,164
R 44,5,16384
R 46,5,16896
buffer_load_dwordx4 v12, s[28:31], s75 offen offset:1024 lds
MA 208,52,164
R 48,2,28672
R 50,2,29184
s_waitcnt lgkmcnt(6)
MA 224,56,164
R 52,5,28672
R 54,5,29184
buffer_load_dwordx4 v13, s[28:31], s75 offen offset:2048 lds
MA 240,60,164
R 56,2,6144
R 58,2,6656
MA 160,32,168
R 60,5,6144
R 62,5,6656
MA 176,36,168
s_waitcnt vmcnt(11)
s_barrier
R 32,2,18432
R 34,2,18944
s_waitcnt lgkmcnt(6)
MA 192,40,168
R 36,5,18432
R 38,5,18944
s_waitcnt vmcnt(3)
v_cmp_ne_u32 vcc, 0x10000, v31
s_nop 1
s_cbranch_vccnz LM_poll1
LM_ok1:
s_add_u32 s83, s82, 0
s_add_u32 m0, s69, 110592
s_add_u32 s75, s59, 442368
MA 208,44,168
R 40,2,30720
R 42,2,31232
buffer_load_dwordx4 a[0:3], v100, s[48:51], s83 offen offset:0 sc1
buffer_load_dwordx4 v108, s[28:31], s75 offen offset:0 lds
MA 224,48,168
R 44,5,30720
R 46,5,31232
MA 240,52,168
R 48,2,8192
R 50,2,8704
s_waitcnt lgkmcnt(6)
MA 160,56,172
R 52,5,8192
R 54,5,8704
buffer_load_dwordx4 a[4:7], v100, s[48:51], s83 offen offset:1024 sc1
MA 176,60,172
R 56,2,20480
R 58,2,20992
MA 192,32,172
R 60,5,20480
R 62,5,20992
buffer_load_dwordx4 a[8:11], v100, s[48:51], s83 offen offset:2048 sc1
MA 208,36,172
R 32,2,32768
R 34,2,33280
buffer_load_dwordx4 v109, s[28:31], s75 offen offset:1024 lds
s_waitcnt lgkmcnt(6)
MA 224,40,172
R 36,5,32768
R 38,5,33280
buffer_load_dwordx4 a[12:15], v100, s[48:51], s83 offen offset:3072 sc1
MA 240,44,172
R 40,2,10240
R 42,2,10752
s_add_u32 s83, s82, 4096
MA 160,48,176
R 44,5,10240
R 46,5,10752
buffer_load_dwordx4 a[16:19], v100, s[48:51], s83 offen offset:0 sc1
buffer_load_dwordx4 v110, s[28:31], s75 offen offset:2048 lds
MA 176,52,176
R 48,2,22528
R 50,2,23040
s_add_u32 m0, s70, 122880
s_add_u32 s75, s58, 442368
s_waitcnt lgkmcnt(6)
MA 192,56,176
R 52,5,22528
R 54,5,23040
buffer_load_dwordx4 v11, s[28:31], s75 offen offset:0 lds
MA 208,60,176
R 56,2,34816
R 58,2,35328
MA 224,32,176
R 60,5,34816
R 62,5,35328
buffer_load_dwordx4 a[20:23], v100, s[48:51], s83 offen offset:1024 sc1
MA 240,36,176
R 32,2,49152
R 34,2,49664
s_waitcnt lgkmcnt(6)
MA 160,40,180
R 36,5,49152
R 38,5,49664
buffer_load_dwordx4 a[24:27], v100, s[48:51], s83 offen offset:2048 sc1
MA 176,44,180
R 40,8,36864
R 42,8,37120
MA 192,48,180
R 44,2,51200
R 46,2,51712
buffer_load_dwordx4 a[28:31], v100, s[48:51], s83 offen offset:3072 sc1
MA 208,52,180
R 48,5,51200
R 50,5,51712
buffer_load_dwordx4 v12, s[28:31], s75 offen offset:1024 lds
s_add_u32 s83, s82, 8192
s_waitcnt lgkmcnt(6)
MA 224,56,180
R 52,8,37888
R 54,8,38144
buffer_load_dwordx4 a[32:35], v100, s[48:51], s83 offen offset:0 sc1
MA 240,60,180
R 56,2,53248
R 58,2,53760
buffer_load_dwordx4 v13, s[28:31], s75 offen offset:2048 lds
s_waitcnt vmcnt(14)
v_mfma_f32_32x32x16_bf16 v[64:79], v[32:35], a[0:3], 0
R 60,5,53248
R 62,5,53760
s_add_u32 m0, s70, 125952
s_add_u32 s75, s58, 470016
v_mfma_f32_32x32x16_bf16 v[80:95], v[36:39], a[0:3], 0
R 32,8,38912
R 34,8,39168
buffer_load_dwordx4 v11, s[28:31], s75 offen offset:0 lds
s_waitcnt lgkmcnt(6)
v_mfma_f32_32x32x16_bf16 a[144:159], v[40:43], a[0:3], 0
R 36,2,55296
R 38,2,55808
buffer_load_dwordx4 a[36:39], v101, s[48:51], s83 offen offset:1024 sc1
s_waitcnt vmcnt(14)
MS 64,44,4
R 40,5,55296
R 42,5,55808
MS 80,48,4
R 44,8,39936
R 46,8,40192
buffer_load_dwordx4 a[40:43], v101, s[48:51], s83 offen offset:2048 sc1
v_mfma_f32_32x32x16_bf16 a[144:159], v[52:55], a[4:7], a[144:159]
R 48,2,57344
R 50,2,57856
s_waitcnt vmcnt(14) lgkmcnt(6)
MS 64,56,8
R 52,5,57344
R 54,5,57856
buffer_load_dwordx4 a[44:47], v101, s[48:51], s83 offen offset:3072 sc1
MS 80,60,8
R 56,8,40960
R 58,8,41216
s_add_u32 s83, s82, 12288
v_mfma_f32_32x32x16_bf16 a[144:159], v[32:35], a[8:11], a[144:159]
R 60,2,59392
R 62,2,59904
buffer_load_dwordx4 a[48:51], v101, s[48:51], s83 offen offset:0 sc1
buffer_load_dwordx4 v12, s[28:31], s75 offen offset:1024 lds
s_waitcnt vmcnt(15)
MS 64,36,12
R 32,5,59392
R 34,5,59904
s_waitcnt lgkmcnt(6)
MS 80,40,12
R 36,8,41984
R 38,8,42240
buffer_load_dwordx4 v13, s[28:31], s75 offen offset:2048 lds
v_mfma_f32_32x32x16_bf16 a[144:159], v[44:47], a[12:15], a[144:159]
R 40,2,61440
R 42,2,61952
s_waitcnt vmcnt(15)
MS 64,48,16
R 44,5,61440
R 46,5,61952
buffer_load_dwordx4 a[52:55], v101, s[48:51], s83 offen offset:1024 sc1
MS 80,52,16
s_barrier
R 48,8,43008
R 50,8,43264
s_waitcnt lgkmcnt(6)
v_mfma_f32_32x32x16_bf16 a[144:159], v[56:59], a[16:19], a[144:159]
R 52,2,63488
R 54,2,64000
buffer_load_dwordx4 a[56:59], v101, s[48:51], s83 offen offset:2048 sc1
s_add_u32 m0, s69, 0
s_add_u32 s75, s60, 2359296
s_waitcnt vmcnt(14)
MS 64,60,20
R 56,5,63488
R 58,5,64000
buffer_load_dwordx4 v15, s[16:19], s75 offen offset:0 lds
MS 80,32,20
R 60,8,44032
R 62,8,44288
buffer_load_dwordx4 a[60:63], v101, s[48:51], s83 offen offset:3072 sc1
v_mfma_f32_32x32x16_bf16 a[144:159], v[36:39], a[20:23], a[144:159]
R 32,3,0
R 34,3,512
s_add_u32 s83, s82, 16384
s_waitcnt vmcnt(15) lgkmcnt(6)
MS 64,40,24
R 36,6,0
R 38,6,512
buffer_load_dwordx4 a[64:67], v101, s[48:51], s83 offen offset:0 sc1
MS 80,44,24
R 40,8,45056
R 42,8,45312
v_mfma_f32_32x32x16_bf16 a[144:159], v[48:51], a[24:27], a[144:159]
R 44,3,2048
R 46,3,2560
s_waitcnt vmcnt(15)
MS 64,52,28
R 48,6,2048
R 50,6,2560
buffer_load_dwordx4 v16, s[16:19], s75 offen offset:1024 lds
s_waitcnt lgkmcnt(6)
MS 80,56,28
R 52,8,46080
R 54,8,46336
buffer_load_dwordx4 a[68:71], v101, s[48:51], s83 offen offset:1024 sc1
v_mfma_f32_32x32x16_bf16 a[144:159], v[60:63], a[28:31], a[144:159]
R 56,3,4096
R 58,3,4608
buffer_load_dwordx4 a[72:75], v102, s[48:51], s83 offen offset:2048 sc1
s_waitcnt vmcnt(16)
MS 64,32,32
R 60,6,4096
R 62,6,4608
buffer_load_dwordx4 v17, s[16:19], s75 offen offset:2048 lds
MS 80,36,32
R 32,8,47104
R 34,8,47360
buffer_load_dwordx4 a[76:79], v102, s[48:51], s83 offen offset:3072 sc1
s_add_u32 m0, s69, 12288
s_add_u32 s75, s60, 2359424
s_waitcnt lgkmcnt(6)
v_mfma_f32_32x32x16_bf16 a[144:159], v[40:43], a[32:35], a[144:159]
R 36,3,6144
R 38,3,6656
buffer_load_dwordx4 v15, s[16:19], s75 offen offset:0 lds
s_add_u32 s83, s82, 20480
s_waitcnt vmcnt(16)
MS 64,44,36
R 40,6,6144
R 42,6,6656
buffer_load_dwordx4 a[80:83], v102, s[48:51], s83 offen offset:0 sc1
MS 80,48,36
R 44,8,48128
R 46,8,48384
v_mfma_f32_32x32x16_bf16 a[144:159], v[52:55], a[36:39], a[144:159]
LM_pad4:
s_cbranch_execz LM_pad8
R 48,3,20480
R 50,3,20992
s_waitcnt vmcnt(16) lgkmcnt(6)
MS 64,56,40
R 52,6,20480
R 54,6,20992
s_lshl_b32 s71, s56, 6
s_add_u32 s71, s71, 1024
v_mul_u32_u24 v104, 1152, v26
v_add_u32 v104, s71, v104
MS 80,60,40
R 56,9,8192
R 58,9,8448
buffer_load_dwordx4 a[84:87], v102, s[48:51], s83 offen offset:1024 sc1
v_mfma_f32_32x32x16_bf16 a[144:159], v[32:35], a[40:43], a[144:159]
R 60,3,22528
R 62,3,23040
s_waitcnt vmcnt(16)
MS 64,36,44
R 32,6,22528
R 34,6,23040
buffer_load_dwordx4 a[88:91], v102, s[48:51], s83 offen offset:2048 sc1
buffer_load_dwordx4 v16, s[16:19], s75 offen offset:1024 lds
s_waitcnt lgkmcnt(6)
MS 80,40,44
R 36,9,9216
R 38,9,9472
v_mfma_f32_32x32x16_bf16 a[144:159], v[44:47], a[44:47], a[144:159]
R 40,3,24576
R 42,3,25088
buffer_load_dwordx4 a[92:95], v102, s[48:51], s83 offen offset:3072 sc1
buffer_load_dwordx4 v17, s[16:19], s75 offen offset:2048 lds
s_add_u32 s100, s100, 4096
s_addc_u32 s101, s101, 0
s_waitcnt vmcnt(19)
MS 64,48,48
R 44,6,24576
R 46,6,25088
global_load_dword v0, v23, s[100:101]
s_add_u32 s83, s82, 24576
s_add_u32 m0, s69, 24576
s_add_u32 s75, s60, 2359552
MS 80,52,48
R 48,9,10240
R 50,9,10496
buffer_load_dwordx4 a[96:99], v102, s[48:51], s83 offen offset:0 sc1
buffer_load_dwordx4 v15, s[16:19], s75 offen offset:0 lds
s_waitcnt lgkmcnt(6)
v_mfma_f32_32x32x16_bf16 a[144:159], v[56:59], a[48:51], a[144:159]
R 52,3,26624
R 54,3,27136
v_lshrrev_b32 v105, 5, v1
s_waitcnt vmcnt(19)
MS 64,60,52
R 56,6,26624
R 58,6,27136
v_lshl_add_u32 v104, v105, 4, v104
MS 80,32,52
R 60,9,11264
R 62,9,11520
v_or_b32 v104, s79, v104
v_mfma_f32_32x32x16_bf16 a[144:159], v[36:39], a[52:55], a[144:159]
R 32,3,28672
R 34,3,29184
buffer_load_dwordx4 a[100:103], v102, s[48:51], s83 offen offset:1024 sc1
s_waitcnt vmcnt(19) lgkmcnt(6)
MS 64,40,56
R 36,6,28672
R 38,6,29184
MS 80,44,56
R 40,9,12288
R 42,9,12544
buffer_load_dwordx4 a[104:107], v102, s[48:51], s83 offen offset:2048 sc1
buffer_load_dwordx4 v[128:131], v104, s[4:7], 0 offen
buffer_load_dwordx4 v[132:135], v104, s[4:7], 0 offen offset:32
v_mfma_f32_32x32x16_bf16 a[144:159], v[48:51], a[56:59], a[144:159]
R 44,3,30720
R 46,3,31232
buffer_load_dwordx4 v16, s[16:19], s75 offen offset:1024 lds
s_waitcnt vmcnt(21)
MS 64,52,60
R 48,6,30720
R 50,6,31232
buffer_load_dwordx4 a[108:111], v103, s[48:51], s83 offen offset:3072 sc1
s_waitcnt lgkmcnt(6)
MS 80,56,60
R 52,9,13312
R 54,9,13568
buffer_load_dwordx4 v17, s[16:19], s75 offen offset:2048 lds
s_add_u32 s83, s82, 28672
v_mfma_f32_32x32x16_bf16 a[144:159], v[60:63], a[60:63], a[144:159]
R 56,3,32768
R 58,3,33280
buffer_load_dwordx4 a[112:115], v103, s[48:51], s83 offen offset:0 sc1
s_waitcnt vmcnt(23)
MS 64,32,64
R 60,6,32768
R 62,6,33280
v_and_b32 v26, 15, v1
MS 80,36,64
s_barrier
R 32,9,14336
R 34,9,14592
s_waitcnt lgkmcnt(6)
v_mfma_f32_32x32x16_bf16 a[144:159], v[40:43], a[64:67], a[144:159]
R 36,3,34816
R 38,3,35328
s_add_u32 m0, s69, 36864
s_add_u32 s75, s60, 3145728
s_waitcnt vmcnt(21)
MS 64,44,68
R 40,6,34816
R 42,6,35328
buffer_load_dwordx4 a[116:119], v103, s[48:51], s83 offen offset:1024 sc1
buffer_load_dwordx4 v15, s[16:19], s75 offen offset:0 lds
MS 80,48,68
R 44,9,15360
R 46,9,15616
v_lshlrev_b32 v26, 4, v26
v_mfma_f32_32x32x16_bf16 a[144:159], v[52:55], a[68:71], a[144:159]
R 48,3,36864
R 50,3,37376
buffer_load_dwordx4 a[120:123], v103, s[48:51], s83 offen offset:2048 sc1
s_waitcnt vmcnt(23) lgkmcnt(6)
MS 64,56,72
R 52,6,36864
R 54,6,37376
v_and_b32 v105, 16, v1
MS 80,60,72
R 56,9,16384
R 58,9,16640
buffer_load_dwordx4 a[124:127], v103, s[48:51], s83 offen offset:3072 sc1
v_mfma_f32_32x32x16_bf16 a[144:159], v[32:35], a[72:75], a[144:159]
R 60,3,38912
R 62,3,39424
v_lshl_add_u32 v26, v105, 6, v26
s_add_u32 s83, s82, 32768
s_waitcnt vmcnt(22)
MS 64,36,76
R 32,6,38912
R 34,6,39424
buffer_load_dwordx4 a[128:131], v103, s[48:51], s83 offen offset:0 sc1
buffer_load_dwordx4 v16, s[16:19], s75 offen offset:1024 lds
s_waitcnt lgkmcnt(6)
MS 80,40,76
R 36,9,17408
R 38,9,17664
v_and_b32 v105, 32, v1
v_mfma_f32_32x32x16_bf16 a[144:159], v[44:47], a[76:79], a[144:159]
R 40,3,40960
R 42,3,41472
v_lshl_add_u32 v26, v105, 4, v26
s_waitcnt vmcnt(22)
MS 64,48,80
R 44,6,40960
R 46,6,41472
buffer_load_dwordx4 v17, s[16:19], s75 offen offset:2048 lds
MS 80,52,80
R 48,9,18432
R 50,9,18688
buffer_load_dwordx4 a[132:135], v103, s[48:51], s83 offen offset:1024 sc1
s_add_u32 m0, s69, 49152
s_add_u32 s75, s60, 3145856
s_waitcnt lgkmcnt(6)
v_mfma_f32_32x32x16_bf16 a[144:159], v[56:59], a[80:83], a[144:159]
R 52,3,43008
R 54,3,43520
buffer_load_dwordx4 v15, s[16:19], s75 offen offset:0 lds
s_waitcnt vmcnt(24)
MS 64,60,84
R 56,6,43008
R 58,6,43520
buffer_load_dwordx4 a[136:139], v103, s[48:51], s83 offen offset:2048 sc1
MS 80,32,84
R 60,9,19456
R 62,9,19712
v_mul_f32 v24, v24, v25
v_mfma_f32_32x32x16_bf16 a[144:159], v[36:39], a[84:87], a[144:159]
R 32,3,57344
R 34,3,57856
buffer_load_dwordx4 a[140:143], v103, s[48:51], s83 offen offset:3072 sc1
s_waitcnt vmcnt(24) lgkmcnt(6)
MS 64,40,88
R 36,6,57344
R 38,6,57856
s_cmp_lt_u32 s56, 2
s_cselect_b32 s71, 1.0, 0
v_mul_f32 v29, s71, v24
MS 80,44,88
R 40,9,45056
R 42,9,45312
v_mfma_f32_32x32x16_bf16 a[144:159], v[48:51], a[88:91], a[144:159]
R 44,3,59392
R 46,3,59904
v_lshlrev_b32 v106, 26, v105
s_waitcnt vmcnt(22)
MS 64,52,92
R 48,6,59392
R 50,6,59904
buffer_load_dwordx4 v16, s[16:19], s75 offen offset:1024 lds
s_waitcnt lgkmcnt(6)
MS 80,56,92
R 52,9,46080
R 54,9,46336
v_and_b32 v105, 31, v1
v_mfma_f32_32x32x16_bf16 a[144:159], v[60:63], a[92:95], a[144:159]
R 56,3,61440
R 58,3,61952
buffer_load_dwordx4 v17, s[16:19], s75 offen offset:2048 lds
s_waitcnt vmcnt(21)
MS 64,32,96
R 60,6,61440
R 62,6,61952
s_add_u32 m0, s69, 61440
s_add_u32 s75, s60, 3145984
MS 80,36,96
R 32,9,47104
R 34,9,47360
buffer_load_dwordx4 v15, s[16:19], s75 offen offset:0 lds
s_waitcnt lgkmcnt(6)
v_mfma_f32_32x32x16_bf16 a[144:159], v[40:43], a[96:99], a[144:159]
R 36,3,63488
R 38,3,64000
v_lshl_add_u32 v106, v105, 3, v106
s_waitcnt vmcnt(21)
MS 64,44,100
R 40,6,63488
R 42,6,64000
v_lshrrev_b32 v109, 1, v105
MS 80,48,100
R 44,9,48128
R 46,9,48384
v_and_b32 v109, 7, v109
v_lshrrev_b32 v108, 5, v1
v_mfma_f32_32x32x16_bf16 a[144:159], v[52:55], a[100:103], a[144:159]
R 48,4,0
R 50,4,512
v_xor_b32 v109, v109, v108
s_waitcnt vmcnt(17) lgkmcnt(6)
MS 64,56,104
R 52,7,0
R 54,7,512
v_lshlrev_b32 v109, 4, v109
MS 80,60,104
R 56,9,49152
R 58,9,49408
v_lshl_add_u32 v108, v105, 7, v109
v_mfma_f32_32x32x16_bf16 a[144:159], v[32:35], a[104:107], a[144:159]
R 60,4,2048
R 62,4,2560
buffer_load_dwordx4 v16, s[16:19], s75 offen offset:1024 lds
s_waitcnt vmcnt(15)
MS 64,36,108
R 32,7,2048
R 34,7,2560
s_add_u32 s71, s68, 147456
v_add_u32 v108, s71, v108
s_waitcnt lgkmcnt(6)
MS 80,40,108
R 36,9,50176
R 38,9,50432
buffer_load_dwordx4 v17, s[16:19], s75 offen offset:2048 lds
v_mfma_f32_32x32x16_bf16 a[144:159], v[44:47], a[108:111], a[144:159]
R 40,4,4096
R 42,4,4608
MS 64,48,112
R 44,7,4096
R 46,7,4608
v_xor_b32 v109, 32, v108
MS 80,52,112
s_barrier
R 48,9,51200
R 50,9,51456
s_waitcnt lgkmcnt(6)
v_mfma_f32_32x32x16_bf16 a[144:159], v[56:59], a[112:115], a[144:159]
R 52,4,6144
R 54,4,6656
s_add_u32 m0, s69, 73728
s_add_u32 s75, s60, 3932160
s_waitcnt vmcnt(13)
MS 64,60,116
R 56,7,6144
R 58,7,6656
buffer_load_dwordx4 v15, s[16:19], s75 offen offset:0 lds
v_xor_b32 v110, 64, v108
MS 80,32,116
R 60,9,52224
R 62,9,52480
v_xor_b32 v111, 96, v108
v_mfma_f32_32x32x16_bf16 a[144:159], v[36:39], a[116:119], a[144:159]
R 32,4,8192
R 34,4,8704
s_lshl_b32 s85, s85, 5
s_add_u32 s85, s85, s82
s_add_u32 s85, s85, 2359296
s_lshl_b32 s87, s56, 11
s_add_u32 s87, s87, s82
s_add_u32 s87, s87, 2392064
s_lshl_b32 s88, s55, 11
s_add_u32 s88, s88, 4718592
s_waitcnt lgkmcnt(6)
MS 64,40,120
R 36,7,8192
R 38,7,8704
MS 80,44,120
R 40,9,53248
R 42,9,53504
v_mfma_f32_32x32x16_bf16 a[144:159], v[48:51], a[120:123], a[144:159]
R 44,4,10240
R 46,4,10752
s_waitcnt vmcnt(11)
MS 64,52,124
R 48,7,10240
R 50,7,10752
buffer_load_dwordx4 v16, s[16:19], s75 offen offset:1024 lds
s_waitcnt lgkmcnt(6)
MS 80,56,124
R 52,9,54272
R 54,9,54528
v_mfma_f32_32x32x16_bf16 a[144:159], v[60:63], a[124:127], a[144:159]
R 56,4,12288
R 58,4,12800
MS 64,32,128
R 60,7,12288
R 62,7,12800
buffer_load_dwordx4 v17, s[16:19], s75 offen offset:2048 lds
MS 80,36,128
R 32,9,55296
R 34,9,55552
s_add_u32 m0, s69, 86016
s_add_u32 s75, s60, 3932288
s_waitcnt lgkmcnt(6)
v_mfma_f32_32x32x16_bf16 a[144:159], v[40:43], a[128:131], a[144:159]
R 36,4,14336
R 38,4,14848
buffer_load_dwordx4 v15, s[16:19], s75 offen offset:0 lds
s_waitcnt vmcnt(9)
MS 64,44,132
R 40,7,14336
R 42,7,14848
MS 80,48,132
R 44,9,56320
R 46,9,56576
v_mfma_f32_32x32x16_bf16 a[144:159], v[52:55], a[132:135], a[144:159]
R 48,2,0
R 50,2,512
s_waitcnt lgkmcnt(6)
MS 64,56,136
R 52,5,0
R 54,5,512
MS 80,60,136
R 56,2,12288
R 58,2,12800
v_mfma_f32_32x32x16_bf16 a[144:159], v[32:35], a[136:139], a[144:159]
R 60,5,12288
R 62,5,12800
ds_read_b128 v[112:115], v108
MS 64,36,140
R 32,2,24576
R 34,2,25088
ds_read_b128 v[116:119], v109
buffer_load_dwordx4 v16, s[16:19], s75 offen offset:1024 lds
s_waitcnt lgkmcnt(8)
MS 80,40,140
R 36,5,24576
R 38,5,25088
ds_read_b128 v[120:123], v110
v_mfma_f32_32x32x16_bf16 a[144:159], v[44:47], a[140:143], a[144:159]
R 40,2,2048
R 42,2,2560
ds_read_b128 v[124:127], v111
buffer_load_dwordx4 v17, s[16:19], s75 offen offset:2048 lds
MA 160,48,184
R 44,5,2048
R 46,5,2560
s_add_u32 m0, s69, 98304
s_add_u32 s75, s60, 3932416
MA 176,52,184
R 48,2,14336
R 50,2,14848
buffer_load_dwordx4 v15, s[16:19], s75 offen offset:0 lds
s_waitcnt lgkmcnt(7)
v_lshlrev_b32 v96, 16, v112
v_and_b32 v97, 0xffff0000, v112
v_lshlrev_b32 v98, 16, v113
v_and_b32 v99, 0xffff0000, v113
v_lshlrev_b32 v19, 16, v114
v_and_b32 v20, 0xffff0000, v114
v_lshlrev_b32 v21, 16, v115
v_and_b32 v22, 0xffff0000, v115
v_fmac_f32 v64, v96, v25
v_fmac_f32 v65, v97, v25
v_fmac_f32 v66, v98, v25
v_fmac_f32 v67, v99, v25
v_fmac_f32 v68, v19, v25
v_fmac_f32 v69, v20, v25
v_fmac_f32 v70, v21, v25
MA 192,56,184
R 52,5,14336
R 54,5,14848
v_fmac_f32 v71, v22, v25
v_add_f32 v64, v64, v24
v_add_f32 v65, v65, v24
v_add_f32 v66, v66, v24
v_add_f32 v67, v67, v24
v_add_f32 v68, v68, v24
v_add_f32 v69, v69, v24
v_add_f32 v70, v70, v24
v_add_f32 v71, v71, v24
v_mov_b32 v104, v64
v_mul_f32 v105, v64, v64
v_add_f32 v104, v104, v65
v_fmac_f32 v105, v65, v65
v_add_f32 v104, v104, v66
v_fmac_f32 v105, v66, v66
MA 208,60,184
R 56,2,26624
R 58,2,27136
v_add_f32 v104, v104, v67
v_fmac_f32 v105, v67, v67
v_add_f32 v104, v104, v68
v_fmac_f32 v105, v68, v68
v_add_f32 v104, v104, v69
v_fmac_f32 v105, v69, v69
v_add_f32 v104, v104, v70
v_fmac_f32 v105, v70, v70
v_add_f32 v104, v104, v71
v_fmac_f32 v105, v71, v71
v_lshlrev_b32 v96, 16, v116
v_and_b32 v97, 0xffff0000, v116
v_lshlrev_b32 v98, 16, v117
v_and_b32 v99, 0xffff0000, v117
v_lshlrev_b32 v19, 16, v118
MA 224,32,184
R 60,5,26624
R 62,5,27136
v_and_b32 v20, 0xffff0000, v118
v_lshlrev_b32 v21, 16, v119
v_and_b32 v22, 0xffff0000, v119
v_fmac_f32 v72, v96, v25
v_fmac_f32 v73, v97, v25
v_fmac_f32 v74, v98, v25
v_fmac_f32 v75, v99, v25
v_fmac_f32 v76, v19, v25
v_fmac_f32 v77, v20, v25
v_fmac_f32 v78, v21, v25
v_fmac_f32 v79, v22, v25
v_add_f32 v72, v72, v24
v_add_f32 v73, v73, v24
v_add_f32 v74, v74, v24
v_add_f32 v75, v75, v24
MA 240,36,184
R 32,2,4096
R 34,2,4608
v_add_f32 v76, v76, v24
v_add_f32 v77, v77, v24
v_add_f32 v78, v78, v24
v_add_f32 v79, v79, v24
v_add_f32 v104, v104, v72
v_fmac_f32 v105, v72, v72
v_add_f32 v104, v104, v73
v_fmac_f32 v105, v73, v73
v_add_f32 v104, v104, v74
v_fmac_f32 v105, v74, v74
v_add_f32 v104, v104, v75
v_fmac_f32 v105, v75, v75
v_add_f32 v104, v104, v76
v_fmac_f32 v105, v76, v76
v_add_f32 v104, v104, v77
v_fmac_f32 v105, v77, v77
s_waitcnt lgkmcnt(2)
MA 160,40,188
R 36,5,4096
R 38,5,4608
v_add_f32 v104, v104, v78
v_fmac_f32 v105, v78, v78
v_add_f32 v104, v104, v79
v_fmac_f32 v105, v79, v79
CV 112,64,65
CV 113,66,67
CV 114,72,73
CV 115,74,75
CV 116,68,69
MA 176,44,188
R 40,2,16384
R 42,2,16896
buffer_store_dwordx4 v[112:115], v26, s[48:51], s85 offen offset:0 sc1
CV 117,70,71
CV 118,76,77
CV 119,78,79
v_lshlrev_b32 v96, 16, v120
v_and_b32 v97, 0xffff0000, v120
v_lshlrev_b32 v98, 16, v121
v_and_b32 v99, 0xffff0000, v121
v_lshlrev_b32 v19, 16, v122
v_and_b32 v20, 0xffff0000, v122
v_lshlrev_b32 v21, 16, v123
MA 192,48,188
R 44,5,16384
R 46,5,16896
buffer_load_dwordx4 v16, s[16:19], s75 offen offset:1024 lds
buffer_store_dwordx4 v[116:119], v26, s[48:51], s85 offen offset:256 sc1
v_and_b32 v22, 0xffff0000, v123
v_fmac_f32 v80, v96, v25
v_fmac_f32 v81, v97, v25
v_fmac_f32 v82, v98, v25
v_fmac_f32 v83, v99, v25
v_fmac_f32 v84, v19, v25
v_fmac_f32 v85, v20, v25
v_fmac_f32 v86, v21, v25
v_fmac_f32 v87, v22, v25
v_add_f32 v80, v80, v24
v_add_f32 v81, v81, v24
v_add_f32 v82, v82, v24
v_add_f32 v83, v83, v24
v_add_f32 v84, v84, v24
MA 208,52,188
R 48,2,28672
R 50,2,29184
v_add_f32 v85, v85, v24
v_add_f32 v86, v86, v24
v_add_f32 v87, v87, v24
v_add_f32 v104, v104, v80
v_fmac_f32 v105, v80, v80
v_add_f32 v104, v104, v81
v_fmac_f32 v105, v81, v81
v_add_f32 v104, v104, v82
v_fmac_f32 v105, v82, v82
v_add_f32 v104, v104, v83
v_fmac_f32 v105, v83, v83
v_add_f32 v104, v104, v84
v_fmac_f32 v105, v84, v84
v_add_f32 v104, v104, v85
v_fmac_f32 v105, v85, v85
v_add_f32 v104, v104, v86
MA 224,56,188
R 52,5,28672
R 54,5,29184
buffer_load_dwordx4 v17, s[16:19], s75 offen offset:2048 lds
v_fmac_f32 v105, v86, v86
v_add_f32 v104, v104, v87
v_fmac_f32 v105, v87, v87
v_lshlrev_b32 v96, 16, v124
v_and_b32 v97, 0xffff0000, v124
v_lshlrev_b32 v98, 16, v125
v_and_b32 v99, 0xffff0000, v125
v_lshlrev_b32 v19, 16, v126
v_and_b32 v20, 0xffff0000, v126
v_lshlrev_b32 v21, 16, v127
v_and_b32 v22, 0xffff0000, v127
v_fmac_f32 v88, v96, v25
v_fmac_f32 v89, v97, v25
v_fmac_f32 v90, v98, v25
MA 240,60,188
R 56,2,6144
R 58,2,6656
v_fmac_f32 v91, v99, v25
v_fmac_f32 v92, v19, v25
v_fmac_f32 v93, v20, v25
v_fmac_f32 v94, v21, v25
v_fmac_f32 v95, v22, v25
v_add_f32 v88, v88, v24
v_add_f32 v89, v89, v24
v_add_f32 v90, v90, v24
v_add_f32 v91, v91, v24
v_add_f32 v92, v92, v24
v_add_f32 v93, v93, v24
v_add_f32 v94, v94, v24
v_add_f32 v95, v95, v24
v_add_f32 v104, v104, v88
v_fmac_f32 v105, v88, v88
s_waitcnt lgkmcnt(2)
MA 160,32,192
R 60,5,6144
R 62,5,6656
v_add_f32 v104, v104, v89
v_fmac_f32 v105, v89, v89
v_add_f32 v104, v104, v90
v_fmac_f32 v105, v90, v90
v_add_f32 v104, v104, v91
v_fmac_f32 v105, v91, v91
v_add_f32 v104, v104, v92
v_fmac_f32 v105, v92, v92
v_add_f32 v104, v104, v93
v_fmac_f32 v105, v93, v93
v_add_f32 v104, v104, v94
v_fmac_f32 v105, v94, v94
v_add_f32 v104, v104, v95
v_fmac_f32 v105, v95, v95
CV 120,80,81
MA 176,36,192
s_waitcnt vmcnt(11)
s_barrier
R 32,2,18432
R 34,2,18944
CV 121,82,83
CV 122,88,89
CV 123,90,91
MA 192,40,192
R 36,5,18432
R 38,5,18944
buffer_store_dwordx4 v[120:123], v26, s[48:51], s85 offen offset:2048 sc1
CV 124,84,85
CV 125,86,87
v_lshrrev_b32 v16, 3, v1
CV 126,92,93
CV 127,94,95
v_accvgpr_read_b32 v64, a144
v_accvgpr_read_b32 v65, a145
v_and_b32 v17, 7, v1
v_accvgpr_read_b32 v66, a146
MA 208,44,192
R 40,2,30720
R 42,2,31232
buffer_store_dwordx4 v[124:127], v26, s[48:51], s85 offen offset:2304 sc1
v_accvgpr_read_b32 v67, a147
v_accvgpr_read_b32 v68, a148
v_accvgpr_read_b32 v69, a149
v_accvgpr_read_b32 v70, a150
v_accvgpr_read_b32 v71, a151
LM_pad5:
s_cbranch_execz LM_pad9
v_accvgpr_read_b32 v72, a152
v_accvgpr_read_b32 v73, a153
v_accvgpr_read_b32 v74, a154
v_accvgpr_read_b32 v75, a155
v_lshlrev_b32 v17, 4, v17
v_accvgpr_read_b32 v76, a156
v_accvgpr_read_b32 v77, a157
v_accvgpr_read_b32 v78, a158
v_accvgpr_read_b32 v79, a159
v_or_b32 v26, s79, v26
v_lshlrev_b32 v96, 16, v128
MA 224,48,192
R 44,5,30720
R 46,5,31232
v_and_b32 v97, 0xffff0000, v128
v_lshlrev_b32 v98, 16, v129
v_and_b32 v99, 0xffff0000, v129
v_lshlrev_b32 v19, 16, v130
v_and_b32 v20, 0xffff0000, v130
v_mul_u32_u24 v15, 9216, v16
v_lshlrev_b32 v21, 16, v131
v_and_b32 v22, 0xffff0000, v131
v_fmac_f32 v64, v96, v25
v_fmac_f32 v65, v97, v25
v_fmac_f32 v66, v98, v25
v_fmac_f32 v67, v99, v25
v_fmac_f32 v68, v19, v25
v_fmac_f32 v69, v20, v25
v_fmac_f32 v70, v21, v25
MA 240,52,192
R 48,2,8192
R 50,2,8704
v_fmac_f32 v71, v22, v25
v_lshlrev_b32 v16, 5, v16
v_add_f32 v64, v64, v29
v_add_f32 v65, v65, v29
v_add_f32 v66, v66, v29
v_add_f32 v67, v67, v29
v_add_f32 v68, v68, v29
v_add_f32 v69, v69, v29
v_add_f32 v70, v70, v29
v_add_f32 v71, v71, v29
v_add_f32 v104, v104, v64
v_fmac_f32 v105, v64, v64
v_and_b32 v16, 64, v16
v_add_f32 v104, v104, v65
v_fmac_f32 v105, v65, v65
s_waitcnt lgkmcnt(2)
MA 160,56,196
R 52,5,8192
R 54,5,8704
v_add_f32 v104, v104, v66
v_fmac_f32 v105, v66, v66
v_add_f32 v104, v104, v67
v_fmac_f32 v105, v67, v67
v_add_f32 v104, v104, v68
v_fmac_f32 v105, v68, v68
v_add_f32 v104, v104, v69
v_fmac_f32 v105, v69, v69
v_xor_b32 v17, v16, v17
v_add_f32 v104, v104, v70
v_fmac_f32 v105, v70, v70
v_add_f32 v104, v104, v71
v_fmac_f32 v105, v71, v71
v_lshlrev_b32 v96, 16, v132
v_and_b32 v97, 0xffff0000, v132
MA 176,60,196
R 56,2,20480
R 58,2,20992
v_lshlrev_b32 v98, 16, v133
v_and_b32 v99, 0xffff0000, v133
v_lshlrev_b32 v19, 16, v134
v_and_b32 v20, 0xffff0000, v134
v_add_u32 v15, v15, v17
v_lshlrev_b32 v21, 16, v135
v_and_b32 v22, 0xffff0000, v135
v_fmac_f32 v72, v96, v25
v_fmac_f32 v73, v97, v25
v_fmac_f32 v74, v98, v25
v_fmac_f32 v75, v99, v25
v_fmac_f32 v76, v19, v25
v_fmac_f32 v77, v20, v25
v_fmac_f32 v78, v21, v25
v_fmac_f32 v79, v22, v25
v_add_u32 v16, 72704, v15
MA 192,32,196
R 60,5,20480
R 62,5,20992
v_add_f32 v72, v72, v29
v_add_f32 v73, v73, v29
v_add_f32 v74, v74, v29
v_add_f32 v75, v75, v29
v_add_f32 v76, v76, v29
v_add_f32 v77, v77, v29
v_add_f32 v78, v78, v29
v_add_f32 v79, v79, v29
v_add_f32 v104, v104, v72
v_fmac_f32 v105, v72, v72
v_add_u32 v17, 145408, v15
v_add_f32 v104, v104, v73
v_fmac_f32 v105, v73, v73
v_add_f32 v104, v104, v74
v_fmac_f32 v105, v74, v74
s_add_u32 s100, s100, 4096
s_addc_u32 s101, s101, 0
MA 208,36,196
R 32,2,32768
R 34,2,33280
global_load_dword v0, v23, s[100:101]
v_add_f32 v104, v104, v75
v_fmac_f32 v105, v75, v75
v_add_f32 v104, v104, v76
v_fmac_f32 v105, v76, v76
v_add_f32 v104, v104, v77
v_fmac_f32 v105, v77, v77
v_add_u32 v18, 218112, v15
v_add_f32 v104, v104, v78
v_fmac_f32 v105, v78, v78
v_add_f32 v104, v104, v79
v_fmac_f32 v105, v79, v79
CV 128,64,65
CV 129,66,67
CV 130,72,73
CV 131,74,75
MA 224,40,196
R 36,5,32768
R 38,5,33280
CV 132,68,69
CV 133,70,71
CV 134,76,77
CV 135,78,79
s_add_u32 m0, s67, 110592
s_add_u32 s75, s61, 0
MA 240,44,196
R 40,2,10240
R 42,2,10752
buffer_load_dwordx4 v15, s[32:35], s75 offen offset:0 lds
buffer_store_dwordx4 v[128:131], v26, s[48:51], s87 offen offset:0 sc1
buffer_store_dwordx4 v[132:135], v26, s[48:51], s87 offen offset:256 sc1
v_mov_b32 v96, v104
v_mov_b32 v97, v105
s_nop 0
v_permlane32_swap_b32 v104, v96
v_permlane32_swap_b32 v105, v97
v_add_f32 v104, v104, v96
v_add_f32 v105, v105, v97
s_lshl_b32 s71, s56, 8
s_add_u32 s71, s71, s88
s_waitcnt lgkmcnt(4)
MA 160,48,200
R 44,5,10240
R 46,5,10752
buffer_store_dwordx2 v[104:105], v106, s[48:51], s71 offen sc1
MA 176,52,200
R 48,2,22528
R 50,2,23040
MA 192,56,200
R 52,5,22528
R 54,5,23040
MA 208,60,200
R 56,2,34816
R 58,2,35328
v_and_b32 v100, 31, v1
v_lshlrev_b32 v100, 3, v100
MA 224,32,200
R 60,5,34816
R 62,5,35328
buffer_load_dwordx4 v16, s[32:35], s75 offen offset:1024 lds
s_waitcnt lgkmcnt(6)
MA 240,36,200
R 32,2,36864
R 34,2,37376
buffer_load_dwordx4 v17, s[32:35], s75 offen offset:2048 lds
v_and_b32 v101, 32, v1
MA 160,40,204
R 36,5,36864
R 38,5,37376
v_lshl_add_u32 v100, v101, 5, v100
v_mov_b32 v27, 0x409d30fc
MA 176,44,204
R 40,2,49152
R 42,2,49664
buffer_load_dwordx4 v18, s[32:35], s75 offen offset:3072 lds
MA 192,48,204
R 44,5,49152
R 46,5,49664
s_add_u32 m0, s67, 114688
s_add_u32 s75, s61, 294912
s_waitcnt lgkmcnt(6)
MA 208,52,204
R 48,2,61440
R 50,2,61952
buffer_load_dwordx4 v15, s[32:35], s75 offen offset:0 lds
v_mov_b32 v28, 0xbeeff558
MA 224,56,204
R 52,5,61440
R 54,5,61952
v_and_b32 v29, 0x7fffffff, v26
MA 240,60,204
R 56,2,38912
R 58,2,39424
v_lshlrev_b32 v102, 3, v101
v_sub_u32 v29, v29, v102
MA 160,32,208
R 60,5,38912
R 62,5,39424
v_lshlrev_b32 v101, 4, v101
v_sub_u32 v8, v3, v101
s_waitcnt lgkmcnt(6)
MA 176,36,208
R 32,2,51200
R 34,2,51712
v_sub_u32 v9, v6, v101
MA 192,40,208
R 36,5,51200
R 38,5,51712
buffer_load_dwordx4 v16, s[32:35], s75 offen offset:1024 lds
MA 208,44,208
R 40,2,63488
R 42,2,64000
MA 224,48,208
R 44,5,63488
R 46,5,64000
buffer_load_dwordx4 v17, s[32:35], s75 offen offset:2048 lds
s_waitcnt lgkmcnt(6)
MA 240,52,208
R 48,2,40960
R 50,2,41472
s_add_u32 s74, s80, 8192
s_waitcnt vmcnt(6)
MA 160,56,212
R 52,5,40960
R 54,5,41472
buffer_store_dword v3, v30, s[48:51], s74 offen sc1
buffer_load_dwordx4 v18, s[32:35], s75 offen offset:3072 lds
s_add_u32 m0, s67, 118784
s_add_u32 s75, s61, 589824
MA 176,60,212
R 56,2,53248
R 58,2,53760
buffer_load_dwordx4 v15, s[32:35], s75 offen offset:0 lds
MA 192,32,212
R 60,5,53248
R 62,5,53760
s_waitcnt lgkmcnt(6)
MA 208,36,212
R 32,3,0
R 34,3,512
MA 224,40,212
R 36,6,0
R 38,6,512
MA 240,44,212
R 40,2,43008
R 42,2,43520
MA 160,48,216
R 44,5,43008
R 46,5,43520
s_waitcnt lgkmcnt(8)
MA 176,52,216
s_barrier
R 48,2,55296
R 50,2,55808
MA 192,56,216
R 52,5,55296
R 54,5,55808
s_add_u32 m0, s67, 0
s_add_u32 s75, s61, 2654208
MA 208,60,216
R 56,3,2048
R 58,3,2560
buffer_load_dwordx4 v15, s[32:35], s75 offen offset:0 lds
s_waitcnt lgkmcnt(6)
MA 224,32,216
R 60,6,2048
R 62,6,2560
MA 240,36,216
R 32,2,45056
R 34,2,45568
MA 160,40,220
R 36,5,45056
R 38,5,45568
MA 176,44,220
R 40,2,57344
R 42,2,57856
s_waitcnt lgkmcnt(8)
MA 192,48,220
R 44,5,57344
R 46,5,57856
MA 208,52,220
R 48,3,4096
R 50,3,4608
buffer_load_dwordx4 v16, s[32:35], s75 offen offset:1024 lds
MA 224,56,220
R 52,6,4096
R 54,6,4608
s_waitcnt lgkmcnt(6)
MA 240,60,220
R 56,2,47104
R 58,2,47616
MA 160,32,224
R 60,5,47104
R 62,5,47616
buffer_load_dwordx4 v17, s[32:35], s75 offen offset:2048 lds
MA 176,36,224
R 32,2,59392
R 34,2,59904
MA 192,40,224
R 36,5,59392
R 38,5,59904
buffer_load_dwordx4 v18, s[32:35], s75 offen offset:3072 lds
s_waitcnt lgkmcnt(6)
MA 208,44,224
R 40,3,6144
R 42,3,6656
s_add_u32 m0, s67, 4096
s_add_u32 s75, s61, 2949120
MA 224,48,224
R 44,6,6144
R 46,6,6656
buffer_load_dwordx4 v15, s[32:35], s75 offen offset:0 lds
MA 240,52,224
R 48,3,8192
R 50,3,8704
MA 160,56,228
R 52,6,8192
R 54,6,8704
s_waitcnt lgkmcnt(6)
MA 176,60,228
R 56,3,20480
R 58,3,20992
MA 192,32,228
R 60,6,20480
R 62,6,20992
s_mov_b32 s81, 42606592
MA 208,36,228
R 32,3,32768
R 34,3,33280
buffer_load_dword v31, v107, s[48:51], s81 offen sc1
MA 224,40,228
R 36,6,32768
R 38,6,33280
s_waitcnt lgkmcnt(6)
MA 240,44,228
R 40,3,10240
R 42,3,10752
buffer_load_dwordx4 v16, s[32:35], s75 offen offset:1024 lds
MA 160,48,232
R 44,6,10240
R 46,6,10752
MA 176,52,232
R 48,3,22528
R 50,3,23040
buffer_load_dwordx4 v17, s[32:35], s75 offen offset:2048 lds
MA 192,56,232
R 52,6,22528
R 54,6,23040
s_waitcnt lgkmcnt(6)
MA 208,60,232
R 56,3,34816
R 58,3,35328
buffer_load_dwordx4 v18, s[32:35], s75 offen offset:3072 lds
MA 224,32,232
R 60,6,34816
R 62,6,35328
MA 240,36,232
R 32,3,12288
R 34,3,12800
s_add_u32 m0, s67, 8192
s_add_u32 s75, s61, 3244032
MA 160,40,236
R 36,6,12288
R 38,6,12800
buffer_load_dwordx4 v15, s[32:35], s75 offen offset:0 lds
s_waitcnt lgkmcnt(6)
MA 176,44,236
R 40,3,24576
R 42,3,25088
MA 192,48,236
R 44,6,24576
R 46,6,25088
MA 208,52,236
R 48,3,36864
R 50,3,37376
MA 224,56,236
R 52,6,36864
R 54,6,37376
s_waitcnt vmcnt(4)
v_cmp_ne_u32 vcc, 0x10000, v31
s_nop 1
s_cbranch_vccnz LM_poll2
LM_ok2:
s_waitcnt lgkmcnt(6)
MA 240,60,236
R 56,3,14336
R 58,3,14848
buffer_load_dwordx2 v[64:65], v100, s[48:51], s88 offen offset:0 sc1
MA 160,32,240
R 60,6,14336
R 62,6,14848
buffer_load_dwordx2 v[66:67], v100, s[48:51], s88 offen offset:256 sc1
MA 176,36,240
s_barrier
R 32,3,26624
R 34,3,27136
buffer_load_dwordx2 v[68:69], v100, s[48:51], s88 offen offset:512 sc1
MA 192,40,240
R 36,6,26624
R 38,6,27136
buffer_load_dwordx2 v[70:71], v100, s[48:51], s88 offen offset:768 sc1
s_add_u32 s83, s82, 2359296
s_add_u32 m0, s67, 36864
s_add_u32 s75, s61, 128
s_waitcnt lgkmcnt(6)
MA 208,44,240
R 40,3,38912
R 42,3,39424
buffer_load_dwordx4 v[112:115], v29, s[48:51], s83 offen offset:0 sc1
buffer_load_dwordx4 v15, s[32:35], s75 offen offset:0 lds
MA 224,48,240
R 44,6,38912
R 46,6,39424
MA 240,52,240
R 48,3,16384
R 50,3,16896
buffer_load_dwordx4 v[116:119], v29, s[48:51], s83 offen offset:512 sc1
MA 160,56,244
R 52,6,16384
R 54,6,16896
buffer_load_dwordx4 v[120:123], v29, s[48:51], s83 offen offset:2048 sc1
s_waitcnt lgkmcnt(6)
MA 176,60,244
R 56,3,28672
R 58,3,29184
buffer_load_dwordx4 v[124:127], v29, s[48:51], s83 offen offset:2560 sc1
s_add_u32 s83, s82, 2363392
MA 192,32,244
R 60,6,28672
R 62,6,29184
buffer_load_dwordx4 v[128:131], v29, s[48:51], s83 offen offset:0 sc1
MA 208,36,244
R 32,3,40960
R 34,3,41472
buffer_load_dwordx4 v16, s[32:35], s75 offen offset:1024 lds
MA 224,40,244
R 36,6,40960
R 38,6,41472
s_waitcnt lgkmcnt(6)
MA 240,44,244
R 40,3,18432
R 42,3,18944
buffer_load_dwordx4 v[132:135], v29, s[48:51], s83 offen offset:512 sc1
MA 160,48,248
R 44,6,18432
R 46,6,18944
buffer_load_dwordx4 v[136:139], v29, s[48:51], s83 offen offset:2048 sc1
buffer_load_dwordx4 v17, s[32:35], s75 offen offset:2048 lds
MA 176,52,248
R 48,3,30720
R 50,3,31232
buffer_load_dwordx4 v[140:143], v29, s[48:51], s83 offen offset:2560 sc1
s_add_u32 s83, s82, 2367488
MA 192,56,248
R 52,6,30720
R 54,6,31232
buffer_load_dwordx4 v[144:147], v29, s[48:51], s83 offen offset:0 sc1
buffer_load_dwordx4 v18, s[32:35], s75 offen offset:3072 lds
s_waitcnt lgkmcnt(6)
MA 208,60,248
R 56,3,43008
R 58,3,43520
s_add_u32 m0, s67, 40960
s_add_u32 s75, s61, 295040
MA 224,32,248
R 60,6,43008
R 62,6,43520
buffer_load_dwordx4 v[148:151], v29, s[48:51], s83 offen offset:512 sc1
buffer_load_dwordx4 v15, s[32:35], s75 offen offset:0 lds
MA 240,36,248
R 32,8,45056
R 34,8,47104
buffer_load_dwordx4 v[152:155], v29, s[48:51], s83 offen offset:2048 sc1
MA 160,40,252
R 36,9,45056
R 38,9,47104
buffer_load_dwordx4 v[156:159], v29, s[48:51], s83 offen offset:2560 sc1
s_waitcnt lgkmcnt(6)
MA 176,44,252
R 40,8,46080
R 42,8,48128
MA 192,48,252
R 44,9,46080
R 46,9,48128
s_add_u32 s83, s82, 2371584
MA 208,52,252
R 48,8,49152
R 50,8,51200
buffer_load_dwordx4 v[160:163], v29, s[48:51], s83 offen offset:0 sc1
MA 224,56,252
R 52,9,49152
R 54,9,51200
s_waitcnt vmcnt(20)
v_add_f32 v64, v64, v66
v_add_f32 v65, v65, v67
s_waitcnt vmcnt(18)
v_add_f32 v68, v68, v70
v_add_f32 v69, v69, v71
v_add_f32 v64, v64, v68
v_add_f32 v65, v65, v69
v_mov_b32 v66, v64
v_mov_b32 v67, v65
s_nop 0
v_permlane32_swap_b32 v64, v66
v_permlane32_swap_b32 v65, v67
v_add_f32 v64, v64, v66
v_add_f32 v65, v65, v67
v_mul_f32 v64, 0xbae38e39, v64
v_mul_f32 v65, 0x3ae38e39, v65
v_fma_f32 v65, -v64, v64, v65
v_max_f32 v65, 0, v65
v_add_f32 v65, 0x3727c5ac, v65
v_rsq_f32 v65, v65
s_nop 0
v_mul_f32 v24, 0xbeeff558, v65
v_cvt_pk_bf16_f32 v26, v24, 0
v_lshlrev_b32 v24, 16, v26
v_mul_f32 v25, v64, v24
s_waitcnt vmcnt(17)
v_dot2_f32_bf16 v64, v112, v26, v25
v_dot2_f32_bf16 v65, v112, v24, v25
v_dot2_f32_bf16 v66, v113, v26, v25
v_dot2_f32_bf16 v67, v113, v24, v25
v_dot2_f32_bf16 v68, v114, v26, v25
v_dot2_f32_bf16 v69, v114, v24, v25
v_dot2_f32_bf16 v70, v115, v26, v25
v_dot2_f32_bf16 v71, v115, v24, v25
s_waitcnt lgkmcnt(0)
MA 240,60,252
R 56,8,50176
R 58,8,52224
buffer_load_dwordx4 v[164:167], v29, s[48:51], s83 offen offset:512 sc1
buffer_load_dwordx4 v16, s[32:35], s75 offen offset:1024 lds
CV 112,64,65
CV 113,66,67
CV 114,68,69
CV 115,70,71
s_waitcnt vmcnt(17)
v_dot2_f32_bf16 v64, v116, v26, v25
v_dot2_f32_bf16 v65, v116, v24, v25
v_dot2_f32_bf16 v66, v117, v26, v25
v_dot2_f32_bf16 v67, v117, v24, v25
v_dot2_f32_bf16 v68, v118, v26, v25
v_dot2_f32_bf16 v69, v118, v24, v25
v_dot2_f32_bf16 v70, v119, v26, v25
v_dot2_f32_bf16 v71, v119, v24, v25
v_mfma_f32_32x32x16_bf16 v[80:95], v[32:35], v[112:115], 0
R 60,9,50176
R 62,9,52224
buffer_load_dwordx4 v[168:171], v29, s[48:51], s83 offen offset:2048 sc1
CV 116,64,65
v_add_u32 v2, 0x10000, v8
CV 117,66,67
CV 118,68,69
CV 119,70,71
v_add_u32 v5, 0x10000, v9
v_mfma_f32_32x32x16_bf16 v[96:111], v[36:39], v[112:115], 0
R 32,8,53248
R 34,8,55296
buffer_load_dwordx4 v[172:175], v29, s[48:51], s83 offen offset:2560 sc1
buffer_load_dwordx4 v17, s[32:35], s75 offen offset:2048 lds
s_waitcnt vmcnt(19)
v_dot2_f32_bf16 v64, v120, v26, v25
v_dot2_f32_bf16 v65, v120, v24, v25
v_dot2_f32_bf16 v66, v121, v26, v25
v_dot2_f32_bf16 v67, v121, v24, v25
v_dot2_f32_bf16 v68, v122, v26, v25
v_dot2_f32_bf16 v69, v122, v24, v25
v_dot2_f32_bf16 v70, v123, v26, v25
v_dot2_f32_bf16 v71, v123, v24, v25
s_add_u32 s83, s82, 2375680
MV 80,40,116
R 36,9,53248
R 38,9,55296
buffer_load_dwordx4 v[176:179], v29, s[48:51], s83 offen offset:0 sc1
CV 120,64,65
v_accvgpr_read_b32 v19, a160
CV 121,66,67
v_accvgpr_read_b32 v20, a161
LM_pad6:
s_cbranch_execz LM_pad10
CV 122,68,69
v_add_u32 v4, 0xffff0000, v8
CV 123,70,71
v_accvgpr_read_b32 v21, a162
MV 96,44,116
R 40,8,54272
R 42,8,56320
buffer_load_dwordx4 v18, s[32:35], s75 offen offset:3072 lds
v_accvgpr_read_b32 v22, a163
CV 72,19,20
v_add_u32 v7, 0xffff0000, v9
CV 73,21,22
v_accvgpr_read_b32 v19, a164
v_accvgpr_read_b32 v20, a165
v_accvgpr_read_b32 v21, a166
s_waitcnt vmcnt(20)
v_dot2_f32_bf16 v64, v124, v26, v25
v_dot2_f32_bf16 v65, v124, v24, v25
v_dot2_f32_bf16 v66, v125, v26, v25
v_dot2_f32_bf16 v67, v125, v24, v25
v_dot2_f32_bf16 v68, v126, v26, v25
v_dot2_f32_bf16 v69, v126, v24, v25
v_dot2_f32_bf16 v70, v127, v26, v25
v_dot2_f32_bf16 v71, v127, v24, v25
MV 80,48,120
R 44,9,54272
R 46,9,56320
buffer_load_dwordx4 v[180:183], v29, s[48:51], s83 offen offset:512 sc1
CV 124,64,65
v_accvgpr_read_b32 v22, a167
CV 125,66,67
CV 74,19,20
CV 126,68,69
CV 127,70,71
CV 75,21,22
MV 96,52,120
R 48,8,57344
R 50,8,59392
v_accvgpr_read_b32 v19, a168
v_accvgpr_read_b32 v20, a169
v_accvgpr_read_b32 v21, a170
v_accvgpr_read_b32 v22, a171
CV 76,19,20
CV 77,21,22
v_accvgpr_read_b32 v19, a172
s_waitcnt vmcnt(20)
v_dot2_f32_bf16 v64, v128, v26, v25
v_dot2_f32_bf16 v65, v128, v24, v25
v_dot2_f32_bf16 v66, v129, v26, v25
v_dot2_f32_bf16 v67, v129, v24, v25
v_dot2_f32_bf16 v68, v130, v26, v25
v_dot2_f32_bf16 v69, v130, v24, v25
v_dot2_f32_bf16 v70, v131, v26, v25
v_dot2_f32_bf16 v71, v131, v24, v25
s_add_u32 m0, s67, 45056
s_add_u32 s75, s61, 589952
s_waitcnt lgkmcnt(2)
MV 80,56,124
R 52,9,57344
R 54,9,59392
buffer_load_dwordx4 v[184:187], v29, s[48:51], s83 offen offset:2048 sc1
buffer_load_dwordx4 v15, s[32:35], s75 offen offset:0 lds
CV 128,64,65
v_accvgpr_read_b32 v20, a173
CV 129,66,67
CV 130,68,69
v_accvgpr_read_b32 v21, a174
CV 131,70,71
MV 96,60,124
R 56,8,58368
R 58,8,60416
buffer_load_dwordx4 v[188:191], v29, s[48:51], s83 offen offset:2560 sc1
v_accvgpr_read_b32 v22, a175
CV 78,19,20
CV 79,21,22
v_permlane16_swap_b32 v72, v76
v_permlane16_swap_b32 v73, v77
v_permlane16_swap_b32 v74, v78
v_permlane16_swap_b32 v75, v79
s_waitcnt vmcnt(21)
v_dot2_f32_bf16 v64, v132, v26, v25
v_dot2_f32_bf16 v65, v132, v24, v25
v_dot2_f32_bf16 v66, v133, v26, v25
v_dot2_f32_bf16 v67, v133, v24, v25
v_dot2_f32_bf16 v68, v134, v26, v25
v_dot2_f32_bf16 v69, v134, v24, v25
v_dot2_f32_bf16 v70, v135, v26, v25
v_dot2_f32_bf16 v71, v135, v24, v25
s_add_u32 s83, s82, 2379776
MV 80,32,128
R 60,9,58368
R 62,9,60416
buffer_load_dwordx4 v[192:195], v29, s[48:51], s83 offen offset:0 sc1
CV 132,64,65
CV 133,66,67
CV 134,68,69
CV 135,70,71
s_add_u32 s84, s78, 4849664
s_add_u32 s100, s100, 4096
s_addc_u32 s101, s101, 0
MV 96,36,128
R 32,8,61440
R 34,8,63488
global_load_dword v0, v23, s[100:101]
buffer_store_dwordx4 v[72:75], v23, s[48:51], s84 offen offset:0 sc1
s_waitcnt vmcnt(23)
v_dot2_f32_bf16 v64, v136, v26, v25
v_dot2_f32_bf16 v65, v136, v24, v25
v_dot2_f32_bf16 v66, v137, v26, v25
v_dot2_f32_bf16 v67, v137, v24, v25
v_dot2_f32_bf16 v68, v138, v26, v25
v_dot2_f32_bf16 v69, v138, v24, v25
v_dot2_f32_bf16 v70, v139, v26, v25
v_dot2_f32_bf16 v71, v139, v24, v25
MV 80,40,132
R 36,9,61440
R 38,9,63488
buffer_load_dwordx4 v[196:199], v29, s[48:51], s83 offen offset:512 sc1
buffer_store_dwordx4 v[76:79], v23, s[48:51], s84 offen offset:1024 sc1
CV 136,64,65
CV 137,66,67
v_accvgpr_read_b32 v19, a176
CV 138,68,69
v_accvgpr_read_b32 v20, a177
CV 139,70,71
v_accvgpr_read_b32 v21, a178
MV 96,44,132
R 40,8,62464
R 42,8,64512
buffer_load_dwordx4 v[200:203], v29, s[48:51], s83 offen offset:2048 sc1
v_accvgpr_read_b32 v22, a179
CV 72,19,20
CV 73,21,22
v_accvgpr_read_b32 v19, a180
v_accvgpr_read_b32 v20, a181
v_accvgpr_read_b32 v21, a182
v_accvgpr_read_b32 v22, a183
s_waitcnt vmcnt(22)
v_dot2_f32_bf16 v64, v140, v26, v25
v_dot2_f32_bf16 v65, v140, v24, v25
v_dot2_f32_bf16 v66, v141, v26, v25
v_dot2_f32_bf16 v67, v141, v24, v25
v_dot2_f32_bf16 v68, v142, v26, v25
v_dot2_f32_bf16 v69, v142, v24, v25
v_dot2_f32_bf16 v70, v143, v26, v25
v_dot2_f32_bf16 v71, v143, v24, v25
s_waitcnt lgkmcnt(2)
MV 80,48,136
R 44,9,62464
R 46,9,64512
buffer_load_dwordx4 v[204:207], v29, s[48:51], s83 offen offset:2560 sc1
CV 140,64,65
CV 74,19,20
CV 141,66,67
CV 75,21,22
CV 142,68,69
v_accvgpr_read_b32 v19, a184
CV 143,70,71
MV 96,52,136
s_barrier
R 48,2,0
R 50,2,2048
v_dot2_f32_bf16 v64, v144, v26, v25
v_dot2_f32_bf16 v65, v144, v24, v25
v_dot2_f32_bf16 v66, v145, v26, v25
v_dot2_f32_bf16 v67, v145, v24, v25
v_dot2_f32_bf16 v68, v146, v26, v25
v_dot2_f32_bf16 v69, v146, v24, v25
v_dot2_f32_bf16 v70, v147, v26, v25
v_dot2_f32_bf16 v71, v147, v24, v25
s_add_u32 s83, s82, 2383872
MV 80,56,140
R 52,5,0
R 54,5,2048
buffer_load_dwordx4 v[208:211], v29, s[48:51], s83 offen offset:0 sc1
CV 144,64,65
v_accvgpr_read_b32 v20, a185
CV 145,66,67
CV 146,68,69
v_accvgpr_read_b32 v21, a186
CV 147,70,71
s_add_u32 m0, s67, 73728
s_add_u32 s75, s61, 2654336
MV 96,60,140
R 56,2,1024
R 58,2,3072
buffer_load_dwordx4 v15, s[32:35], s75 offen offset:0 lds
v_accvgpr_read_b32 v22, a187
CV 76,19,20
CV 77,21,22
v_accvgpr_read_b32 v19, a188
v_accvgpr_read_b32 v20, a189
v_accvgpr_read_b32 v21, a190
v_accvgpr_read_b32 v22, a191
s_waitcnt vmcnt(20)
v_dot2_f32_bf16 v64, v148, v26, v25
v_dot2_f32_bf16 v65, v148, v24, v25
v_dot2_f32_bf16 v66, v149, v26, v25
v_dot2_f32_bf16 v67, v149, v24, v25
v_dot2_f32_bf16 v68, v150, v26, v25
v_dot2_f32_bf16 v69, v150, v24, v25
v_dot2_f32_bf16 v70, v151, v26, v25
v_dot2_f32_bf16 v71, v151, v24, v25
MV 80,32,144
R 60,5,1024
R 62,5,3072
buffer_load_dwordx4 v[212:215], v29, s[48:51], s83 offen offset:512 sc1
CV 78,19,20
CV 148,64,65
CV 149,66,67
CV 79,21,22
CV 150,68,69
v_permlane16_swap_b32 v72, v76
CV 151,70,71
v_permlane16_swap_b32 v73, v77
MV 96,36,144
R 32,2,4096
R 34,2,6144
buffer_load_dwordx4 v[216:219], v29, s[48:51], s83 offen offset:2048 sc1
v_permlane16_swap_b32 v74, v78
v_permlane16_swap_b32 v75, v79
v_dot2_f32_bf16 v64, v152, v26, v25
v_dot2_f32_bf16 v65, v152, v24, v25
v_dot2_f32_bf16 v66, v153, v26, v25
v_dot2_f32_bf16 v67, v153, v24, v25
v_dot2_f32_bf16 v68, v154, v26, v25
v_dot2_f32_bf16 v69, v154, v24, v25
v_dot2_f32_bf16 v70, v155, v26, v25
v_dot2_f32_bf16 v71, v155, v24, v25
s_waitcnt lgkmcnt(4)
MV 80,40,148
R 36,5,4096
R 38,5,6144
buffer_load_dwordx4 v[220:223], v29, s[48:51], s83 offen offset:2560 sc1
buffer_store_dwordx4 v[72:75], v23, s[48:51], s84 offen offset:2048 sc1
CV 152,64,65
CV 153,66,67
CV 154,68,69
CV 155,70,71
s_add_u32 s83, s82, 2387968
MV 96,44,148
R 40,2,5120
R 42,2,7168
buffer_load_dwordx4 v[224:227], v29, s[48:51], s83 offen offset:0 sc1
buffer_store_dwordx4 v[76:79], v23, s[48:51], s84 offen offset:3072 sc1
v_accvgpr_read_b32 v19, a192
v_accvgpr_read_b32 v20, a193
v_accvgpr_read_b32 v21, a194
v_accvgpr_read_b32 v22, a195
v_dot2_f32_bf16 v64, v156, v26, v25
v_dot2_f32_bf16 v65, v156, v24, v25
v_dot2_f32_bf16 v66, v157, v26, v25
v_dot2_f32_bf16 v67, v157, v24, v25
v_dot2_f32_bf16 v68, v158, v26, v25
v_dot2_f32_bf16 v69, v158, v24, v25
v_dot2_f32_bf16 v70, v159, v26, v25
v_dot2_f32_bf16 v71, v159, v24, v25
MV 80,48,152
R 44,5,5120
R 46,5,7168
CV 156,64,65
CV 72,19,20
CV 157,66,67
CV 73,21,22
CV 158,68,69
v_accvgpr_read_b32 v19, a196
CV 159,70,71
v_accvgpr_read_b32 v20, a197
MV 96,52,152
R 48,2,8192
R 50,2,10240
buffer_load_dwordx4 v[228:231], v29, s[48:51], s83 offen offset:512 sc1
buffer_load_dwordx4 v16, s[32:35], s75 offen offset:1024 lds
v_accvgpr_read_b32 v21, a198
v_accvgpr_read_b32 v22, a199
CV 74,19,20
CV 75,21,22
v_accvgpr_read_b32 v19, a200
v_accvgpr_read_b32 v20, a201
v_dot2_f32_bf16 v64, v160, v26, v25
v_dot2_f32_bf16 v65, v160, v24, v25
v_dot2_f32_bf16 v66, v161, v26, v25
v_dot2_f32_bf16 v67, v161, v24, v25
v_dot2_f32_bf16 v68, v162, v26, v25
v_dot2_f32_bf16 v69, v162, v24, v25
v_dot2_f32_bf16 v70, v163, v26, v25
v_dot2_f32_bf16 v71, v163, v24, v25
MV 80,56,156
R 52,5,8192
R 54,5,10240
v_accvgpr_read_b32 v21, a202
CV 160,64,65
v_accvgpr_read_b32 v22, a203
CV 161,66,67
CV 76,19,20
CV 162,68,69
CV 77,21,22
CV 163,70,71
v_accvgpr_read_b32 v19, a204
s_waitcnt lgkmcnt(2)
MV 96,60,156
R 56,2,9216
R 58,2,11264
buffer_load_dwordx4 v[232:235], v29, s[48:51], s83 offen offset:2048 sc1
v_accvgpr_read_b32 v20, a205
v_accvgpr_read_b32 v21, a206
v_accvgpr_read_b32 v22, a207
CV 78,19,20
CV 79,21,22
v_permlane16_swap_b32 v72, v76
v_permlane16_swap_b32 v73, v77
s_waitcnt vmcnt(21)
v_dot2_f32_bf16 v64, v164, v26, v25
v_dot2_f32_bf16 v65, v164, v24, v25
v_dot2_f32_bf16 v66, v165, v26, v25
v_dot2_f32_bf16 v67, v165, v24, v25
v_dot2_f32_bf16 v68, v166, v26, v25
v_dot2_f32_bf16 v69, v166, v24, v25
v_dot2_f32_bf16 v70, v167, v26, v25
v_dot2_f32_bf16 v71, v167, v24, v25
MV 80,32,160
R 60,5,9216
R 62,5,11264
buffer_load_dwordx4 v[236:239], v29, s[48:51], s83 offen offset:2560 sc1
buffer_load_dwordx4 v17, s[32:35], s75 offen offset:2048 lds
CV 164,64,65
CV 165,66,67
v_permlane16_swap_b32 v74, v78
CV 166,68,69
CV 167,70,71
s_add_u32 s83, s82, 2392064
MV 96,36,160
R 32,2,12288
R 34,2,14336
buffer_load_dwordx4 v[240:243], v29, s[48:51], s83 offen offset:0 sc1
v_permlane16_swap_b32 v75, v79
v_dot2_f32_bf16 v64, v168, v26, v25
v_dot2_f32_bf16 v65, v168, v24, v25
v_dot2_f32_bf16 v66, v169, v26, v25
v_dot2_f32_bf16 v67, v169, v24, v25
v_dot2_f32_bf16 v68, v170, v26, v25
v_dot2_f32_bf16 v69, v170, v24, v25
v_dot2_f32_bf16 v70, v171, v26, v25
v_dot2_f32_bf16 v71, v171, v24, v25
s_add_u32 s84, s78, 4853760
MV 80,40,164
R 36,5,12288
R 38,5,14336
buffer_load_dwordx4 v18, s[32:35], s75 offen offset:3072 lds
buffer_store_dwordx4 v[72:75], v23, s[48:51], s84 offen offset:0 sc1
CV 168,64,65
CV 169,66,67
CV 170,68,69
CV 171,70,71
MV 96,44,164
R 40,2,13312
R 42,2,15360
buffer_load_dwordx4 v[244:247], v29, s[48:51], s83 offen offset:512 sc1
buffer_store_dwordx4 v[76:79], v23, s[48:51], s84 offen offset:1024 sc1
v_accvgpr_read_b32 v19, a208
v_accvgpr_read_b32 v20, a209
v_accvgpr_read_b32 v21, a210
v_accvgpr_read_b32 v22, a211
v_dot2_f32_bf16 v64, v172, v26, v25
v_dot2_f32_bf16 v65, v172, v24, v25
v_dot2_f32_bf16 v66, v173, v26, v25
v_dot2_f32_bf16 v67, v173, v24, v25
v_dot2_f32_bf16 v68, v174, v26, v25
v_dot2_f32_bf16 v69, v174, v24, v25
v_dot2_f32_bf16 v70, v175, v26, v25
v_dot2_f32_bf16 v71, v175, v24, v25
s_add_u32 m0, s67, 77824
s_add_u32 s75, s61, 2949248
MV 80,48,168
R 44,5,13312
R 46,5,15360
buffer_load_dwordx4 v[248:251], v29, s[48:51], s83 offen offset:2048 sc1
buffer_load_dwordx4 v15, s[32:35], s75 offen offset:0 lds
CV 172,64,65
CV 72,19,20
CV 173,66,67
CV 174,68,69
CV 73,21,22
CV 175,70,71
s_waitcnt lgkmcnt(3)
MV 96,52,168
R 48,4,0
R 50,4,2048
buffer_load_dwordx4 v[252:255], v29, s[48:51], s83 offen offset:2560 sc1
v_accvgpr_read_b32 v19, a212
v_accvgpr_read_b32 v20, a213
v_accvgpr_read_b32 v21, a214
v_accvgpr_read_b32 v22, a215
CV 74,19,20
CV 75,21,22
v_accvgpr_read_b32 v19, a216
v_dot2_f32_bf16 v64, v176, v26, v25
v_dot2_f32_bf16 v65, v176, v24, v25
v_dot2_f32_bf16 v66, v177, v26, v25
v_dot2_f32_bf16 v67, v177, v24, v25
v_dot2_f32_bf16 v68, v178, v26, v25
v_dot2_f32_bf16 v69, v178, v24, v25
v_dot2_f32_bf16 v70, v179, v26, v25
v_dot2_f32_bf16 v71, v179, v24, v25
MV 80,56,172
R 52,7,0
R 54,7,2048
v_accvgpr_read_b32 v20, a217
CV 176,64,65
v_accvgpr_read_b32 v21, a218
CV 177,66,67
v_accvgpr_read_b32 v22, a219
CV 178,68,69
CV 76,19,20
CV 179,70,71
CV 77,21,22
MV 96,60,172
R 56,4,1024
R 58,4,3072
v_accvgpr_read_b32 v19, a220
v_accvgpr_read_b32 v20, a221
v_accvgpr_read_b32 v21, a222
v_accvgpr_read_b32 v22, a223
CV 78,19,20
CV 79,21,22
v_permlane16_swap_b32 v72, v76
v_permlane16_swap_b32 v73, v77
v_dot2_f32_bf16 v64, v180, v26, v25
v_dot2_f32_bf16 v65, v180, v24, v25
v_dot2_f32_bf16 v66, v181, v26, v25
v_dot2_f32_bf16 v67, v181, v24, v25
v_dot2_f32_bf16 v68, v182, v26, v25
v_dot2_f32_bf16 v69, v182, v24, v25
v_dot2_f32_bf16 v70, v183, v26, v25
v_dot2_f32_bf16 v71, v183, v24, v25
MV 80,32,176
R 60,7,1024
R 62,7,3072
CV 180,64,65
v_permlane16_swap_b32 v74, v78
CV 181,66,67
v_permlane16_swap_b32 v75, v79
CV 182,68,69
CV 183,70,71
MV 96,36,176
R 32,4,4096
R 34,4,6144
buffer_store_dwordx4 v[72:75], v23, s[48:51], s84 offen offset:2048 sc1
s_waitcnt vmcnt(28)
v_dot2_f32_bf16 v64, v184, v26, v25
v_dot2_f32_bf16 v65, v184, v24, v25
v_dot2_f32_bf16 v66, v185, v26, v25
v_dot2_f32_bf16 v67, v185, v24, v25
v_dot2_f32_bf16 v68, v186, v26, v25
v_dot2_f32_bf16 v69, v186, v24, v25
v_dot2_f32_bf16 v70, v187, v26, v25
v_dot2_f32_bf16 v71, v187, v24, v25
s_waitcnt lgkmcnt(4)
MV 80,40,180
R 36,7,4096
R 38,7,6144
buffer_store_dwordx4 v[76:79], v23, s[48:51], s84 offen offset:3072 sc1
CV 184,64,65
v_accvgpr_read_b32 v19, a224
CV 185,66,67
v_accvgpr_read_b32 v20, a225
CV 186,68,69
v_accvgpr_read_b32 v21, a226
CV 187,70,71
v_accvgpr_read_b32 v22, a227
MV 96,44,180
R 40,4,5120
R 42,4,7168
buffer_load_dwordx4 v16, s[32:35], s75 offen offset:1024 lds
CV 72,19,20
CV 73,21,22
v_accvgpr_read_b32 v19, a228
v_accvgpr_read_b32 v20, a229
v_accvgpr_read_b32 v21, a230
v_accvgpr_read_b32 v22, a231
CV 74,19,20
v_dot2_f32_bf16 v64, v188, v26, v25
v_dot2_f32_bf16 v65, v188, v24, v25
v_dot2_f32_bf16 v66, v189, v26, v25
v_dot2_f32_bf16 v67, v189, v24, v25
v_dot2_f32_bf16 v68, v190, v26, v25
v_dot2_f32_bf16 v69, v190, v24, v25
v_dot2_f32_bf16 v70, v191, v26, v25
v_dot2_f32_bf16 v71, v191, v24, v25
MV 80,48,184
R 44,7,5120
R 46,7,7168
CV 188,64,65
CV 75,21,22
CV 189,66,67
v_accvgpr_read_b32 v19, a232
v_accvgpr_read_b32 v20, a233
CV 190,68,69
v_accvgpr_read_b32 v21, a234
CV 191,70,71
MV 96,52,184
R 48,4,8192
R 50,4,10240
buffer_load_dwordx4 v17, s[32:35], s75 offen offset:2048 lds
v_accvgpr_read_b32 v22, a235
CV 76,19,20
CV 77,21,22
v_accvgpr_read_b32 v19, a236
v_accvgpr_read_b32 v20, a237
v_accvgpr_read_b32 v21, a238
v_accvgpr_read_b32 v22, a239
CV 78,19,20
v_dot2_f32_bf16 v64, v192, v26, v25
v_dot2_f32_bf16 v65, v192, v24, v25
v_dot2_f32_bf16 v66, v193, v26, v25
v_dot2_f32_bf16 v67, v193, v24, v25
v_dot2_f32_bf16 v68, v194, v26, v25
v_dot2_f32_bf16 v69, v194, v24, v25
v_dot2_f32_bf16 v70, v195, v26, v25
v_dot2_f32_bf16 v71, v195, v24, v25
MV 80,56,188
R 52,7,8192
R 54,7,10240
CV 192,64,65
CV 79,21,22
CV 193,66,67
v_permlane16_swap_b32 v72, v76
CV 194,68,69
LM_pad7:
s_cbranch_execz LM_pad11
v_permlane16_swap_b32 v73, v77
CV 195,70,71
v_permlane16_swap_b32 v74, v78
s_waitcnt lgkmcnt(2)
MV 96,60,188
R 56,4,9216
R 58,4,11264
buffer_load_dwordx4 v18, s[32:35], s75 offen offset:3072 lds
v_permlane16_swap_b32 v75, v79
s_waitcnt vmcnt(18)
v_dot2_f32_bf16 v64, v196, v26, v25
v_dot2_f32_bf16 v65, v196, v24, v25
v_dot2_f32_bf16 v66, v197, v26, v25
v_dot2_f32_bf16 v67, v197, v24, v25
v_dot2_f32_bf16 v68, v198, v26, v25
v_dot2_f32_bf16 v69, v198, v24, v25
v_dot2_f32_bf16 v70, v199, v26, v25
v_dot2_f32_bf16 v71, v199, v24, v25
s_add_u32 s84, s78, 4857856
MV 80,32,192
R 60,7,9216
R 62,7,11264
buffer_store_dwordx4 v[72:75], v23, s[48:51], s84 offen offset:0 sc1
CV 196,64,65
CV 197,66,67
CV 198,68,69
CV 199,70,71
MV 96,36,192
R 32,4,12288
R 34,4,14336
buffer_store_dwordx4 v[76:79], v23, s[48:51], s84 offen offset:1024 sc1
v_accvgpr_read_b32 v19, a240
v_accvgpr_read_b32 v20, a241
v_accvgpr_read_b32 v21, a242
v_accvgpr_read_b32 v22, a243
CV 72,19,20
CV 73,21,22
v_dot2_f32_bf16 v64, v200, v26, v25
v_dot2_f32_bf16 v65, v200, v24, v25
v_dot2_f32_bf16 v66, v201, v26, v25
v_dot2_f32_bf16 v67, v201, v24, v25
v_dot2_f32_bf16 v68, v202, v26, v25
v_dot2_f32_bf16 v69, v202, v24, v25
v_dot2_f32_bf16 v70, v203, v26, v25
v_dot2_f32_bf16 v71, v203, v24, v25
s_add_u32 m0, s67, 81920
s_add_u32 s75, s61, 3244160
MV 80,40,196
R 36,7,12288
R 38,7,14336
buffer_load_dwordx4 v15, s[32:35], s75 offen offset:0 lds
CV 200,64,65
v_accvgpr_read_b32 v19, a244
CV 201,66,67
CV 202,68,69
v_accvgpr_read_b32 v20, a245
CV 203,70,71
v_accvgpr_read_b32 v21, a246
MV 96,44,196
R 40,4,13312
R 42,4,15360
v_accvgpr_read_b32 v22, a247
CV 74,19,20
CV 75,21,22
v_accvgpr_read_b32 v19, a248
v_accvgpr_read_b32 v20, a249
v_accvgpr_read_b32 v21, a250
v_accvgpr_read_b32 v22, a251
CV 76,19,20
v_dot2_f32_bf16 v64, v204, v26, v25
v_dot2_f32_bf16 v65, v204, v24, v25
v_dot2_f32_bf16 v66, v205, v26, v25
v_dot2_f32_bf16 v67, v205, v24, v25
v_dot2_f32_bf16 v68, v206, v26, v25
v_dot2_f32_bf16 v69, v206, v24, v25
v_dot2_f32_bf16 v70, v207, v26, v25
v_dot2_f32_bf16 v71, v207, v24, v25
MV 80,48,200
R 44,7,13312
R 46,7,15360
CV 204,64,65
CV 77,21,22
CV 205,66,67
v_accvgpr_read_b32 v19, a252
CV 206,68,69
v_accvgpr_read_b32 v20, a253
v_accvgpr_read_b32 v21, a254
CV 207,70,71
s_add_u32 s100, s100, 4096
s_addc_u32 s101, s101, 0
s_waitcnt lgkmcnt(2)
MV 96,52,200
R 48,4,16384
R 50,4,18432
global_load_dword v0, v23, s[100:101]
v_accvgpr_read_b32 v22, a255
CV 78,19,20
CV 79,21,22
v_permlane16_swap_b32 v72, v76
v_permlane16_swap_b32 v73, v77
v_permlane16_swap_b32 v74, v78
v_permlane16_swap_b32 v75, v79
v_dot2_f32_bf16 v64, v208, v26, v25
v_dot2_f32_bf16 v65, v208, v24, v25
v_dot2_f32_bf16 v66, v209, v26, v25
v_dot2_f32_bf16 v67, v209, v24, v25
v_dot2_f32_bf16 v68, v210, v26, v25
v_dot2_f32_bf16 v69, v210, v24, v25
v_dot2_f32_bf16 v70, v211, v26, v25
v_dot2_f32_bf16 v71, v211, v24, v25
MV 80,56,204
R 52,7,16384
R 54,7,18432
buffer_store_dwordx4 v[72:75], v23, s[48:51], s84 offen offset:2048 sc1
CV 208,64,65
CV 209,66,67
CV 210,68,69
CV 211,70,71
v_accvgpr_write_b32 a144, v208
v_accvgpr_write_b32 a145, v209
MV 96,60,204
R 56,4,17408
R 58,4,19456
v_accvgpr_write_b32 a146, v210
v_accvgpr_write_b32 a147, v211
v_dot2_f32_bf16 v64, v212, v26, v25
v_dot2_f32_bf16 v65, v212, v24, v25
v_dot2_f32_bf16 v66, v213, v26, v25
v_dot2_f32_bf16 v67, v213, v24, v25
v_dot2_f32_bf16 v68, v214, v26, v25
v_dot2_f32_bf16 v69, v214, v24, v25
v_dot2_f32_bf16 v70, v215, v26, v25
v_dot2_f32_bf16 v71, v215, v24, v25
MS 80,32,144
R 60,7,17408
R 62,7,19456
buffer_store_dwordx4 v[76:79], v23, s[48:51], s84 offen offset:3072 sc1
CV 212,64,65
CV 213,66,67
CV 214,68,69
CV 215,70,71
v_accvgpr_write_b32 a148, v212
v_accvgpr_write_b32 a149, v213
v_accvgpr_write_b32 a150, v214
v_accvgpr_write_b32 a151, v215
MS 96,36,144
s_barrier
R 32,4,20480
R 34,4,22528
v_dot2_f32_bf16 v64, v216, v26, v25
v_dot2_f32_bf16 v65, v216, v24, v25
v_dot2_f32_bf16 v66, v217, v26, v25
v_dot2_f32_bf16 v67, v217, v24, v25
v_dot2_f32_bf16 v68, v218, v26, v25
v_dot2_f32_bf16 v69, v218, v24, v25
v_dot2_f32_bf16 v70, v219, v26, v25
v_dot2_f32_bf16 v71, v219, v24, v25
MS 80,40,148
R 36,7,20480
R 38,7,22528
CV 216,64,65
CV 217,66,67
CV 218,68,69
CV 219,70,71
v_accvgpr_write_b32 a152, v216
s_add_u32 m0, s67, 110592
s_add_u32 s75, s61, 256
s_waitcnt lgkmcnt(4)
MS 96,44,148
R 40,4,21504
R 42,4,23552
buffer_load_dwordx4 v15, s[32:35], s75 offen offset:0 lds
v_accvgpr_write_b32 a153, v217
v_accvgpr_write_b32 a154, v218
v_accvgpr_write_b32 a155, v219
v_dot2_f32_bf16 v64, v220, v26, v25
v_dot2_f32_bf16 v65, v220, v24, v25
v_dot2_f32_bf16 v66, v221, v26, v25
v_dot2_f32_bf16 v67, v221, v24, v25
v_dot2_f32_bf16 v68, v222, v26, v25
v_dot2_f32_bf16 v69, v222, v24, v25
v_dot2_f32_bf16 v70, v223, v26, v25
v_dot2_f32_bf16 v71, v223, v24, v25
MS 80,48,152
R 44,7,21504
R 46,7,23552
CV 220,64,65
CV 221,66,67
CV 222,68,69
CV 223,70,71
v_accvgpr_write_b32 a156, v220
v_accvgpr_write_b32 a157, v221
MS 96,52,152
R 48,4,24576
R 50,4,26624
v_accvgpr_write_b32 a158, v222
v_accvgpr_write_b32 a159, v223
v_dot2_f32_bf16 v64, v224, v26, v25
v_dot2_f32_bf16 v65, v224, v24, v25
v_dot2_f32_bf16 v66, v225, v26, v25
v_dot2_f32_bf16 v67, v225, v24, v25
v_dot2_f32_bf16 v68, v226, v26, v25
v_dot2_f32_bf16 v69, v226, v24, v25
v_dot2_f32_bf16 v70, v227, v26, v25
v_dot2_f32_bf16 v71, v227, v24, v25
MS 80,56,156
R 52,7,24576
R 54,7,26624
CV 224,64,65
CV 225,66,67
CV 226,68,69
CV 227,70,71
v_accvgpr_write_b32 a160, v224
v_accvgpr_write_b32 a161, v225
MS 96,60,156
R 56,4,25600
R 58,4,27648
v_accvgpr_write_b32 a162, v226
v_accvgpr_write_b32 a163, v227
s_waitcnt vmcnt(9)
v_dot2_f32_bf16 v64, v228, v26, v25
v_dot2_f32_bf16 v65, v228, v24, v25
v_dot2_f32_bf16 v66, v229, v26, v25
v_dot2_f32_bf16 v67, v229, v24, v25
v_dot2_f32_bf16 v68, v230, v26, v25
v_dot2_f32_bf16 v69, v230, v24, v25
v_dot2_f32_bf16 v70, v231, v26, v25
v_dot2_f32_bf16 v71, v231, v24, v25
s_waitcnt lgkmcnt(4)
MS 80,32,160
R 60,7,25600
R 62,7,27648
CV 228,64,65
CV 229,66,67
CV 230,68,69
CV 231,70,71
v_accvgpr_write_b32 a164, v228
v_accvgpr_write_b32 a165, v229
MS 96,36,160
R 32,4,28672
R 34,4,30720
buffer_load_dwordx4 v16, s[32:35], s75 offen offset:1024 lds
v_accvgpr_write_b32 a166, v230
v_accvgpr_write_b32 a167, v231
v_dot2_f32_bf16 v64, v232, v26, v25
v_dot2_f32_bf16 v65, v232, v24, v25
v_dot2_f32_bf16 v66, v233, v26, v25
v_dot2_f32_bf16 v67, v233, v24, v25
v_dot2_f32_bf16 v68, v234, v26, v25
v_dot2_f32_bf16 v69, v234, v24, v25
v_dot2_f32_bf16 v70, v235, v26, v25
v_dot2_f32_bf16 v71, v235, v24, v25
MS 80,40,164
R 36,7,28672
R 38,7,30720
CV 232,64,65
CV 233,66,67
CV 234,68,69
CV 235,70,71
v_accvgpr_write_b32 a168, v232
v_accvgpr_write_b32 a169, v233
MS 96,44,164
R 40,4,29696
R 42,4,31744
v_accvgpr_write_b32 a170, v234
v_accvgpr_write_b32 a171, v235
v_dot2_f32_bf16 v64, v236, v26, v25
v_dot2_f32_bf16 v65, v236, v24, v25
v_dot2_f32_bf16 v66, v237, v26, v25
v_dot2_f32_bf16 v67, v237, v24, v25
v_dot2_f32_bf16 v68, v238, v26, v25
v_dot2_f32_bf16 v69, v238, v24, v25
v_dot2_f32_bf16 v70, v239, v26, v25
v_dot2_f32_bf16 v71, v239, v24, v25
MS 80,48,168
R 44,7,29696
R 46,7,31744
buffer_load_dwordx4 v17, s[32:35], s75 offen offset:2048 lds
CV 236,64,65
CV 237,66,67
CV 238,68,69
CV 239,70,71
v_accvgpr_write_b32 a172, v236
v_accvgpr_write_b32 a173, v237
s_waitcnt lgkmcnt(4)
MS 96,52,168
R 48,4,32768
R 50,4,34816
v_accvgpr_write_b32 a174, v238
v_accvgpr_write_b32 a175, v239
v_dot2_f32_bf16 v64, v240, v26, v25
v_dot2_f32_bf16 v65, v240, v24, v25
v_dot2_f32_bf16 v66, v241, v26, v25
v_dot2_f32_bf16 v67, v241, v24, v25
v_dot2_f32_bf16 v68, v242, v26, v25
v_dot2_f32_bf16 v69, v242, v24, v25
v_dot2_f32_bf16 v70, v243, v26, v25
v_dot2_f32_bf16 v71, v243, v24, v25
s_add_u32 s74, s80, 16384
s_waitcnt vmcnt(3)
MS 80,56,172
R 52,7,32768
R 54,7,34816
buffer_store_dword v3, v30, s[48:51], s74 offen sc1
buffer_load_dwordx4 v18, s[32:35], s75 offen offset:3072 lds
CV 240,64,65
CV 241,66,67
CV 242,68,69
CV 243,70,71
MS 96,60,172
R 56,4,33792
R 58,4,35840
v_accvgpr_write_b32 a176, v240
v_accvgpr_write_b32 a177, v241
v_accvgpr_write_b32 a178, v242
v_accvgpr_write_b32 a179, v243
v_dot2_f32_bf16 v64, v244, v26, v25
v_dot2_f32_bf16 v65, v244, v24, v25
v_dot2_f32_bf16 v66, v245, v26, v25
v_dot2_f32_bf16 v67, v245, v24, v25
v_dot2_f32_bf16 v68, v246, v26, v25
v_dot2_f32_bf16 v69, v246, v24, v25
v_dot2_f32_bf16 v70, v247, v26, v25
v_dot2_f32_bf16 v71, v247, v24, v25
s_add_u32 m0, s67, 114688
s_add_u32 s75, s61, 295168
MS 80,32,176
R 60,7,33792
R 62,7,35840
buffer_load_dwordx4 v15, s[32:35], s75 offen offset:0 lds
CV 244,64,65
CV 245,66,67
CV 246,68,69
CV 247,70,71
v_accvgpr_write_b32 a180, v244
MS 96,36,176
R 32,4,36864
R 34,4,38912
v_accvgpr_write_b32 a181, v245
v_accvgpr_write_b32 a182, v246
v_accvgpr_write_b32 a183, v247
v_dot2_f32_bf16 v64, v248, v26, v25
v_dot2_f32_bf16 v65, v248, v24, v25
v_dot2_f32_bf16 v66, v249, v26, v25
v_dot2_f32_bf16 v67, v249, v24, v25
v_dot2_f32_bf16 v68, v250, v26, v25
v_dot2_f32_bf16 v69, v250, v24, v25
v_dot2_f32_bf16 v70, v251, v26, v25
v_dot2_f32_bf16 v71, v251, v24, v25
s_waitcnt lgkmcnt(4)
MS 80,40,180
R 36,7,36864
R 38,7,38912
CV 248,64,65
CV 249,66,67
CV 250,68,69
CV 251,70,71
v_accvgpr_write_b32 a184, v248
v_accvgpr_write_b32 a185, v249
MS 96,44,180
R 40,4,37888
R 42,4,39936
v_accvgpr_write_b32 a186, v250
v_accvgpr_write_b32 a187, v251
v_dot2_f32_bf16 v64, v252, v26, v25
v_dot2_f32_bf16 v65, v252, v24, v25
v_dot2_f32_bf16 v66, v253, v26, v25
v_dot2_f32_bf16 v67, v253, v24, v25
v_dot2_f32_bf16 v68, v254, v26, v25
v_dot2_f32_bf16 v69, v254, v24, v25
v_dot2_f32_bf16 v70, v255, v26, v25
v_dot2_f32_bf16 v71, v255, v24, v25
MS 80,48,184
R 44,7,37888
R 46,7,39936
CV 252,64,65
CV 253,66,67
CV 254,68,69
CV 255,70,71
v_accvgpr_write_b32 a188, v252
v_accvgpr_write_b32 a189, v253
MS 96,52,184
R 48,4,40960
R 50,4,43008
v_accvgpr_write_b32 a190, v254
v_accvgpr_write_b32 a191, v255
s_nop 1
MS 80,56,188
R 52,7,40960
R 54,7,43008
s_waitcnt lgkmcnt(6)
MS 96,60,188
R 56,4,41984
R 58,4,44032
buffer_load_dwordx4 v16, s[32:35], s75 offen offset:1024 lds
v_mfma_f32_32x32x16_bf16 v[208:223], v[32:35], v[112:115], 0
R 60,7,41984
R 62,7,44032
v_mfma_f32_32x32x16_bf16 v[224:239], v[36:39], v[112:115], 0
R 32,4,45056
R 34,4,47104
buffer_load_dwordx4 v17, s[32:35], s75 offen offset:2048 lds
MV 208,40,116
R 36,7,45056
R 38,7,47104
s_waitcnt lgkmcnt(6)
MV 224,44,116
R 40,4,46080
R 42,4,48128
buffer_load_dwordx4 v18, s[32:35], s75 offen offset:3072 lds
v_fma_f32 v64, v80, v80, v27
v_fma_f32 v65, v81, v81, v27
v_fma_f32 v66, v82, v82, v27
v_fma_f32 v67, v83, v83, v27
MV 208,48,120
R 44,7,46080
R 46,7,48128
v_mul_f32 v64, v64, v80
v_mul_f32 v65, v65, v81
v_mul_f32 v66, v66, v82
v_mul_f32 v67, v67, v83
v_exp_f32 v64, v64
MV 224,52,120
R 48,4,49152
R 50,4,51200
v_exp_f32 v65, v65
s_add_u32 m0, s67, 118784
s_add_u32 s75, s61, 590080
MV 208,56,124
R 52,7,49152
R 54,7,51200
buffer_load_dwordx4 v15, s[32:35], s75 offen offset:0 lds
v_exp_f32 v66, v66
v_exp_f32 v67, v67
s_waitcnt lgkmcnt(4)
MV 224,60,124
R 56,4,50176
R 58,4,52224
v_fma_f32 v64, v64, v28, v28
v_fma_f32 v65, v65, v28, v28
v_fma_f32 v66, v66, v28, v28
v_fma_f32 v67, v67, v28, v28
v_rcp_f32 v64, v64
MV 208,32,128
R 60,7,50176
R 62,7,52224
v_rcp_f32 v65, v65
v_rcp_f32 v66, v66
MV 224,36,128
R 32,4,53248
R 34,4,55296
v_rcp_f32 v67, v67
v_mul_f32 v80, v80, v64
v_mul_f32 v81, v81, v65
v_mul_f32 v82, v82, v66
MV 208,40,132
R 36,7,53248
R 38,7,55296
v_mul_f32 v83, v83, v67
CV 80,80,81
CV 82,82,83
v_fma_f32 v64, v84, v84, v27
v_fma_f32 v65, v85, v85, v27
MV 224,44,132
R 40,4,54272
R 42,4,56320
v_fma_f32 v66, v86, v86, v27
v_fma_f32 v67, v87, v87, v27
v_mul_f32 v64, v64, v84
v_mul_f32 v65, v65, v85
v_mul_f32 v66, v66, v86
s_waitcnt lgkmcnt(4)
MV 208,48,136
R 44,7,54272
R 46,7,56320
v_mul_f32 v67, v67, v87
v_exp_f32 v64, v64
v_exp_f32 v65, v65
MV 224,52,136
s_barrier
R 48,4,57344
R 50,4,59392
MV 208,56,140
R 52,7,57344
R 54,7,59392
v_exp_f32 v66, v66
v_exp_f32 v67, v67
s_add_u32 m0, s67, 0
s_add_u32 s75, s61, 2654464
MV 224,60,140
R 56,4,58368
R 58,4,60416
buffer_load_dwordx4 v15, s[32:35], s75 offen offset:0 lds
v_fma_f32 v64, v64, v28, v28
v_fma_f32 v65, v65, v28, v28
v_fma_f32 v66, v66, v28, v28
MV 208,32,144
R 60,7,58368
R 62,7,60416
v_fma_f32 v67, v67, v28, v28
v_rcp_f32 v64, v64
v_rcp_f32 v65, v65
s_waitcnt lgkmcnt(4)
MV 224,36,144
R 32,4,61440
R 34,4,63488
v_rcp_f32 v66, v66
v_rcp_f32 v67, v67
MV 208,40,148
R 36,7,61440
R 38,7,63488
v_mul_f32 v84, v84, v64
v_mul_f32 v85, v85, v65
v_mul_f32 v86, v86, v66
v_mul_f32 v87, v87, v67
CV 84,84,85
MV 224,44,148
R 40,4,62464
R 42,4,64512
CV 86,86,87
v_fma_f32 v64, v88, v88, v27
v_fma_f32 v65, v89, v89, v27
v_fma_f32 v66, v90, v90, v27
v_fma_f32 v67, v91, v91, v27
MV 208,48,152
R 44,7,62464
R 46,7,64512
v_mul_f32 v64, v64, v88
v_mul_f32 v65, v65, v89
v_mul_f32 v66, v66, v90
v_mul_f32 v67, v67, v91
v_exp_f32 v64, v64
MV 224,52,152
R 48,8,0
R 50,8,2048
buffer_load_dwordx4 v16, s[32:35], s75 offen offset:1024 lds
v_exp_f32 v65, v65
v_exp_f32 v66, v66
s_waitcnt lgkmcnt(4)
MV 208,56,156
R 52,9,0
R 54,9,2048
v_exp_f32 v67, v67
v_fma_f32 v64, v64, v28, v28
v_fma_f32 v65, v65, v28, v28
LM_pad8:
s_cbranch_execz LM_pad12
MV 224,60,156
R 56,8,1024
R 58,8,3072
v_fma_f32 v66, v66, v28, v28
v_fma_f32 v67, v67, v28, v28
v_rcp_f32 v64, v64
v_rcp_f32 v65, v65
MV 208,32,160
R 60,9,1024
R 62,9,3072
buffer_load_dwordx4 v17, s[32:35], s75 offen offset:2048 lds
v_rcp_f32 v66, v66
MV 224,36,160
R 32,8,4096
R 34,8,6144
v_rcp_f32 v67, v67
v_mul_f32 v88, v88, v64
v_mul_f32 v89, v89, v65
v_mul_f32 v90, v90, v66
MV 208,40,164
R 36,9,4096
R 38,9,6144
buffer_load_dwordx4 v18, s[32:35], s75 offen offset:3072 lds
v_mul_f32 v91, v91, v67
v_permlane16_swap_b32 v80, v84
v_permlane16_swap_b32 v82, v86
v_accvgpr_write_b32 a0, v80
s_waitcnt lgkmcnt(5)
MV 224,44,164
R 40,8,5120
R 42,8,7168
v_accvgpr_write_b32 a1, v82
v_accvgpr_write_b32 a4, v84
v_accvgpr_write_b32 a5, v86
CV 88,88,89
s_add_u32 m0, s67, 4096
s_add_u32 s75, s61, 2949376
MV 208,48,168
R 44,9,5120
R 46,9,7168
buffer_load_dwordx4 v15, s[32:35], s75 offen offset:0 lds
CV 90,90,91
v_fma_f32 v64, v92, v92, v27
v_fma_f32 v65, v93, v93, v27
MV 224,52,168
R 48,8,8192
R 50,8,10240
v_fma_f32 v66, v94, v94, v27
v_fma_f32 v67, v95, v95, v27
v_mul_f32 v64, v64, v92
v_mul_f32 v65, v65, v93
v_mul_f32 v66, v66, v94
MV 208,56,172
R 52,9,8192
R 54,9,10240
v_mul_f32 v67, v67, v95
v_exp_f32 v64, v64
v_exp_f32 v65, v65
s_add_u32 s100, s100, 4096
s_addc_u32 s101, s101, 0
s_waitcnt lgkmcnt(4)
MV 224,60,172
R 56,8,9216
R 58,8,11264
global_load_dword v0, v23, s[100:101]
v_exp_f32 v66, v66
v_exp_f32 v67, v67
v_fma_f32 v64, v64, v28, v28
MV 208,32,176
R 60,9,9216
R 62,9,11264
v_fma_f32 v65, v65, v28, v28
v_fma_f32 v66, v66, v28, v28
v_fma_f32 v67, v67, v28, v28
v_rcp_f32 v64, v64
MV 224,36,176
R 32,8,12288
R 34,8,14336
v_rcp_f32 v65, v65
v_rcp_f32 v66, v66
v_rcp_f32 v67, v67
MV 208,40,180
R 36,9,12288
R 38,9,14336
v_mul_f32 v92, v92, v64
v_mul_f32 v93, v93, v65
v_mul_f32 v94, v94, v66
v_mul_f32 v95, v95, v67
MV 224,44,180
R 40,8,13312
R 42,8,15360
buffer_load_dwordx4 v16, s[32:35], s75 offen offset:1024 lds
CV 92,92,93
CV 94,94,95
s_nop 0
v_permlane16_swap_b32 v88, v92
s_waitcnt lgkmcnt(4)
MV 208,48,184
R 44,9,13312
R 46,9,15360
v_permlane16_swap_b32 v90, v94
v_accvgpr_write_b32 a2, v88
v_accvgpr_write_b32 a3, v90
v_accvgpr_write_b32 a6, v92
v_accvgpr_write_b32 a7, v94
MV 224,52,184
R 48,8,16384
R 50,8,18432
buffer_load_dwordx4 v17, s[32:35], s75 offen offset:2048 lds
v_fma_f32 v64, v96, v96, v27
v_fma_f32 v65, v97, v97, v27
v_fma_f32 v66, v98, v98, v27
v_fma_f32 v67, v99, v99, v27
MV 208,56,188
R 52,9,16384
R 54,9,18432
v_mul_f32 v64, v64, v96
v_mul_f32 v65, v65, v97
v_mul_f32 v66, v66, v98
v_mul_f32 v67, v67, v99
v_exp_f32 v64, v64
MV 224,60,188
R 56,8,17408
R 58,8,19456
buffer_load_dwordx4 v18, s[32:35], s75 offen offset:3072 lds
v_exp_f32 v65, v65
v_exp_f32 v66, v66
MV 208,32,192
R 60,9,17408
R 62,9,19456
v_exp_f32 v67, v67
v_fma_f32 v64, v64, v28, v28
v_fma_f32 v65, v65, v28, v28
s_waitcnt lgkmcnt(4)
MV 224,36,192
R 32,8,20480
R 34,8,22528
v_fma_f32 v66, v66, v28, v28
v_fma_f32 v67, v67, v28, v28
v_rcp_f32 v64, v64
s_add_u32 m0, s67, 8192
s_add_u32 s75, s61, 3244288
MV 208,40,196
R 36,9,20480
R 38,9,22528
buffer_load_dwordx4 v15, s[32:35], s75 offen offset:0 lds
v_rcp_f32 v65, v65
v_rcp_f32 v66, v66
MV 224,44,196
R 40,8,21504
R 42,8,23552
v_rcp_f32 v67, v67
v_mul_f32 v96, v96, v64
v_mul_f32 v97, v97, v65
MV 208,48,200
R 44,9,21504
R 46,9,23552
v_mul_f32 v98, v98, v66
v_mul_f32 v99, v99, v67
CV 96,96,97
CV 98,98,99
v_fma_f32 v64, v100, v100, v27
MV 224,52,200
R 48,8,24576
R 50,8,26624
v_fma_f32 v65, v101, v101, v27
v_fma_f32 v66, v102, v102, v27
v_fma_f32 v67, v103, v103, v27
v_mul_f32 v64, v64, v100
v_mul_f32 v65, v65, v101
s_waitcnt lgkmcnt(4)
MV 208,56,204
R 52,9,24576
R 54,9,26624
v_mul_f32 v66, v66, v102
v_mul_f32 v67, v67, v103
v_exp_f32 v64, v64
MV 224,60,204
R 56,8,25600
R 58,8,27648
v_exp_f32 v65, v65
v_exp_f32 v66, v66
v_exp_f32 v67, v67
MS 208,32,144
R 60,9,25600
R 62,9,27648
v_fma_f32 v64, v64, v28, v28
v_fma_f32 v65, v65, v28, v28
v_fma_f32 v66, v66, v28, v28
v_fma_f32 v67, v67, v28, v28
MS 224,36,144
s_waitcnt vmcnt(10)
s_barrier
R 32,8,28672
R 34,8,30720
MS 208,40,148
R 36,9,28672
R 38,9,30720
v_rcp_f32 v64, v64
v_rcp_f32 v65, v65
s_add_u32 m0, s67, 36864
s_add_u32 s75, s61, 384
s_waitcnt lgkmcnt(4)
MS 224,44,148
R 40,8,29696
R 42,8,31744
buffer_load_dwordx4 v15, s[32:35], s75 offen offset:0 lds
v_rcp_f32 v66, v66
v_rcp_f32 v67, v67
MS 208,48,152
R 44,9,29696
R 46,9,31744
v_mul_f32 v100, v100, v64
v_mul_f32 v101, v101, v65
v_mul_f32 v102, v102, v66
v_mul_f32 v103, v103, v67
MS 224,52,152
R 48,8,32768
R 50,8,34816
CV 100,100,101
CV 102,102,103
v_fma_f32 v64, v104, v104, v27
v_fma_f32 v65, v105, v105, v27
v_fma_f32 v66, v106, v106, v27
MS 208,56,156
R 52,9,32768
R 54,9,34816
v_fma_f32 v67, v107, v107, v27
v_mul_f32 v64, v64, v104
v_mul_f32 v65, v65, v105
v_mul_f32 v66, v66, v106
v_mul_f32 v67, v67, v107
MS 224,60,156
R 56,8,33792
R 58,8,35840
v_exp_f32 v64, v64
v_exp_f32 v65, v65
v_exp_f32 v66, v66
s_waitcnt lgkmcnt(4)
MS 208,32,160
R 60,9,33792
R 62,9,35840
v_exp_f32 v67, v67
v_fma_f32 v64, v64, v28, v28
v_fma_f32 v65, v65, v28, v28
MS 224,36,160
R 32,8,36864
R 34,8,38912
buffer_load_dwordx4 v16, s[32:35], s75 offen offset:1024 lds
v_fma_f32 v66, v66, v28, v28
v_fma_f32 v67, v67, v28, v28
v_rcp_f32 v64, v64
MS 208,40,164
R 36,9,36864
R 38,9,38912
v_rcp_f32 v65, v65
v_rcp_f32 v66, v66
MS 224,44,164
R 40,8,37888
R 42,8,39936
v_rcp_f32 v67, v67
v_mul_f32 v104, v104, v64
v_mul_f32 v105, v105, v65
v_mul_f32 v106, v106, v66
MS 208,48,168
R 44,9,37888
R 46,9,39936
buffer_load_dwordx4 v17, s[32:35], s75 offen offset:2048 lds
v_mul_f32 v107, v107, v67
v_permlane16_swap_b32 v96, v100
v_permlane16_swap_b32 v98, v102
v_accvgpr_write_b32 a8, v96
s_waitcnt lgkmcnt(4)
MS 224,52,168
R 48,8,40960
R 50,8,43008
v_accvgpr_write_b32 a9, v98
v_accvgpr_write_b32 a12, v100
v_accvgpr_write_b32 a13, v102
CV 104,104,105
CV 106,106,107
MS 208,56,172
R 52,9,40960
R 54,9,43008
buffer_load_dwordx4 v18, s[32:35], s75 offen offset:3072 lds
v_fma_f32 v64, v108, v108, v27
v_fma_f32 v65, v109, v109, v27
v_fma_f32 v66, v110, v110, v27
v_fma_f32 v67, v111, v111, v27
MS 224,60,172
R 56,8,41984
R 58,8,44032
v_mul_f32 v64, v64, v108
v_mul_f32 v65, v65, v109
v_mul_f32 v66, v66, v110
s_add_u32 m0, s67, 40960
s_add_u32 s75, s61, 295296
MS 208,32,176
R 60,9,41984
R 62,9,44032
buffer_load_dwordx4 v15, s[32:35], s75 offen offset:0 lds
v_mul_f32 v67, v67, v111
v_exp_f32 v64, v64
v_exp_f32 v65, v65
MS 224,36,176
R 32,8,45056
R 34,8,47104
v_exp_f32 v66, v66
v_exp_f32 v67, v67
s_waitcnt lgkmcnt(4)
MS 208,40,180
R 36,9,45056
R 38,9,47104
v_fma_f32 v64, v64, v28, v28
v_fma_f32 v65, v65, v28, v28
v_fma_f32 v66, v66, v28, v28
v_fma_f32 v67, v67, v28, v28
v_rcp_f32 v64, v64
MS 224,44,180
R 40,8,46080
R 42,8,48128
v_rcp_f32 v65, v65
v_rcp_f32 v66, v66
MS 208,48,184
R 44,9,46080
R 46,9,48128
v_rcp_f32 v67, v67
v_mul_f32 v108, v108, v64
v_mul_f32 v109, v109, v65
v_mul_f32 v110, v110, v66
MS 224,52,184
R 48,8,49152
R 50,8,51200
v_mul_f32 v111, v111, v67
CV 108,108,109
CV 110,110,111
s_nop 0
v_permlane16_swap_b32 v104, v108
MS 208,56,188
R 52,9,49152
R 54,9,51200
v_permlane16_swap_b32 v106, v110
v_accvgpr_write_b32 a10, v104
v_accvgpr_write_b32 a11, v106
v_accvgpr_write_b32 a14, v108
v_accvgpr_write_b32 a15, v110
s_waitcnt lgkmcnt(4)
MS 224,60,188
R 56,8,50176
R 58,8,52224
buffer_load_dwordx4 v16, s[32:35], s75 offen offset:1024 lds
v_mfma_f32_32x32x16_bf16 v[240:255], v[32:35], v[112:115], 0
R 60,9,50176
R 62,9,52224
v_mfma_f32_32x32x16_bf16 v[80:95], v[36:39], v[112:115], 0
R 32,8,53248
R 34,8,55296
buffer_load_dwordx4 v17, s[32:35], s75 offen offset:2048 lds
MV 240,40,116
R 36,9,53248
R 38,9,55296
MV 80,44,116
R 40,8,54272
R 42,8,56320
buffer_load_dwordx4 v18, s[32:35], s75 offen offset:3072 lds
v_fma_f32 v64, v208, v208, v27
v_fma_f32 v65, v209, v209, v27
v_fma_f32 v66, v210, v210, v27
v_fma_f32 v67, v211, v211, v27
s_waitcnt lgkmcnt(6)
MV 240,48,120
R 44,9,54272
R 46,9,56320
v_mul_f32 v64, v64, v208
v_mul_f32 v65, v65, v209
v_mul_f32 v66, v66, v210
v_mul_f32 v67, v67, v211
v_exp_f32 v64, v64
MV 80,52,120
R 48,8,57344
R 50,8,59392
v_exp_f32 v65, v65
s_add_u32 m0, s67, 45056
s_add_u32 s75, s61, 590208
MV 240,56,124
R 52,9,57344
R 54,9,59392
buffer_load_dwordx4 v15, s[32:35], s75 offen offset:0 lds
v_exp_f32 v66, v66
v_exp_f32 v67, v67
MV 80,60,124
R 56,8,58368
R 58,8,60416
v_fma_f32 v64, v64, v28, v28
v_fma_f32 v65, v65, v28, v28
v_fma_f32 v66, v66, v28, v28
v_fma_f32 v67, v67, v28, v28
v_rcp_f32 v64, v64
s_waitcnt lgkmcnt(4)
MV 240,32,128
R 60,9,58368
R 62,9,60416
v_rcp_f32 v65, v65
v_rcp_f32 v66, v66
MV 80,36,128
R 32,8,61440
R 34,8,63488
v_rcp_f32 v67, v67
v_mul_f32 v208, v208, v64
v_mul_f32 v209, v209, v65
v_mul_f32 v210, v210, v66
MV 240,40,132
R 36,9,61440
R 38,9,63488
v_mul_f32 v211, v211, v67
CV 208,208,209
CV 210,210,211
v_fma_f32 v64, v212, v212, v27
v_fma_f32 v65, v213, v213, v27
MV 80,44,132
R 40,8,62464
R 42,8,64512
v_fma_f32 v66, v214, v214, v27
v_fma_f32 v67, v215, v215, v27
v_mul_f32 v64, v64, v212
v_mul_f32 v65, v65, v213
v_mul_f32 v66, v66, v214
MV 240,48,136
R 44,9,62464
R 46,9,64512
v_mul_f32 v67, v67, v215
v_exp_f32 v64, v64
v_exp_f32 v65, v65
s_waitcnt lgkmcnt(4)
MV 80,52,136
s_waitcnt vmcnt(9)
s_barrier
R 48,2,0
R 50,2,2048
MV 240,56,140
R 52,5,0
R 54,5,2048
v_exp_f32 v66, v66
v_exp_f32 v67, v67
s_add_u32 m0, s67, 73728
s_add_u32 s75, s61, 2654592
MV 80,60,140
R 56,2,1024
R 58,2,3072
buffer_load_dwordx4 v15, s[32:35], s75 offen offset:0 lds
v_fma_f32 v64, v64, v28, v28
v_fma_f32 v65, v65, v28, v28
v_fma_f32 v66, v66, v28, v28
MV 240,32,144
R 60,5,1024
R 62,5,3072
v_fma_f32 v67, v67, v28, v28
v_rcp_f32 v64, v64
v_rcp_f32 v65, v65
MV 80,36,144
R 32,2,4096
R 34,2,6144
v_rcp_f32 v66, v66
v_rcp_f32 v67, v67
s_waitcnt lgkmcnt(5)
MV 240,40,148
R 36,5,4096
R 38,5,6144
v_mul_f32 v212, v212, v64
v_mul_f32 v213, v213, v65
v_mul_f32 v214, v214, v66
v_mul_f32 v215, v215, v67
CV 212,212,213
MV 80,44,148
R 40,2,5120
R 42,2,7168
CV 214,214,215
v_fma_f32 v64, v216, v216, v27
v_fma_f32 v65, v217, v217, v27
v_fma_f32 v66, v218, v218, v27
v_fma_f32 v67, v219, v219, v27
MV 240,48,152
R 44,5,5120
R 46,5,7168
v_mul_f32 v64, v64, v216
v_mul_f32 v65, v65, v217
v_mul_f32 v66, v66, v218
v_mul_f32 v67, v67, v219
v_exp_f32 v64, v64
MV 80,52,152
R 48,2,8192
R 50,2,10240
buffer_load_dwordx4 v16, s[32:35], s75 offen offset:1024 lds
v_exp_f32 v65, v65
v_exp_f32 v66, v66
s_waitcnt lgkmcnt(4)
MV 240,56,156
R 52,5,8192
R 54,5,10240
v_exp_f32 v67, v67
v_fma_f32 v64, v64, v28, v28
v_fma_f32 v65, v65, v28, v28
MV 80,60,156
R 56,2,9216
R 58,2,11264
v_fma_f32 v66, v66, v28, v28
v_fma_f32 v67, v67, v28, v28
v_rcp_f32 v64, v64
v_rcp_f32 v65, v65
MV 240,32,160
R 60,5,9216
R 62,5,11264
buffer_load_dwordx4 v17, s[32:35], s75 offen offset:2048 lds
v_rcp_f32 v66, v66
MV 80,36,160
R 32,2,12288
R 34,2,14336
v_rcp_f32 v67, v67
v_mul_f32 v216, v216, v64
v_mul_f32 v217, v217, v65
v_mul_f32 v218, v218, v66
MV 240,40,164
R 36,5,12288
R 38,5,14336
buffer_load_dwordx4 v18, s[32:35], s75 offen offset:3072 lds
v_mul_f32 v219, v219, v67
v_permlane16_swap_b32 v208, v212
v_permlane16_swap_b32 v210, v214
v_accvgpr_write_b32 a16, v208
s_waitcnt lgkmcnt(5)
MV 80,44,164
R 40,2,13312
R 42,2,15360
v_accvgpr_write_b32 a17, v210
v_accvgpr_write_b32 a20, v212
v_accvgpr_write_b32 a21, v214
CV 216,216,217
s_add_u32 m0, s67, 77824
s_add_u32 s75, s61, 2949504
MV 240,48,168
R 44,5,13312
R 46,5,15360
buffer_load_dwordx4 v15, s[32:35], s75 offen offset:0 lds
CV 218,218,219
v_fma_f32 v64, v220, v220, v27
v_fma_f32 v65, v221, v221, v27
MV 80,52,168
R 48,4,0
R 50,4,2048
v_fma_f32 v66, v222, v222, v27
v_fma_f32 v67, v223, v223, v27
v_mul_f32 v64, v64, v220
v_mul_f32 v65, v65, v221
v_mul_f32 v66, v66, v222
MV 240,56,172
R 52,7,0
R 54,7,2048
v_mul_f32 v67, v67, v223
v_exp_f32 v64, v64
v_exp_f32 v65, v65
s_waitcnt lgkmcnt(4)
MV 80,60,172
R 56,4,1024
R 58,4,3072
v_exp_f32 v66, v66
v_exp_f32 v67, v67
v_fma_f32 v64, v64, v28, v28
MV 240,32,176
R 60,7,1024
R 62,7,3072
v_fma_f32 v65, v65, v28, v28
v_fma_f32 v66, v66, v28, v28
v_fma_f32 v67, v67, v28, v28
v_rcp_f32 v64, v64
MV 80,36,176
R 32,4,4096
R 34,4,6144
v_rcp_f32 v65, v65
v_rcp_f32 v66, v66
v_rcp_f32 v67, v67
MV 240,40,180
R 36,7,4096
R 38,7,6144
v_mul_f32 v220, v220, v64
v_mul_f32 v221, v221, v65
v_mul_f32 v222, v222, v66
v_mul_f32 v223, v223, v67
MV 80,44,180
R 40,4,5120
R 42,4,7168
buffer_load_dwordx4 v16, s[32:35], s75 offen offset:1024 lds
CV 220,220,221
CV 222,222,223
s_nop 0
v_permlane16_swap_b32 v216, v220
s_waitcnt lgkmcnt(4)
MV 240,48,184
R 44,7,5120
R 46,7,7168
v_permlane16_swap_b32 v218, v222
v_accvgpr_write_b32 a18, v216
v_accvgpr_write_b32 a19, v218
v_accvgpr_write_b32 a22, v220
v_accvgpr_write_b32 a23, v222
MV 80,52,184
R 48,4,8192
R 50,4,10240
LM_pad9:
s_cbranch_execz LM_ret
buffer_load_dwordx4 v17, s[32:35], s75 offen offset:2048 lds
v_fma_f32 v64, v224, v224, v27
v_fma_f32 v65, v225, v225, v27
v_fma_f32 v66, v226, v226, v27
v_fma_f32 v67, v227, v227, v27
MV 240,56,188
R 52,7,8192
R 54,7,10240
v_mul_f32 v64, v64, v224
v_mul_f32 v65, v65, v225
v_mul_f32 v66, v66, v226
v_mul_f32 v67, v67, v227
v_exp_f32 v64, v64
MV 80,60,188
R 56,4,9216
R 58,4,11264
buffer_load_dwordx4 v18, s[32:35], s75 offen offset:3072 lds
v_exp_f32 v65, v65
v_exp_f32 v66, v66
MV 240,32,192
R 60,7,9216
R 62,7,11264
v_exp_f32 v67, v67
v_fma_f32 v64, v64, v28, v28
v_fma_f32 v65, v65, v28, v28
s_waitcnt lgkmcnt(4)
MV 80,36,192
R 32,4,12288
R 34,4,14336
v_fma_f32 v66, v66, v28, v28
v_fma_f32 v67, v67, v28, v28
v_rcp_f32 v64, v64
s_add_u32 m0, s67, 81920
s_add_u32 s75, s61, 3244416
MV 240,40,196
R 36,7,12288
R 38,7,14336
buffer_load_dwordx4 v15, s[32:35], s75 offen offset:0 lds
v_rcp_f32 v65, v65
v_rcp_f32 v66, v66
MV 80,44,196
R 40,4,13312
R 42,4,15360
v_rcp_f32 v67, v67
v_mul_f32 v224, v224, v64
v_mul_f32 v225, v225, v65
MV 240,48,200
R 44,7,13312
R 46,7,15360
v_mul_f32 v226, v226, v66
v_mul_f32 v227, v227, v67
CV 224,224,225
CV 226,226,227
v_fma_f32 v64, v228, v228, v27
MV 80,52,200
R 48,4,16384
R 50,4,18432
v_fma_f32 v65, v229, v229, v27
v_fma_f32 v66, v230, v230, v27
v_fma_f32 v67, v231, v231, v27
v_mul_f32 v64, v64, v228
v_mul_f32 v65, v65, v229
s_add_u32 s100, s100, 4096
s_addc_u32 s101, s101, 0
s_waitcnt lgkmcnt(4)
MV 240,56,204
R 52,7,16384
R 54,7,18432
global_load_dword v0, v23, s[100:101]
v_mul_f32 v66, v66, v230
v_mul_f32 v67, v67, v231
v_exp_f32 v64, v64
MV 80,60,204
R 56,4,17408
R 58,4,19456
v_exp_f32 v65, v65
v_exp_f32 v66, v66
v_exp_f32 v67, v67
MS 240,32,144
R 60,7,17408
R 62,7,19456
v_fma_f32 v64, v64, v28, v28
v_fma_f32 v65, v65, v28, v28
v_fma_f32 v66, v66, v28, v28
v_fma_f32 v67, v67, v28, v28
MS 80,36,144
s_waitcnt vmcnt(10)
s_barrier
R 32,4,20480
R 34,4,22528
MS 240,40,148
R 36,7,20480
R 38,7,22528
v_rcp_f32 v64, v64
v_rcp_f32 v65, v65
s_add_u32 m0, s67, 110592
s_add_u32 s75, s61, 512
s_waitcnt lgkmcnt(4)
MS 80,44,148
R 40,4,21504
R 42,4,23552
buffer_load_dwordx4 v15, s[32:35], s75 offen offset:0 lds
v_rcp_f32 v66, v66
v_rcp_f32 v67, v67
MS 240,48,152
R 44,7,21504
R 46,7,23552
v_mul_f32 v228, v228, v64
v_mul_f32 v229, v229, v65
v_mul_f32 v230, v230, v66
v_mul_f32 v231, v231, v67
MS 80,52,152
R 48,4,24576
R 50,4,26624
CV 228,228,229
CV 230,230,231
v_fma_f32 v64, v232, v232, v27
v_fma_f32 v65, v233, v233, v27
v_fma_f32 v66, v234, v234, v27
MS 240,56,156
R 52,7,24576
R 54,7,26624
v_fma_f32 v67, v235, v235, v27
v_mul_f32 v64, v64, v232
v_mul_f32 v65, v65, v233
v_mul_f32 v66, v66, v234
v_mul_f32 v67, v67, v235
MS 80,60,156
R 56,4,25600
R 58,4,27648
v_exp_f32 v64, v64
v_exp_f32 v65, v65
v_exp_f32 v66, v66
s_waitcnt lgkmcnt(4)
MS 240,32,160
R 60,7,25600
R 62,7,27648
v_exp_f32 v67, v67
v_fma_f32 v64, v64, v28, v28
v_fma_f32 v65, v65, v28, v28
MS 80,36,160
R 32,4,28672
R 34,4,30720
buffer_load_dwordx4 v16, s[32:35], s75 offen offset:1024 lds
v_fma_f32 v66, v66, v28, v28
v_fma_f32 v67, v67, v28, v28
v_rcp_f32 v64, v64
MS 240,40,164
R 36,7,28672
R 38,7,30720
v_rcp_f32 v65, v65
v_rcp_f32 v66, v66
MS 80,44,164
R 40,4,29696
R 42,4,31744
v_rcp_f32 v67, v67
v_mul_f32 v232, v232, v64
v_mul_f32 v233, v233, v65
v_mul_f32 v234, v234, v66
MS 240,48,168
R 44,7,29696
R 46,7,31744
buffer_load_dwordx4 v17, s[32:35], s75 offen offset:2048 lds
v_mul_f32 v235, v235, v67
v_permlane16_swap_b32 v224, v228
v_permlane16_swap_b32 v226, v230
v_accvgpr_write_b32 a24, v224
s_waitcnt lgkmcnt(4)
MS 80,52,168
R 48,4,32768
R 50,4,34816
v_accvgpr_write_b32 a25, v226
v_accvgpr_write_b32 a28, v228
v_accvgpr_write_b32 a29, v230
CV 232,232,233
CV 234,234,235
MS 240,56,172
R 52,7,32768
R 54,7,34816
buffer_load_dwordx4 v18, s[32:35], s75 offen offset:3072 lds
v_fma_f32 v64, v236, v236, v27
v_fma_f32 v65, v237, v237, v27
v_fma_f32 v66, v238, v238, v27
v_fma_f32 v67, v239, v239, v27
MS 80,60,172
R 56,4,33792
R 58,4,35840
v_mul_f32 v64, v64, v236
v_mul_f32 v65, v65, v237
v_mul_f32 v66, v66, v238
s_add_u32 m0, s67, 114688
s_add_u32 s75, s61, 295424
MS 240,32,176
R 60,7,33792
R 62,7,35840
buffer_load_dwordx4 v15, s[32:35], s75 offen offset:0 lds
v_mul_f32 v67, v67, v239
v_exp_f32 v64, v64
v_exp_f32 v65, v65
MS 80,36,176
R 32,4,36864
R 34,4,38912
v_exp_f32 v66, v66
v_exp_f32 v67, v67
s_waitcnt lgkmcnt(4)
MS 240,40,180
R 36,7,36864
R 38,7,38912
v_fma_f32 v64, v64, v28, v28
v_fma_f32 v65, v65, v28, v28
v_fma_f32 v66, v66, v28, v28
v_fma_f32 v67, v67, v28, v28
v_rcp_f32 v64, v64
MS 80,44,180
R 40,4,37888
R 42,4,39936
v_rcp_f32 v65, v65
v_rcp_f32 v66, v66
MS 240,48,184
R 44,7,37888
R 46,7,39936
v_rcp_f32 v67, v67
v_mul_f32 v236, v236, v64
v_mul_f32 v237, v237, v65
v_mul_f32 v238, v238, v66
MS 80,52,184
R 48,4,40960
R 50,4,43008
v_mul_f32 v239, v239, v67
CV 236,236,237
CV 238,238,239
s_nop 0
v_permlane16_swap_b32 v232, v236
MS 240,56,188
R 52,7,40960
R 54,7,43008
v_permlane16_swap_b32 v234, v238
v_accvgpr_write_b32 a26, v232
v_accvgpr_write_b32 a27, v234
v_accvgpr_write_b32 a30, v236
v_accvgpr_write_b32 a31, v238
s_waitcnt lgkmcnt(4)
MS 80,60,188
R 56,4,41984
R 58,4,44032
buffer_load_dwordx4 v16, s[32:35], s75 offen offset:1024 lds
v_mfma_f32_32x32x16_bf16 v[96:111], v[32:35], v[112:115], 0
R 60,7,41984
R 62,7,44032
v_mfma_f32_32x32x16_bf16 v[208:223], v[36:39], v[112:115], 0
R 32,4,45056
R 34,4,47104
buffer_load_dwordx4 v17, s[32:35], s75 offen offset:2048 lds
MV 96,40,116
R 36,7,45056
R 38,7,47104
MV 208,44,116
R 40,4,46080
R 42,4,48128
buffer_load_dwordx4 v18, s[32:35], s75 offen offset:3072 lds
v_fma_f32 v64, v240, v240, v27
v_fma_f32 v65, v241, v241, v27
v_fma_f32 v66, v242, v242, v27
v_fma_f32 v67, v243, v243, v27
s_waitcnt lgkmcnt(6)
MV 96,48,120
R 44,7,46080
R 46,7,48128
v_mul_f32 v64, v64, v240
v_mul_f32 v65, v65, v241
v_mul_f32 v66, v66, v242
v_mul_f32 v67, v67, v243
v_exp_f32 v64, v64
MV 208,52,120
R 48,4,49152
R 50,4,51200
v_exp_f32 v65, v65
s_add_u32 m0, s67, 118784
s_add_u32 s75, s61, 590336
MV 96,56,124
R 52,7,49152
R 54,7,51200
buffer_load_dwordx4 v15, s[32:35], s75 offen offset:0 lds
v_exp_f32 v66, v66
v_exp_f32 v67, v67
MV 208,60,124
R 56,4,50176
R 58,4,52224
v_fma_f32 v64, v64, v28, v28
v_fma_f32 v65, v65, v28, v28
v_fma_f32 v66, v66, v28, v28
v_fma_f32 v67, v67, v28, v28
v_rcp_f32 v64, v64
s_waitcnt lgkmcnt(4)
MV 96,32,128
R 60,7,50176
R 62,7,52224
v_rcp_f32 v65, v65
v_rcp_f32 v66, v66
MV 208,36,128
R 32,4,53248
R 34,4,55296
v_rcp_f32 v67, v67
v_mul_f32 v240, v240, v64
v_mul_f32 v241, v241, v65
v_mul_f32 v242, v242, v66
MV 96,40,132
R 36,7,53248
R 38,7,55296
v_mul_f32 v243, v243, v67
CV 240,240,241
CV 242,242,243
v_fma_f32 v64, v244, v244, v27
v_fma_f32 v65, v245, v245, v27
MV 208,44,132
R 40,4,54272
R 42,4,56320
v_fma_f32 v66, v246, v246, v27
v_fma_f32 v67, v247, v247, v27
v_mul_f32 v64, v64, v244
v_mul_f32 v65, v65, v245
v_mul_f32 v66, v66, v246
MV 96,48,136
R 44,7,54272
R 46,7,56320
v_mul_f32 v67, v67, v247
v_exp_f32 v64, v64
v_exp_f32 v65, v65
s_waitcnt lgkmcnt(4)
MV 208,52,136
s_waitcnt vmcnt(10)
s_barrier
R 48,4,57344
R 50,4,59392
MV 96,56,140
R 52,7,57344
R 54,7,59392
v_exp_f32 v66, v66
v_exp_f32 v67, v67
s_add_u32 m0, s67, 0
s_add_u32 s75, s61, 2654720
MV 208,60,140
R 56,4,58368
R 58,4,60416
buffer_load_dwordx4 v15, s[32:35], s75 offen offset:0 lds
v_fma_f32 v64, v64, v28, v28
v_fma_f32 v65, v65, v28, v28
v_fma_f32 v66, v66, v28, v28
MV 96,32,144
R 60,7,58368
R 62,7,60416
v_fma_f32 v67, v67, v28, v28
v_rcp_f32 v64, v64
v_rcp_f32 v65, v65
MV 208,36,144
R 32,4,61440
R 34,4,63488
v_rcp_f32 v66, v66
v_rcp_f32 v67, v67
s_waitcnt lgkmcnt(5)
MV 96,40,148
R 36,7,61440
R 38,7,63488
v_mul_f32 v244, v244, v64
v_mul_f32 v245, v245, v65
v_mul_f32 v246, v246, v66
v_mul_f32 v247, v247, v67
CV 244,244,245
MV 208,44,148
R 40,4,62464
R 42,4,64512
CV 246,246,247
v_fma_f32 v64, v248, v248, v27
v_fma_f32 v65, v249, v249, v27
v_fma_f32 v66, v250, v250, v27
v_fma_f32 v67, v251, v251, v27
MV 96,48,152
R 44,7,62464
R 46,7,64512
v_mul_f32 v64, v64, v248
v_mul_f32 v65, v65, v249
v_mul_f32 v66, v66, v250
v_mul_f32 v67, v67, v251
v_exp_f32 v64, v64
MV 208,52,152
R 48,8,0
R 50,8,2048
buffer_load_dwordx4 v16, s[32:35], s75 offen offset:1024 lds
v_exp_f32 v65, v65
v_exp_f32 v66, v66
s_waitcnt lgkmcnt(4)
MV 96,56,156
R 52,9,0
R 54,9,2048
v_exp_f32 v67, v67
v_fma_f32 v64, v64, v28, v28
v_fma_f32 v65, v65, v28, v28
MV 208,60,156
R 56,8,1024
R 58,8,3072
v_fma_f32 v66, v66, v28, v28
v_fma_f32 v67, v67, v28, v28
v_rcp_f32 v64, v64
v_rcp_f32 v65, v65
MV 96,32,160
R 60,9,1024
R 62,9,3072
buffer_load_dwordx4 v17, s[32:35], s75 offen offset:2048 lds
v_rcp_f32 v66, v66
MV 208,36,160
R 32,8,4096
R 34,8,6144
v_rcp_f32 v67, v67
v_mul_f32 v248, v248, v64
v_mul_f32 v249, v249, v65
v_mul_f32 v250, v250, v66
MV 96,40,164
R 36,9,4096
R 38,9,6144
buffer_load_dwordx4 v18, s[32:35], s75 offen offset:3072 lds
v_mul_f32 v251, v251, v67
v_permlane16_swap_b32 v240, v244
v_permlane16_swap_b32 v242, v246
v_accvgpr_write_b32 a32, v240
s_waitcnt lgkmcnt(5)
MV 208,44,164
R 40,8,5120
R 42,8,7168
v_accvgpr_write_b32 a33, v242
v_accvgpr_write_b32 a36, v244
v_accvgpr_write_b32 a37, v246
CV 248,248,249
s_add_u32 m0, s67, 4096
s_add_u32 s75, s61, 2949632
MV 96,48,168
R 44,9,5120
R 46,9,7168
buffer_load_dwordx4 v15, s[32:35], s75 offen offset:0 lds
CV 250,250,251
v_fma_f32 v64, v252, v252, v27
v_fma_f32 v65, v253, v253, v27
MV 208,52,168
R 48,8,8192
R 50,8,10240
v_fma_f32 v66, v254, v254, v27
v_fma_f32 v67, v255, v255, v27
v_mul_f32 v64, v64, v252
v_mul_f32 v65, v65, v253
v_mul_f32 v66, v66, v254
MV 96,56,172
R 52,9,8192
R 54,9,10240
v_mul_f32 v67, v67, v255
v_exp_f32 v64, v64
v_exp_f32 v65, v65
s_waitcnt lgkmcnt(4)
MV 208,60,172
R 56,8,9216
R 58,8,11264
v_exp_f32 v66, v66
v_exp_f32 v67, v67
v_fma_f32 v64, v64, v28, v28
MV 96,32,176
R 60,9,9216
R 62,9,11264
v_fma_f32 v65, v65, v28, v28
v_fma_f32 v66, v66, v28, v28
v_fma_f32 v67, v67, v28, v28
v_rcp_f32 v64, v64
MV 208,36,176
R 32,8,12288
R 34,8,14336
v_rcp_f32 v65, v65
v_rcp_f32 v66, v66
v_rcp_f32 v67, v67
MV 96,40,180
R 36,9,12288
R 38,9,14336
v_mul_f32 v252, v252, v64
v_mul_f32 v253, v253, v65
v_mul_f32 v254, v254, v66
v_mul_f32 v255, v255, v67
MV 208,44,180
R 40,8,13312
R 42,8,15360
buffer_load_dwordx4 v16, s[32:35], s75 offen offset:1024 lds
CV 252,252,253
CV 254,254,255
s_nop 0
v_permlane16_swap_b32 v248, v252
s_waitcnt lgkmcnt(4)
MV 96,48,184
R 44,9,13312
R 46,9,15360
v_permlane16_swap_b32 v250, v254
v_accvgpr_write_b32 a34, v248
v_accvgpr_write_b32 a35, v250
v_accvgpr_write_b32 a38, v252
v_accvgpr_write_b32 a39, v254
MV 208,52,184
R 48,8,16384
R 50,8,18432
buffer_load_dwordx4 v17, s[32:35], s75 offen offset:2048 lds
v_fma_f32 v64, v80, v80, v27
v_fma_f32 v65, v81, v81, v27
v_fma_f32 v66, v82, v82, v27
v_fma_f32 v67, v83, v83, v27
MV 96,56,188
R 52,9,16384
R 54,9,18432
v_mul_f32 v64, v64, v80
v_mul_f32 v65, v65, v81
v_mul_f32 v66, v66, v82
v_mul_f32 v67, v67, v83
v_exp_f32 v64, v64
MV 208,60,188
R 56,8,17408
R 58,8,19456
buffer_load_dwordx4 v18, s[32:35], s75 offen offset:3072 lds
v_exp_f32 v65, v65
v_exp_f32 v66, v66
MV 96,32,192
R 60,9,17408
R 62,9,19456
v_exp_f32 v67, v67
v_fma_f32 v64, v64, v28, v28
v_fma_f32 v65, v65, v28, v28
s_waitcnt lgkmcnt(4)
MV 208,36,192
R 32,8,20480
R 34,8,22528
v_fma_f32 v66, v66, v28, v28
v_fma_f32 v67, v67, v28, v28
v_rcp_f32 v64, v64
s_add_u32 m0, s67, 8192
s_add_u32 s75, s61, 3244544
MV 96,40,196
R 36,9,20480
R 38,9,22528
buffer_load_dwordx4 v15, s[32:35], s75 offen offset:0 lds
v_rcp_f32 v65, v65
v_rcp_f32 v66, v66
MV 208,44,196
R 40,8,21504
R 42,8,23552
v_rcp_f32 v67, v67
v_mul_f32 v80, v80, v64
v_mul_f32 v81, v81, v65
MV 96,48,200
R 44,9,21504
R 46,9,23552
v_mul_f32 v82, v82, v66
v_mul_f32 v83, v83, v67
CV 80,80,81
CV 82,82,83
v_fma_f32 v64, v84, v84, v27
MV 208,52,200
R 48,8,24576
R 50,8,26624
v_fma_f32 v65, v85, v85, v27
v_fma_f32 v66, v86, v86, v27
v_fma_f32 v67, v87, v87, v27
v_mul_f32 v64, v64, v84
v_mul_f32 v65, v65, v85
s_waitcnt lgkmcnt(4)
MV 96,56,204
R 52,9,24576
R 54,9,26624
v_mul_f32 v66, v66, v86
v_mul_f32 v67, v67, v87
v_exp_f32 v64, v64
MV 208,60,204
R 56,8,25600
R 58,8,27648
v_exp_f32 v65, v65
v_exp_f32 v66, v66
v_exp_f32 v67, v67
MS 96,32,144
R 60,9,25600
R 62,9,27648
v_fma_f32 v64, v64, v28, v28
v_fma_f32 v65, v65, v28, v28
v_fma_f32 v66, v66, v28, v28
v_fma_f32 v67, v67, v28, v28
MS 208,36,144
s_waitcnt vmcnt(9)
s_barrier
R 32,8,28672
R 34,8,30720
MS 96,40,148
R 36,9,28672
R 38,9,30720
v_rcp_f32 v64, v64
v_rcp_f32 v65, v65
s_add_u32 m0, s67, 36864
s_add_u32 s75, s61, 640
s_waitcnt lgkmcnt(4)
MS 208,44,148
R 40,8,29696
R 42,8,31744
buffer_load_dwordx4 v15, s[32:35], s75 offen offset:0 lds
v_rcp_f32 v66, v66
v_rcp_f32 v67, v67
MS 96,48,152
R 44,9,29696
R 46,9,31744
v_mul_f32 v84, v84, v64
v_mul_f32 v85, v85, v65
LM_pad10:
s_cbranch_execz LM_ret
v_mul_f32 v86, v86, v66
v_mul_f32 v87, v87, v67
MS 208,52,152
R 48,8,32768
R 50,8,34816
CV 84,84,85
CV 86,86,87
v_fma_f32 v64, v88, v88, v27
v_fma_f32 v65, v89, v89, v27
v_fma_f32 v66, v90, v90, v27
MS 96,56,156
R 52,9,32768
R 54,9,34816
v_fma_f32 v67, v91, v91, v27
v_mul_f32 v64, v64, v88
v_mul_f32 v65, v65, v89
v_mul_f32 v66, v66, v90
v_mul_f32 v67, v67, v91
MS 208,60,156
R 56,8,33792
R 58,8,35840
v_exp_f32 v64, v64
v_exp_f32 v65, v65
v_exp_f32 v66, v66
s_waitcnt lgkmcnt(4)
MS 96,32,160
R 60,9,33792
R 62,9,35840
v_exp_f32 v67, v67
v_fma_f32 v64, v64, v28, v28
v_fma_f32 v65, v65, v28, v28
MS 208,36,160
R 32,8,36864
R 34,8,38912
buffer_load_dwordx4 v16, s[32:35], s75 offen offset:1024 lds
v_fma_f32 v66, v66, v28, v28
v_fma_f32 v67, v67, v28, v28
v_rcp_f32 v64, v64
MS 96,40,164
R 36,9,36864
R 38,9,38912
v_rcp_f32 v65, v65
v_rcp_f32 v66, v66
MS 208,44,164
R 40,8,37888
R 42,8,39936
v_rcp_f32 v67, v67
v_mul_f32 v88, v88, v64
v_mul_f32 v89, v89, v65
v_mul_f32 v90, v90, v66
MS 96,48,168
R 44,9,37888
R 46,9,39936
buffer_load_dwordx4 v17, s[32:35], s75 offen offset:2048 lds
v_mul_f32 v91, v91, v67
v_permlane16_swap_b32 v80, v84
v_permlane16_swap_b32 v82, v86
v_accvgpr_write_b32 a40, v80
s_waitcnt lgkmcnt(4)
MS 208,52,168
R 48,8,40960
R 50,8,43008
v_accvgpr_write_b32 a41, v82
v_accvgpr_write_b32 a44, v84
v_accvgpr_write_b32 a45, v86
CV 88,88,89
CV 90,90,91
s_add_u32 s100, s100, 4096
s_addc_u32 s101, s101, 0
MS 96,56,172
R 52,9,40960
R 54,9,43008
global_load_dword v0, v23, s[100:101]
buffer_load_dwordx4 v18, s[32:35], s75 offen offset:3072 lds
v_fma_f32 v64, v92, v92, v27
v_fma_f32 v65, v93, v93, v27
v_fma_f32 v66, v94, v94, v27
v_fma_f32 v67, v95, v95, v27
MS 208,60,172
R 56,8,41984
R 58,8,44032
v_mul_f32 v64, v64, v92
v_mul_f32 v65, v65, v93
v_mul_f32 v66, v66, v94
s_add_u32 m0, s67, 40960
s_add_u32 s75, s61, 295552
MS 96,32,176
R 60,9,41984
R 62,9,44032
buffer_load_dwordx4 v15, s[32:35], s75 offen offset:0 lds
v_mul_f32 v67, v67, v95
v_exp_f32 v64, v64
v_exp_f32 v65, v65
MS 208,36,176
R 32,8,45056
R 34,8,47104
v_exp_f32 v66, v66
v_exp_f32 v67, v67
s_waitcnt lgkmcnt(4)
MS 96,40,180
R 36,9,45056
R 38,9,47104
v_fma_f32 v64, v64, v28, v28
v_fma_f32 v65, v65, v28, v28
v_fma_f32 v66, v66, v28, v28
v_fma_f32 v67, v67, v28, v28
v_rcp_f32 v64, v64
MS 208,44,180
R 40,8,46080
R 42,8,48128
v_rcp_f32 v65, v65
v_rcp_f32 v66, v66
MS 96,48,184
R 44,9,46080
R 46,9,48128
v_rcp_f32 v67, v67
v_mul_f32 v92, v92, v64
v_mul_f32 v93, v93, v65
v_mul_f32 v94, v94, v66
MS 208,52,184
R 48,8,49152
R 50,8,51200
v_mul_f32 v95, v95, v67
CV 92,92,93
CV 94,94,95
s_nop 0
v_permlane16_swap_b32 v88, v92
MS 96,56,188
R 52,9,49152
R 54,9,51200
v_permlane16_swap_b32 v90, v94
v_accvgpr_write_b32 a42, v88
v_accvgpr_write_b32 a43, v90
v_accvgpr_write_b32 a46, v92
v_accvgpr_write_b32 a47, v94
s_waitcnt lgkmcnt(4)
MS 208,60,188
R 56,8,50176
R 58,8,52224
buffer_load_dwordx4 v16, s[32:35], s75 offen offset:1024 lds
v_mfma_f32_32x32x16_bf16 v[224:239], v[32:35], v[112:115], 0
R 60,9,50176
R 62,9,52224
v_mfma_f32_32x32x16_bf16 v[240:255], v[36:39], v[112:115], 0
R 32,8,53248
R 34,8,55296
buffer_load_dwordx4 v17, s[32:35], s75 offen offset:2048 lds
MV 224,40,116
R 36,9,53248
R 38,9,55296
MV 240,44,116
R 40,8,54272
R 42,8,56320
buffer_load_dwordx4 v18, s[32:35], s75 offen offset:3072 lds
v_fma_f32 v64, v96, v96, v27
v_fma_f32 v65, v97, v97, v27
v_fma_f32 v66, v98, v98, v27
v_fma_f32 v67, v99, v99, v27
s_waitcnt lgkmcnt(6)
MV 224,48,120
R 44,9,54272
R 46,9,56320
v_mul_f32 v64, v64, v96
v_mul_f32 v65, v65, v97
v_mul_f32 v66, v66, v98
v_mul_f32 v67, v67, v99
v_exp_f32 v64, v64
MV 240,52,120
R 48,8,57344
R 50,8,59392
v_exp_f32 v65, v65
s_add_u32 m0, s67, 45056
s_add_u32 s75, s61, 590464
MV 224,56,124
R 52,9,57344
R 54,9,59392
buffer_load_dwordx4 v15, s[32:35], s75 offen offset:0 lds
v_exp_f32 v66, v66
v_exp_f32 v67, v67
MV 240,60,124
R 56,8,58368
R 58,8,60416
v_fma_f32 v64, v64, v28, v28
v_fma_f32 v65, v65, v28, v28
v_fma_f32 v66, v66, v28, v28
v_fma_f32 v67, v67, v28, v28
v_rcp_f32 v64, v64
s_waitcnt lgkmcnt(4)
MV 224,32,128
R 60,9,58368
R 62,9,60416
v_rcp_f32 v65, v65
v_rcp_f32 v66, v66
MV 240,36,128
R 32,8,61440
R 34,8,63488
v_rcp_f32 v67, v67
v_mul_f32 v96, v96, v64
v_mul_f32 v97, v97, v65
v_mul_f32 v98, v98, v66
MV 224,40,132
R 36,9,61440
R 38,9,63488
v_mul_f32 v99, v99, v67
CV 96,96,97
CV 98,98,99
v_fma_f32 v64, v100, v100, v27
v_fma_f32 v65, v101, v101, v27
MV 240,44,132
R 40,8,62464
R 42,8,64512
v_fma_f32 v66, v102, v102, v27
v_fma_f32 v67, v103, v103, v27
v_mul_f32 v64, v64, v100
v_mul_f32 v65, v65, v101
v_mul_f32 v66, v66, v102
MV 224,48,136
R 44,9,62464
R 46,9,64512
v_mul_f32 v67, v67, v103
v_exp_f32 v64, v64
v_exp_f32 v65, v65
s_waitcnt lgkmcnt(4)
MV 240,52,136
s_waitcnt vmcnt(10)
s_barrier
R 48,2,0
R 50,2,2048
MV 224,56,140
R 52,5,0
R 54,5,2048
v_exp_f32 v66, v66
v_exp_f32 v67, v67
s_add_u32 m0, s67, 73728
s_add_u32 s75, s61, 2654848
MV 240,60,140
R 56,2,1024
R 58,2,3072
buffer_load_dwordx4 v15, s[32:35], s75 offen offset:0 lds
v_fma_f32 v64, v64, v28, v28
v_fma_f32 v65, v65, v28, v28
v_fma_f32 v66, v66, v28, v28
MV 224,32,144
R 60,5,1024
R 62,5,3072
v_fma_f32 v67, v67, v28, v28
v_rcp_f32 v64, v64
v_rcp_f32 v65, v65
MV 240,36,144
R 32,2,4096
R 34,2,6144
v_rcp_f32 v66, v66
v_rcp_f32 v67, v67
s_waitcnt lgkmcnt(5)
MV 224,40,148
R 36,5,4096
R 38,5,6144
v_mul_f32 v100, v100, v64
v_mul_f32 v101, v101, v65
v_mul_f32 v102, v102, v66
v_mul_f32 v103, v103, v67
CV 100,100,101
MV 240,44,148
R 40,2,5120
R 42,2,7168
CV 102,102,103
v_fma_f32 v64, v104, v104, v27
v_fma_f32 v65, v105, v105, v27
v_fma_f32 v66, v106, v106, v27
v_fma_f32 v67, v107, v107, v27
MV 224,48,152
R 44,5,5120
R 46,5,7168
v_mul_f32 v64, v64, v104
v_mul_f32 v65, v65, v105
v_mul_f32 v66, v66, v106
v_mul_f32 v67, v67, v107
v_exp_f32 v64, v64
MV 240,52,152
R 48,2,8192
R 50,2,10240
buffer_load_dwordx4 v16, s[32:35], s75 offen offset:1024 lds
v_exp_f32 v65, v65
v_exp_f32 v66, v66
s_waitcnt lgkmcnt(4)
MV 224,56,156
R 52,5,8192
R 54,5,10240
v_exp_f32 v67, v67
v_fma_f32 v64, v64, v28, v28
v_fma_f32 v65, v65, v28, v28
MV 240,60,156
R 56,2,9216
R 58,2,11264
v_fma_f32 v66, v66, v28, v28
v_fma_f32 v67, v67, v28, v28
v_rcp_f32 v64, v64
v_rcp_f32 v65, v65
MV 224,32,160
R 60,5,9216
R 62,5,11264
buffer_load_dwordx4 v17, s[32:35], s75 offen offset:2048 lds
v_rcp_f32 v66, v66
MV 240,36,160
R 32,2,12288
R 34,2,14336
v_rcp_f32 v67, v67
v_mul_f32 v104, v104, v64
v_mul_f32 v105, v105, v65
v_mul_f32 v106, v106, v66
MV 224,40,164
R 36,5,12288
R 38,5,14336
buffer_load_dwordx4 v18, s[32:35], s75 offen offset:3072 lds
v_mul_f32 v107, v107, v67
v_permlane16_swap_b32 v96, v100
v_permlane16_swap_b32 v98, v102
v_accvgpr_write_b32 a48, v96
s_waitcnt lgkmcnt(5)
MV 240,44,164
R 40,2,13312
R 42,2,15360
v_accvgpr_write_b32 a49, v98
v_accvgpr_write_b32 a52, v100
v_accvgpr_write_b32 a53, v102
CV 104,104,105
s_add_u32 m0, s67, 77824
s_add_u32 s75, s61, 2949760
MV 224,48,168
R 44,5,13312
R 46,5,15360
buffer_load_dwordx4 v15, s[32:35], s75 offen offset:0 lds
CV 106,106,107
v_fma_f32 v64, v108, v108, v27
v_fma_f32 v65, v109, v109, v27
MV 240,52,168
R 48,4,0
R 50,4,2048
v_fma_f32 v66, v110, v110, v27
v_fma_f32 v67, v111, v111, v27
v_mul_f32 v64, v64, v108
v_mul_f32 v65, v65, v109
v_mul_f32 v66, v66, v110
MV 224,56,172
R 52,7,0
R 54,7,2048
v_mul_f32 v67, v67, v111
v_exp_f32 v64, v64
v_exp_f32 v65, v65
s_waitcnt lgkmcnt(4)
MV 240,60,172
R 56,4,1024
R 58,4,3072
v_exp_f32 v66, v66
v_exp_f32 v67, v67
v_fma_f32 v64, v64, v28, v28
MV 224,32,176
R 60,7,1024
R 62,7,3072
v_fma_f32 v65, v65, v28, v28
v_fma_f32 v66, v66, v28, v28
v_fma_f32 v67, v67, v28, v28
v_rcp_f32 v64, v64
MV 240,36,176
R 32,4,4096
R 34,4,6144
v_rcp_f32 v65, v65
v_rcp_f32 v66, v66
v_rcp_f32 v67, v67
MV 224,40,180
R 36,7,4096
R 38,7,6144
v_mul_f32 v108, v108, v64
v_mul_f32 v109, v109, v65
v_mul_f32 v110, v110, v66
v_mul_f32 v111, v111, v67
MV 240,44,180
R 40,4,5120
R 42,4,7168
buffer_load_dwordx4 v16, s[32:35], s75 offen offset:1024 lds
CV 108,108,109
CV 110,110,111
s_nop 0
v_permlane16_swap_b32 v104, v108
s_waitcnt lgkmcnt(4)
MV 224,48,184
R 44,7,5120
R 46,7,7168
v_permlane16_swap_b32 v106, v110
v_accvgpr_write_b32 a50, v104
v_accvgpr_write_b32 a51, v106
v_accvgpr_write_b32 a54, v108
v_accvgpr_write_b32 a55, v110
MV 240,52,184
R 48,4,8192
R 50,4,10240
buffer_load_dwordx4 v17, s[32:35], s75 offen offset:2048 lds
v_fma_f32 v64, v208, v208, v27
v_fma_f32 v65, v209, v209, v27
v_fma_f32 v66, v210, v210, v27
v_fma_f32 v67, v211, v211, v27
MV 224,56,188
R 52,7,8192
R 54,7,10240
v_mul_f32 v64, v64, v208
v_mul_f32 v65, v65, v209
v_mul_f32 v66, v66, v210
v_mul_f32 v67, v67, v211
v_exp_f32 v64, v64
MV 240,60,188
R 56,4,9216
R 58,4,11264
buffer_load_dwordx4 v18, s[32:35], s75 offen offset:3072 lds
v_exp_f32 v65, v65
v_exp_f32 v66, v66
MV 224,32,192
R 60,7,9216
R 62,7,11264
v_exp_f32 v67, v67
v_fma_f32 v64, v64, v28, v28
v_fma_f32 v65, v65, v28, v28
s_waitcnt lgkmcnt(4)
MV 240,36,192
R 32,4,12288
R 34,4,14336
v_fma_f32 v66, v66, v28, v28
v_fma_f32 v67, v67, v28, v28
v_rcp_f32 v64, v64
s_add_u32 m0, s67, 81920
s_add_u32 s75, s61, 3244672
MV 224,40,196
R 36,7,12288
R 38,7,14336
buffer_load_dwordx4 v15, s[32:35], s75 offen offset:0 lds
v_rcp_f32 v65, v65
v_rcp_f32 v66, v66
MV 240,44,196
R 40,4,13312
R 42,4,15360
v_rcp_f32 v67, v67
v_mul_f32 v208, v208, v64
v_mul_f32 v209, v209, v65
MV 224,48,200
R 44,7,13312
R 46,7,15360
v_mul_f32 v210, v210, v66
v_mul_f32 v211, v211, v67
CV 208,208,209
CV 210,210,211
v_fma_f32 v64, v212, v212, v27
MV 240,52,200
R 48,4,16384
R 50,4,18432
v_fma_f32 v65, v213, v213, v27
v_fma_f32 v66, v214, v214, v27
v_fma_f32 v67, v215, v215, v27
v_mul_f32 v64, v64, v212
v_mul_f32 v65, v65, v213
s_waitcnt lgkmcnt(4)
MV 224,56,204
R 52,7,16384
R 54,7,18432
v_mul_f32 v66, v66, v214
v_mul_f32 v67, v67, v215
v_exp_f32 v64, v64
MV 240,60,204
R 56,4,17408
R 58,4,19456
v_exp_f32 v65, v65
v_exp_f32 v66, v66
v_exp_f32 v67, v67
MS 224,32,144
R 60,7,17408
R 62,7,19456
v_fma_f32 v64, v64, v28, v28
v_fma_f32 v65, v65, v28, v28
v_fma_f32 v66, v66, v28, v28
v_fma_f32 v67, v67, v28, v28
MS 240,36,144
s_waitcnt vmcnt(9)
s_barrier
R 32,4,20480
R 34,4,22528
MS 224,40,148
R 36,7,20480
R 38,7,22528
v_rcp_f32 v64, v64
v_rcp_f32 v65, v65
s_add_u32 m0, s67, 110592
s_add_u32 s75, s61, 768
s_waitcnt lgkmcnt(4)
MS 240,44,148
R 40,4,21504
R 42,4,23552
buffer_load_dwordx4 v15, s[32:35], s75 offen offset:0 lds
v_rcp_f32 v66, v66
v_rcp_f32 v67, v67
MS 224,48,152
R 44,7,21504
R 46,7,23552
v_mul_f32 v212, v212, v64
v_mul_f32 v213, v213, v65
v_mul_f32 v214, v214, v66
v_mul_f32 v215, v215, v67
MS 240,52,152
R 48,4,24576
R 50,4,26624
CV 212,212,213
CV 214,214,215
v_fma_f32 v64, v216, v216, v27
v_fma_f32 v65, v217, v217, v27
v_fma_f32 v66, v218, v218, v27
MS 224,56,156
R 52,7,24576
R 54,7,26624
v_fma_f32 v67, v219, v219, v27
v_mul_f32 v64, v64, v216
v_mul_f32 v65, v65, v217
v_mul_f32 v66, v66, v218
v_mul_f32 v67, v67, v219
MS 240,60,156
R 56,4,25600
R 58,4,27648
v_exp_f32 v64, v64
v_exp_f32 v65, v65
v_exp_f32 v66, v66
s_waitcnt lgkmcnt(4)
MS 224,32,160
R 60,7,25600
R 62,7,27648
v_exp_f32 v67, v67
v_fma_f32 v64, v64, v28, v28
v_fma_f32 v65, v65, v28, v28
MS 240,36,160
R 32,4,28672
R 34,4,30720
buffer_load_dwordx4 v16, s[32:35], s75 offen offset:1024 lds
v_fma_f32 v66, v66, v28, v28
v_fma_f32 v67, v67, v28, v28
v_rcp_f32 v64, v64
MS 224,40,164
R 36,7,28672
R 38,7,30720
v_rcp_f32 v65, v65
v_rcp_f32 v66, v66
MS 240,44,164
R 40,4,29696
R 42,4,31744
v_rcp_f32 v67, v67
v_mul_f32 v216, v216, v64
v_mul_f32 v217, v217, v65
v_mul_f32 v218, v218, v66
MS 224,48,168
R 44,7,29696
R 46,7,31744
buffer_load_dwordx4 v17, s[32:35], s75 offen offset:2048 lds
v_mul_f32 v219, v219, v67
v_permlane16_swap_b32 v208, v212
v_permlane16_swap_b32 v210, v214
v_accvgpr_write_b32 a56, v208
s_waitcnt lgkmcnt(4)
MS 240,52,168
R 48,4,32768
R 50,4,34816
v_accvgpr_write_b32 a57, v210
v_accvgpr_write_b32 a60, v212
v_accvgpr_write_b32 a61, v214
CV 216,216,217
CV 218,218,219
MS 224,56,172
R 52,7,32768
R 54,7,34816
buffer_load_dwordx4 v18, s[32:35], s75 offen offset:3072 lds
v_fma_f32 v64, v220, v220, v27
v_fma_f32 v65, v221, v221, v27
v_fma_f32 v66, v222, v222, v27
v_fma_f32 v67, v223, v223, v27
MS 240,60,172
R 56,4,33792
R 58,4,35840
v_mul_f32 v64, v64, v220
v_mul_f32 v65, v65, v221
v_mul_f32 v66, v66, v222
s_add_u32 m0, s67, 114688
s_add_u32 s75, s61, 295680
MS 224,32,176
R 60,7,33792
R 62,7,35840
buffer_load_dwordx4 v15, s[32:35], s75 offen offset:0 lds
v_mul_f32 v67, v67, v223
v_exp_f32 v64, v64
v_exp_f32 v65, v65
MS 240,36,176
R 32,4,36864
R 34,4,38912
v_exp_f32 v66, v66
v_exp_f32 v67, v67
s_waitcnt lgkmcnt(4)
MS 224,40,180
R 36,7,36864
R 38,7,38912
v_fma_f32 v64, v64, v28, v28
v_fma_f32 v65, v65, v28, v28
v_fma_f32 v66, v66, v28, v28
v_fma_f32 v67, v67, v28, v28
v_rcp_f32 v64, v64
MS 240,44,180
LM_pad11:
s_cbranch_execz LM_ret
R 40,4,37888
R 42,4,39936
v_rcp_f32 v65, v65
v_rcp_f32 v66, v66
MS 224,48,184
R 44,7,37888
R 46,7,39936
v_rcp_f32 v67, v67
v_mul_f32 v220, v220, v64
v_mul_f32 v221, v221, v65
v_mul_f32 v222, v222, v66
MS 240,52,184
R 48,4,40960
R 50,4,43008
v_mul_f32 v223, v223, v67
CV 220,220,221
CV 222,222,223
s_nop 0
v_permlane16_swap_b32 v216, v220
MS 224,56,188
R 52,7,40960
R 54,7,43008
v_permlane16_swap_b32 v218, v222
v_accvgpr_write_b32 a58, v216
v_accvgpr_write_b32 a59, v218
v_accvgpr_write_b32 a62, v220
v_accvgpr_write_b32 a63, v222
s_waitcnt lgkmcnt(4)
MS 240,60,188
R 56,4,41984
R 58,4,44032
buffer_load_dwordx4 v16, s[32:35], s75 offen offset:1024 lds
v_mfma_f32_32x32x16_bf16 v[80:95], v[32:35], v[112:115], 0
R 60,7,41984
R 62,7,44032
v_mfma_f32_32x32x16_bf16 v[96:111], v[36:39], v[112:115], 0
R 32,4,45056
R 34,4,47104
buffer_load_dwordx4 v17, s[32:35], s75 offen offset:2048 lds
MV 80,40,116
R 36,7,45056
R 38,7,47104
MV 96,44,116
R 40,4,46080
R 42,4,48128
buffer_load_dwordx4 v18, s[32:35], s75 offen offset:3072 lds
v_fma_f32 v64, v224, v224, v27
v_fma_f32 v65, v225, v225, v27
v_fma_f32 v66, v226, v226, v27
v_fma_f32 v67, v227, v227, v27
s_add_u32 s100, s100, 4096
s_addc_u32 s101, s101, 0
s_waitcnt lgkmcnt(6)
MV 80,48,120
R 44,7,46080
R 46,7,48128
global_load_dword v0, v23, s[100:101]
v_mul_f32 v64, v64, v224
v_mul_f32 v65, v65, v225
v_mul_f32 v66, v66, v226
v_mul_f32 v67, v67, v227
v_exp_f32 v64, v64
MV 96,52,120
R 48,4,49152
R 50,4,51200
v_exp_f32 v65, v65
s_add_u32 m0, s67, 118784
s_add_u32 s75, s61, 590592
MV 80,56,124
R 52,7,49152
R 54,7,51200
buffer_load_dwordx4 v15, s[32:35], s75 offen offset:0 lds
v_exp_f32 v66, v66
v_exp_f32 v67, v67
MV 96,60,124
R 56,4,50176
R 58,4,52224
v_fma_f32 v64, v64, v28, v28
v_fma_f32 v65, v65, v28, v28
v_fma_f32 v66, v66, v28, v28
v_fma_f32 v67, v67, v28, v28
v_rcp_f32 v64, v64
s_waitcnt lgkmcnt(4)
MV 80,32,128
R 60,7,50176
R 62,7,52224
v_rcp_f32 v65, v65
v_rcp_f32 v66, v66
MV 96,36,128
R 32,4,53248
R 34,4,55296
v_rcp_f32 v67, v67
v_mul_f32 v224, v224, v64
v_mul_f32 v225, v225, v65
v_mul_f32 v226, v226, v66
MV 80,40,132
R 36,7,53248
R 38,7,55296
v_mul_f32 v227, v227, v67
CV 224,224,225
CV 226,226,227
v_fma_f32 v64, v228, v228, v27
v_fma_f32 v65, v229, v229, v27
MV 96,44,132
R 40,4,54272
R 42,4,56320
v_fma_f32 v66, v230, v230, v27
v_fma_f32 v67, v231, v231, v27
v_mul_f32 v64, v64, v228
v_mul_f32 v65, v65, v229
v_mul_f32 v66, v66, v230
MV 80,48,136
R 44,7,54272
R 46,7,56320
v_mul_f32 v67, v67, v231
v_exp_f32 v64, v64
v_exp_f32 v65, v65
s_waitcnt lgkmcnt(4)
MV 96,52,136
s_waitcnt vmcnt(10)
s_barrier
R 48,4,57344
R 50,4,59392
MV 80,56,140
R 52,7,57344
R 54,7,59392
v_exp_f32 v66, v66
v_exp_f32 v67, v67
s_add_u32 m0, s67, 0
s_add_u32 s75, s61, 2654976
MV 96,60,140
R 56,4,58368
R 58,4,60416
buffer_load_dwordx4 v15, s[32:35], s75 offen offset:0 lds
v_fma_f32 v64, v64, v28, v28
v_fma_f32 v65, v65, v28, v28
v_fma_f32 v66, v66, v28, v28
MV 80,32,144
R 60,7,58368
R 62,7,60416
v_fma_f32 v67, v67, v28, v28
v_rcp_f32 v64, v64
v_rcp_f32 v65, v65
MV 96,36,144
R 32,4,61440
R 34,4,63488
v_rcp_f32 v66, v66
v_rcp_f32 v67, v67
s_waitcnt lgkmcnt(5)
MV 80,40,148
R 36,7,61440
R 38,7,63488
v_mul_f32 v228, v228, v64
v_mul_f32 v229, v229, v65
v_mul_f32 v230, v230, v66
v_mul_f32 v231, v231, v67
CV 228,228,229
MV 96,44,148
R 40,4,62464
R 42,4,64512
CV 230,230,231
v_fma_f32 v64, v232, v232, v27
v_fma_f32 v65, v233, v233, v27
v_fma_f32 v66, v234, v234, v27
v_fma_f32 v67, v235, v235, v27
MV 80,48,152
R 44,7,62464
R 46,7,64512
v_mul_f32 v64, v64, v232
v_mul_f32 v65, v65, v233
v_mul_f32 v66, v66, v234
v_mul_f32 v67, v67, v235
v_exp_f32 v64, v64
MV 96,52,152
R 48,8,0
R 50,8,2048
buffer_load_dwordx4 v16, s[32:35], s75 offen offset:1024 lds
v_exp_f32 v65, v65
v_exp_f32 v66, v66
s_waitcnt lgkmcnt(4)
MV 80,56,156
R 52,9,0
R 54,9,2048
v_exp_f32 v67, v67
v_fma_f32 v64, v64, v28, v28
v_fma_f32 v65, v65, v28, v28
MV 96,60,156
R 56,8,1024
R 58,8,3072
v_fma_f32 v66, v66, v28, v28
v_fma_f32 v67, v67, v28, v28
v_rcp_f32 v64, v64
v_rcp_f32 v65, v65
MV 80,32,160
R 60,9,1024
R 62,9,3072
buffer_load_dwordx4 v17, s[32:35], s75 offen offset:2048 lds
v_rcp_f32 v66, v66
MV 96,36,160
R 32,8,4096
R 34,8,6144
v_rcp_f32 v67, v67
v_mul_f32 v232, v232, v64
v_mul_f32 v233, v233, v65
v_mul_f32 v234, v234, v66
MV 80,40,164
R 36,9,4096
R 38,9,6144
buffer_load_dwordx4 v18, s[32:35], s75 offen offset:3072 lds
v_mul_f32 v235, v235, v67
v_permlane16_swap_b32 v224, v228
v_permlane16_swap_b32 v226, v230
v_accvgpr_write_b32 a64, v224
s_waitcnt lgkmcnt(5)
MV 96,44,164
R 40,8,5120
R 42,8,7168
v_accvgpr_write_b32 a65, v226
v_accvgpr_write_b32 a68, v228
v_accvgpr_write_b32 a69, v230
CV 232,232,233
s_add_u32 m0, s67, 4096
s_add_u32 s75, s61, 2949888
MV 80,48,168
R 44,9,5120
R 46,9,7168
buffer_load_dwordx4 v15, s[32:35], s75 offen offset:0 lds
CV 234,234,235
v_fma_f32 v64, v236, v236, v27
v_fma_f32 v65, v237, v237, v27
MV 96,52,168
R 48,8,8192
R 50,8,10240
v_fma_f32 v66, v238, v238, v27
v_fma_f32 v67, v239, v239, v27
v_mul_f32 v64, v64, v236
v_mul_f32 v65, v65, v237
v_mul_f32 v66, v66, v238
MV 80,56,172
R 52,9,8192
R 54,9,10240
v_mul_f32 v67, v67, v239
v_exp_f32 v64, v64
v_exp_f32 v65, v65
s_waitcnt lgkmcnt(4)
MV 96,60,172
R 56,8,9216
R 58,8,11264
v_exp_f32 v66, v66
v_exp_f32 v67, v67
v_fma_f32 v64, v64, v28, v28
MV 80,32,176
R 60,9,9216
R 62,9,11264
v_fma_f32 v65, v65, v28, v28
v_fma_f32 v66, v66, v28, v28
v_fma_f32 v67, v67, v28, v28
v_rcp_f32 v64, v64
MV 96,36,176
R 32,8,12288
R 34,8,14336
v_rcp_f32 v65, v65
v_rcp_f32 v66, v66
v_rcp_f32 v67, v67
MV 80,40,180
R 36,9,12288
R 38,9,14336
v_mul_f32 v236, v236, v64
v_mul_f32 v237, v237, v65
v_mul_f32 v238, v238, v66
v_mul_f32 v239, v239, v67
MV 96,44,180
R 40,8,13312
R 42,8,15360
buffer_load_dwordx4 v16, s[32:35], s75 offen offset:1024 lds
CV 236,236,237
CV 238,238,239
s_nop 0
v_permlane16_swap_b32 v232, v236
s_waitcnt lgkmcnt(4)
MV 80,48,184
R 44,9,13312
R 46,9,15360
v_permlane16_swap_b32 v234, v238
v_accvgpr_write_b32 a66, v232
v_accvgpr_write_b32 a67, v234
v_accvgpr_write_b32 a70, v236
v_accvgpr_write_b32 a71, v238
MV 96,52,184
R 48,8,16384
R 50,8,18432
buffer_load_dwordx4 v17, s[32:35], s75 offen offset:2048 lds
v_fma_f32 v64, v240, v240, v27
v_fma_f32 v65, v241, v241, v27
v_fma_f32 v66, v242, v242, v27
v_fma_f32 v67, v243, v243, v27
MV 80,56,188
R 52,9,16384
R 54,9,18432
v_mul_f32 v64, v64, v240
v_mul_f32 v65, v65, v241
v_mul_f32 v66, v66, v242
v_mul_f32 v67, v67, v243
v_exp_f32 v64, v64
MV 96,60,188
R 56,8,17408
R 58,8,19456
buffer_load_dwordx4 v18, s[32:35], s75 offen offset:3072 lds
v_exp_f32 v65, v65
v_exp_f32 v66, v66
MV 80,32,192
R 60,9,17408
R 62,9,19456
v_exp_f32 v67, v67
v_fma_f32 v64, v64, v28, v28
v_fma_f32 v65, v65, v28, v28
s_waitcnt lgkmcnt(4)
MV 96,36,192
R 32,8,20480
R 34,8,22528
v_fma_f32 v66, v66, v28, v28
v_fma_f32 v67, v67, v28, v28
v_rcp_f32 v64, v64
s_add_u32 m0, s67, 8192
s_add_u32 s75, s61, 3244800
MV 80,40,196
R 36,9,20480
R 38,9,22528
buffer_load_dwordx4 v15, s[32:35], s75 offen offset:0 lds
v_rcp_f32 v65, v65
v_rcp_f32 v66, v66
MV 96,44,196
R 40,8,21504
R 42,8,23552
v_rcp_f32 v67, v67
v_mul_f32 v240, v240, v64
v_mul_f32 v241, v241, v65
MV 80,48,200
R 44,9,21504
R 46,9,23552
v_mul_f32 v242, v242, v66
v_mul_f32 v243, v243, v67
CV 240,240,241
CV 242,242,243
v_fma_f32 v64, v244, v244, v27
MV 96,52,200
R 48,8,24576
R 50,8,26624
v_fma_f32 v65, v245, v245, v27
v_fma_f32 v66, v246, v246, v27
v_fma_f32 v67, v247, v247, v27
v_mul_f32 v64, v64, v244
v_mul_f32 v65, v65, v245
s_waitcnt lgkmcnt(4)
MV 80,56,204
R 52,9,24576
R 54,9,26624
v_mul_f32 v66, v66, v246
v_mul_f32 v67, v67, v247
v_exp_f32 v64, v64
MV 96,60,204
R 56,8,25600
R 58,8,27648
v_exp_f32 v65, v65
v_exp_f32 v66, v66
v_exp_f32 v67, v67
MS 80,32,144
R 60,9,25600
R 62,9,27648
v_fma_f32 v64, v64, v28, v28
v_fma_f32 v65, v65, v28, v28
v_fma_f32 v66, v66, v28, v28
v_fma_f32 v67, v67, v28, v28
MS 96,36,144
s_waitcnt vmcnt(9)
s_barrier
R 32,8,28672
R 34,8,30720
MS 80,40,148
R 36,9,28672
R 38,9,30720
v_rcp_f32 v64, v64
v_rcp_f32 v65, v65
s_add_u32 m0, s67, 36864
s_add_u32 s75, s61, 896
s_waitcnt lgkmcnt(4)
MS 96,44,148
R 40,8,29696
R 42,8,31744
buffer_load_dwordx4 v15, s[32:35], s75 offen offset:0 lds
v_rcp_f32 v66, v66
v_rcp_f32 v67, v67
MS 80,48,152
R 44,9,29696
R 46,9,31744
v_mul_f32 v244, v244, v64
v_mul_f32 v245, v245, v65
v_mul_f32 v246, v246, v66
v_mul_f32 v247, v247, v67
MS 96,52,152
R 48,8,32768
R 50,8,34816
CV 244,244,245
CV 246,246,247
v_fma_f32 v64, v248, v248, v27
v_fma_f32 v65, v249, v249, v27
v_fma_f32 v66, v250, v250, v27
MS 80,56,156
R 52,9,32768
R 54,9,34816
v_fma_f32 v67, v251, v251, v27
v_mul_f32 v64, v64, v248
v_mul_f32 v65, v65, v249
v_mul_f32 v66, v66, v250
v_mul_f32 v67, v67, v251
MS 96,60,156
R 56,8,33792
R 58,8,35840
v_exp_f32 v64, v64
v_exp_f32 v65, v65
v_exp_f32 v66, v66
s_waitcnt lgkmcnt(4)
MS 80,32,160
R 60,9,33792
R 62,9,35840
v_exp_f32 v67, v67
v_fma_f32 v64, v64, v28, v28
v_fma_f32 v65, v65, v28, v28
MS 96,36,160
R 32,8,36864
R 34,8,38912
buffer_load_dwordx4 v16, s[32:35], s75 offen offset:1024 lds
v_fma_f32 v66, v66, v28, v28
v_fma_f32 v67, v67, v28, v28
v_rcp_f32 v64, v64
MS 80,40,164
R 36,9,36864
R 38,9,38912
v_rcp_f32 v65, v65
v_rcp_f32 v66, v66
MS 96,44,164
R 40,8,37888
R 42,8,39936
v_rcp_f32 v67, v67
v_mul_f32 v248, v248, v64
v_mul_f32 v249, v249, v65
v_mul_f32 v250, v250, v66
MS 80,48,168
R 44,9,37888
R 46,9,39936
buffer_load_dwordx4 v17, s[32:35], s75 offen offset:2048 lds
v_mul_f32 v251, v251, v67
v_permlane16_swap_b32 v240, v244
v_permlane16_swap_b32 v242, v246
v_accvgpr_write_b32 a72, v240
s_waitcnt lgkmcnt(4)
MS 96,52,168
R 48,8,40960
R 50,8,43008
v_accvgpr_write_b32 a73, v242
v_accvgpr_write_b32 a76, v244
v_accvgpr_write_b32 a77, v246
CV 248,248,249
CV 250,250,251
MS 80,56,172
R 52,9,40960
R 54,9,43008
buffer_load_dwordx4 v18, s[32:35], s75 offen offset:3072 lds
v_fma_f32 v64, v252, v252, v27
v_fma_f32 v65, v253, v253, v27
v_fma_f32 v66, v254, v254, v27
v_fma_f32 v67, v255, v255, v27
MS 96,60,172
R 56,8,41984
R 58,8,44032
v_mul_f32 v64, v64, v252
v_mul_f32 v65, v65, v253
v_mul_f32 v66, v66, v254
s_add_u32 m0, s67, 40960
s_add_u32 s75, s61, 295808
MS 80,32,176
R 60,9,41984
R 62,9,44032
buffer_load_dwordx4 v15, s[32:35], s75 offen offset:0 lds
v_mul_f32 v67, v67, v255
v_exp_f32 v64, v64
v_exp_f32 v65, v65
MS 96,36,176
R 32,8,45056
R 34,8,47104
v_exp_f32 v66, v66
v_exp_f32 v67, v67
s_waitcnt lgkmcnt(4)
MS 80,40,180
R 36,9,45056
R 38,9,47104
v_fma_f32 v64, v64, v28, v28
v_fma_f32 v65, v65, v28, v28
v_fma_f32 v66, v66, v28, v28
v_fma_f32 v67, v67, v28, v28
v_rcp_f32 v64, v64
MS 96,44,180
R 40,8,46080
R 42,8,48128
v_rcp_f32 v65, v65
v_rcp_f32 v66, v66
MS 80,48,184
R 44,9,46080
R 46,9,48128
v_rcp_f32 v67, v67
v_mul_f32 v252, v252, v64
v_mul_f32 v253, v253, v65
v_mul_f32 v254, v254, v66
MS 96,52,184
R 48,8,49152
R 50,8,51200
v_mul_f32 v255, v255, v67
CV 252,252,253
CV 254,254,255
s_nop 0
v_permlane16_swap_b32 v248, v252
MS 80,56,188
R 52,9,49152
R 54,9,51200
v_permlane16_swap_b32 v250, v254
v_accvgpr_write_b32 a74, v248
v_accvgpr_write_b32 a75, v250
v_accvgpr_write_b32 a78, v252
v_accvgpr_write_b32 a79, v254
s_waitcnt lgkmcnt(4)
MS 96,60,188
R 56,8,50176
R 58,8,52224
buffer_load_dwordx4 v16, s[32:35], s75 offen offset:1024 lds
v_mfma_f32_32x32x16_bf16 v[208:223], v[32:35], v[112:115], 0
R 60,9,50176
R 62,9,52224
v_mfma_f32_32x32x16_bf16 v[224:239], v[36:39], v[112:115], 0
R 32,8,53248
R 34,8,55296
buffer_load_dwordx4 v17, s[32:35], s75 offen offset:2048 lds
MV 208,40,116
R 36,9,53248
R 38,9,55296
MV 224,44,116
R 40,8,54272
R 42,8,56320
buffer_load_dwordx4 v18, s[32:35], s75 offen offset:3072 lds
v_fma_f32 v64, v80, v80, v27
v_fma_f32 v65, v81, v81, v27
v_fma_f32 v66, v82, v82, v27
v_fma_f32 v67, v83, v83, v27
s_waitcnt lgkmcnt(6)
MV 208,48,120
R 44,9,54272
R 46,9,56320
v_mul_f32 v64, v64, v80
v_mul_f32 v65, v65, v81
v_mul_f32 v66, v66, v82
v_mul_f32 v67, v67, v83
v_exp_f32 v64, v64
MV 224,52,120
R 48,8,57344
R 50,8,59392
v_exp_f32 v65, v65
s_add_u32 m0, s67, 45056
s_add_u32 s75, s61, 590720
MV 208,56,124
R 52,9,57344
R 54,9,59392
buffer_load_dwordx4 v15, s[32:35], s75 offen offset:0 lds
v_exp_f32 v66, v66
v_exp_f32 v67, v67
MV 224,60,124
R 56,8,58368
R 58,8,60416
v_fma_f32 v64, v64, v28, v28
v_fma_f32 v65, v65, v28, v28
v_fma_f32 v66, v66, v28, v28
v_fma_f32 v67, v67, v28, v28
v_rcp_f32 v64, v64
s_waitcnt lgkmcnt(4)
MV 208,32,128
R 60,9,58368
R 62,9,60416
v_rcp_f32 v65, v65
v_rcp_f32 v66, v66
MV 224,36,128
R 32,8,61440
R 34,8,63488
v_rcp_f32 v67, v67
v_mul_f32 v80, v80, v64
v_mul_f32 v81, v81, v65
v_mul_f32 v82, v82, v66
MV 208,40,132
R 36,9,61440
R 38,9,63488
v_mul_f32 v83, v83, v67
CV 80,80,81
CV 82,82,83
v_fma_f32 v64, v84, v84, v27
v_fma_f32 v65, v85, v85, v27
MV 224,44,132
R 40,8,62464
R 42,8,64512
LM_pad12:
s_cbranch_execz LM_ret
v_fma_f32 v66, v86, v86, v27
v_fma_f32 v67, v87, v87, v27
v_mul_f32 v64, v64, v84
v_mul_f32 v65, v65, v85
v_mul_f32 v66, v66, v86
MV 208,48,136
R 44,9,62464
R 46,9,64512
v_mul_f32 v67, v67, v87
v_exp_f32 v64, v64
v_exp_f32 v65, v65
s_waitcnt lgkmcnt(4)
MV 224,52,136
s_waitcnt vmcnt(9)
s_barrier
R 48,2,0
R 50,2,2048
MV 208,56,140
R 52,5,0
R 54,5,2048
v_exp_f32 v66, v66
v_exp_f32 v67, v67
s_add_u32 m0, s67, 73728
s_add_u32 s75, s61, 2655104
MV 224,60,140
R 56,2,1024
R 58,2,3072
buffer_load_dwordx4 v15, s[32:35], s75 offen offset:0 lds
v_fma_f32 v64, v64, v28, v28
v_fma_f32 v65, v65, v28, v28
v_fma_f32 v66, v66, v28, v28
MV 208,32,144
R 60,5,1024
R 62,5,3072
v_fma_f32 v67, v67, v28, v28
v_rcp_f32 v64, v64
v_rcp_f32 v65, v65
MV 224,36,144
R 32,2,4096
R 34,2,6144
v_rcp_f32 v66, v66
v_rcp_f32 v67, v67
s_waitcnt lgkmcnt(5)
MV 208,40,148
R 36,5,4096
R 38,5,6144
v_mul_f32 v84, v84, v64
v_mul_f32 v85, v85, v65
v_mul_f32 v86, v86, v66
v_mul_f32 v87, v87, v67
CV 84,84,85
MV 224,44,148
R 40,2,5120
R 42,2,7168
CV 86,86,87
v_fma_f32 v64, v88, v88, v27
v_fma_f32 v65, v89, v89, v27
v_fma_f32 v66, v90, v90, v27
v_fma_f32 v67, v91, v91, v27
MV 208,48,152
R 44,5,5120
R 46,5,7168
v_mul_f32 v64, v64, v88
v_mul_f32 v65, v65, v89
v_mul_f32 v66, v66, v90
v_mul_f32 v67, v67, v91
v_exp_f32 v64, v64
s_add_u32 s100, s100, 4096
s_addc_u32 s101, s101, 0
MV 224,52,152
R 48,2,8192
R 50,2,10240
global_load_dword v0, v23, s[100:101]
buffer_load_dwordx4 v16, s[32:35], s75 offen offset:1024 lds
v_exp_f32 v65, v65
v_exp_f32 v66, v66
s_waitcnt lgkmcnt(4)
MV 208,56,156
R 52,5,8192
R 54,5,10240
v_exp_f32 v67, v67
v_fma_f32 v64, v64, v28, v28
v_fma_f32 v65, v65, v28, v28
MV 224,60,156
R 56,2,9216
R 58,2,11264
v_fma_f32 v66, v66, v28, v28
v_fma_f32 v67, v67, v28, v28
v_rcp_f32 v64, v64
v_rcp_f32 v65, v65
MV 208,32,160
R 60,5,9216
R 62,5,11264
buffer_load_dwordx4 v17, s[32:35], s75 offen offset:2048 lds
v_rcp_f32 v66, v66
MV 224,36,160
R 32,2,12288
R 34,2,14336
v_rcp_f32 v67, v67
v_mul_f32 v88, v88, v64
v_mul_f32 v89, v89, v65
v_mul_f32 v90, v90, v66
MV 208,40,164
R 36,5,12288
R 38,5,14336
buffer_load_dwordx4 v18, s[32:35], s75 offen offset:3072 lds
v_mul_f32 v91, v91, v67
v_permlane16_swap_b32 v80, v84
v_permlane16_swap_b32 v82, v86
v_accvgpr_write_b32 a80, v80
s_waitcnt lgkmcnt(5)
MV 224,44,164
s_mov_b64 exec, 0
s_cmp_eq_u32 s52, 0
s_cbranch_scc1 LM_pad13
s_cmp_eq_u32 s52, 1
s_cbranch_scc1 LM_pad14
s_cmp_eq_u32 s52, 2
s_cbranch_scc1 LM_pad15
s_branch LM_pad16
LM_cr0:
s_mov_b64 exec, -1
R 40,2,13312
R 42,2,15360
v_accvgpr_write_b32 a81, v82
v_accvgpr_write_b32 a84, v84
v_accvgpr_write_b32 a85, v86
CV 88,88,89
s_add_u32 m0, s67, 77824
s_add_u32 s75, s61, 2950016
MV 208,48,168
R 44,5,13312
R 46,5,15360
buffer_load_dwordx4 v15, s[32:35], s75 offen offset:0 lds
CV 90,90,91
v_fma_f32 v64, v92, v92, v27
v_fma_f32 v65, v93, v93, v27
MV 224,52,168
R 48,4,0
R 50,4,2048
v_fma_f32 v66, v94, v94, v27
v_fma_f32 v67, v95, v95, v27
v_mul_f32 v64, v64, v92
v_mul_f32 v65, v65, v93
v_mul_f32 v66, v66, v94
MV 208,56,172
R 52,7,0
R 54,7,2048
v_mul_f32 v67, v67, v95
v_exp_f32 v64, v64
v_exp_f32 v65, v65
s_waitcnt lgkmcnt(4)
MV 224,60,172
R 56,4,1024
R 58,4,3072
v_exp_f32 v66, v66
v_exp_f32 v67, v67
v_fma_f32 v64, v64, v28, v28
MV 208,32,176
R 60,7,1024
R 62,7,3072
v_fma_f32 v65, v65, v28, v28
v_fma_f32 v66, v66, v28, v28
v_fma_f32 v67, v67, v28, v28
v_rcp_f32 v64, v64
MV 224,36,176
R 32,4,4096
R 34,4,6144
v_rcp_f32 v65, v65
v_rcp_f32 v66, v66
v_rcp_f32 v67, v67
MV 208,40,180
R 36,7,4096
R 38,7,6144
v_mul_f32 v92, v92, v64
v_mul_f32 v93, v93, v65
v_mul_f32 v94, v94, v66
v_mul_f32 v95, v95, v67
MV 224,44,180
R 40,4,5120
R 42,4,7168
buffer_load_dwordx4 v16, s[32:35], s75 offen offset:1024 lds
CV 92,92,93
CV 94,94,95
s_nop 0
v_permlane16_swap_b32 v88, v92
s_waitcnt lgkmcnt(4)
MV 208,48,184
R 44,7,5120
R 46,7,7168
v_permlane16_swap_b32 v90, v94
v_accvgpr_write_b32 a82, v88
v_accvgpr_write_b32 a83, v90
v_accvgpr_write_b32 a86, v92
v_accvgpr_write_b32 a87, v94
MV 224,52,184
R 48,4,8192
R 50,4,10240
buffer_load_dwordx4 v17, s[32:35], s75 offen offset:2048 lds
v_fma_f32 v64, v96, v96, v27
v_fma_f32 v65, v97, v97, v27
v_fma_f32 v66, v98, v98, v27
v_fma_f32 v67, v99, v99, v27
MV 208,56,188
R 52,7,8192
R 54,7,10240
v_mul_f32 v64, v64, v96
v_mul_f32 v65, v65, v97
v_mul_f32 v66, v66, v98
v_mul_f32 v67, v67, v99
v_exp_f32 v64, v64
MV 224,60,188
R 56,4,9216
R 58,4,11264
buffer_load_dwordx4 v18, s[32:35], s75 offen offset:3072 lds
v_exp_f32 v65, v65
v_exp_f32 v66, v66
MV 208,32,192
R 60,7,9216
R 62,7,11264
v_exp_f32 v67, v67
v_fma_f32 v64, v64, v28, v28
v_fma_f32 v65, v65, v28, v28
s_waitcnt lgkmcnt(4)
MV 224,36,192
R 32,4,12288
R 34,4,14336
v_fma_f32 v66, v66, v28, v28
v_fma_f32 v67, v67, v28, v28
v_rcp_f32 v64, v64
s_add_u32 m0, s67, 81920
s_add_u32 s75, s61, 3244928
MV 208,40,196
R 36,7,12288
R 38,7,14336
buffer_load_dwordx4 v15, s[32:35], s75 offen offset:0 lds
v_rcp_f32 v65, v65
v_rcp_f32 v66, v66
MV 224,44,196
R 40,4,13312
R 42,4,15360
v_rcp_f32 v67, v67
v_mul_f32 v96, v96, v64
v_mul_f32 v97, v97, v65
MV 208,48,200
R 44,7,13312
R 46,7,15360
v_mul_f32 v98, v98, v66
v_mul_f32 v99, v99, v67
CV 96,96,97
CV 98,98,99
v_fma_f32 v64, v100, v100, v27
MV 224,52,200
R 48,4,16384
R 50,4,18432
v_fma_f32 v65, v101, v101, v27
v_fma_f32 v66, v102, v102, v27
v_fma_f32 v67, v103, v103, v27
v_mul_f32 v64, v64, v100
v_mul_f32 v65, v65, v101
s_waitcnt lgkmcnt(4)
MV 208,56,204
R 52,7,16384
R 54,7,18432
v_mul_f32 v66, v66, v102
v_mul_f32 v67, v67, v103
v_exp_f32 v64, v64
MV 224,60,204
R 56,4,17408
R 58,4,19456
v_exp_f32 v65, v65
v_exp_f32 v66, v66
v_exp_f32 v67, v67
MS 208,32,144
R 60,7,17408
R 62,7,19456
v_fma_f32 v64, v64, v28, v28
v_fma_f32 v65, v65, v28, v28
v_fma_f32 v66, v66, v28, v28
v_fma_f32 v67, v67, v28, v28
MS 224,36,144
s_waitcnt vmcnt(10)
s_barrier
R 32,4,20480
R 34,4,22528
MS 208,40,148
R 36,7,20480
R 38,7,22528
v_rcp_f32 v64, v64
v_rcp_f32 v65, v65
s_add_u32 m0, s67, 110592
s_add_u32 s75, s61, 1024
s_waitcnt lgkmcnt(4)
MS 224,44,148
R 40,4,21504
R 42,4,23552
buffer_load_dwordx4 v15, s[32:35], s75 offen offset:0 lds
v_rcp_f32 v66, v66
v_rcp_f32 v67, v67
MS 208,48,152
R 44,7,21504
R 46,7,23552
v_mul_f32 v100, v100, v64
v_mul_f32 v101, v101, v65
v_mul_f32 v102, v102, v66
v_mul_f32 v103, v103, v67
MS 224,52,152
R 48,4,24576
R 50,4,26624
CV 100,100,101
CV 102,102,103
v_fma_f32 v64, v104, v104, v27
v_fma_f32 v65, v105, v105, v27
v_fma_f32 v66, v106, v106, v27
MS 208,56,156
R 52,7,24576
R 54,7,26624
v_fma_f32 v67, v107, v107, v27
v_mul_f32 v64, v64, v104
v_mul_f32 v65, v65, v105
v_mul_f32 v66, v66, v106
v_mul_f32 v67, v67, v107
MS 224,60,156
R 56,4,25600
R 58,4,27648
v_exp_f32 v64, v64
v_exp_f32 v65, v65
v_exp_f32 v66, v66
s_waitcnt lgkmcnt(4)
MS 208,32,160
R 60,7,25600
R 62,7,27648
v_exp_f32 v67, v67
v_fma_f32 v64, v64, v28, v28
v_fma_f32 v65, v65, v28, v28
MS 224,36,160
R 32,4,28672
R 34,4,30720
buffer_load_dwordx4 v16, s[32:35], s75 offen offset:1024 lds
v_fma_f32 v66, v66, v28, v28
v_fma_f32 v67, v67, v28, v28
v_rcp_f32 v64, v64
MS 208,40,164
R 36,7,28672
R 38,7,30720
v_rcp_f32 v65, v65
v_rcp_f32 v66, v66
MS 224,44,164
R 40,4,29696
R 42,4,31744
v_rcp_f32 v67, v67
v_mul_f32 v104, v104, v64
v_mul_f32 v105, v105, v65
v_mul_f32 v106, v106, v66
MS 208,48,168
R 44,7,29696
R 46,7,31744
buffer_load_dwordx4 v17, s[32:35], s75 offen offset:2048 lds
v_mul_f32 v107, v107, v67
v_permlane16_swap_b32 v96, v100
v_permlane16_swap_b32 v98, v102
v_accvgpr_write_b32 a88, v96
s_waitcnt lgkmcnt(4)
MS 224,52,168
R 48,4,32768
R 50,4,34816
v_accvgpr_write_b32 a89, v98
v_accvgpr_write_b32 a92, v100
v_accvgpr_write_b32 a93, v102
CV 104,104,105
CV 106,106,107
MS 208,56,172
R 52,7,32768
R 54,7,34816
buffer_load_dwordx4 v18, s[32:35], s75 offen offset:3072 lds
v_fma_f32 v64, v108, v108, v27
v_fma_f32 v65, v109, v109, v27
v_fma_f32 v66, v110, v110, v27
v_fma_f32 v67, v111, v111, v27
MS 224,60,172
R 56,4,33792
R 58,4,35840
v_mul_f32 v64, v64, v108
v_mul_f32 v65, v65, v109
v_mul_f32 v66, v66, v110
s_add_u32 m0, s67, 114688
s_add_u32 s75, s61, 295936
MS 208,32,176
R 60,7,33792
R 62,7,35840
buffer_load_dwordx4 v15, s[32:35], s75 offen offset:0 lds
v_mul_f32 v67, v67, v111
v_exp_f32 v64, v64
v_exp_f32 v65, v65
MS 224,36,176
R 32,4,36864
R 34,4,38912
v_exp_f32 v66, v66
v_exp_f32 v67, v67
s_waitcnt lgkmcnt(4)
MS 208,40,180
R 36,7,36864
R 38,7,38912
v_fma_f32 v64, v64, v28, v28
v_fma_f32 v65, v65, v28, v28
v_fma_f32 v66, v66, v28, v28
v_fma_f32 v67, v67, v28, v28
v_rcp_f32 v64, v64
MS 224,44,180
R 40,4,37888
R 42,4,39936
v_rcp_f32 v65, v65
v_rcp_f32 v66, v66
MS 208,48,184
R 44,7,37888
R 46,7,39936
v_rcp_f32 v67, v67
v_mul_f32 v108, v108, v64
v_mul_f32 v109, v109, v65
v_mul_f32 v110, v110, v66
MS 224,52,184
R 48,4,40960
R 50,4,43008
v_mul_f32 v111, v111, v67
CV 108,108,109
CV 110,110,111
s_nop 0
v_permlane16_swap_b32 v104, v108
MS 208,56,188
R 52,7,40960
R 54,7,43008
v_permlane16_swap_b32 v106, v110
v_accvgpr_write_b32 a90, v104
v_accvgpr_write_b32 a91, v106
v_accvgpr_write_b32 a94, v108
v_accvgpr_write_b32 a95, v110
s_waitcnt lgkmcnt(4)
MS 224,60,188
R 56,4,41984
R 58,4,44032
buffer_load_dwordx4 v16, s[32:35], s75 offen offset:1024 lds
v_mfma_f32_32x32x16_bf16 v[240:255], v[32:35], v[112:115], 0
R 60,7,41984
R 62,7,44032
v_mfma_f32_32x32x16_bf16 v[80:95], v[36:39], v[112:115], 0
R 32,4,45056
R 34,4,47104
buffer_load_dwordx4 v17, s[32:35], s75 offen offset:2048 lds
MV 240,40,116
R 36,7,45056
R 38,7,47104
MV 80,44,116
R 40,4,46080
R 42,4,48128
buffer_load_dwordx4 v18, s[32:35], s75 offen offset:3072 lds
v_fma_f32 v64, v208, v208, v27
v_fma_f32 v65, v209, v209, v27
v_fma_f32 v66, v210, v210, v27
v_fma_f32 v67, v211, v211, v27
s_waitcnt lgkmcnt(6)
MV 240,48,120
R 44,7,46080
R 46,7,48128
v_mul_f32 v64, v64, v208
v_mul_f32 v65, v65, v209
v_mul_f32 v66, v66, v210
v_mul_f32 v67, v67, v211
v_exp_f32 v64, v64
MV 80,52,120
R 48,4,49152
R 50,4,51200
v_exp_f32 v65, v65
s_add_u32 m0, s67, 118784
s_add_u32 s75, s61, 590848
MV 240,56,124
R 52,7,49152
R 54,7,51200
buffer_load_dwordx4 v15, s[32:35], s75 offen offset:0 lds
v_exp_f32 v66, v66
v_exp_f32 v67, v67
MV 80,60,124
R 56,4,50176
R 58,4,52224
v_fma_f32 v64, v64, v28, v28
v_fma_f32 v65, v65, v28, v28
v_fma_f32 v66, v66, v28, v28
v_fma_f32 v67, v67, v28, v28
v_rcp_f32 v64, v64
s_waitcnt lgkmcnt(4)
MV 240,32,128
R 60,7,50176
R 62,7,52224
v_rcp_f32 v65, v65
v_rcp_f32 v66, v66
MV 80,36,128
R 32,4,53248
R 34,4,55296
v_rcp_f32 v67, v67
v_mul_f32 v208, v208, v64
v_mul_f32 v209, v209, v65
v_mul_f32 v210, v210, v66
MV 240,40,132
R 36,7,53248
R 38,7,55296
v_mul_f32 v211, v211, v67
CV 208,208,209
CV 210,210,211
v_fma_f32 v64, v212, v212, v27
v_fma_f32 v65, v213, v213, v27
MV 80,44,132
R 40,4,54272
R 42,4,56320
v_fma_f32 v66, v214, v214, v27
v_fma_f32 v67, v215, v215, v27
v_mul_f32 v64, v64, v212
v_mul_f32 v65, v65, v213
v_mul_f32 v66, v66, v214
MV 240,48,136
R 44,7,54272
R 46,7,56320
v_mul_f32 v67, v67, v215
v_exp_f32 v64, v64
v_exp_f32 v65, v65
s_waitcnt lgkmcnt(4)
MV 80,52,136
s_waitcnt vmcnt(9)
s_barrier
R 48,4,57344
R 50,4,59392
MV 240,56,140
R 52,7,57344
R 54,7,59392
v_exp_f32 v66, v66
v_exp_f32 v67, v67
s_add_u32 m0, s67, 0
s_add_u32 s75, s61, 2655232
MV 80,60,140
R 56,4,58368
R 58,4,60416
buffer_load_dwordx4 v15, s[32:35], s75 offen offset:0 lds
v_fma_f32 v64, v64, v28, v28
v_fma_f32 v65, v65, v28, v28
v_fma_f32 v66, v66, v28, v28
MV 240,32,144
R 60,7,58368
R 62,7,60416
v_fma_f32 v67, v67, v28, v28
v_rcp_f32 v64, v64
v_rcp_f32 v65, v65
MV 80,36,144
R 32,4,61440
R 34,4,63488
v_rcp_f32 v66, v66
v_rcp_f32 v67, v67
s_waitcnt lgkmcnt(5)
MV 240,40,148
R 36,7,61440
R 38,7,63488
v_mul_f32 v212, v212, v64
v_mul_f32 v213, v213, v65
v_mul_f32 v214, v214, v66
v_mul_f32 v215, v215, v67
CV 212,212,213
MV 80,44,148
R 40,4,62464
R 42,4,64512
CV 214,214,215
v_fma_f32 v64, v216, v216, v27
v_fma_f32 v65, v217, v217, v27
v_fma_f32 v66, v218, v218, v27
v_fma_f32 v67, v219, v219, v27
MV 240,48,152
R 44,7,62464
R 46,7,64512
v_mul_f32 v64, v64, v216
v_mul_f32 v65, v65, v217
v_mul_f32 v66, v66, v218
v_mul_f32 v67, v67, v219
v_exp_f32 v64, v64
MV 80,52,152
R 48,8,0
R 50,8,2048
buffer_load_dwordx4 v16, s[32:35], s75 offen offset:1024 lds
v_exp_f32 v65, v65
v_exp_f32 v66, v66
s_waitcnt lgkmcnt(4)
MV 240,56,156
R 52,9,0
R 54,9,2048
v_exp_f32 v67, v67
v_fma_f32 v64, v64, v28, v28
v_fma_f32 v65, v65, v28, v28
MV 80,60,156
R 56,8,1024
R 58,8,3072
v_fma_f32 v66, v66, v28, v28
v_fma_f32 v67, v67, v28, v28
v_rcp_f32 v64, v64
v_rcp_f32 v65, v65
MV 240,32,160
R 60,9,1024
R 62,9,3072
buffer_load_dwordx4 v17, s[32:35], s75 offen offset:2048 lds
v_rcp_f32 v66, v66
MV 80,36,160
R 32,8,4096
R 34,8,6144
v_rcp_f32 v67, v67
v_mul_f32 v216, v216, v64
v_mul_f32 v217, v217, v65
v_mul_f32 v218, v218, v66
MV 240,40,164
R 36,9,4096
R 38,9,6144
buffer_load_dwordx4 v18, s[32:35], s75 offen offset:3072 lds
LM_pad13:
s_cbranch_execz LM_cr0
v_mul_f32 v219, v219, v67
v_permlane16_swap_b32 v208, v212
v_permlane16_swap_b32 v210, v214
v_accvgpr_write_b32 a96, v208
s_waitcnt lgkmcnt(5)
MV 80,44,164
R 40,8,5120
R 42,8,7168
v_accvgpr_write_b32 a97, v210
v_accvgpr_write_b32 a100, v212
v_accvgpr_write_b32 a101, v214
CV 216,216,217
s_add_u32 m0, s67, 4096
s_add_u32 s75, s61, 2950144
MV 240,48,168
R 44,9,5120
R 46,9,7168
buffer_load_dwordx4 v15, s[32:35], s75 offen offset:0 lds
CV 218,218,219
v_fma_f32 v64, v220, v220, v27
v_fma_f32 v65, v221, v221, v27
MV 80,52,168
R 48,8,8192
R 50,8,10240
v_fma_f32 v66, v222, v222, v27
v_fma_f32 v67, v223, v223, v27
v_mul_f32 v64, v64, v220
v_mul_f32 v65, v65, v221
v_mul_f32 v66, v66, v222
MV 240,56,172
R 52,9,8192
R 54,9,10240
v_mul_f32 v67, v67, v223
v_exp_f32 v64, v64
v_exp_f32 v65, v65
s_waitcnt lgkmcnt(4)
MV 80,60,172
R 56,8,9216
R 58,8,11264
v_exp_f32 v66, v66
v_exp_f32 v67, v67
v_fma_f32 v64, v64, v28, v28
MV 240,32,176
R 60,9,9216
R 62,9,11264
v_fma_f32 v65, v65, v28, v28
v_fma_f32 v66, v66, v28, v28
v_fma_f32 v67, v67, v28, v28
v_rcp_f32 v64, v64
MV 80,36,176
R 32,8,12288
R 34,8,14336
v_rcp_f32 v65, v65
v_rcp_f32 v66, v66
v_rcp_f32 v67, v67
MV 240,40,180
R 36,9,12288
R 38,9,14336
v_mul_f32 v220, v220, v64
v_mul_f32 v221, v221, v65
v_mul_f32 v222, v222, v66
v_mul_f32 v223, v223, v67
MV 80,44,180
R 40,8,13312
R 42,8,15360
buffer_load_dwordx4 v16, s[32:35], s75 offen offset:1024 lds
CV 220,220,221
CV 222,222,223
s_nop 0
v_permlane16_swap_b32 v216, v220
s_waitcnt lgkmcnt(4)
MV 240,48,184
R 44,9,13312
R 46,9,15360
v_permlane16_swap_b32 v218, v222
v_accvgpr_write_b32 a98, v216
v_accvgpr_write_b32 a99, v218
v_accvgpr_write_b32 a102, v220
v_accvgpr_write_b32 a103, v222
s_add_u32 s100, s100, 4096
s_addc_u32 s101, s101, 0
MV 80,52,184
R 48,8,16384
R 50,8,18432
global_load_dword v0, v23, s[100:101]
buffer_load_dwordx4 v17, s[32:35], s75 offen offset:2048 lds
v_fma_f32 v64, v224, v224, v27
v_fma_f32 v65, v225, v225, v27
v_fma_f32 v66, v226, v226, v27
v_fma_f32 v67, v227, v227, v27
v_mul_f32 v64, v64, v224
MV 240,56,188
R 52,9,16384
R 54,9,18432
v_mul_f32 v65, v65, v225
v_mul_f32 v66, v66, v226
v_mul_f32 v67, v67, v227
v_exp_f32 v64, v64
MV 80,60,188
R 56,8,17408
R 58,8,19456
buffer_load_dwordx4 v18, s[32:35], s75 offen offset:3072 lds
v_exp_f32 v65, v65
v_exp_f32 v66, v66
MV 240,32,192
R 60,9,17408
R 62,9,19456
v_exp_f32 v67, v67
v_fma_f32 v64, v64, v28, v28
v_fma_f32 v65, v65, v28, v28
v_fma_f32 v66, v66, v28, v28
v_fma_f32 v67, v67, v28, v28
s_waitcnt lgkmcnt(4)
MV 80,36,192
R 32,8,20480
R 34,8,22528
v_rcp_f32 v64, v64
v_rcp_f32 v65, v65
s_add_u32 m0, s67, 8192
s_add_u32 s75, s61, 3245056
MV 240,40,196
R 36,9,20480
R 38,9,22528
buffer_load_dwordx4 v15, s[32:35], s75 offen offset:0 lds
v_rcp_f32 v66, v66
v_rcp_f32 v67, v67
MV 80,44,196
R 40,8,21504
R 42,8,23552
v_mul_f32 v224, v224, v64
v_mul_f32 v225, v225, v65
v_mul_f32 v226, v226, v66
v_mul_f32 v227, v227, v67
CV 224,224,225
CV 226,226,227
MV 240,48,200
R 44,9,21504
R 46,9,23552
v_fma_f32 v64, v228, v228, v27
v_fma_f32 v65, v229, v229, v27
v_fma_f32 v66, v230, v230, v27
v_fma_f32 v67, v231, v231, v27
v_mul_f32 v64, v64, v228
MV 80,52,200
R 48,8,24576
R 50,8,26624
v_mul_f32 v65, v65, v229
v_mul_f32 v66, v66, v230
v_mul_f32 v67, v67, v231
v_exp_f32 v64, v64
s_waitcnt lgkmcnt(4)
MV 240,56,204
R 52,9,24576
R 54,9,26624
v_exp_f32 v65, v65
v_exp_f32 v66, v66
v_exp_f32 v67, v67
MV 80,60,204
R 56,8,25600
R 58,8,27648
v_fma_f32 v64, v64, v28, v28
v_fma_f32 v65, v65, v28, v28
v_fma_f32 v66, v66, v28, v28
v_fma_f32 v67, v67, v28, v28
v_rcp_f32 v64, v64
MS 240,32,144
R 60,9,25600
R 62,9,27648
v_rcp_f32 v65, v65
v_rcp_f32 v66, v66
v_rcp_f32 v67, v67
MS 80,36,144
s_waitcnt vmcnt(10)
s_barrier
R 32,8,28672
R 34,8,30720
MS 240,40,148
R 36,9,28672
R 38,9,30720
v_lshrrev_b32 v12, 3, v1
v_and_b32 v13, 7, v1
v_mul_f32 v228, v228, v64
v_mul_u32_u24 v11, 1152, v12
s_waitcnt lgkmcnt(4)
MS 80,44,148
R 40,8,29696
R 42,8,31744
v_mul_f32 v229, v229, v65
v_mul_f32 v230, v230, v66
v_and_b32 v12, 6, v12
v_mul_f32 v231, v231, v67
v_xor_b32 v13, v12, v13
CV 228,228,229
MS 240,48,152
R 44,9,29696
R 46,9,31744
CV 230,230,231
v_lshl_add_u32 v11, v13, 4, v11
v_fma_f32 v64, v232, v232, v27
v_add_u32 v12, 8192, v11
v_fma_f32 v65, v233, v233, v27
MS 80,52,152
R 48,8,32768
R 50,8,34816
v_fma_f32 v66, v234, v234, v27
v_add_u32 v13, 16384, v11
v_fma_f32 v67, v235, v235, v27
v_add_u32 v14, 24576, v11
v_mul_f32 v64, v64, v232
MS 240,56,156
R 52,9,32768
R 54,9,34816
v_mul_f32 v65, v65, v233
v_and_b32 v19, 3, v1
v_mul_f32 v66, v66, v234
v_lshlrev_b32 v19, 3, v19
v_mul_f32 v67, v67, v235
v_and_b32 v20, 60, v1
MS 80,60,156
R 56,8,33792
R 58,8,35840
v_exp_f32 v64, v64
v_lshl_add_u32 v19, v20, 5, v19
v_exp_f32 v65, v65
v_and_b32 v20, 24, v1
s_waitcnt lgkmcnt(4)
MS 240,32,160
R 60,9,33792
R 62,9,35840
v_lshl_add_u32 v19, v20, 2, v19
v_exp_f32 v66, v66
v_xor_b32 v20, 32, v19
v_exp_f32 v67, v67
MS 80,36,160
R 32,8,36864
R 34,8,38912
v_xor_b32 v21, 64, v19
v_fma_f32 v64, v64, v28, v28
v_xor_b32 v22, 96, v19
v_fma_f32 v65, v65, v28, v28
MS 240,40,164
R 36,9,36864
R 38,9,38912
v_fma_f32 v66, v66, v28, v28
v_fma_f32 v67, v67, v28, v28
v_rcp_f32 v64, v64
s_add_u32 m0, s67, 36864
s_add_u32 s75, s62, 0
MS 80,44,164
R 40,8,37888
R 42,8,39936
buffer_load_dwordx4 v11, s[36:39], s75 offen offset:0 lds
v_rcp_f32 v65, v65
v_rcp_f32 v66, v66
MS 240,48,168
R 44,9,37888
R 46,9,39936
v_rcp_f32 v67, v67
v_mul_f32 v232, v232, v64
v_mul_f32 v233, v233, v65
v_mul_f32 v234, v234, v66
v_mul_f32 v235, v235, v67
s_waitcnt lgkmcnt(4)
MS 80,52,168
R 48,8,40960
R 50,8,43008
v_permlane16_swap_b32 v224, v228
v_permlane16_swap_b32 v226, v230
v_accvgpr_write_b32 a104, v224
v_accvgpr_write_b32 a105, v226
v_accvgpr_write_b32 a108, v228
MS 240,56,172
R 52,9,40960
R 54,9,43008
v_accvgpr_write_b32 a109, v230
CV 232,232,233
CV 234,234,235
v_fma_f32 v64, v236, v236, v27
v_fma_f32 v65, v237, v237, v27
v_fma_f32 v66, v238, v238, v27
MS 80,60,172
R 56,8,41984
R 58,8,44032
v_fma_f32 v67, v239, v239, v27
v_mul_f32 v64, v64, v236
v_mul_f32 v65, v65, v237
v_mul_f32 v66, v66, v238
v_mul_f32 v67, v67, v239
MS 240,32,176
R 60,9,41984
R 62,9,44032
buffer_load_dwordx4 v12, s[36:39], s75 offen offset:1024 lds
v_exp_f32 v64, v64
v_exp_f32 v65, v65
MS 80,36,176
R 32,8,45056
R 34,8,47104
buffer_load_dwordx4 v13, s[36:39], s75 offen offset:2048 lds
v_exp_f32 v66, v66
v_exp_f32 v67, v67
v_fma_f32 v64, v64, v28, v28
s_waitcnt lgkmcnt(4)
MS 240,40,180
R 36,9,45056
R 38,9,47104
v_fma_f32 v65, v65, v28, v28
v_fma_f32 v66, v66, v28, v28
v_fma_f32 v67, v67, v28, v28
v_rcp_f32 v64, v64
MS 80,44,180
R 40,8,46080
R 42,8,48128
buffer_load_dwordx4 v14, s[36:39], s75 offen offset:3072 lds
v_rcp_f32 v65, v65
v_rcp_f32 v66, v66
v_rcp_f32 v67, v67
MS 240,48,184
R 44,9,46080
R 46,9,48128
v_mul_f32 v236, v236, v64
v_mul_f32 v237, v237, v65
s_add_u32 m0, s67, 40960
s_add_u32 s75, s62, 36864
MS 80,52,184
R 48,8,49152
R 50,8,51200
buffer_load_dwordx4 v11, s[36:39], s75 offen offset:0 lds
v_mul_f32 v238, v238, v66
v_mul_f32 v239, v239, v67
CV 236,236,237
CV 238,238,239
s_nop 0
v_permlane16_swap_b32 v232, v236
MS 240,56,188
R 52,9,49152
R 54,9,51200
v_permlane16_swap_b32 v234, v238
v_accvgpr_write_b32 a106, v232
v_accvgpr_write_b32 a107, v234
v_accvgpr_write_b32 a110, v236
v_accvgpr_write_b32 a111, v238
s_waitcnt lgkmcnt(4)
MS 80,60,188
R 56,8,50176
R 58,8,52224
v_mfma_f32_32x32x16_bf16 v[96:111], v[32:35], v[112:115], 0
R 60,9,50176
R 62,9,52224
v_mfma_f32_32x32x16_bf16 v[208:223], v[36:39], v[112:115], 0
R 32,8,53248
R 34,8,55296
MV 96,40,116
R 36,9,53248
R 38,9,55296
buffer_load_dwordx4 v12, s[36:39], s75 offen offset:1024 lds
MV 208,44,116
R 40,8,54272
R 42,8,56320
v_fma_f32 v64, v240, v240, v27
v_fma_f32 v65, v241, v241, v27
v_fma_f32 v66, v242, v242, v27
v_fma_f32 v67, v243, v243, v27
v_mul_f32 v64, v64, v240
s_waitcnt lgkmcnt(6)
MV 96,48,120
R 44,9,54272
R 46,9,56320
buffer_load_dwordx4 v13, s[36:39], s75 offen offset:2048 lds
v_mul_f32 v65, v65, v241
v_mul_f32 v66, v66, v242
v_mul_f32 v67, v67, v243
v_exp_f32 v64, v64
MV 208,52,120
R 48,8,57344
R 50,8,59392
v_exp_f32 v65, v65
v_exp_f32 v66, v66
MV 96,56,124
R 52,9,57344
R 54,9,59392
buffer_load_dwordx4 v14, s[36:39], s75 offen offset:3072 lds
v_exp_f32 v67, v67
s_add_u32 m0, s67, 45056
s_add_u32 s75, s62, 73728
MV 208,60,124
R 56,8,58368
R 58,8,60416
buffer_load_dwordx4 v11, s[36:39], s75 offen offset:0 lds
v_fma_f32 v64, v64, v28, v28
v_fma_f32 v65, v65, v28, v28
v_fma_f32 v66, v66, v28, v28
v_fma_f32 v67, v67, v28, v28
s_waitcnt lgkmcnt(4)
MV 96,32,128
R 60,9,58368
R 62,9,60416
v_rcp_f32 v64, v64
v_rcp_f32 v65, v65
v_rcp_f32 v66, v66
MV 208,36,128
R 32,8,61440
R 34,8,63488
v_rcp_f32 v67, v67
v_mul_f32 v240, v240, v64
v_mul_f32 v241, v241, v65
MV 96,40,132
R 36,9,61440
R 38,9,63488
v_mul_f32 v242, v242, v66
v_mul_f32 v243, v243, v67
CV 240,240,241
CV 242,242,243
v_fma_f32 v64, v244, v244, v27
MV 208,44,132
R 40,8,62464
R 42,8,64512
v_fma_f32 v65, v245, v245, v27
v_fma_f32 v66, v246, v246, v27
v_fma_f32 v67, v247, v247, v27
v_mul_f32 v64, v64, v244
v_mul_f32 v65, v65, v245
MV 96,48,136
R 44,9,62464
R 46,9,64512
v_mul_f32 v66, v66, v246
v_mul_f32 v67, v67, v247
v_exp_f32 v64, v64
v_exp_f32 v65, v65
s_waitcnt lgkmcnt(4)
MV 208,52,136
s_waitcnt vmcnt(9)
s_barrier
R 48,2,0
R 50,2,2048
MV 96,56,140
R 52,5,0
R 54,5,2048
v_exp_f32 v66, v66
s_add_u32 m0, s67, 73728
s_add_u32 s75, s62, 331776
MV 208,60,140
R 56,2,1024
R 58,2,3072
buffer_load_dwordx4 v11, s[36:39], s75 offen offset:0 lds
v_exp_f32 v67, v67
v_fma_f32 v64, v64, v28, v28
v_fma_f32 v65, v65, v28, v28
MV 96,32,144
R 60,5,1024
R 62,5,3072
v_fma_f32 v66, v66, v28, v28
v_fma_f32 v67, v67, v28, v28
v_rcp_f32 v64, v64
v_rcp_f32 v65, v65
MV 208,36,144
R 32,2,4096
R 34,2,6144
v_rcp_f32 v66, v66
v_rcp_f32 v67, v67
s_waitcnt lgkmcnt(4)
MV 96,40,148
R 36,5,4096
R 38,5,6144
v_mul_f32 v244, v244, v64
v_mul_f32 v245, v245, v65
v_mul_f32 v246, v246, v66
v_mul_f32 v247, v247, v67
CV 244,244,245
MV 208,44,148
R 40,2,5120
R 42,2,7168
CV 246,246,247
v_fma_f32 v64, v248, v248, v27
v_fma_f32 v65, v249, v249, v27
v_fma_f32 v66, v250, v250, v27
v_fma_f32 v67, v251, v251, v27
MV 96,48,152
R 44,5,5120
R 46,5,7168
v_mul_f32 v64, v64, v248
v_mul_f32 v65, v65, v249
v_mul_f32 v66, v66, v250
v_mul_f32 v67, v67, v251
MV 208,52,152
R 48,2,8192
R 50,2,10240
buffer_load_dwordx4 v12, s[36:39], s75 offen offset:1024 lds
v_exp_f32 v64, v64
v_exp_f32 v65, v65
MV 96,56,156
R 52,5,8192
R 54,5,10240
v_exp_f32 v66, v66
v_exp_f32 v67, v67
v_fma_f32 v64, v64, v28, v28
s_waitcnt lgkmcnt(4)
MV 208,60,156
R 56,2,9216
R 58,2,11264
v_fma_f32 v65, v65, v28, v28
v_fma_f32 v66, v66, v28, v28
v_fma_f32 v67, v67, v28, v28
v_rcp_f32 v64, v64
MV 96,32,160
R 60,5,9216
R 62,5,11264
buffer_load_dwordx4 v13, s[36:39], s75 offen offset:2048 lds
v_rcp_f32 v65, v65
v_rcp_f32 v66, v66
MV 208,36,160
R 32,2,12288
R 34,2,14336
v_rcp_f32 v67, v67
v_mul_f32 v248, v248, v64
v_mul_f32 v249, v249, v65
v_mul_f32 v250, v250, v66
MV 96,40,164
R 36,5,12288
R 38,5,14336
buffer_load_dwordx4 v14, s[36:39], s75 offen offset:3072 lds
v_mul_f32 v251, v251, v67
v_permlane16_swap_b32 v240, v244
v_permlane16_swap_b32 v242, v246
v_accvgpr_write_b32 a112, v240
MV 208,44,164
R 40,2,13312
R 42,2,15360
v_accvgpr_write_b32 a113, v242
v_accvgpr_write_b32 a116, v244
v_accvgpr_write_b32 a117, v246
s_add_u32 m0, s67, 77824
s_add_u32 s75, s62, 368640
s_waitcnt lgkmcnt(4)
MV 96,48,168
R 44,5,13312
R 46,5,15360
buffer_load_dwordx4 v11, s[36:39], s75 offen offset:0 lds
CV 248,248,249
CV 250,250,251
v_fma_f32 v64, v252, v252, v27
v_fma_f32 v65, v253, v253, v27
MV 208,52,168
R 48,4,0
R 50,4,2048
v_fma_f32 v66, v254, v254, v27
v_fma_f32 v67, v255, v255, v27
v_mul_f32 v64, v64, v252
v_mul_f32 v65, v65, v253
v_mul_f32 v66, v66, v254
MV 96,56,172
R 52,7,0
R 54,7,2048
v_mul_f32 v67, v67, v255
v_exp_f32 v64, v64
v_exp_f32 v65, v65
MV 208,60,172
R 56,4,1024
R 58,4,3072
v_exp_f32 v66, v66
v_exp_f32 v67, v67
v_fma_f32 v64, v64, v28, v28
MV 96,32,176
R 60,7,1024
R 62,7,3072
v_fma_f32 v65, v65, v28, v28
v_fma_f32 v66, v66, v28, v28
v_fma_f32 v67, v67, v28, v28
v_rcp_f32 v64, v64
s_waitcnt lgkmcnt(4)
MV 208,36,176
R 32,4,4096
R 34,4,6144
v_rcp_f32 v65, v65
v_rcp_f32 v66, v66
v_rcp_f32 v67, v67
MV 96,40,180
R 36,7,4096
R 38,7,6144
v_mul_f32 v252, v252, v64
v_mul_f32 v253, v253, v65
v_mul_f32 v254, v254, v66
v_mul_f32 v255, v255, v67
MV 208,44,180
R 40,4,5120
R 42,4,7168
buffer_load_dwordx4 v12, s[36:39], s75 offen offset:1024 lds
CV 252,252,253
CV 254,254,255
s_nop 0
v_permlane16_swap_b32 v248, v252
MV 96,48,184
R 44,7,5120
R 46,7,7168
v_permlane16_swap_b32 v250, v254
v_accvgpr_write_b32 a114, v248
v_accvgpr_write_b32 a115, v250
v_accvgpr_write_b32 a118, v252
v_accvgpr_write_b32 a119, v254
MV 208,52,184
R 48,4,8192
R 50,4,10240
buffer_load_dwordx4 v13, s[36:39], s75 offen offset:2048 lds
v_fma_f32 v64, v80, v80, v27
v_fma_f32 v65, v81, v81, v27
v_fma_f32 v66, v82, v82, v27
v_fma_f32 v67, v83, v83, v27
s_waitcnt lgkmcnt(4)
MV 96,56,188
LM_pad14:
s_cbranch_execz LM_cr0
R 52,7,8192
R 54,7,10240
v_mul_f32 v64, v64, v80
v_mul_f32 v65, v65, v81
v_mul_f32 v66, v66, v82
v_mul_f32 v67, v67, v83
v_exp_f32 v64, v64
MV 208,60,188
R 56,4,9216
R 58,4,11264
buffer_load_dwordx4 v14, s[36:39], s75 offen offset:3072 lds
v_exp_f32 v65, v65
v_exp_f32 v66, v66
MV 96,32,192
R 60,7,9216
R 62,7,11264
v_exp_f32 v67, v67
v_fma_f32 v64, v64, v28, v28
v_fma_f32 v65, v65, v28, v28
MV 208,36,192
R 32,4,12288
R 34,4,14336
v_fma_f32 v66, v66, v28, v28
v_fma_f32 v67, v67, v28, v28
v_rcp_f32 v64, v64
s_add_u32 m0, s67, 81920
s_add_u32 s75, s62, 405504
MV 96,40,196
R 36,7,12288
R 38,7,14336
buffer_load_dwordx4 v11, s[36:39], s75 offen offset:0 lds
v_rcp_f32 v65, v65
v_rcp_f32 v66, v66
s_waitcnt lgkmcnt(4)
MV 208,44,196
R 40,4,13312
R 42,4,15360
v_rcp_f32 v67, v67
v_mul_f32 v80, v80, v64
v_mul_f32 v81, v81, v65
MV 96,48,200
R 44,7,13312
R 46,7,15360
v_mul_f32 v82, v82, v66
v_mul_f32 v83, v83, v67
CV 80,80,81
CV 82,82,83
v_fma_f32 v64, v84, v84, v27
MV 208,52,200
R 48,4,16384
R 50,4,18432
v_fma_f32 v65, v85, v85, v27
v_fma_f32 v66, v86, v86, v27
v_fma_f32 v67, v87, v87, v27
v_mul_f32 v64, v64, v84
v_mul_f32 v65, v65, v85
MV 96,56,204
R 52,7,16384
R 54,7,18432
v_mul_f32 v66, v66, v86
v_mul_f32 v67, v67, v87
v_exp_f32 v64, v64
MV 208,60,204
R 56,4,17408
R 58,4,19456
v_exp_f32 v65, v65
v_exp_f32 v66, v66
v_exp_f32 v67, v67
s_waitcnt lgkmcnt(4)
MS 96,32,144
R 60,7,17408
R 62,7,19456
v_fma_f32 v64, v64, v28, v28
v_fma_f32 v65, v65, v28, v28
v_fma_f32 v66, v66, v28, v28
v_fma_f32 v67, v67, v28, v28
MS 208,36,144
s_waitcnt vmcnt(9)
s_barrier
R 32,4,20480
R 34,4,22528
s_add_u32 s100, s100, 4096
s_addc_u32 s101, s101, 0
MS 96,40,148
R 36,7,20480
R 38,7,22528
global_load_dword v0, v23, s[100:101]
v_rcp_f32 v64, v64
v_rcp_f32 v65, v65
s_add_u32 m0, s67, 110592
s_add_u32 s75, s62, 128
MS 208,44,148
R 40,4,21504
R 42,4,23552
buffer_load_dwordx4 v11, s[36:39], s75 offen offset:0 lds
v_rcp_f32 v66, v66
v_rcp_f32 v67, v67
MS 96,48,152
R 44,7,21504
R 46,7,23552
v_mul_f32 v84, v84, v64
v_mul_f32 v85, v85, v65
v_mul_f32 v86, v86, v66
v_mul_f32 v87, v87, v67
s_waitcnt lgkmcnt(4)
MS 208,52,152
R 48,4,24576
R 50,4,26624
CV 84,84,85
CV 86,86,87
v_fma_f32 v64, v88, v88, v27
v_fma_f32 v65, v89, v89, v27
v_fma_f32 v66, v90, v90, v27
MS 96,56,156
R 52,7,24576
R 54,7,26624
v_fma_f32 v67, v91, v91, v27
v_mul_f32 v64, v64, v88
v_mul_f32 v65, v65, v89
v_mul_f32 v66, v66, v90
v_mul_f32 v67, v67, v91
MS 208,60,156
R 56,4,25600
R 58,4,27648
v_exp_f32 v64, v64
v_exp_f32 v65, v65
v_exp_f32 v66, v66
MS 96,32,160
R 60,7,25600
R 62,7,27648
v_exp_f32 v67, v67
v_fma_f32 v64, v64, v28, v28
v_fma_f32 v65, v65, v28, v28
MS 208,36,160
R 32,4,28672
R 34,4,30720
buffer_load_dwordx4 v12, s[36:39], s75 offen offset:1024 lds
v_fma_f32 v66, v66, v28, v28
v_fma_f32 v67, v67, v28, v28
v_rcp_f32 v64, v64
s_waitcnt lgkmcnt(4)
MS 96,40,164
R 36,7,28672
R 38,7,30720
v_rcp_f32 v65, v65
v_rcp_f32 v66, v66
MS 208,44,164
R 40,4,29696
R 42,4,31744
v_rcp_f32 v67, v67
v_mul_f32 v88, v88, v64
v_mul_f32 v89, v89, v65
v_mul_f32 v90, v90, v66
MS 96,48,168
R 44,7,29696
R 46,7,31744
buffer_load_dwordx4 v13, s[36:39], s75 offen offset:2048 lds
v_mul_f32 v91, v91, v67
v_permlane16_swap_b32 v80, v84
v_permlane16_swap_b32 v82, v86
v_accvgpr_write_b32 a120, v80
MS 208,52,168
R 48,4,32768
R 50,4,34816
v_accvgpr_write_b32 a121, v82
v_accvgpr_write_b32 a124, v84
v_accvgpr_write_b32 a125, v86
CV 88,88,89
CV 90,90,91
MS 96,56,172
R 52,7,32768
R 54,7,34816
buffer_load_dwordx4 v14, s[36:39], s75 offen offset:3072 lds
v_fma_f32 v64, v92, v92, v27
v_fma_f32 v65, v93, v93, v27
v_fma_f32 v66, v94, v94, v27
v_fma_f32 v67, v95, v95, v27
s_waitcnt lgkmcnt(4)
MS 208,60,172
R 56,4,33792
R 58,4,35840
v_mul_f32 v64, v64, v92
v_mul_f32 v65, v65, v93
v_mul_f32 v66, v66, v94
s_add_u32 m0, s67, 114688
s_add_u32 s75, s62, 36992
MS 96,32,176
R 60,7,33792
R 62,7,35840
buffer_load_dwordx4 v11, s[36:39], s75 offen offset:0 lds
v_mul_f32 v67, v67, v95
v_exp_f32 v64, v64
v_exp_f32 v65, v65
MS 208,36,176
R 32,19,36864
R 34,19,38912
v_exp_f32 v66, v66
v_exp_f32 v67, v67
MS 96,40,180
R 36,20,36864
R 38,20,38912
v_fma_f32 v64, v64, v28, v28
v_fma_f32 v65, v65, v28, v28
v_fma_f32 v66, v66, v28, v28
v_fma_f32 v67, v67, v28, v28
v_rcp_f32 v64, v64
MS 208,44,180
R 40,21,36864
R 42,21,38912
v_rcp_f32 v65, v65
v_rcp_f32 v66, v66
s_waitcnt lgkmcnt(4)
MS 96,48,184
R 44,22,36864
R 46,22,38912
v_rcp_f32 v67, v67
v_mul_f32 v92, v92, v64
v_mul_f32 v93, v93, v65
v_mul_f32 v94, v94, v66
MS 208,52,184
R 48,19,40960
R 50,19,43008
v_mul_f32 v95, v95, v67
CV 92,92,93
CV 94,94,95
s_nop 0
v_permlane16_swap_b32 v88, v92
MS 96,56,188
R 52,20,40960
R 54,20,43008
v_permlane16_swap_b32 v90, v94
v_accvgpr_write_b32 a122, v88
v_accvgpr_write_b32 a123, v90
v_accvgpr_write_b32 a126, v92
v_accvgpr_write_b32 a127, v94
MS 208,60,188
R 56,21,40960
R 58,21,43008
buffer_load_dwordx4 v12, s[36:39], s75 offen offset:1024 lds
v_mfma_f32_16x16x32_bf16 v[112:115], v[32:35], a[0:3], 0
R 60,22,40960
v_add_u32 v176, 0x10000, v19
v_mfma_f32_16x16x32_bf16 v[120:123], v[32:35], a[4:7], 0
R 62,22,43008
v_add_u32 v177, 0x10000, v20
s_waitcnt lgkmcnt(6)
v_mfma_f32_16x16x32_bf16 v[116:119], v[36:39], a[0:3], 0
R 184,19,45056
R 186,19,47104
R 188,20,45056
R 190,20,47104
R 192,21,45056
R 194,21,47104
buffer_load_dwordx4 v13, s[36:39], s75 offen offset:2048 lds
v_mfma_f32_16x16x32_bf16 v[124:127], v[36:39], a[4:7], 0
R 196,22,45056
R 198,22,47104
R 200,19,49152
R 202,19,51200
R 32,20,49152
R 34,20,51200
v_mfma_f32_16x16x32_bf16 v[128:131], v[40:43], a[0:3], 0
R 36,21,49152
v_add_u32 v178, 0x10000, v21
v_mfma_f32_16x16x32_bf16 v[136:139], v[40:43], a[4:7], 0
R 38,21,51200
v_add_u32 v179, 0x10000, v22
v_mfma_f32_16x16x32_bf16 v[132:135], v[44:47], a[0:3], 0
R 40,22,49152
buffer_load_dwordx4 v14, s[36:39], s75 offen offset:3072 lds
v_add_u32 v180, 0x20000, v19
v_fma_f32 v64, v96, v96, v27
v_mfma_f32_16x16x32_bf16 v[140:143], v[44:47], a[4:7], 0
R 42,22,51200
v_fma_f32 v65, v97, v97, v27
v_fma_f32 v66, v98, v98, v27
v_add_u32 v181, 0x20000, v20
NA 112,48,8
R 44,19,53248
v_fma_f32 v67, v99, v99, v27
v_mul_f32 v64, v64, v96
v_add_u32 v182, 0x20000, v21
NA 120,48,12
R 46,19,55296
v_mul_f32 v65, v65, v97
v_add_u32 v183, 0x20000, v22
v_mul_f32 v66, v66, v98
s_waitcnt lgkmcnt(5)
NA 116,52,8
R 48,20,53248
v_mul_f32 v67, v67, v99
v_exp_f32 v64, v64
NA 124,52,12
R 50,20,55296
v_exp_f32 v65, v65
s_add_u32 m0, s67, 118784
s_add_u32 s75, s62, 73856
NA 128,56,8
R 52,21,53248
buffer_load_dwordx4 v11, s[36:39], s75 offen offset:0 lds
v_exp_f32 v66, v66
NA 136,56,12
R 54,21,55296
v_exp_f32 v67, v67
NA 132,60,8
R 56,22,53248
v_fma_f32 v64, v64, v28, v28
v_fma_f32 v65, v65, v28, v28
v_fma_f32 v66, v66, v28, v28
NA 140,60,12
R 58,22,55296
v_fma_f32 v67, v67, v28, v28
v_rcp_f32 v64, v64
NA 112,184,16
R 60,19,57344
v_rcp_f32 v65, v65
v_rcp_f32 v66, v66
NA 120,184,20
R 62,19,59392
v_rcp_f32 v67, v67
NA 116,188,16
R 184,20,57344
v_mul_f32 v96, v96, v64
v_mul_f32 v97, v97, v65
NA 124,188,20
R 186,20,59392
v_mul_f32 v98, v98, v66
v_mul_f32 v99, v99, v67
NA 128,192,16
R 188,21,57344
CV 96,96,97
CV 98,98,99
v_fma_f32 v64, v100, v100, v27
NA 136,192,20
R 190,21,59392
v_fma_f32 v65, v101, v101, v27
v_fma_f32 v66, v102, v102, v27
v_fma_f32 v67, v103, v103, v27
NA 132,196,16
R 192,22,57344
v_mul_f32 v64, v64, v100
v_mul_f32 v65, v65, v101
v_mul_f32 v66, v66, v102
NA 140,196,20
R 194,22,59392
v_mul_f32 v67, v67, v103
v_exp_f32 v64, v64
NA 112,200,24
R 196,19,61440
v_exp_f32 v65, v65
v_exp_f32 v66, v66
NA 120,200,28
R 198,19,63488
v_exp_f32 v67, v67
NA 116,32,24
s_waitcnt vmcnt(10)
s_barrier
R 200,20,61440
NA 124,32,28
R 202,20,63488
s_waitcnt lgkmcnt(5)
NA 128,36,24
R 32,21,61440
v_fma_f32 v64, v64, v28, v28
v_fma_f32 v65, v65, v28, v28
NA 136,36,28
R 34,21,63488
v_fma_f32 v66, v66, v28, v28
s_add_u32 m0, s67, 0
s_add_u32 s75, s62, 331904
NA 132,40,24
R 36,22,61440
buffer_load_dwordx4 v11, s[36:39], s75 offen offset:0 lds
v_fma_f32 v67, v67, v28, v28
v_rcp_f32 v64, v64
NA 140,40,28
R 38,22,63488
v_rcp_f32 v65, v65
NA 112,44,32
R 40,176,0
v_rcp_f32 v66, v66
v_rcp_f32 v67, v67
NA 120,44,36
R 42,176,2048
v_mul_f32 v100, v100, v64
v_mul_f32 v101, v101, v65
NA 116,48,32
R 44,177,0
v_mul_f32 v102, v102, v66
v_mul_f32 v103, v103, v67
CV 100,100,101
NA 124,48,36
R 46,177,2048
CV 102,102,103
v_fma_f32 v64, v104, v104, v27
NA 128,52,32
R 48,178,0
v_fma_f32 v65, v105, v105, v27
v_fma_f32 v66, v106, v106, v27
v_fma_f32 v67, v107, v107, v27
NA 136,52,36
R 50,178,2048
v_mul_f32 v64, v64, v104
v_mul_f32 v65, v65, v105
v_mul_f32 v66, v66, v106
NA 132,56,32
R 52,179,0
v_mul_f32 v67, v67, v107
v_exp_f32 v64, v64
NA 140,56,36
R 54,179,2048
v_exp_f32 v65, v65
NA 112,60,40
R 56,176,4096
v_exp_f32 v66, v66
v_exp_f32 v67, v67
NA 120,60,44
R 58,176,6144
v_fma_f32 v64, v64, v28, v28
v_fma_f32 v65, v65, v28, v28
NA 116,184,40
R 60,177,4096
buffer_load_dwordx4 v12, s[36:39], s75 offen offset:1024 lds
v_fma_f32 v66, v66, v28, v28
v_fma_f32 v67, v67, v28, v28
NA 124,184,44
R 62,177,6144
v_rcp_f32 v64, v64
v_rcp_f32 v65, v65
NA 128,188,40
R 184,178,4096
v_rcp_f32 v66, v66
NA 136,188,44
R 186,178,6144
v_rcp_f32 v67, v67
s_waitcnt lgkmcnt(5)
NA 132,192,40
R 188,179,4096
v_mul_f32 v104, v104, v64
v_mul_f32 v105, v105, v65
v_mul_f32 v106, v106, v66
NA 140,192,44
R 190,179,6144
v_mul_f32 v107, v107, v67
v_permlane16_swap_b32 v96, v100
v_permlane16_swap_b32 v98, v102
NA 112,196,48
R 192,176,8192
buffer_load_dwordx4 v13, s[36:39], s75 offen offset:2048 lds
v_accvgpr_write_b32 a128, v96
v_accvgpr_write_b32 a129, v98
NA 120,196,52
R 194,176,10240
v_accvgpr_write_b32 a132, v100
v_accvgpr_write_b32 a133, v102
CV 104,104,105
NA 116,200,48
R 196,177,8192
CV 106,106,107
v_fma_f32 v64, v108, v108, v27
v_fma_f32 v65, v109, v109, v27
NA 124,200,52
R 198,177,10240
v_fma_f32 v66, v110, v110, v27
v_fma_f32 v67, v111, v111, v27
NA 128,32,48
R 200,178,8192
buffer_load_dwordx4 v14, s[36:39], s75 offen offset:3072 lds
v_mul_f32 v64, v64, v108
v_mul_f32 v65, v65, v109
v_mul_f32 v66, v66, v110
NA 136,32,52
R 202,178,10240
v_mul_f32 v67, v67, v111
v_exp_f32 v64, v64
NA 132,36,48
R 32,179,8192
v_exp_f32 v65, v65
NA 140,36,52
R 34,179,10240
v_exp_f32 v66, v66
s_add_u32 m0, s67, 4096
s_add_u32 s75, s62, 368768
NA 112,40,56
R 36,176,12288
buffer_load_dwordx4 v11, s[36:39], s75 offen offset:0 lds
v_exp_f32 v67, v67
NA 120,40,60
R 38,176,14336
v_fma_f32 v64, v64, v28, v28
v_fma_f32 v65, v65, v28, v28
NA 116,44,56
R 40,177,12288
v_fma_f32 v66, v66, v28, v28
v_fma_f32 v67, v67, v28, v28
v_rcp_f32 v64, v64
NA 124,44,60
R 42,177,14336
v_rcp_f32 v65, v65
NA 128,48,56
R 44,178,12288
v_rcp_f32 v66, v66
NA 136,48,60
R 46,178,14336
v_rcp_f32 v67, v67
v_mul_f32 v108, v108, v64
NA 132,52,56
R 48,179,12288
v_mul_f32 v109, v109, v65
v_mul_f32 v110, v110, v66
v_mul_f32 v111, v111, v67
NA 140,52,60
R 50,179,14336
CV 108,108,109
CV 110,110,111
s_nop 0
v_permlane16_swap_b32 v104, v108
s_waitcnt lgkmcnt(5)
NA 112,56,64
R 52,176,16384
v_permlane16_swap_b32 v106, v110
v_accvgpr_write_b32 a130, v104
v_accvgpr_write_b32 a131, v106
NA 120,56,68
R 54,176,18432
v_accvgpr_write_b32 a134, v108
v_accvgpr_write_b32 a135, v110
NA 116,60,64
R 56,177,16384
v_fma_f32 v64, v208, v208, v27
v_fma_f32 v65, v209, v209, v27
v_fma_f32 v66, v210, v210, v27
NA 124,60,68
R 58,177,18432
v_fma_f32 v67, v211, v211, v27
v_mul_f32 v64, v64, v208
v_mul_f32 v65, v65, v209
NA 128,184,64
R 60,178,16384
v_mul_f32 v66, v66, v210
v_mul_f32 v67, v67, v211
v_exp_f32 v64, v64
NA 136,184,68
R 62,178,18432
v_exp_f32 v65, v65
NA 132,188,64
R 184,179,16384
buffer_load_dwordx4 v12, s[36:39], s75 offen offset:1024 lds
v_exp_f32 v66, v66
NA 140,188,68
R 186,179,18432
v_exp_f32 v67, v67
NA 112,192,72
R 188,176,20480
v_fma_f32 v64, v64, v28, v28
v_fma_f32 v65, v65, v28, v28
v_fma_f32 v66, v66, v28, v28
NA 120,192,76
R 190,176,22528
v_fma_f32 v67, v67, v28, v28
v_rcp_f32 v64, v64
NA 116,196,72
R 192,177,20480
buffer_load_dwordx4 v13, s[36:39], s75 offen offset:2048 lds
v_rcp_f32 v65, v65
NA 124,196,76
R 194,177,22528
v_rcp_f32 v66, v66
NA 128,200,72
R 196,178,20480
v_rcp_f32 v67, v67
v_mul_f32 v208, v208, v64
NA 136,200,76
R 198,178,22528
v_mul_f32 v209, v209, v65
v_mul_f32 v210, v210, v66
NA 132,32,72
R 200,179,20480
buffer_load_dwordx4 v14, s[36:39], s75 offen offset:3072 lds
v_mul_f32 v211, v211, v67
CV 208,208,209
NA 140,32,76
R 202,179,22528
CV 210,210,211
v_fma_f32 v64, v212, v212, v27
v_fma_f32 v65, v213, v213, v27
NA 112,36,80
R 32,176,24576
v_fma_f32 v66, v214, v214, v27
v_fma_f32 v67, v215, v215, v27
v_mul_f32 v64, v64, v212
NA 120,36,84
R 34,176,26624
v_mul_f32 v65, v65, v213
v_mul_f32 v66, v66, v214
s_waitcnt lgkmcnt(5)
NA 116,40,80
R 36,177,24576
v_mul_f32 v67, v67, v215
v_exp_f32 v64, v64
LM_pad15:
s_cbranch_execz LM_cr0
NA 124,40,84
R 38,177,26624
v_exp_f32 v65, v65
s_add_u32 m0, s67, 8192
s_add_u32 s75, s62, 405632
NA 128,44,80
R 40,178,24576
buffer_load_dwordx4 v11, s[36:39], s75 offen offset:0 lds
v_exp_f32 v66, v66
NA 136,44,84
R 42,178,26624
v_exp_f32 v67, v67
NA 132,48,80
R 44,179,24576
v_fma_f32 v64, v64, v28, v28
v_fma_f32 v65, v65, v28, v28
v_fma_f32 v66, v66, v28, v28
NA 140,48,84
R 46,179,26624
v_fma_f32 v67, v67, v28, v28
v_rcp_f32 v64, v64
NA 112,52,88
R 48,176,28672
v_rcp_f32 v65, v65
v_rcp_f32 v66, v66
NA 120,52,92
R 50,176,30720
v_rcp_f32 v67, v67
NA 116,56,88
R 52,177,28672
v_mul_f32 v212, v212, v64
v_mul_f32 v213, v213, v65
NA 124,56,92
R 54,177,30720
v_mul_f32 v214, v214, v66
v_mul_f32 v215, v215, v67
NA 128,60,88
R 56,178,28672
CV 212,212,213
CV 214,214,215
v_fma_f32 v64, v216, v216, v27
NA 136,60,92
R 58,178,30720
v_fma_f32 v65, v217, v217, v27
v_fma_f32 v66, v218, v218, v27
v_fma_f32 v67, v219, v219, v27
NA 132,184,88
R 60,179,28672
v_mul_f32 v64, v64, v216
v_mul_f32 v65, v65, v217
v_mul_f32 v66, v66, v218
NA 140,184,92
R 62,179,30720
v_mul_f32 v67, v67, v219
v_exp_f32 v64, v64
NA 112,188,96
R 184,176,32768
v_exp_f32 v65, v65
NA 120,188,100
R 186,176,34816
v_exp_f32 v66, v66
NA 116,192,96
s_waitcnt vmcnt(9)
s_barrier
R 188,177,32768
NA 124,192,100
R 190,177,34816
s_waitcnt lgkmcnt(5)
NA 128,196,96
R 192,178,32768
v_exp_f32 v67, v67
v_fma_f32 v64, v64, v28, v28
NA 136,196,100
R 194,178,34816
v_fma_f32 v65, v65, v28, v28
s_add_u32 m0, s67, 36864
s_add_u32 s75, s62, 256
NA 132,200,96
R 196,179,32768
buffer_load_dwordx4 v11, s[36:39], s75 offen offset:0 lds
v_fma_f32 v66, v66, v28, v28
v_fma_f32 v67, v67, v28, v28
NA 140,200,100
R 198,179,34816
v_rcp_f32 v64, v64
v_rcp_f32 v65, v65
s_add_u32 s100, s100, 4096
s_addc_u32 s101, s101, 0
NA 112,32,104
R 200,176,36864
global_load_dword v0, v23, s[100:101]
v_rcp_f32 v66, v66
NA 120,32,108
R 202,176,38912
v_rcp_f32 v67, v67
NA 116,36,104
R 32,177,36864
v_mul_f32 v216, v216, v64
v_mul_f32 v217, v217, v65
v_mul_f32 v218, v218, v66
NA 124,36,108
R 34,177,38912
v_mul_f32 v219, v219, v67
v_permlane16_swap_b32 v208, v212
v_permlane16_swap_b32 v210, v214
NA 128,40,104
R 36,178,36864
v_accvgpr_write_b32 a136, v208
v_accvgpr_write_b32 a137, v210
v_accvgpr_write_b32 a140, v212
NA 136,40,108
R 38,178,38912
v_accvgpr_write_b32 a141, v214
CV 216,216,217
NA 132,44,104
R 40,179,36864
CV 218,218,219
v_fma_f32 v64, v220, v220, v27
v_fma_f32 v65, v221, v221, v27
NA 140,44,108
R 42,179,38912
v_fma_f32 v66, v222, v222, v27
v_fma_f32 v67, v223, v223, v27
v_mul_f32 v64, v64, v220
NA 112,48,112
R 44,176,40960
v_mul_f32 v65, v65, v221
v_mul_f32 v66, v66, v222
v_mul_f32 v67, v67, v223
NA 120,48,116
R 46,176,43008
v_exp_f32 v64, v64
NA 116,52,112
R 48,177,40960
buffer_load_dwordx4 v12, s[36:39], s75 offen offset:1024 lds
v_exp_f32 v65, v65
NA 124,52,116
R 50,177,43008
v_exp_f32 v66, v66
v_exp_f32 v67, v67
NA 128,56,112
R 52,178,40960
v_fma_f32 v64, v64, v28, v28
v_fma_f32 v65, v65, v28, v28
NA 136,56,116
R 54,178,43008
v_fma_f32 v66, v66, v28, v28
v_fma_f32 v67, v67, v28, v28
s_waitcnt lgkmcnt(5)
NA 132,60,112
R 56,179,40960
v_rcp_f32 v64, v64
v_rcp_f32 v65, v65
NA 140,60,116
R 58,179,43008
v_rcp_f32 v66, v66
NA 112,184,120
R 60,176,45056
buffer_load_dwordx4 v13, s[36:39], s75 offen offset:2048 lds
v_rcp_f32 v67, v67
NA 120,184,124
R 62,176,47104
v_mul_f32 v220, v220, v64
v_mul_f32 v221, v221, v65
NA 116,188,120
R 184,176,49152
v_mul_f32 v222, v222, v66
v_mul_f32 v223, v223, v67
CV 220,220,221
NA 124,188,124
R 186,176,51200
CV 222,222,223
v_permlane16_swap_b32 v216, v220
s_nop 0
v_permlane16_swap_b32 v218, v222
NA 128,192,120
R 188,176,53248
buffer_load_dwordx4 v14, s[36:39], s75 offen offset:3072 lds
v_accvgpr_write_b32 a138, v216
v_accvgpr_write_b32 a139, v218
NA 136,192,124
R 190,176,55296
v_accvgpr_write_b32 a142, v220
v_accvgpr_write_b32 a143, v222
NA 132,196,120
R 192,176,57344
s_add_u32 m0, s67, 40960
s_add_u32 s75, s62, 37120
NA 140,196,124
R 194,176,59392
NA 112,200,128
R 196,176,61440
buffer_load_dwordx4 v11, s[36:39], s75 offen offset:0 lds
NA 120,200,132
R 198,176,63488
NA 116,32,128
R 200,180,0
NA 124,32,132
R 202,180,2048
NA 128,36,128
R 32,180,4096
NA 136,36,132
R 34,180,6144
NA 132,40,128
R 36,180,8192
NA 140,40,132
R 38,180,10240
s_waitcnt lgkmcnt(7)
NA 112,44,136
R 40,180,12288
NA 120,44,140
R 42,180,14336
NA 116,48,136
R 44,177,45056
NA 124,48,140
R 46,177,47104
NA 128,52,136
R 48,177,49152
s_lshr_b32 s73, s52, 1
s_and_b32 s74, s52, 1
s_lshl_b32 s85, s74, 9
s_and_b32 s72, s53, 1
s_lshl_b32 s72, s72, 7
s_add_u32 s85, s85, s72
NA 136,52,140
R 50,177,51200
NA 132,56,136
R 52,177,53248
buffer_load_dwordx4 v12, s[36:39], s75 offen offset:1024 lds
s_and_b32 s72, s53, 2
s_lshl_b32 s72, s72, 9
s_add_u32 s85, s85, s72
s_lshl_b32 s72, s73, 11
s_add_u32 s85, s85, s72
s_lshr_b32 s71, s53, 2
NA 140,56,140
R 54,177,55296
v_mfma_f32_16x16x32_bf16 v[144:147], v[60:63], a[0:3], 0
R 56,177,57344
s_lshl_b32 s72, s54, 5
s_add_u32 s72, s72, s71
s_mul_i32 s84, s72, 36864
s_add_u32 s84, s84, s85
s_lshl_b32 s72, s54, 2
s_add_u32 s72, s72, s71
v_mfma_f32_16x16x32_bf16 v[152:155], v[60:63], a[4:7], 0
R 58,177,59392
NA 152,184,12
R 60,177,61440
buffer_load_dwordx4 v13, s[36:39], s75 offen offset:2048 lds
s_lshl_b32 s88, s72, 7
s_mul_i32 s72, s72, 36864
s_add_u32 s85, s85, s72
s_add_u32 s85, s85, 2359296
s_lshl_b32 s72, s54, 4
s_add_u32 s72, s72, s53
NA 144,184,8
R 62,177,63488
NA 144,188,16
R 184,181,0
s_mul_i32 s86, s72, 9216
s_lshl_b32 s73, s73, 6
s_lshl_b32 s74, s74, 4
s_add_u32 s87, s73, s74
s_lshl_b32 s79, s52, 10
NA 152,188,20
R 186,181,2048
NA 152,192,28
R 188,181,4096
buffer_load_dwordx4 v14, s[36:39], s75 offen offset:3072 lds
NA 144,192,24
R 190,181,6144
s_waitcnt lgkmcnt(5)
NA 144,196,32
R 192,181,8192
CV 112,112,113
NA 152,196,36
R 194,181,10240
CV 113,114,115
NA 152,200,44
R 196,181,12288
v_and_b32 v25, 7, v1
NA 144,200,40
R 198,181,14336
s_add_u32 m0, s67, 45056
s_add_u32 s75, s62, 73984
NA 144,32,48
R 200,178,45056
buffer_load_dwordx4 v11, s[36:39], s75 offen offset:0 lds
NA 152,32,52
R 202,178,47104
NA 152,36,60
R 32,178,49152
v_and_b32 v29, 8, v1
NA 144,36,56
R 34,178,51200
CV 114,116,117
NA 144,40,64
R 36,178,53248
v_lshrrev_b32 v28, 4, v1
NA 152,40,68
R 38,178,55296
CV 115,118,119
v_mfma_f32_16x16x32_bf16 v[148:151], v[44:47], a[0:3], 0
R 40,178,57344
v_lshlrev_b32 v18, 4, v25
v_mfma_f32_16x16x32_bf16 v[156:159], v[44:47], a[4:7], 0
R 42,178,59392
s_add_u32 s76, s78, 23724032
NA 156,48,12
R 44,178,61440
buffer_store_dwordx4 v[112:115], v23, s[48:51], s76 offen offset:0 sc1
NA 148,48,8
R 46,178,63488
NA 148,52,16
R 48,182,0
v_lshl_add_u32 v18, v29, 5, v18
NA 156,52,20
R 50,182,2048
v_mul_u32_u24 v15, 294912, v28
NA 156,56,28
R 52,182,4096
v_add_u32 v15, v15, v18
NA 148,56,24
R 54,182,6144
v_add_u32 v16, 0x1000, v15
s_waitcnt lgkmcnt(6)
NA 148,60,32
s_waitcnt vmcnt(11)
s_barrier
R 56,182,8192
NA 156,60,36
R 58,182,10240
NA 156,184,44
R 60,182,12288
s_add_u32 m0, s67, 73728
s_add_u32 s75, s62, 332032
NA 148,184,40
R 62,182,14336
NA 148,188,48
R 184,179,45056
buffer_load_dwordx4 v11, s[36:39], s75 offen offset:0 lds
NA 156,188,52
R 186,179,47104
v_lshl_add_u32 v18, v28, 12, v18
NA 156,192,60
R 188,179,49152
v_mul_u32_u24 v17, 1152, v25
NA 148,192,56
R 190,179,51200
v_add3_u32 v17, v17, v29, s87
NA 148,196,64
R 192,179,53248
CV 116,120,121
NA 156,196,68
R 194,179,55296
CV 117,122,123
v_mfma_f32_16x16x32_bf16 v[160:163], v[200:203], a[0:3], 0
R 196,179,57344
v_lshl_add_u32 v17, v28, 5, v17
v_mfma_f32_16x16x32_bf16 v[168:171], v[200:203], a[4:7], 0
R 198,179,59392
CV 118,124,125
NA 168,32,12
R 200,179,61440
CV 119,126,127
NA 160,32,8
R 202,179,63488
v_and_b32 v25, 32, v1
NA 160,36,16
R 32,183,0
v_lshl_add_u32 v17, v25, 1, v17
NA 168,36,20
R 34,183,2048
v_add_u32 v26, 147456, v17
NA 168,40,28
R 36,183,4096
buffer_load_dwordx4 v12, s[36:39], s75 offen offset:1024 lds
buffer_store_dwordx4 v[116:119], v23, s[48:51], s76 offen offset:1024 sc1
NA 160,40,24
R 38,183,6144
s_waitcnt lgkmcnt(6)
NA 160,44,32
R 40,183,8192
v_lshlrev_b32 v25, 26, v25
NA 168,44,36
R 42,183,10240
NA 168,48,44
R 44,183,12288
v_or_b32 v27, v25, v17
NA 160,48,40
R 46,183,14336
v_mov_b32 v25, 2147483648
NA 160,52,48
R 48,19,0
buffer_load_dwordx4 v13, s[36:39], s75 offen offset:2048 lds
v_cmp_gt_u32 vcc, 16, v1
s_nop 1
v_cndmask_b32 v28, v25, v18, vcc
NA 168,52,52
R 50,19,2048
NA 168,56,60
R 52,19,4096
v_and_b32 v24, 15, v1
NA 160,56,56
R 54,19,6144
NA 160,60,64
R 56,19,8192
buffer_load_dwordx4 v14, s[36:39], s75 offen offset:3072 lds
NA 168,60,68
R 58,19,10240
v_lshl_add_u32 v24, v24, 2, s88
v_mfma_f32_16x16x32_bf16 v[164:167], v[184:187], a[0:3], 0
R 60,19,12288
s_add_u32 m0, s67, 77824
s_add_u32 s75, s62, 368896
v_mfma_f32_16x16x32_bf16 v[172:175], v[184:187], a[4:7], 0
R 62,19,14336
NA 172,188,12
R 184,19,16384
buffer_load_dwordx4 v11, s[36:39], s75 offen offset:0 lds
NA 164,188,8
R 186,19,18432
NA 164,192,16
R 188,19,20480
NA 172,192,20
R 190,19,22528
NA 172,196,28
R 192,19,24576
CV 128,128,129
NA 164,196,24
R 194,19,26624
s_waitcnt lgkmcnt(6)
NA 164,200,32
R 196,19,28672
CV 129,130,131
NA 172,200,36
R 198,19,30720
NA 172,32,44
R 200,19,32768
CV 130,132,133
NA 164,32,40
R 202,19,34816
NA 164,36,48
R 32,20,0
CV 131,134,135
NA 172,36,52
R 34,20,2048
NA 172,40,60
R 36,20,4096
NA 164,40,56
R 38,20,6144
NA 164,44,64
R 40,20,8192
buffer_load_dwordx4 v12, s[36:39], s75 offen offset:1024 lds
buffer_store_dwordx4 v[128:131], v23, s[48:51], s76 offen offset:2048 sc1
NA 172,44,68
R 42,20,10240
NA 144,48,72
R 44,20,12288
NA 152,48,76
R 46,20,14336
NA 152,52,84
R 48,20,16384
buffer_load_dwordx4 v13, s[36:39], s75 offen offset:2048 lds
NA 144,52,80
R 50,20,18432
NA 144,56,88
R 52,20,20480
NA 152,56,92
R 54,20,22528
NA 152,60,100
R 56,20,24576
buffer_load_dwordx4 v14, s[36:39], s75 offen offset:3072 lds
NA 144,60,96
R 58,20,26624
s_waitcnt lgkmcnt(6)
NA 144,184,104
R 60,20,28672
NA 152,184,108
R 62,20,30720
NA 152,188,116
R 184,20,32768
s_add_u32 m0, s67, 81920
s_add_u32 s75, s62, 405760
NA 144,188,112
R 186,20,34816
NA 144,192,120
R 188,21,0
buffer_load_dwordx4 v11, s[36:39], s75 offen offset:0 lds
NA 152,192,124
R 190,21,2048
NA 152,196,132
R 192,21,4096
NA 144,196,128
R 194,21,6144
NA 144,200,136
R 196,21,8192
CV 132,136,137
NA 152,200,140
R 198,21,10240
NA 148,32,72
R 200,21,12288
CV 133,138,139
NA 156,32,76
R 202,21,14336
NA 156,36,84
R 32,21,16384
CV 134,140,141
NA 148,36,80
R 34,21,18432
NA 148,40,88
R 36,21,20480
CV 135,142,143
NA 156,40,92
R 38,21,22528
NA 156,44,100
R 40,21,24576
NA 148,44,96
R 42,21,26624
s_waitcnt lgkmcnt(6)
NA 148,48,104
s_waitcnt vmcnt(12)
s_barrier
R 44,21,28672
buffer_store_dwordx4 v[132:135], v23, s[48:51], s76 offen offset:3072 sc1
NA 156,48,108
R 46,21,30720
NA 156,52,116
R 48,21,32768
s_add_u32 m0, s67, 110592
s_add_u32 s75, s62, 384
NA 148,52,112
R 50,21,34816
NA 148,56,120
R 52,22,0
buffer_load_dwordx4 v11, s[36:39], s75 offen offset:0 lds
NA 156,56,124
R 54,22,2048
NA 156,60,132
R 56,22,4096
NA 148,60,128
R 58,22,6144
NA 148,184,136
R 60,22,8192
NA 156,184,140
R 62,22,10240
NA 160,188,72
R 184,22,12288
NA 168,188,76
R 186,22,14336
NA 168,192,84
R 188,22,16384
NA 160,192,80
R 190,22,18432
NA 160,196,88
R 192,22,20480
NA 168,196,92
R 194,22,22528
NA 168,200,100
R 196,22,24576
buffer_load_dwordx4 v12, s[36:39], s75 offen offset:1024 lds
LM_pad16:
s_cbranch_execz LM_cr0
NA 160,200,96
R 198,22,26624
s_waitcnt lgkmcnt(7)
NA 160,32,104
R 200,22,28672
NA 168,32,108
R 202,22,30720
NA 168,36,116
R 32,22,32768
NA 160,36,112
R 34,22,34816
NA 160,40,120
R 36,19,36864
buffer_load_dwordx4 v13, s[36:39], s75 offen offset:2048 lds
NA 168,40,124
R 38,19,38912
NA 168,44,132
R 40,19,40960
NA 160,44,128
R 42,19,43008
NA 160,48,136
R 44,19,45056
buffer_load_dwordx4 v14, s[36:39], s75 offen offset:3072 lds
NA 168,48,140
R 46,19,47104
NA 164,52,72
R 48,19,49152
s_add_u32 m0, s67, 114688
s_add_u32 s75, s62, 37248
NA 172,52,76
R 50,19,51200
NA 172,56,84
R 52,19,53248
buffer_load_dwordx4 v11, s[36:39], s75 offen offset:0 lds
NA 164,56,80
R 54,19,55296
NA 164,60,88
R 56,19,57344
NA 172,60,92
R 58,19,59392
s_waitcnt lgkmcnt(6)
NA 172,184,100
R 60,19,61440
NA 164,184,96
R 62,19,63488
NA 164,188,104
R 184,176,0
NA 172,188,108
R 186,176,2048
NA 172,192,116
R 188,176,4096
NA 164,192,112
R 190,176,6144
NA 164,196,120
R 192,20,36864
NA 172,196,124
R 194,20,38912
NA 172,200,132
R 196,20,40960
NA 164,200,128
R 198,20,43008
NA 164,32,136
R 200,20,45056
buffer_load_dwordx4 v12, s[36:39], s75 offen offset:1024 lds
NA 172,32,140
R 202,20,47104
v_mfma_f32_16x16x32_bf16 v[112:115], v[36:39], a[0:3], 0
R 32,20,49152
v_mfma_f32_16x16x32_bf16 v[120:123], v[36:39], a[4:7], 0
R 34,20,51200
NA 120,40,12
R 36,20,53248
buffer_load_dwordx4 v13, s[36:39], s75 offen offset:2048 lds
NA 112,40,8
R 38,20,55296
NA 112,44,16
R 40,20,57344
NA 120,44,20
R 42,20,59392
s_waitcnt lgkmcnt(7)
NA 120,48,28
R 44,20,61440
buffer_load_dwordx4 v14, s[36:39], s75 offen offset:3072 lds
NA 112,48,24
R 46,20,63488
NA 112,52,32
R 48,177,0
CV 144,144,145
NA 120,52,36
R 50,177,2048
CV 145,146,147
NA 120,56,44
R 52,177,4096
s_add_u32 m0, s67, 118784
s_add_u32 s75, s62, 74112
NA 112,56,40
R 54,177,6144
NA 112,60,48
s_mov_b64 exec, 0
s_cmp_eq_u32 s52, 0
s_cbranch_scc1 LM_pad17
s_cmp_eq_u32 s52, 1
s_cbranch_scc1 LM_pad18
s_cmp_eq_u32 s52, 2
s_cbranch_scc1 LM_pad19
s_branch LM_pad20
LM_cr1:
s_mov_b64 exec, -1
R 56,21,36864
buffer_load_dwordx4 v11, s[36:39], s75 offen offset:0 lds
NA 120,60,52
R 58,21,38912
NA 120,184,60
R 60,21,40960
CV 146,148,149
NA 112,184,56
R 62,21,43008
NA 112,188,64
R 184,21,45056
CV 147,150,151
NA 120,188,68
R 186,21,47104
v_mfma_f32_16x16x32_bf16 v[116:119], v[192:195], a[0:3], 0
R 188,21,49152
s_add_u32 s76, s78, 23728128
v_mfma_f32_16x16x32_bf16 v[124:127], v[192:195], a[4:7], 0
R 190,21,51200
NA 124,196,12
R 192,21,53248
buffer_store_dwordx4 v[144:147], v23, s[48:51], s76 offen offset:0 sc1
NA 116,196,8
R 194,21,55296
s_waitcnt lgkmcnt(6)
NA 116,200,16
R 196,21,57344
NA 124,200,20
R 198,21,59392
NA 124,32,28
R 200,21,61440
NA 116,32,24
R 202,21,63488
NA 116,36,32
s_waitcnt vmcnt(11)
s_barrier
R 32,178,0
NA 124,36,36
R 34,178,2048
NA 124,40,44
R 36,178,4096
s_add_u32 m0, s67, 0
s_add_u32 s75, s62, 332160
NA 116,40,40
R 38,178,6144
NA 116,44,48
R 40,22,36864
buffer_load_dwordx4 v11, s[36:39], s75 offen offset:0 lds
NA 124,44,52
R 42,22,38912
NA 124,48,60
R 44,22,40960
NA 116,48,56
R 46,22,43008
NA 116,52,64
R 48,22,45056
CV 148,152,153
NA 124,52,68
R 50,22,47104
CV 149,154,155
v_mfma_f32_16x16x32_bf16 v[128:131], v[56:59], a[0:3], 0
R 52,22,49152
CV 150,156,157
v_mfma_f32_16x16x32_bf16 v[136:139], v[56:59], a[4:7], 0
R 54,22,51200
NA 136,60,12
R 56,22,53248
CV 151,158,159
NA 128,60,8
R 58,22,55296
s_waitcnt lgkmcnt(6)
NA 128,184,16
R 60,22,57344
NA 136,184,20
R 62,22,59392
NA 136,188,28
R 184,22,61440
buffer_load_dwordx4 v12, s[36:39], s75 offen offset:1024 lds
buffer_store_dwordx4 v[148:151], v23, s[48:51], s76 offen offset:1024 sc1
NA 128,188,24
R 186,22,63488
NA 128,192,32
R 188,179,0
NA 136,192,36
R 190,179,2048
NA 136,196,44
R 192,179,4096
NA 128,196,40
R 194,179,6144
NA 128,200,48
R 196,176,8192
buffer_load_dwordx4 v13, s[36:39], s75 offen offset:2048 lds
NA 136,200,52
R 198,176,10240
NA 136,32,60
R 200,176,12288
NA 128,32,56
R 202,176,14336
NA 128,36,64
R 32,176,16384
buffer_load_dwordx4 v14, s[36:39], s75 offen offset:3072 lds
NA 136,36,68
R 34,176,18432
v_mfma_f32_16x16x32_bf16 v[132:135], v[40:43], a[0:3], 0
R 36,176,20480
s_add_u32 m0, s67, 4096
s_add_u32 s75, s62, 369024
v_mfma_f32_16x16x32_bf16 v[140:143], v[40:43], a[4:7], 0
R 38,176,22528
NA 140,44,12
R 40,176,24576
buffer_load_dwordx4 v11, s[36:39], s75 offen offset:0 lds
NA 132,44,8
R 42,176,26624
s_waitcnt lgkmcnt(6)
NA 132,48,16
R 44,176,28672
NA 140,48,20
R 46,176,30720
NA 140,52,28
R 48,176,32768
CV 160,160,161
NA 132,52,24
R 50,176,34816
NA 132,56,32
R 52,176,36864
CV 161,162,163
NA 140,56,36
R 54,176,38912
NA 140,60,44
R 56,176,40960
CV 162,164,165
NA 132,60,40
R 58,176,43008
NA 132,184,48
R 60,177,8192
CV 163,166,167
NA 140,184,52
R 62,177,10240
NA 140,188,60
R 184,177,12288
NA 132,188,56
R 186,177,14336
NA 132,192,64
R 188,177,16384
buffer_load_dwordx4 v12, s[36:39], s75 offen offset:1024 lds
buffer_store_dwordx4 v[160:163], v23, s[48:51], s76 offen offset:2048 sc1
NA 140,192,68
R 190,177,18432
NA 112,196,72
R 192,177,20480
NA 120,196,76
R 194,177,22528
NA 120,200,84
R 196,177,24576
buffer_load_dwordx4 v13, s[36:39], s75 offen offset:2048 lds
NA 112,200,80
R 198,177,26624
s_waitcnt lgkmcnt(6)
NA 112,32,88
R 200,177,28672
NA 120,32,92
R 202,177,30720
NA 120,36,100
R 32,177,32768
buffer_load_dwordx4 v14, s[36:39], s75 offen offset:3072 lds
NA 112,36,96
R 34,177,34816
NA 112,40,104
R 36,177,36864
NA 120,40,108
R 38,177,38912
NA 120,44,116
R 40,177,40960
s_add_u32 m0, s67, 8192
s_add_u32 s75, s62, 405888
NA 112,44,112
R 42,177,43008
NA 112,48,120
R 44,178,8192
buffer_load_dwordx4 v11, s[36:39], s75 offen offset:0 lds
NA 120,48,124
R 46,178,10240
NA 120,52,132
R 48,178,12288
NA 112,52,128
R 50,178,14336
NA 112,56,136
R 52,178,16384
CV 164,168,169
NA 120,56,140
R 54,178,18432
NA 116,60,72
R 56,178,20480
CV 165,170,171
NA 124,60,76
R 58,178,22528
NA 124,184,84
R 60,178,24576
CV 166,172,173
NA 116,184,80
R 62,178,26624
s_waitcnt lgkmcnt(6)
NA 116,188,88
R 184,178,28672
CV 167,174,175
NA 124,188,92
R 186,178,30720
NA 124,192,100
R 188,178,32768
NA 116,192,96
R 190,178,34816
NA 116,196,104
s_waitcnt vmcnt(12)
s_barrier
R 192,178,36864
buffer_store_dwordx4 v[164:167], v23, s[48:51], s76 offen offset:3072 sc1
NA 124,196,108
R 194,178,38912
NA 124,200,116
R 196,178,40960
s_add_u32 m0, s67, 36864
s_add_u32 s75, s62, 512
NA 116,200,112
R 198,178,43008
NA 116,32,120
R 200,179,8192
buffer_load_dwordx4 v11, s[36:39], s75 offen offset:0 lds
NA 124,32,124
R 202,179,10240
NA 124,36,132
R 32,179,12288
NA 116,36,128
R 34,179,14336
NA 116,40,136
R 36,179,16384
NA 124,40,140
R 38,179,18432
NA 128,44,72
R 40,179,20480
NA 136,44,76
R 42,179,22528
NA 136,48,84
R 44,179,24576
NA 128,48,80
R 46,179,26624
s_waitcnt lgkmcnt(7)
NA 128,52,88
R 48,179,28672
NA 136,52,92
R 50,179,30720
NA 136,56,100
R 52,179,32768
buffer_load_dwordx4 v12, s[36:39], s75 offen offset:1024 lds
NA 128,56,96
R 54,179,34816
NA 128,60,104
R 56,179,36864
NA 136,60,108
R 58,179,38912
NA 136,184,116
R 60,179,40960
NA 128,184,112
R 62,179,43008
NA 128,188,120
R 184,176,45056
buffer_load_dwordx4 v13, s[36:39], s75 offen offset:2048 lds
NA 136,188,124
R 186,176,47104
NA 136,192,132
R 188,176,49152
NA 128,192,128
R 190,176,51200
NA 128,196,136
R 192,176,53248
buffer_load_dwordx4 v14, s[36:39], s75 offen offset:3072 lds
NA 136,196,140
R 194,176,55296
NA 132,200,72
R 196,176,57344
s_add_u32 m0, s67, 40960
s_add_u32 s75, s62, 37376
NA 140,200,76
R 198,176,59392
s_waitcnt lgkmcnt(6)
NA 140,32,84
R 200,176,61440
buffer_load_dwordx4 v11, s[36:39], s75 offen offset:0 lds
NA 132,32,80
R 202,176,63488
NA 132,36,88
R 32,180,0
NA 140,36,92
R 34,180,2048
NA 140,40,100
R 36,180,4096
NA 132,40,96
R 38,180,6144
NA 132,44,104
R 40,180,8192
NA 140,44,108
R 42,180,10240
NA 140,48,116
R 44,180,12288
NA 132,48,112
R 46,180,14336
NA 132,52,120
R 48,177,45056
NA 140,52,124
R 50,177,47104
NA 140,56,132
R 52,177,49152
NA 132,56,128
R 54,177,51200
NA 132,60,136
R 56,177,53248
buffer_load_dwordx4 v12, s[36:39], s75 offen offset:1024 lds
NA 140,60,140
R 58,177,55296
v_mfma_f32_16x16x32_bf16 v[144:147], v[184:187], a[0:3], 0
R 60,177,57344
v_mfma_f32_16x16x32_bf16 v[152:155], v[184:187], a[4:7], 0
R 62,177,59392
s_waitcnt lgkmcnt(7)
NA 152,188,12
R 184,177,61440
buffer_load_dwordx4 v13, s[36:39], s75 offen offset:2048 lds
NA 144,188,8
R 186,177,63488
NA 144,192,16
R 188,181,0
NA 152,192,20
R 190,181,2048
NA 152,196,28
R 192,181,4096
buffer_load_dwordx4 v14, s[36:39], s75 offen offset:3072 lds
NA 144,196,24
R 194,181,6144
NA 144,200,32
R 196,181,8192
CV 112,112,113
NA 152,200,36
R 198,181,10240
CV 113,114,115
NA 152,32,44
R 200,181,12288
s_add_u32 m0, s67, 45056
s_add_u32 s75, s62, 74240
NA 144,32,40
R 202,181,14336
NA 144,36,48
R 32,178,45056
buffer_load_dwordx4 v11, s[36:39], s75 offen offset:0 lds
NA 152,36,52
R 34,178,47104
NA 152,40,60
R 36,178,49152
CV 114,116,117
NA 144,40,56
R 38,178,51200
NA 144,44,64
R 40,178,53248
CV 115,118,119
NA 152,44,68
R 42,178,55296
s_waitcnt lgkmcnt(6)
v_mfma_f32_16x16x32_bf16 v[148:151], v[48:51], a[0:3], 0
R 44,178,57344
s_add_u32 s76, s78, 23732224
v_mfma_f32_16x16x32_bf16 v[156:159], v[48:51], a[4:7], 0
R 46,178,59392
NA 156,52,12
R 48,178,61440
buffer_store_dwordx4 v[112:115], v23, s[48:51], s76 offen offset:0 sc1
NA 148,52,8
R 50,178,63488
NA 148,56,16
R 52,182,0
NA 156,56,20
R 54,182,2048
NA 156,60,28
R 56,182,4096
NA 148,60,24
R 58,182,6144
NA 148,184,32
s_waitcnt vmcnt(11)
s_barrier
R 60,182,8192
NA 156,184,36
R 62,182,10240
s_add_u32 s74, s80, 24576
s_waitcnt vmcnt(10)
NA 156,188,44
R 184,182,12288
buffer_store_dword v3, v30, s[48:51], s74 offen sc1
NA 148,188,40
R 186,182,14336
s_add_u32 m0, s67, 73728
s_add_u32 s75, s62, 332288
NA 148,192,48
R 188,179,45056
buffer_load_dwordx4 v11, s[36:39], s75 offen offset:0 lds
NA 156,192,52
R 190,179,47104
NA 156,196,60
R 192,179,49152
NA 148,196,56
R 194,179,51200
NA 148,200,64
R 196,179,53248
CV 116,120,121
NA 156,200,68
R 198,179,55296
CV 117,122,123
s_waitcnt lgkmcnt(6)
v_mfma_f32_16x16x32_bf16 v[160:163], v[32:35], a[0:3], 0
R 200,179,57344
CV 118,124,125
v_mfma_f32_16x16x32_bf16 v[168:171], v[32:35], a[4:7], 0
R 202,179,59392
LM_pad17:
s_cbranch_execz LM_cr1
NA 168,36,12
R 32,179,61440
CV 119,126,127
NA 160,36,8
R 34,179,63488
NA 160,40,16
R 36,183,0
NA 168,40,20
R 38,183,2048
NA 168,44,28
R 40,183,4096
buffer_load_dwordx4 v12, s[36:39], s75 offen offset:1024 lds
buffer_store_dwordx4 v[116:119], v23, s[48:51], s76 offen offset:1024 sc1
NA 160,44,24
R 42,183,6144
NA 160,48,32
R 44,183,8192
NA 168,48,36
R 46,183,10240
NA 168,52,44
R 48,183,12288
NA 160,52,40
R 50,183,14336
NA 160,56,48
R 52,19,0
buffer_load_dwordx4 v13, s[36:39], s75 offen offset:2048 lds
NA 168,56,52
R 54,19,2048
NA 168,60,60
R 56,19,4096
NA 160,60,56
R 58,19,6144
NA 160,184,64
R 60,19,8192
buffer_load_dwordx4 v14, s[36:39], s75 offen offset:3072 lds
NA 168,184,68
R 62,19,10240
s_waitcnt lgkmcnt(6)
v_mfma_f32_16x16x32_bf16 v[164:167], v[188:191], a[0:3], 0
R 184,19,12288
s_add_u32 m0, s67, 77824
s_add_u32 s75, s62, 369152
v_mfma_f32_16x16x32_bf16 v[172:175], v[188:191], a[4:7], 0
R 186,19,14336
NA 172,192,12
R 188,19,16384
buffer_load_dwordx4 v11, s[36:39], s75 offen offset:0 lds
NA 164,192,8
R 190,19,18432
NA 164,196,16
R 192,19,20480
NA 172,196,20
R 194,19,22528
NA 172,200,28
R 196,19,24576
CV 128,128,129
NA 164,200,24
R 198,19,26624
NA 164,32,32
R 200,19,28672
CV 129,130,131
NA 172,32,36
R 202,19,30720
NA 172,36,44
R 32,19,32768
CV 130,132,133
NA 164,36,40
R 34,19,34816
NA 164,40,48
R 36,20,0
CV 131,134,135
NA 172,40,52
R 38,20,2048
NA 172,44,60
R 40,20,4096
NA 164,44,56
R 42,20,6144
NA 164,48,64
R 44,20,8192
buffer_load_dwordx4 v12, s[36:39], s75 offen offset:1024 lds
buffer_store_dwordx4 v[128:131], v23, s[48:51], s76 offen offset:2048 sc1
NA 172,48,68
R 46,20,10240
s_waitcnt lgkmcnt(6)
NA 144,52,72
R 48,20,12288
NA 152,52,76
R 50,20,14336
NA 152,56,84
R 52,20,16384
buffer_load_dwordx4 v13, s[36:39], s75 offen offset:2048 lds
NA 144,56,80
R 54,20,18432
NA 144,60,88
R 56,20,20480
NA 152,60,92
R 58,20,22528
NA 152,184,100
R 60,20,24576
buffer_load_dwordx4 v14, s[36:39], s75 offen offset:3072 lds
NA 144,184,96
R 62,20,26624
NA 144,188,104
R 184,20,28672
NA 152,188,108
R 186,20,30720
NA 152,192,116
R 188,20,32768
s_add_u32 m0, s67, 81920
s_add_u32 s75, s62, 406016
NA 144,192,112
R 190,20,34816
NA 144,196,120
R 192,21,0
buffer_load_dwordx4 v11, s[36:39], s75 offen offset:0 lds
NA 152,196,124
R 194,21,2048
NA 152,200,132
R 196,21,4096
NA 144,200,128
R 198,21,6144
NA 144,32,136
R 200,21,8192
CV 132,136,137
NA 152,32,140
R 202,21,10240
s_waitcnt lgkmcnt(6)
NA 148,36,72
R 32,21,12288
CV 133,138,139
NA 156,36,76
R 34,21,14336
NA 156,40,84
R 36,21,16384
CV 134,140,141
NA 148,40,80
R 38,21,18432
NA 148,44,88
R 40,21,20480
CV 135,142,143
NA 156,44,92
R 42,21,22528
NA 156,48,100
R 44,21,24576
NA 148,48,96
R 46,21,26624
NA 148,52,104
s_waitcnt vmcnt(13)
s_barrier
R 48,21,28672
buffer_store_dwordx4 v[132:135], v23, s[48:51], s76 offen offset:3072 sc1
NA 156,52,108
R 50,21,30720
NA 156,56,116
R 52,21,32768
s_add_u32 m0, s67, 110592
s_add_u32 s75, s62, 640
NA 148,56,112
R 54,21,34816
NA 148,60,120
R 56,22,0
buffer_load_dwordx4 v11, s[36:39], s75 offen offset:0 lds
NA 156,60,124
R 58,22,2048
NA 156,184,132
R 60,22,4096
NA 148,184,128
R 62,22,6144
NA 148,188,136
R 184,22,8192
NA 156,188,140
R 186,22,10240
s_waitcnt lgkmcnt(7)
NA 160,192,72
R 188,22,12288
NA 168,192,76
R 190,22,14336
NA 168,196,84
R 192,22,16384
NA 160,196,80
R 194,22,18432
NA 160,200,88
R 196,22,20480
NA 168,200,92
R 198,22,22528
NA 168,32,100
R 200,22,24576
buffer_load_dwordx4 v12, s[36:39], s75 offen offset:1024 lds
NA 160,32,96
R 202,22,26624
NA 160,36,104
R 32,22,28672
NA 168,36,108
R 34,22,30720
NA 168,40,116
R 36,22,32768
NA 160,40,112
R 38,22,34816
NA 160,44,120
R 40,19,36864
buffer_load_dwordx4 v13, s[36:39], s75 offen offset:2048 lds
NA 168,44,124
R 42,19,38912
NA 168,48,132
R 44,19,40960
NA 160,48,128
R 46,19,43008
s_waitcnt lgkmcnt(7)
NA 160,52,136
R 48,19,45056
buffer_load_dwordx4 v14, s[36:39], s75 offen offset:3072 lds
NA 168,52,140
R 50,19,47104
NA 164,56,72
R 52,19,49152
s_add_u32 m0, s67, 114688
s_add_u32 s75, s62, 37504
NA 172,56,76
R 54,19,51200
NA 172,60,84
R 56,19,53248
buffer_load_dwordx4 v11, s[36:39], s75 offen offset:0 lds
NA 164,60,80
R 58,19,55296
NA 164,184,88
R 60,19,57344
NA 172,184,92
R 62,19,59392
NA 172,188,100
R 184,19,61440
NA 164,188,96
R 186,19,63488
NA 164,192,104
R 188,176,0
NA 172,192,108
R 190,176,2048
NA 172,196,116
R 192,176,4096
NA 164,196,112
R 194,176,6144
NA 164,200,120
R 196,20,36864
NA 172,200,124
R 198,20,38912
s_waitcnt lgkmcnt(7)
NA 172,32,132
R 200,20,40960
NA 164,32,128
R 202,20,43008
NA 164,36,136
R 32,20,45056
buffer_load_dwordx4 v12, s[36:39], s75 offen offset:1024 lds
NA 172,36,140
R 34,20,47104
v_mfma_f32_16x16x32_bf16 v[112:115], v[40:43], a[0:3], 0
R 36,20,49152
v_mfma_f32_16x16x32_bf16 v[120:123], v[40:43], a[4:7], 0
R 38,20,51200
NA 120,44,12
R 40,20,53248
buffer_load_dwordx4 v13, s[36:39], s75 offen offset:2048 lds
NA 112,44,8
R 42,20,55296
NA 112,48,16
R 44,20,57344
NA 120,48,20
R 46,20,59392
NA 120,52,28
R 48,20,61440
buffer_load_dwordx4 v14, s[36:39], s75 offen offset:3072 lds
NA 112,52,24
R 50,20,63488
NA 112,56,32
R 52,177,0
CV 144,144,145
NA 120,56,36
R 54,177,2048
CV 145,146,147
NA 120,60,44
R 56,177,4096
s_add_u32 m0, s67, 118784
s_add_u32 s75, s62, 74368
NA 112,60,40
R 58,177,6144
s_waitcnt lgkmcnt(6)
NA 112,184,48
R 60,21,36864
buffer_load_dwordx4 v11, s[36:39], s75 offen offset:0 lds
NA 120,184,52
R 62,21,38912
NA 120,188,60
R 184,21,40960
CV 146,148,149
NA 112,188,56
R 186,21,43008
NA 112,192,64
R 188,21,45056
CV 147,150,151
NA 120,192,68
R 190,21,47104
v_mfma_f32_16x16x32_bf16 v[116:119], v[196:199], a[0:3], 0
R 192,21,49152
s_add_u32 s76, s78, 23736320
v_mfma_f32_16x16x32_bf16 v[124:127], v[196:199], a[4:7], 0
R 194,21,51200
NA 124,200,12
R 196,21,53248
buffer_store_dwordx4 v[144:147], v23, s[48:51], s76 offen offset:0 sc1
NA 116,200,8
R 198,21,55296
NA 116,32,16
R 200,21,57344
NA 124,32,20
R 202,21,59392
NA 124,36,28
R 32,21,61440
NA 116,36,24
R 34,21,63488
NA 116,40,32
s_waitcnt vmcnt(11)
s_barrier
R 36,178,0
NA 124,40,36
R 38,178,2048
NA 124,44,44
R 40,178,4096
s_add_u32 m0, s67, 0
s_add_u32 s75, s62, 332416
NA 116,44,40
R 42,178,6144
s_waitcnt lgkmcnt(6)
NA 116,48,48
R 44,22,36864
buffer_load_dwordx4 v11, s[36:39], s75 offen offset:0 lds
NA 124,48,52
R 46,22,38912
NA 124,52,60
R 48,22,40960
NA 116,52,56
R 50,22,43008
NA 116,56,64
R 52,22,45056
CV 148,152,153
NA 124,56,68
R 54,22,47104
CV 149,154,155
v_mfma_f32_16x16x32_bf16 v[128:131], v[60:63], a[0:3], 0
R 56,22,49152
CV 150,156,157
v_mfma_f32_16x16x32_bf16 v[136:139], v[60:63], a[4:7], 0
R 58,22,51200
NA 136,184,12
R 60,22,53248
CV 151,158,159
NA 128,184,8
R 62,22,55296
NA 128,188,16
R 184,22,57344
NA 136,188,20
R 186,22,59392
NA 136,192,28
R 188,22,61440
buffer_load_dwordx4 v12, s[36:39], s75 offen offset:1024 lds
buffer_store_dwordx4 v[148:151], v23, s[48:51], s76 offen offset:1024 sc1
NA 128,192,24
R 190,22,63488
NA 128,196,32
R 192,179,0
NA 136,196,36
R 194,179,2048
NA 136,200,44
R 196,179,4096
NA 128,200,40
R 198,179,6144
s_waitcnt lgkmcnt(6)
NA 128,32,48
R 200,176,8192
buffer_load_dwordx4 v13, s[36:39], s75 offen offset:2048 lds
NA 136,32,52
R 202,176,10240
NA 136,36,60
R 32,176,12288
NA 128,36,56
R 34,176,14336
NA 128,40,64
R 36,176,16384
buffer_load_dwordx4 v14, s[36:39], s75 offen offset:3072 lds
NA 136,40,68
R 38,176,18432
v_mfma_f32_16x16x32_bf16 v[132:135], v[44:47], a[0:3], 0
R 40,176,20480
s_add_u32 m0, s67, 4096
s_add_u32 s75, s62, 369280
v_mfma_f32_16x16x32_bf16 v[140:143], v[44:47], a[4:7], 0
R 42,176,22528
NA 140,48,12
R 44,176,24576
buffer_load_dwordx4 v11, s[36:39], s75 offen offset:0 lds
NA 132,48,8
R 46,176,26624
NA 132,52,16
R 48,176,28672
NA 140,52,20
R 50,176,30720
NA 140,56,28
R 52,176,32768
CV 160,160,161
NA 132,56,24
R 54,176,34816
NA 132,60,32
R 56,176,36864
CV 161,162,163
NA 140,60,36
R 58,176,38912
NA 140,184,44
R 60,176,40960
CV 162,164,165
NA 132,184,40
R 62,176,43008
s_waitcnt lgkmcnt(6)
NA 132,188,48
R 184,177,8192
CV 163,166,167
NA 140,188,52
R 186,177,10240
NA 140,192,60
R 188,177,12288
NA 132,192,56
R 190,177,14336
NA 132,196,64
R 192,177,16384
buffer_load_dwordx4 v12, s[36:39], s75 offen offset:1024 lds
buffer_store_dwordx4 v[160:163], v23, s[48:51], s76 offen offset:2048 sc1
NA 140,196,68
R 194,177,18432
NA 112,200,72
R 196,177,20480
NA 120,200,76
R 198,177,22528
NA 120,32,84
R 200,177,24576
buffer_load_dwordx4 v13, s[36:39], s75 offen offset:2048 lds
NA 112,32,80
R 202,177,26624
NA 112,36,88
R 32,177,28672
NA 120,36,92
R 34,177,30720
NA 120,40,100
R 36,177,32768
buffer_load_dwordx4 v14, s[36:39], s75 offen offset:3072 lds
NA 112,40,96
R 38,177,34816
NA 112,44,104
R 40,177,36864
NA 120,44,108
R 42,177,38912
NA 120,48,116
R 44,177,40960
s_add_u32 m0, s67, 8192
s_add_u32 s75, s62, 406144
NA 112,48,112
R 46,177,43008
s_waitcnt lgkmcnt(6)
NA 112,52,120
R 48,178,8192
buffer_load_dwordx4 v11, s[36:39], s75 offen offset:0 lds
NA 120,52,124
R 50,178,10240
NA 120,56,132
R 52,178,12288
NA 112,56,128
R 54,178,14336
NA 112,60,136
R 56,178,16384
CV 164,168,169
NA 120,60,140
R 58,178,18432
NA 116,184,72
R 60,178,20480
CV 165,170,171
NA 124,184,76
R 62,178,22528
NA 124,188,84
R 184,178,24576
CV 166,172,173
NA 116,188,80
R 186,178,26624
NA 116,192,88
R 188,178,28672
CV 167,174,175
NA 124,192,92
R 190,178,30720
NA 124,196,100
R 192,178,32768
NA 116,196,96
R 194,178,34816
NA 116,200,104
s_waitcnt vmcnt(12)
s_barrier
R 196,178,36864
buffer_store_dwordx4 v[164:167], v23, s[48:51], s76 offen offset:3072 sc1
NA 124,200,108
R 198,178,38912
NA 124,32,116
R 200,178,40960
s_add_u32 m0, s67, 36864
s_add_u32 s75, s62, 768
NA 116,32,112
R 202,178,43008
s_waitcnt lgkmcnt(6)
NA 116,36,120
R 32,179,8192
buffer_load_dwordx4 v11, s[36:39], s75 offen offset:0 lds
NA 124,36,124
R 34,179,10240
NA 124,40,132
R 36,179,12288
NA 116,40,128
R 38,179,14336
NA 116,44,136
LM_pad18:
s_cbranch_execz LM_cr1
R 40,179,16384
NA 124,44,140
R 42,179,18432
NA 128,48,72
R 44,179,20480
NA 136,48,76
R 46,179,22528
NA 136,52,84
R 48,179,24576
NA 128,52,80
R 50,179,26624
NA 128,56,88
R 52,179,28672
NA 136,56,92
R 54,179,30720
NA 136,60,100
R 56,179,32768
buffer_load_dwordx4 v12, s[36:39], s75 offen offset:1024 lds
NA 128,60,96
R 58,179,34816
NA 128,184,104
R 60,179,36864
NA 136,184,108
R 62,179,38912
NA 136,188,116
R 184,179,40960
NA 128,188,112
R 186,179,43008
s_waitcnt lgkmcnt(7)
NA 128,192,120
R 188,176,45056
buffer_load_dwordx4 v13, s[36:39], s75 offen offset:2048 lds
NA 136,192,124
R 190,176,47104
NA 136,196,132
R 192,176,49152
NA 128,196,128
R 194,176,51200
NA 128,200,136
R 196,176,53248
buffer_load_dwordx4 v14, s[36:39], s75 offen offset:3072 lds
NA 136,200,140
R 198,176,55296
NA 132,32,72
R 200,176,57344
s_add_u32 m0, s67, 40960
s_add_u32 s75, s62, 37632
NA 140,32,76
R 202,176,59392
NA 140,36,84
R 32,176,61440
buffer_load_dwordx4 v11, s[36:39], s75 offen offset:0 lds
NA 132,36,80
R 34,176,63488
NA 132,40,88
R 36,180,0
NA 140,40,92
R 38,180,2048
NA 140,44,100
R 40,180,4096
NA 132,44,96
R 42,180,6144
NA 132,48,104
R 44,180,8192
NA 140,48,108
R 46,180,10240
s_waitcnt lgkmcnt(7)
NA 140,52,116
R 48,180,12288
NA 132,52,112
R 50,180,14336
NA 132,56,120
R 52,177,45056
NA 140,56,124
R 54,177,47104
NA 140,60,132
R 56,177,49152
NA 132,60,128
R 58,177,51200
NA 132,184,136
R 60,177,53248
buffer_load_dwordx4 v12, s[36:39], s75 offen offset:1024 lds
NA 140,184,140
R 62,177,55296
v_mfma_f32_16x16x32_bf16 v[144:147], v[188:191], a[0:3], 0
R 184,177,57344
v_mfma_f32_16x16x32_bf16 v[152:155], v[188:191], a[4:7], 0
R 186,177,59392
NA 152,192,12
R 188,177,61440
buffer_load_dwordx4 v13, s[36:39], s75 offen offset:2048 lds
NA 144,192,8
R 190,177,63488
NA 144,196,16
R 192,181,0
NA 152,196,20
R 194,181,2048
NA 152,200,28
R 196,181,4096
buffer_load_dwordx4 v14, s[36:39], s75 offen offset:3072 lds
NA 144,200,24
R 198,181,6144
s_mov_b32 s81, 42622976
s_waitcnt lgkmcnt(6)
NA 144,32,32
R 200,181,8192
buffer_load_dword v31, v24, s[48:51], s81 offen sc1
NA 152,32,36
R 202,181,10240
CV 112,112,113
NA 152,36,44
R 32,181,12288
s_add_u32 m0, s67, 45056
s_add_u32 s75, s62, 74496
NA 144,36,40
R 34,181,14336
NA 144,40,48
R 36,178,45056
buffer_load_dwordx4 v11, s[36:39], s75 offen offset:0 lds
NA 152,40,52
R 38,178,47104
NA 152,44,60
R 40,178,49152
CV 113,114,115
NA 144,44,56
R 42,178,51200
NA 144,48,64
R 44,178,53248
CV 114,116,117
NA 152,48,68
R 46,178,55296
v_mfma_f32_16x16x32_bf16 v[148:151], v[52:55], a[0:3], 0
R 48,178,57344
CV 115,118,119
v_mfma_f32_16x16x32_bf16 v[156:159], v[52:55], a[4:7], 0
R 50,178,59392
s_add_u32 s76, s78, 23740416
NA 156,56,12
R 52,178,61440
buffer_store_dwordx4 v[112:115], v23, s[48:51], s76 offen offset:0 sc1
NA 148,56,8
R 54,178,63488
NA 148,60,16
R 56,182,0
NA 156,60,20
R 58,182,2048
NA 156,184,28
R 60,182,4096
NA 148,184,24
R 62,182,6144
s_waitcnt lgkmcnt(6)
NA 148,188,32
s_waitcnt vmcnt(12)
s_barrier
R 184,182,8192
NA 156,188,36
R 186,182,10240
s_add_u32 s74, s80, 32768
s_waitcnt vmcnt(11)
NA 156,192,44
R 188,182,12288
buffer_store_dword v3, v30, s[48:51], s74 offen sc1
NA 148,192,40
R 190,182,14336
s_add_u32 m0, s67, 73728
s_add_u32 s75, s62, 332544
NA 148,196,48
R 192,179,45056
buffer_load_dwordx4 v11, s[36:39], s75 offen offset:0 lds
NA 156,196,52
R 194,179,47104
NA 156,200,60
R 196,179,49152
NA 148,200,56
R 198,179,51200
NA 148,32,64
R 200,179,53248
CV 116,120,121
NA 156,32,68
R 202,179,55296
v_mfma_f32_16x16x32_bf16 v[160:163], v[36:39], a[0:3], 0
R 32,179,57344
CV 117,122,123
v_mfma_f32_16x16x32_bf16 v[168:171], v[36:39], a[4:7], 0
R 34,179,59392
NA 168,40,12
R 36,179,61440
CV 118,124,125
NA 160,40,8
R 38,179,63488
CV 119,126,127
NA 160,44,16
R 40,183,0
NA 168,44,20
R 42,183,2048
NA 168,48,28
R 44,183,4096
buffer_load_dwordx4 v12, s[36:39], s75 offen offset:1024 lds
buffer_store_dwordx4 v[116:119], v23, s[48:51], s76 offen offset:1024 sc1
NA 160,48,24
R 46,183,6144
s_waitcnt lgkmcnt(6)
NA 160,52,32
R 48,183,8192
NA 168,52,36
R 50,183,10240
NA 168,56,44
R 52,183,12288
NA 160,56,40
R 54,183,14336
NA 160,60,48
R 56,19,0
buffer_load_dwordx4 v13, s[36:39], s75 offen offset:2048 lds
NA 168,60,52
R 58,19,2048
NA 168,184,60
R 60,19,4096
NA 160,184,56
R 62,19,6144
NA 160,188,64
R 184,19,8192
buffer_load_dwordx4 v14, s[36:39], s75 offen offset:3072 lds
NA 168,188,68
R 186,19,10240
v_mfma_f32_16x16x32_bf16 v[164:167], v[192:195], a[0:3], 0
R 188,19,12288
s_add_u32 m0, s67, 77824
s_add_u32 s75, s62, 369408
v_mfma_f32_16x16x32_bf16 v[172:175], v[192:195], a[4:7], 0
R 190,19,14336
NA 172,196,12
R 192,19,16384
buffer_load_dwordx4 v11, s[36:39], s75 offen offset:0 lds
s_waitcnt vmcnt(9)
v_cmp_ne_u32 vcc, 0x10000, v31
s_nop 1
s_cbranch_vccnz LM_poll3
LM_ok3:
NA 164,196,8
R 194,19,18432
NA 164,200,16
R 196,19,20480
s_add_u32 s0, s84, 4849664
NA 172,200,20
R 198,19,22528
NA 172,32,28
R 200,19,24576
buffer_load_dwordx4 a[144:147], v15, s[48:51], s0 offen sc1
NA 164,32,24
R 202,19,26624
CV 128,128,129
s_waitcnt lgkmcnt(5)
NA 164,36,32
R 32,19,28672
CV 129,130,131
NA 172,36,36
R 34,19,30720
NA 172,40,44
R 36,19,32768
CV 130,132,133
NA 164,40,40
R 38,19,34816
NA 164,44,48
R 40,20,0
CV 131,134,135
NA 172,44,52
R 42,20,2048
NA 172,48,60
R 44,20,4096
NA 164,48,56
R 46,20,6144
NA 164,52,64
R 48,20,8192
buffer_load_dwordx4 v12, s[36:39], s75 offen offset:1024 lds
buffer_store_dwordx4 v[128:131], v23, s[48:51], s76 offen offset:2048 sc1
NA 172,52,68
R 50,20,10240
NA 144,56,72
R 52,20,12288
NA 152,56,76
R 54,20,14336
NA 152,60,84
R 56,20,16384
buffer_load_dwordx4 v13, s[36:39], s75 offen offset:2048 lds
NA 144,60,80
R 58,20,18432
NA 144,184,88
R 60,20,20480
NA 152,184,92
R 62,20,22528
NA 152,188,100
R 184,20,24576
buffer_load_dwordx4 v14, s[36:39], s75 offen offset:3072 lds
NA 144,188,96
R 186,20,26624
s_waitcnt lgkmcnt(6)
NA 144,192,104
R 188,20,28672
buffer_load_dwordx4 a[148:151], v16, s[48:51], s0 offen sc1
NA 152,192,108
R 190,20,30720
NA 152,196,116
R 192,20,32768
s_add_u32 m0, s67, 81920
s_add_u32 s75, s62, 406272
NA 144,196,112
R 194,20,34816
NA 144,200,120
R 196,21,0
buffer_load_dwordx4 v11, s[36:39], s75 offen offset:0 lds
NA 152,200,124
R 198,21,2048
NA 152,32,132
R 200,21,4096
CV 132,136,137
NA 144,32,128
R 202,21,6144
CV 133,138,139
NA 144,36,136
R 32,21,8192
s_add_u32 s0, s84, 4997120
NA 152,36,140
R 34,21,10240
NA 148,40,72
R 36,21,12288
buffer_load_dwordx4 a[152:155], v15, s[48:51], s0 offen sc1
NA 156,40,76
R 38,21,14336
NA 156,44,84
R 40,21,16384
CV 134,140,141
NA 148,44,80
R 42,21,18432
CV 135,142,143
NA 148,48,88
R 44,21,20480
NA 156,48,92
R 46,21,22528
NA 156,52,100
R 48,21,24576
buffer_store_dwordx4 v[132:135], v23, s[48:51], s76 offen offset:3072 sc1
NA 148,52,96
R 50,21,26624
s_waitcnt lgkmcnt(6)
NA 148,56,104
s_waitcnt vmcnt(17)
s_barrier
R 52,21,28672
NA 156,56,108
R 54,21,30720
NA 156,60,116
R 56,21,32768
s_add_u32 m0, s67, 110592
s_add_u32 s75, s62, 896
NA 148,60,112
R 58,21,34816
NA 148,184,120
R 60,22,0
buffer_load_dwordx4 v11, s[36:39], s75 offen offset:0 lds
NA 156,184,124
R 62,22,2048
NA 156,188,132
R 184,22,4096
NA 148,188,128
R 186,22,6144
NA 148,192,136
R 188,22,8192
NA 156,192,140
R 190,22,10240
NA 160,196,72
R 192,22,12288
buffer_load_dwordx4 v12, s[36:39], s75 offen offset:1024 lds
NA 168,196,76
R 194,22,14336
NA 168,200,84
R 196,22,16384
buffer_load_dwordx4 a[156:159], v16, s[48:51], s0 offen sc1
NA 160,200,80
R 198,22,18432
NA 160,32,88
R 200,22,20480
buffer_load_dwordx4 v13, s[36:39], s75 offen offset:2048 lds
NA 168,32,92
R 202,22,22528
NA 168,36,100
R 32,22,24576
buffer_load_dwordx4 v14, s[36:39], s75 offen offset:3072 lds
NA 160,36,96
R 34,22,26624
s_add_u32 m0, s67, 114688
s_add_u32 s75, s62, 37760
s_waitcnt lgkmcnt(6)
NA 160,40,104
R 36,22,28672
buffer_load_dwordx4 v11, s[36:39], s75 offen offset:0 lds
NA 168,40,108
R 38,22,30720
NA 168,44,116
R 40,22,32768
NA 160,44,112
R 42,22,34816
NA 160,48,120
R 44,19,36864
s_add_u32 s0, s84, 23724032
NA 168,48,124
R 46,19,38912
NA 168,52,132
R 48,19,40960
buffer_load_dwordx4 a[160:163], v15, s[48:51], s0 offen sc1
NA 160,52,128
R 50,19,43008
NA 160,56,136
R 52,19,45056
buffer_load_dwordx4 v12, s[36:39], s75 offen offset:1024 lds
NA 168,56,140
R 54,19,47104
NA 164,60,72
R 56,19,49152
NA 172,60,76
R 58,19,51200
NA 172,184,84
R 60,19,53248
buffer_load_dwordx4 v13, s[36:39], s75 offen offset:2048 lds
NA 164,184,80
R 62,19,55296
NA 164,188,88
R 184,19,57344
buffer_load_dwordx4 v14, s[36:39], s75 offen offset:3072 lds
NA 172,188,92
R 186,19,59392
s_add_u32 m0, s67, 118784
s_add_u32 s75, s62, 74624
NA 172,192,100
R 188,19,61440
buffer_load_dwordx4 v11, s[36:39], s75 offen offset:0 lds
NA 164,192,96
R 190,19,63488
s_waitcnt lgkmcnt(6)
NA 164,196,104
R 192,176,0
NA 172,196,108
R 194,176,2048
NA 172,200,116
R 196,176,4096
NA 164,200,112
R 198,176,6144
NA 164,32,120
R 200,20,36864
s_add_u32 m0, s79, 147456
s_add_u32 s75, s86, s79
s_add_u32 s75, s75, 0
NA 172,32,124
R 202,20,38912
NA 172,36,132
R 32,20,40960
buffer_load_dwordx4 v23, s[4:7], s75 offen lds
NA 164,36,128
R 34,20,43008
NA 164,40,136
R 36,20,45056
buffer_load_dwordx4 a[164:167], v16, s[48:51], s0 offen sc1
NA 172,40,140
R 38,20,47104
v_mfma_f32_16x16x32_bf16 v[112:115], v[44:47], a[0:3], 0
R 40,20,49152
v_mfma_f32_16x16x32_bf16 v[120:123], v[44:47], a[4:7], 0
R 42,20,51200
NA 120,48,12
R 44,20,53248
NA 112,48,8
R 46,20,55296
NA 112,52,16
R 48,20,57344
s_add_u32 m0, s79, 151552
s_add_u32 s75, s86, s79
s_add_u32 s75, s75, 4096
NA 120,52,20
R 50,20,59392
NA 120,56,28
R 52,20,61440
buffer_load_dwordx4 v23, s[4:7], s75 offen lds
NA 112,56,24
R 54,20,63488
CV 144,144,145
s_add_u32 s0, s84, 23871488
s_waitcnt lgkmcnt(6)
NA 112,60,32
R 56,177,0
buffer_load_dwordx4 a[168:171], v15, s[48:51], s0 offen sc1
CV 145,146,147
NA 120,60,36
R 58,177,2048
CV 146,148,149
NA 120,184,44
R 60,177,4096
CV 147,150,151
NA 112,184,40
R 62,177,6144
s_add_u32 s76, s78, 23744512
NA 112,188,48
R 184,21,36864
buffer_store_dwordx4 v[144:147], v23, s[48:51], s76 offen offset:0 sc1
NA 120,188,52
R 186,21,38912
NA 120,192,60
R 188,21,40960
NA 112,192,56
R 190,21,43008
NA 112,196,64
R 192,21,45056
CV 148,152,153
NA 120,196,68
R 194,21,47104
s_mov_b32 m0, 155648
s_add_u32 s75, s86, 8192
v_mfma_f32_16x16x32_bf16 v[116:119], v[200:203], a[0:3], 0
R 196,21,49152
buffer_load_dwordx4 v23, s[4:7], s75 offen lds
v_mfma_f32_16x16x32_bf16 v[124:127], v[200:203], a[4:7], 0
R 198,21,51200
CV 149,154,155
NA 124,32,12
R 200,21,53248
LM_pad19:
s_cbranch_execz LM_cr1
CV 150,156,157
NA 116,32,8
R 202,21,55296
CV 151,158,159
NA 116,36,16
R 32,21,57344
buffer_store_dwordx4 v[148:151], v23, s[48:51], s76 offen offset:1024 sc1
NA 124,36,20
R 34,21,59392
NA 124,40,28
R 36,21,61440
NA 116,40,24
R 38,21,63488
s_waitcnt lgkmcnt(6)
NA 116,44,32
s_waitcnt vmcnt(20)
s_barrier
R 40,178,0
NA 124,44,36
R 42,178,2048
NA 124,48,44
R 44,178,4096
buffer_load_dwordx4 a[172:175], v16, s[48:51], s0 offen sc1
NA 116,48,40
R 46,178,6144
s_add_u32 m0, s67, 0
s_add_u32 s75, s62, 332672
NA 116,52,48
R 48,22,36864
buffer_load_dwordx4 v11, s[36:39], s75 offen offset:0 lds
NA 124,52,52
R 50,22,38912
NA 124,56,60
R 52,22,40960
CV 160,160,161
NA 116,56,56
R 54,22,43008
CV 161,162,163
NA 116,60,64
R 56,22,45056
CV 162,164,165
NA 124,60,68
R 58,22,47104
CV 163,166,167
v_mfma_f32_16x16x32_bf16 v[128:131], v[184:187], a[0:3], 0
R 60,22,49152
buffer_store_dwordx4 v[160:163], v23, s[48:51], s76 offen offset:2048 sc1
v_mfma_f32_16x16x32_bf16 v[136:139], v[184:187], a[4:7], 0
R 62,22,51200
NA 136,188,12
R 184,22,53248
NA 128,188,8
R 186,22,55296
NA 128,192,16
R 188,22,57344
buffer_load_dwordx4 a[240:243], v18, s[48:51], s85 offen sc1
NA 136,192,20
R 190,22,59392
CV 164,168,169
NA 136,196,28
R 192,22,61440
buffer_load_dwordx4 v12, s[36:39], s75 offen offset:1024 lds
NA 128,196,24
R 194,22,63488
CV 165,170,171
s_waitcnt lgkmcnt(6)
NA 128,200,32
R 196,179,0
CV 166,172,173
NA 136,200,36
R 198,179,2048
CV 167,174,175
NA 136,32,44
R 200,179,4096
NA 128,32,40
R 202,179,6144
NA 128,36,48
R 32,176,8192
buffer_load_dwordx4 v13, s[36:39], s75 offen offset:2048 lds
buffer_store_dwordx4 v[164:167], v23, s[48:51], s76 offen offset:3072 sc1
NA 136,36,52
R 34,176,10240
s_add_u32 s85, s85, 16384
NA 136,40,60
R 36,176,12288
buffer_load_dwordx4 a[244:247], v18, s[48:51], s85 offen sc1
NA 128,40,56
R 38,176,14336
NA 128,44,64
R 40,176,16384
buffer_load_dwordx4 v14, s[36:39], s75 offen offset:3072 lds
NA 136,44,68
R 42,176,18432
v_mfma_f32_16x16x32_bf16 v[132:135], v[48:51], a[0:3], 0
R 44,176,20480
s_add_u32 m0, s67, 4096
s_add_u32 s75, s62, 369536
v_mfma_f32_16x16x32_bf16 v[140:143], v[48:51], a[4:7], 0
R 46,176,22528
NA 140,52,12
R 48,176,24576
buffer_load_dwordx4 v11, s[36:39], s75 offen offset:0 lds
NA 132,52,8
R 50,176,26624
NA 132,56,16
R 52,176,28672
NA 140,56,20
R 54,176,30720
NA 140,60,28
R 56,176,32768
NA 132,60,24
R 58,176,34816
s_waitcnt lgkmcnt(7)
NA 132,184,32
R 60,176,36864
NA 140,184,36
R 62,176,38912
NA 140,188,44
R 184,176,40960
NA 132,188,40
R 186,176,43008
NA 132,192,48
R 188,177,8192
NA 140,192,52
R 190,177,10240
NA 140,196,60
R 192,177,12288
s_add_u32 s85, s85, 16384
NA 132,196,56
R 194,177,14336
NA 132,200,64
R 196,177,16384
buffer_load_dwordx4 a[248:251], v28, s[48:51], s85 offen sc1
buffer_load_dwordx4 v12, s[36:39], s75 offen offset:1024 lds
NA 140,200,68
R 198,177,18432
NA 112,32,72
R 200,177,20480
NA 120,32,76
R 202,177,22528
NA 120,36,84
R 32,177,24576
buffer_load_dwordx4 v13, s[36:39], s75 offen offset:2048 lds
NA 112,36,80
R 34,177,26624
NA 112,40,88
R 36,177,28672
NA 120,40,92
R 38,177,30720
s_waitcnt lgkmcnt(7)
NA 120,44,100
R 40,177,32768
buffer_load_dwordx4 v14, s[36:39], s75 offen offset:3072 lds
NA 112,44,96
R 42,177,34816
NA 112,48,104
R 44,177,36864
NA 120,48,108
R 46,177,38912
NA 120,52,116
R 48,177,40960
s_add_u32 m0, s67, 8192
s_add_u32 s75, s62, 406400
NA 112,52,112
R 50,177,43008
NA 112,56,120
R 52,178,8192
buffer_load_dwordx4 v11, s[36:39], s75 offen offset:0 lds
NA 120,56,124
R 54,178,10240
NA 120,60,132
R 56,178,12288
NA 112,60,128
R 58,178,14336
NA 112,184,136
R 60,178,16384
NA 120,184,140
R 62,178,18432
NA 116,188,72
R 184,178,20480
NA 124,188,76
R 186,178,22528
NA 124,192,84
R 188,178,24576
s_mov_b32 s81, 42631168
NA 116,192,80
R 190,178,26624
s_waitcnt lgkmcnt(7)
NA 116,196,88
R 192,178,28672
buffer_load_dword v31, v24, s[48:51], s81 offen sc1
NA 124,196,92
R 194,178,30720
NA 124,200,100
R 196,178,32768
NA 116,200,96
R 198,178,34816
NA 116,32,104
s_waitcnt vmcnt(17)
s_barrier
R 200,178,36864
NA 124,32,108
R 202,178,38912
NA 124,36,116
R 32,178,40960
s_add_u32 m0, s67, 36864
s_add_u32 s75, s62, 1024
NA 116,36,112
R 34,178,43008
NA 116,40,120
R 36,179,8192
buffer_load_dwordx4 v11, s[36:39], s75 offen offset:0 lds
NA 124,40,124
R 38,179,10240
NA 124,44,132
R 40,179,12288
NA 116,44,128
R 42,179,14336
NA 116,48,136
R 44,179,16384
NA 124,48,140
R 46,179,18432
NA 128,52,72
R 48,179,20480
NA 136,52,76
R 50,179,22528
s_waitcnt lgkmcnt(7)
NA 136,56,84
R 52,179,24576
s_add_u32 s74, s80, 40960
s_waitcnt vmcnt(10)
NA 128,56,80
R 54,179,26624
NA 128,60,88
R 56,179,28672
buffer_store_dword v3, v30, s[48:51], s74 offen sc1
NA 136,60,92
R 58,179,30720
NA 136,184,100
R 60,179,32768
buffer_load_dwordx4 v12, s[36:39], s75 offen offset:1024 lds
NA 128,184,96
R 62,179,34816
NA 128,188,104
R 184,179,36864
NA 136,188,108
R 186,179,38912
NA 136,192,116
R 188,179,40960
NA 128,192,112
R 190,179,43008
NA 128,196,120
R 192,176,45056
buffer_load_dwordx4 v13, s[36:39], s75 offen offset:2048 lds
NA 136,196,124
R 194,176,47104
NA 136,200,132
R 196,176,49152
NA 128,200,128
R 198,176,51200
NA 128,32,136
R 200,176,53248
buffer_load_dwordx4 v14, s[36:39], s75 offen offset:3072 lds
NA 136,32,140
R 202,176,55296
s_waitcnt lgkmcnt(6)
NA 132,36,72
R 32,176,57344
s_add_u32 m0, s67, 40960
s_add_u32 s75, s62, 37888
NA 140,36,76
R 34,176,59392
NA 140,40,84
R 36,176,61440
buffer_load_dwordx4 v11, s[36:39], s75 offen offset:0 lds
NA 132,40,80
R 38,176,63488
NA 132,44,88
R 40,180,0
NA 140,44,92
R 42,180,2048
NA 140,48,100
R 44,180,4096
NA 132,48,96
R 46,180,6144
NA 132,52,104
R 48,180,8192
NA 140,52,108
R 50,180,10240
NA 140,56,116
R 52,180,12288
NA 132,56,112
R 54,180,14336
NA 132,60,120
R 56,177,45056
NA 140,60,124
R 58,177,47104
NA 140,184,132
R 60,177,49152
NA 132,184,128
R 62,177,51200
NA 132,188,136
R 184,177,53248
buffer_load_dwordx4 v12, s[36:39], s75 offen offset:1024 lds
s_waitcnt vmcnt(7)
v_cmp_ne_u32 vcc, 0x10000, v31
s_nop 1
s_cbranch_vccnz LM_poll4
LM_ok4:
NA 140,188,140
R 186,177,55296
s_waitcnt lgkmcnt(6)
v_mfma_f32_16x16x32_bf16 v[144:147], v[192:195], a[0:3], 0
R 188,177,57344
s_add_u32 s0, s84, 4857856
v_mfma_f32_16x16x32_bf16 v[152:155], v[192:195], a[4:7], 0
R 190,177,59392
NA 152,196,12
R 192,177,61440
buffer_load_dwordx4 a[176:179], v15, s[48:51], s0 offen sc1
buffer_load_dwordx4 v13, s[36:39], s75 offen offset:2048 lds
NA 144,196,8
R 194,177,63488
NA 144,200,16
R 196,181,0
NA 152,200,20
R 198,181,2048
NA 152,32,28
R 200,181,4096
buffer_load_dwordx4 v14, s[36:39], s75 offen offset:3072 lds
NA 144,32,24
R 202,181,6144
CV 112,112,113
NA 144,36,32
R 32,181,8192
CV 113,114,115
NA 152,36,36
R 34,181,10240
NA 152,40,44
R 36,181,12288
s_add_u32 m0, s67, 45056
s_add_u32 s75, s62, 74752
NA 144,40,40
R 38,181,14336
NA 144,44,48
R 40,178,45056
buffer_load_dwordx4 v11, s[36:39], s75 offen offset:0 lds
NA 152,44,52
R 42,178,47104
NA 152,48,60
R 44,178,49152
CV 114,116,117
NA 144,48,56
R 46,178,51200
CV 115,118,119
NA 144,52,64
R 48,178,53248
s_add_u32 s76, s78, 23748608
NA 152,52,68
R 50,178,55296
s_waitcnt lgkmcnt(6)
v_mfma_f32_16x16x32_bf16 v[148:151], v[56:59], a[0:3], 0
R 52,178,57344
buffer_store_dwordx4 v[112:115], v23, s[48:51], s76 offen offset:0 sc1
v_mfma_f32_16x16x32_bf16 v[156:159], v[56:59], a[4:7], 0
R 54,178,59392
NA 156,60,12
R 56,178,61440
NA 148,60,8
R 58,178,63488
NA 148,184,16
R 60,182,0
NA 156,184,20
R 62,182,2048
NA 156,188,28
R 184,182,4096
buffer_load_dwordx4 a[180:183], v16, s[48:51], s0 offen sc1
NA 148,188,24
R 186,182,6144
NA 148,192,32
s_barrier
R 188,182,8192
NA 156,192,36
R 190,182,10240
NA 156,196,44
R 192,182,12288
s_add_u32 m0, s67, 73728
s_add_u32 s75, s62, 332800
NA 148,196,40
R 194,182,14336
NA 148,200,48
R 196,179,45056
buffer_load_dwordx4 v11, s[36:39], s75 offen offset:0 lds
NA 156,200,52
R 198,179,47104
NA 156,32,60
R 200,179,49152
CV 116,120,121
NA 148,32,56
R 202,179,51200
NA 148,36,64
R 32,179,53248
s_add_u32 s0, s84, 5005312
NA 156,36,68
R 34,179,55296
s_waitcnt lgkmcnt(6)
v_mfma_f32_16x16x32_bf16 v[160:163], v[40:43], a[0:3], 0
R 36,179,57344
buffer_load_dwordx4 a[184:187], v15, s[48:51], s0 offen sc1
v_mfma_f32_16x16x32_bf16 v[168:171], v[40:43], a[4:7], 0
R 38,179,59392
CV 117,122,123
NA 168,44,12
R 40,179,61440
CV 118,124,125
NA 160,44,8
R 42,179,63488
NA 160,48,16
R 44,183,0
CV 119,126,127
NA 168,48,20
R 46,183,2048
NA 168,52,28
R 48,183,4096
buffer_load_dwordx4 v12, s[36:39], s75 offen offset:1024 lds
NA 160,52,24
R 50,183,6144
NA 160,56,32
R 52,183,8192
buffer_store_dwordx4 v[116:119], v23, s[48:51], s76 offen offset:1024 sc1
NA 168,56,36
R 54,183,10240
NA 168,60,44
R 56,183,12288
NA 160,60,40
R 58,183,14336
NA 160,184,48
R 60,19,0
buffer_load_dwordx4 v13, s[36:39], s75 offen offset:2048 lds
NA 168,184,52
R 62,19,2048
NA 168,188,60
R 184,19,4096
NA 160,188,56
R 186,19,6144
NA 160,192,64
R 188,19,8192
buffer_load_dwordx4 v14, s[36:39], s75 offen offset:3072 lds
NA 168,192,68
R 190,19,10240
s_waitcnt lgkmcnt(6)
v_mfma_f32_16x16x32_bf16 v[164:167], v[196:199], a[0:3], 0
R 192,19,12288
s_add_u32 m0, s67, 77824
s_add_u32 s75, s62, 369664
v_mfma_f32_16x16x32_bf16 v[172:175], v[196:199], a[4:7], 0
R 194,19,14336
NA 172,200,12
R 196,19,16384
buffer_load_dwordx4 v11, s[36:39], s75 offen offset:0 lds
NA 164,200,8
R 198,19,18432
NA 164,32,16
R 200,19,20480
buffer_load_dwordx4 a[188:191], v16, s[48:51], s0 offen sc1
NA 172,32,20
R 202,19,22528
NA 172,36,28
R 32,19,24576
CV 128,128,129
NA 164,36,24
R 34,19,26624
NA 164,40,32
R 36,19,28672
CV 129,130,131
NA 172,40,36
R 38,19,30720
NA 172,44,44
R 40,19,32768
CV 130,132,133
NA 164,44,40
R 42,19,34816
CV 131,134,135
NA 164,48,48
R 44,20,0
NA 172,48,52
R 46,20,2048
NA 172,52,60
R 48,20,4096
buffer_store_dwordx4 v[128:131], v23, s[48:51], s76 offen offset:2048 sc1
NA 164,52,56
R 50,20,6144
s_add_u32 s0, s84, 23732224
NA 164,56,64
R 52,20,8192
buffer_load_dwordx4 a[192:195], v15, s[48:51], s0 offen sc1
buffer_load_dwordx4 v12, s[36:39], s75 offen offset:1024 lds
NA 172,56,68
R 54,20,10240
s_waitcnt lgkmcnt(6)
NA 144,60,72
R 56,20,12288
NA 152,60,76
R 58,20,14336
NA 152,184,84
R 60,20,16384
buffer_load_dwordx4 v13, s[36:39], s75 offen offset:2048 lds
NA 144,184,80
R 62,20,18432
NA 144,188,88
R 184,20,20480
NA 152,188,92
R 186,20,22528
NA 152,192,100
R 188,20,24576
buffer_load_dwordx4 v14, s[36:39], s75 offen offset:3072 lds
NA 144,192,96
R 190,20,26624
NA 144,196,104
R 192,20,28672
NA 152,196,108
R 194,20,30720
NA 152,200,116
R 196,20,32768
LM_pad20:
s_cbranch_execz LM_cr1
s_add_u32 m0, s67, 81920
s_add_u32 s75, s62, 406528
NA 144,200,112
R 198,20,34816
NA 144,32,120
R 200,21,0
buffer_load_dwordx4 v11, s[36:39], s75 offen offset:0 lds
NA 152,32,124
R 202,21,2048
NA 152,36,132
R 32,21,4096
NA 144,36,128
R 34,21,6144
NA 144,40,136
R 36,21,8192
CV 132,136,137
NA 152,40,140
R 38,21,10240
s_waitcnt lgkmcnt(6)
NA 148,44,72
R 40,21,12288
CV 133,138,139
NA 156,44,76
R 42,21,14336
CV 134,140,141
NA 156,48,84
R 44,21,16384
buffer_load_dwordx4 a[196:199], v16, s[48:51], s0 offen sc1
NA 148,48,80
R 46,21,18432
NA 148,52,88
R 48,21,20480
CV 135,142,143
NA 156,52,92
R 50,21,22528
NA 156,56,100
R 52,21,24576
NA 148,56,96
R 54,21,26624
NA 148,60,104
s_waitcnt vmcnt(17)
s_barrier
R 56,21,28672
buffer_store_dwordx4 v[132:135], v23, s[48:51], s76 offen offset:3072 sc1
NA 156,60,108
R 58,21,30720
NA 156,184,116
R 60,21,32768
NA 148,184,112
R 62,21,34816
NA 148,188,120
R 184,22,0
s_add_u32 s0, s84, 23879680
NA 156,188,124
R 186,22,2048
NA 156,192,132
R 188,22,4096
buffer_load_dwordx4 a[200:203], v15, s[48:51], s0 offen sc1
NA 148,192,128
R 190,22,6144
NA 148,196,136
R 192,22,8192
NA 156,196,140
R 194,22,10240
s_waitcnt lgkmcnt(6)
NA 160,200,72
R 196,22,12288
NA 168,200,76
R 198,22,14336
NA 168,32,84
R 200,22,16384
NA 160,32,80
R 202,22,18432
NA 160,36,88
R 32,22,20480
NA 168,36,92
R 34,22,22528
NA 168,40,100
R 36,22,24576
NA 160,40,96
R 38,22,26624
NA 160,44,104
R 40,22,28672
NA 168,44,108
R 42,22,30720
NA 168,48,116
R 44,22,32768
NA 160,48,112
R 46,22,34816
NA 160,52,120
R 48,19,36864
NA 168,52,124
R 50,19,38912
NA 168,56,132
R 52,19,40960
NA 160,56,128
R 54,19,43008
NA 160,60,136
R 56,19,45056
NA 168,60,140
R 58,19,47104
s_waitcnt lgkmcnt(7)
NA 164,184,72
R 60,19,49152
buffer_load_dwordx4 a[204:207], v16, s[48:51], s0 offen sc1
NA 172,184,76
R 62,19,51200
NA 172,188,84
R 184,19,53248
NA 164,188,80
R 186,19,55296
NA 164,192,88
R 188,19,57344
NA 172,192,92
R 190,19,59392
NA 172,196,100
R 192,19,61440
NA 164,196,96
R 194,19,63488
NA 164,200,104
R 196,176,0
NA 172,200,108
R 198,176,2048
NA 172,32,116
R 200,176,4096
NA 164,32,112
R 202,176,6144
NA 164,36,120
R 32,20,36864
s_mov_b32 s81, 42639360
NA 172,36,124
R 34,20,38912
NA 172,40,132
R 36,20,40960
buffer_load_dword v31, v24, s[48:51], s81 offen sc1
NA 164,40,128
R 38,20,43008
s_waitcnt lgkmcnt(6)
NA 164,44,136
R 40,20,45056
NA 172,44,140
R 42,20,47104
v_mfma_f32_16x16x32_bf16 v[112:115], v[48:51], a[0:3], 0
R 44,20,49152
v_mfma_f32_16x16x32_bf16 v[120:123], v[48:51], a[4:7], 0
R 46,20,51200
NA 120,52,12
R 48,20,53248
NA 112,52,8
R 50,20,55296
NA 112,56,16
R 52,20,57344
NA 120,56,20
R 54,20,59392
NA 120,60,28
R 56,20,61440
CV 144,144,145
NA 112,60,24
R 58,20,63488
CV 145,146,147
NA 112,184,32
R 60,177,0
CV 146,148,149
NA 120,184,36
R 62,177,2048
CV 147,150,151
NA 120,188,44
R 184,177,4096
s_add_u32 s76, s78, 23752704
NA 112,188,40
R 186,177,6144
NA 112,192,48
R 188,21,36864
buffer_store_dwordx4 v[144:147], v23, s[48:51], s76 offen offset:0 sc1
NA 120,192,52
R 190,21,38912
NA 120,196,60
R 192,21,40960
NA 112,196,56
R 194,21,43008
s_waitcnt lgkmcnt(6)
NA 112,200,64
R 196,21,45056
CV 148,152,153
NA 120,200,68
R 198,21,47104
v_mfma_f32_16x16x32_bf16 v[116:119], v[32:35], a[0:3], 0
R 200,21,49152
CV 149,154,155
v_mfma_f32_16x16x32_bf16 v[124:127], v[32:35], a[4:7], 0
R 202,21,51200
CV 150,156,157
NA 124,36,12
R 32,21,53248
CV 151,158,159
NA 116,36,8
R 34,21,55296
NA 116,40,16
R 36,21,57344
NA 124,40,20
R 38,21,59392
NA 124,44,28
R 40,21,61440
buffer_store_dwordx4 v[148:151], v23, s[48:51], s76 offen offset:1024 sc1
NA 116,44,24
R 42,21,63488
NA 116,48,32
s_waitcnt vmcnt(7)
s_barrier
R 44,178,0
NA 124,48,36
R 46,178,2048
NA 124,52,44
R 48,178,4096
NA 116,52,40
R 50,178,6144
NA 116,56,48
R 52,22,36864
NA 124,56,52
R 54,22,38912
NA 124,60,60
R 56,22,40960
CV 160,160,161
NA 116,60,56
R 58,22,43008
CV 161,162,163
s_waitcnt lgkmcnt(6)
NA 116,184,64
R 60,22,45056
CV 162,164,165
NA 124,184,68
R 62,22,47104
CV 163,166,167
v_mfma_f32_16x16x32_bf16 v[128:131], v[188:191], a[0:3], 0
R 184,22,49152
v_mfma_f32_16x16x32_bf16 v[136:139], v[188:191], a[4:7], 0
R 186,22,51200
NA 136,192,12
R 188,22,53248
buffer_store_dwordx4 v[160:163], v23, s[48:51], s76 offen offset:2048 sc1
NA 128,192,8
R 190,22,55296
NA 128,196,16
R 192,22,57344
NA 136,196,20
R 194,22,59392
NA 136,200,28
R 196,22,61440
CV 164,168,169
NA 128,200,24
R 198,22,63488
CV 165,170,171
NA 128,32,32
R 200,179,0
s_waitcnt vmcnt(3)
v_cmp_ne_u32 vcc, 0x10000, v31
s_nop 1
s_cbranch_vccnz LM_poll5
LM_ok5:
NA 136,32,36
R 202,179,2048
NA 136,36,44
R 32,179,4096
CV 166,172,173
NA 128,36,40
R 34,179,6144
s_add_u32 s0, s84, 4866048
NA 128,40,48
R 36,176,8192
buffer_load_dwordx4 a[208:211], v15, s[48:51], s0 offen sc1
NA 136,40,52
R 38,176,10240
CV 167,174,175
NA 136,44,60
R 40,176,12288
NA 128,44,56
R 42,176,14336
s_waitcnt lgkmcnt(6)
NA 128,48,64
R 44,176,16384
buffer_store_dwordx4 v[164:167], v23, s[48:51], s76 offen offset:3072 sc1
NA 136,48,68
R 46,176,18432
v_mfma_f32_16x16x32_bf16 v[132:135], v[52:55], a[0:3], 0
R 48,176,20480
v_mfma_f32_16x16x32_bf16 v[140:143], v[52:55], a[4:7], 0
R 50,176,22528
NA 140,56,12
R 52,176,24576
NA 132,56,8
R 54,176,26624
NA 132,60,16
R 56,176,28672
NA 140,60,20
R 58,176,30720
NA 140,184,28
R 60,176,32768
NA 132,184,24
R 62,176,34816
NA 132,188,32
R 184,176,36864
buffer_load_dwordx4 a[212:215], v16, s[48:51], s0 offen sc1
NA 140,188,36
R 186,176,38912
NA 140,192,44
R 188,176,40960
NA 132,192,40
R 190,176,43008
NA 132,196,48
R 192,177,8192
s_add_u32 s0, s84, 5013504
NA 140,196,52
R 194,177,10240
NA 140,200,60
R 196,177,12288
buffer_load_dwordx4 a[216:219], v15, s[48:51], s0 offen sc1
NA 132,200,56
R 198,177,14336
s_waitcnt lgkmcnt(6)
NA 132,32,64
R 200,177,16384
NA 140,32,68
R 202,177,18432
NA 112,36,72
R 32,177,20480
NA 120,36,76
R 34,177,22528
NA 120,40,84
R 36,177,24576
NA 112,40,80
R 38,177,26624
NA 112,44,88
R 40,177,28672
NA 120,44,92
R 42,177,30720
NA 120,48,100
R 44,177,32768
NA 112,48,96
R 46,177,34816
NA 112,52,104
R 48,177,36864
NA 120,52,108
R 50,177,38912
NA 120,56,116
R 52,177,40960
buffer_load_dwordx4 a[220:223], v16, s[48:51], s0 offen sc1
NA 112,56,112
R 54,177,43008
NA 112,60,120
R 56,178,8192
NA 120,60,124
R 58,178,10240
NA 120,184,132
R 60,178,12288
NA 112,184,128
R 62,178,14336
s_waitcnt lgkmcnt(7)
NA 112,188,136
R 184,178,16384
s_add_u32 s0, s84, 23740416
NA 120,188,140
R 186,178,18432
NA 116,192,72
R 188,178,20480
buffer_load_dwordx4 a[224:227], v15, s[48:51], s0 offen sc1
NA 124,192,76
R 190,178,22528
NA 124,196,84
R 192,178,24576
NA 116,196,80
R 194,178,26624
NA 116,200,88
R 196,178,28672
NA 124,200,92
R 198,178,30720
NA 124,32,100
R 200,178,32768
NA 116,32,96
R 202,178,34816
NA 116,36,104
R 32,178,36864
s_add_u32 s74, s80, 49152
s_waitcnt vmcnt(4)
NA 124,36,108
R 34,178,38912
NA 124,40,116
R 36,178,40960
buffer_store_dword v3, v30, s[48:51], s74 offen sc1
NA 116,40,112
R 38,178,43008
NA 116,44,120
R 40,179,8192
NA 124,44,124
R 42,179,10240
s_waitcnt lgkmcnt(6)
NA 124,48,132
R 44,179,12288
buffer_load_dwordx4 a[228:231], v16, s[48:51], s0 offen sc1
NA 116,48,128
R 46,179,14336
NA 116,52,136
R 48,179,16384
NA 124,52,140
R 50,179,18432
NA 128,56,72
R 52,179,20480
NA 136,56,76
R 54,179,22528
NA 136,60,84
R 56,179,24576
s_add_u32 s0, s84, 23887872
NA 128,60,80
R 58,179,26624
NA 128,184,88
R 60,179,28672
buffer_load_dwordx4 a[232:235], v15, s[48:51], s0 offen sc1
NA 136,184,92
R 62,179,30720
NA 136,188,100
R 184,179,32768
NA 128,188,96
R 186,179,34816
NA 128,192,104
R 188,179,36864
CV 112,112,113
NA 136,192,108
R 190,179,38912
NA 136,196,116
R 192,179,40960
NA 128,196,112
R 194,179,43008
NA 128,200,120
CV 113,114,115
NA 136,200,124
CV 114,116,117
s_waitcnt lgkmcnt(5)
NA 136,32,132
CV 115,118,119
NA 128,32,128
s_add_u32 s76, s78, 23756800
NA 128,36,136
buffer_store_dwordx4 v[112:115], v23, s[48:51], s76 offen offset:0 sc1
NA 136,36,140
NA 132,40,72
buffer_load_dwordx4 a[236:239], v16, s[48:51], s0 offen sc1
NA 140,40,76
NA 140,44,84
CV 116,120,121
NA 132,44,80
NA 132,48,88
CV 117,122,123
NA 140,48,92
CV 118,124,125
NA 140,52,100
CV 119,126,127
NA 132,52,96
NA 132,56,104
buffer_store_dwordx4 v[116:119], v23, s[48:51], s76 offen offset:1024 sc1
NA 140,56,108
NA 140,60,116
NA 132,60,112
s_waitcnt lgkmcnt(0)
NA 132,184,120
NA 140,184,124
NA 140,188,132
NA 132,188,128
NA 132,192,136
NA 140,192,140
CV 128,128,129
CV 129,130,131
s_nop 4
CV 130,132,133
CV 131,134,135
buffer_store_dwordx4 v[128:131], v23, s[48:51], s76 offen offset:2048 sc1
CV 132,136,137
CV 133,138,139
CV 134,140,141
CV 135,142,143
buffer_store_dwordx4 v[132:135], v23, s[48:51], s76 offen offset:3072 sc1
ds_read_b64 v[48:49], v26 offset:0
ds_read_b64 v[50:51], v26 offset:256
ds_read_b64 v[52:53], v26 offset:512
ds_read_b64 v[54:55], v26 offset:768
ds_read_b64 v[56:57], v26 offset:1024
v_and_b32 v58, 1, v1
v_lshlrev_b32 v58, 4, v58
v_mov_b32 v59, 0x3f80
v_lshlrev_b32 v58, v58, v59
v_bfe_u32 v59, v1, 1, 3
v_cmp_eq_u32 vcc, 0, v59
s_nop 1
v_cndmask_b32 v32, 0, v58, vcc
v_cmp_eq_u32 vcc, 1, v59
s_nop 1
v_cndmask_b32 v33, 0, v58, vcc
v_cmp_eq_u32 vcc, 2, v59
s_nop 1
v_cndmask_b32 v34, 0, v58, vcc
v_cmp_eq_u32 vcc, 3, v59
s_nop 1
v_cndmask_b32 v35, 0, v58, vcc
v_cmp_eq_u32 vcc, 4, v59
s_nop 1
v_cndmask_b32 v36, 0, v58, vcc
v_cmp_eq_u32 vcc, 5, v59
s_nop 1
v_cndmask_b32 v37, 0, v58, vcc
v_cmp_eq_u32 vcc, 6, v59
s_nop 1
v_cndmask_b32 v38, 0, v58, vcc
v_cmp_eq_u32 vcc, 7, v59
s_nop 1
v_cndmask_b32 v39, 0, v58, vcc
v_lshrrev_b32 v59, 1, v1
v_xor_b32 v59, v59, v1
v_and_b32 v59, 8, v59
v_or_b32 v40, v32, v36
v_or_b32 v41, v33, v37
v_or_b32 v42, v34, v38
v_or_b32 v43, v35, v39
v_cmp_eq_u32 vcc, 0, v59
s_nop 1
v_cndmask_b32 v40, 0, v40, vcc
v_cndmask_b32 v41, 0, v41, vcc
v_cndmask_b32 v42, 0, v42, vcc
v_cndmask_b32 v43, 0, v43, vcc
v_cmp_gt_u32 vcc, 32, v1
s_nop 1
v_cndmask_b32 v44, v40, 0, vcc
v_cndmask_b32 v45, v41, 0, vcc
v_cndmask_b32 v46, v42, 0, vcc
v_cndmask_b32 v47, v43, 0, vcc
v_cndmask_b32 v40, 0, v40, vcc
v_cndmask_b32 v41, 0, v41, vcc
v_cndmask_b32 v42, 0, v42, vcc
v_cndmask_b32 v43, 0, v43, vcc
s_mov_b32 s81, 42647552
buffer_load_dword v31, v24, s[48:51], s81 offen sc1
v_add_u32 v27, 147456, v27
s_add_u32 s72, s79, 147456
v_add_u32 v62, s72, v23
s_cmp_eq_u32 s52, 0
s_cselect_b32 s72, 0, 2147483648
v_or_b32 v63, s72, v23
s_add_u32 s86, s86, s79
s_add_u32 s87, s86, 4096
s_add_u32 s88, s86, 8192
v_mfma_f32_16x16x32_bf16 v[84:87], v[40:43], a[240:243], 0
s_waitcnt lgkmcnt(0)
v_lshlrev_b32 v184, 16, v48
v_and_b32 v185, 0xffff0000, v48
v_lshlrev_b32 v186, 16, v49
v_and_b32 v187, 0xffff0000, v49
v_mfma_f32_16x16x32_bf16 v[88:91], v[44:47], a[240:243], 0
v_lshlrev_b32 v188, 16, v50
v_and_b32 v189, 0xffff0000, v50
v_lshlrev_b32 v190, 16, v51
v_and_b32 v191, 0xffff0000, v51
v_mfma_f32_16x16x32_bf16 v[92:95], v[40:43], a[244:247], 0
v_lshlrev_b32 v192, 16, v52
v_and_b32 v193, 0xffff0000, v52
v_lshlrev_b32 v194, 16, v53
v_and_b32 v195, 0xffff0000, v53
v_mfma_f32_16x16x32_bf16 v[96:99], v[44:47], a[244:247], 0
v_lshlrev_b32 v196, 16, v54
v_and_b32 v197, 0xffff0000, v54
v_lshlrev_b32 v198, 16, v55
v_and_b32 v199, 0xffff0000, v55
v_mfma_f32_16x16x32_bf16 v[100:103], v[40:43], a[248:251], 0
v_lshlrev_b32 v200, 16, v56
v_and_b32 v201, 0xffff0000, v56
v_lshlrev_b32 v202, 16, v57
v_and_b32 v203, 0xffff0000, v57
v_mfma_f32_16x16x32_bf16 v[64:67], v[32:35], a[144:147], 0
NA 64,36,148
NA 64,32,152
NA 64,36,156
NA 84,32,160
NA 84,36,164
NA 84,32,168
NA 84,36,172
v_mfma_f32_16x16x32_bf16 v[68:71], v[32:35], a[176:179], 0
NA 68,36,180
NA 68,32,184
NA 68,36,188
NA 88,32,192
NA 88,36,196
NA 88,32,200
NA 88,36,204
s_waitcnt vmcnt(1)
s_add_u32 s74, s80, 57344
buffer_store_dword v3, v30, s[48:51], s74 offen sc1
s_waitcnt vmcnt(1)
v_cmp_ne_u32 vcc, 0x10000, v31
s_nop 1
s_cbranch_vccnz LM_poll6
LM_ok6:
s_add_u32 s0, s84, 4874240
buffer_load_dwordx4 v[224:227], v15, s[48:51], s0 offen sc1
buffer_load_dwordx4 v[228:231], v16, s[48:51], s0 offen sc1
s_add_u32 s0, s84, 5021696
buffer_load_dwordx4 v[232:235], v15, s[48:51], s0 offen sc1
buffer_load_dwordx4 v[236:239], v16, s[48:51], s0 offen sc1
s_add_u32 s0, s84, 23748608
buffer_load_dwordx4 v[240:243], v15, s[48:51], s0 offen sc1
buffer_load_dwordx4 v[244:247], v16, s[48:51], s0 offen sc1
s_add_u32 s0, s84, 23896064
buffer_load_dwordx4 v[248:251], v15, s[48:51], s0 offen sc1
buffer_load_dwordx4 v[252:255], v16, s[48:51], s0 offen sc1
v_mfma_f32_16x16x32_bf16 v[72:75], v[32:35], a[208:211], 0
NA 72,36,212
NA 72,32,216
NA 72,36,220
NA 92,32,224
NA 92,36,228
NA 92,32,232
NA 92,36,236
v_mul_f32 v204, 0xbfb8aa3b, v84
v_mul_f32 v205, 0xbfb8aa3b, v85
v_mul_f32 v206, 0xbfb8aa3b, v86
v_mul_f32 v207, 0xbfb8aa3b, v87
v_mul_f32 v208, 0xbfb8aa3b, v88
v_mul_f32 v209, 0xbfb8aa3b, v89
v_mul_f32 v210, 0xbfb8aa3b, v90
v_mul_f32 v211, 0xbfb8aa3b, v91
v_mul_f32 v212, 0xbfb8aa3b, v92
v_mul_f32 v213, 0xbfb8aa3b, v93
v_mul_f32 v214, 0xbfb8aa3b, v94
v_mul_f32 v215, 0xbfb8aa3b, v95
v_exp_f32 v204, v204
v_exp_f32 v205, v205
v_exp_f32 v206, v206
v_exp_f32 v207, v207
v_exp_f32 v208, v208
v_exp_f32 v209, v209
v_exp_f32 v210, v210
v_exp_f32 v211, v211
v_exp_f32 v212, v212
v_exp_f32 v213, v213
v_exp_f32 v214, v214
v_exp_f32 v215, v215
v_add_f32 v204, 1.0, v204
v_add_f32 v205, 1.0, v205
v_add_f32 v206, 1.0, v206
v_add_f32 v207, 1.0, v207
v_add_f32 v208, 1.0, v208
v_add_f32 v209, 1.0, v209
v_add_f32 v210, 1.0, v210
v_add_f32 v211, 1.0, v211
v_add_f32 v212, 1.0, v212
v_add_f32 v213, 1.0, v213
v_add_f32 v214, 1.0, v214
v_add_f32 v215, 1.0, v215
v_rcp_f32 v204, v204
v_rcp_f32 v205, v205
v_rcp_f32 v206, v206
v_rcp_f32 v207, v207
v_rcp_f32 v208, v208
v_rcp_f32 v209, v209
v_rcp_f32 v210, v210
v_rcp_f32 v211, v211
v_rcp_f32 v212, v212
v_rcp_f32 v213, v213
v_rcp_f32 v214, v214
v_rcp_f32 v215, v215
v_mul_f32 v84, v84, v204
v_mul_f32 v85, v85, v205
v_mul_f32 v86, v86, v206
v_mul_f32 v87, v87, v207
v_mul_f32 v88, v88, v208
v_mul_f32 v89, v89, v209
v_mul_f32 v90, v90, v210
v_mul_f32 v91, v91, v211
v_mul_f32 v92, v92, v212
v_mul_f32 v93, v93, v213
v_mul_f32 v94, v94, v214
v_mul_f32 v95, v95, v215
v_fmac_f32 v184, v64, v84
v_fmac_f32 v185, v65, v85
v_fmac_f32 v186, v66, v86
v_fmac_f32 v187, v67, v87
v_fmac_f32 v188, v68, v88
v_fmac_f32 v189, v69, v89
v_fmac_f32 v190, v70, v90
v_fmac_f32 v191, v71, v91
v_fmac_f32 v192, v72, v92
v_fmac_f32 v193, v73, v93
v_fmac_f32 v194, v74, v94
v_fmac_f32 v195, v75, v95
CV 174,184,185
CV 175,186,187
CV 176,188,189
CV 177,190,191
CV 178,192,193
CV 179,194,195
ds_write_b64 v26, v[174:175] offset:0
ds_write_b64 v26, v[176:177] offset:256
ds_write_b64 v26, v[178:179] offset:512
s_mov_b32 s81, 42655744
buffer_load_dword v31, v24, s[48:51], s81 offen sc1
s_waitcnt vmcnt(8)
v_mfma_f32_16x16x32_bf16 v[76:79], v[32:35], v[224:227], 0
s_waitcnt vmcnt(7)
NV 76,36,228
s_waitcnt vmcnt(6)
NV 76,32,232
s_waitcnt vmcnt(5)
NV 76,36,236
s_waitcnt vmcnt(4)
NV 96,32,240
s_waitcnt vmcnt(3)
NV 96,36,244
s_waitcnt vmcnt(2)
NV 96,32,248
s_waitcnt vmcnt(1)
NV 96,36,252
s_nop 7
v_mul_f32 v216, 0xbfb8aa3b, v96
v_mul_f32 v217, 0xbfb8aa3b, v97
v_mul_f32 v218, 0xbfb8aa3b, v98
v_mul_f32 v219, 0xbfb8aa3b, v99
v_exp_f32 v216, v216
v_exp_f32 v217, v217
v_exp_f32 v218, v218
v_exp_f32 v219, v219
v_add_f32 v216, 1.0, v216
v_add_f32 v217, 1.0, v217
v_add_f32 v218, 1.0, v218
v_add_f32 v219, 1.0, v219
v_rcp_f32 v216, v216
v_rcp_f32 v217, v217
v_rcp_f32 v218, v218
v_rcp_f32 v219, v219
v_mul_f32 v96, v96, v216
v_mul_f32 v97, v97, v217
v_mul_f32 v98, v98, v218
v_mul_f32 v99, v99, v219
v_fmac_f32 v196, v76, v96
v_fmac_f32 v197, v77, v97
v_fmac_f32 v198, v78, v98
v_fmac_f32 v199, v79, v99
CV 180,196,197
CV 181,198,199
s_waitcnt vmcnt(0)
v_cmp_ne_u32 vcc, 0x10000, v31
s_nop 1
s_cbranch_vccnz LM_poll7
LM_ok7:
s_add_u32 s0, s84, 4882432
buffer_load_dwordx4 v[144:147], v15, s[48:51], s0 offen sc1
s_add_u32 s0, s84, 5029888
buffer_load_dwordx4 v[152:155], v15, s[48:51], s0 offen sc1
s_add_u32 s0, s84, 23756800
buffer_load_dwordx4 v[160:163], v15, s[48:51], s0 offen sc1
s_add_u32 s0, s84, 23904256
buffer_load_dwordx4 v[168:171], v15, s[48:51], s0 offen sc1
ds_write_b64 v26, v[180:181] offset:768
s_waitcnt vmcnt(3)
v_mfma_f32_16x16x32_bf16 v[80:83], v[32:35], v[144:147], 0
s_waitcnt vmcnt(2)
NV 80,32,152
s_waitcnt vmcnt(1)
NV 100,32,160
s_waitcnt vmcnt(0)
NV 100,32,168
s_nop 7
v_mul_f32 v220, 0xbfb8aa3b, v100
v_mul_f32 v221, 0xbfb8aa3b, v101
v_mul_f32 v222, 0xbfb8aa3b, v102
v_mul_f32 v223, 0xbfb8aa3b, v103
v_exp_f32 v220, v220
v_exp_f32 v221, v221
v_exp_f32 v222, v222
v_exp_f32 v223, v223
v_add_f32 v220, 1.0, v220
v_add_f32 v221, 1.0, v221
v_add_f32 v222, 1.0, v222
v_add_f32 v223, 1.0, v223
v_rcp_f32 v220, v220
v_rcp_f32 v221, v221
v_rcp_f32 v222, v222
v_rcp_f32 v223, v223
v_mul_f32 v100, v100, v220
v_mul_f32 v101, v101, v221
v_mul_f32 v102, v102, v222
v_mul_f32 v103, v103, v223
v_fmac_f32 v200, v80, v100
v_fmac_f32 v201, v81, v101
v_fmac_f32 v202, v82, v102
v_fmac_f32 v203, v83, v103
CV 182,200,201
CV 183,202,203
ds_write_b64 v27, v[182:183] offset:1024
s_waitcnt lgkmcnt(0)
s_barrier
ds_read_b128 v[224:227], v62 offset:0
ds_read_b128 v[228:231], v62 offset:4096
ds_read_b128 v[232:235], v62 offset:8192
s_waitcnt lgkmcnt(2)
buffer_store_dwordx4 v[224:227], v23, s[40:43], s86 offen sc1
s_waitcnt lgkmcnt(1)
buffer_store_dwordx4 v[228:231], v23, s[40:43], s87 offen sc1
s_waitcnt lgkmcnt(0)
buffer_store_dwordx4 v[232:235], v63, s[40:43], s88 offen sc1
LM_end:
s_endpgm
LM_poll0:
s_sleep 4
buffer_load_dword v31, v111, s[44:47], 0 offen sc1
s_sub_u32 s77, s77, 1
s_cmp_eq_u32 s77, 0
s_cbranch_scc1 LM_end
s_waitcnt vmcnt(0)
v_cmp_ne_u32 vcc, 0x10000, v31
s_nop 1
s_cbranch_vccnz LM_poll0
s_branch LM_ok0
LM_poll1:
s_sleep 4
buffer_load_dword v31, v105, s[48:51], s81 offen sc1
s_sub_u32 s77, s77, 1
s_cmp_eq_u32 s77, 0
s_cbranch_scc1 LM_end
s_waitcnt vmcnt(0)
v_cmp_ne_u32 vcc, 0x10000, v31
s_nop 1
s_cbranch_vccnz LM_poll1
s_branch LM_ok1
LM_poll2:
s_sleep 4
buffer_load_dword v31, v107, s[48:51], s81 offen sc1
s_sub_u32 s77, s77, 1
s_cmp_eq_u32 s77, 0
s_cbranch_scc1 LM_end
s_waitcnt vmcnt(0)
v_cmp_ne_u32 vcc, 0x10000, v31
s_nop 1
s_cbranch_vccnz LM_poll2
s_branch LM_ok2
LM_poll3:
s_sleep 4
buffer_load_dword v31, v24, s[48:51], s81 offen sc1
s_sub_u32 s77, s77, 1
s_cmp_eq_u32 s77, 0
s_cbranch_scc1 LM_end
s_waitcnt vmcnt(0)
v_cmp_ne_u32 vcc, 0x10000, v31
s_nop 1
s_cbranch_vccnz LM_poll3
s_branch LM_ok3
LM_poll4:
s_sleep 4
buffer_load_dword v31, v24, s[48:51], s81 offen sc1
s_sub_u32 s77, s77, 1
s_cmp_eq_u32 s77, 0
s_cbranch_scc1 LM_end
s_waitcnt vmcnt(0)
v_cmp_ne_u32 vcc, 0x10000, v31
s_nop 1
s_cbranch_vccnz LM_poll4
s_branch LM_ok4
LM_poll5:
s_sleep 4
buffer_load_dword v31, v24, s[48:51], s81 offen sc1
s_sub_u32 s77, s77, 1
s_cmp_eq_u32 s77, 0
s_cbranch_scc1 LM_end
s_waitcnt vmcnt(0)
v_cmp_ne_u32 vcc, 0x10000, v31
s_nop 1
s_cbranch_vccnz LM_poll5
s_branch LM_ok5
LM_poll6:
s_sleep 1
buffer_load_dword v31, v24, s[48:51], s81 offen sc1
s_sub_u32 s77, s77, 1
s_cmp_eq_u32 s77, 0
s_cbranch_scc1 LM_end
s_waitcnt vmcnt(0)
v_cmp_ne_u32 vcc, 0x10000, v31
s_nop 1
s_cbranch_vccnz LM_poll6
s_branch LM_ok6
LM_poll7:
s_sleep 1
buffer_load_dword v31, v24, s[48:51], s81 offen sc1
s_sub_u32 s77, s77, 1
s_cmp_eq_u32 s77, 0
s_cbranch_scc1 LM_end
s_waitcnt vmcnt(0)
v_cmp_ne_u32 vcc, 0x10000, v31
s_nop 1
s_cbranch_vccnz LM_poll7
s_branch LM_ok7
LA_start:
s_mov_b64 exec, 0
s_cmp_eq_u32 s52, 0
s_cbranch_scc1 LA_pad1
s_cmp_eq_u32 s52, 1
s_cbranch_scc1 LA_pad2
s_cmp_eq_u32 s52, 2
s_cbranch_scc1 LA_pad3
s_branch LA_pad4
.p2align 12
LA_ret:
s_mov_b64 exec, -1
s_getpc_b64 s[100:101]
s_and_b32 s100, s100, 0xfffff000
s_lshl_b32 s71, s52, 10
s_add_u32 s100, s100, s71
s_addc_u32 s101, s101, 0
s_lshl_b32 s71, s56, 10
s_mul_i32 s58, s52, 196608
s_add_u32 s58, s58, s71
s_lshl_b32 s72, s56, 20
s_add_u32 s72, s72, 393216
s_lshr_b32 s73, s52, 1
s_and_b32 s74, s52, 1
s_mul_i32 s59, s74, 589824
s_add_u32 s59, s59, s71
s_lshl_b32 s71, s73, 7
s_add_u32 s61, s72, s71
s_add_u32 s59, s59, s71
s_add_u32 s59, s59, 384
s_lshl_b32 s71, s74, 13
s_add_u32 s61, s61, s71
s_lshl_b32 s71, s73, 13
s_add_u32 s60, s72, s71
s_lshl_b32 s71, s74, 7
s_add_u32 s60, s60, s71
s_mul_i32 s71, s73, 393216
s_add_u32 s62, s60, s71
s_add_u32 s62, s62, 122880
s_mul_i32 s63, s56, 589824
s_mul_i32 s71, s52, 73728
s_add_u32 s63, s63, s71
v_lshrrev_b32 v12, 3, v1
v_and_b32 v13, 7, v1
v_mul_u32_u24 v11, 256, v12
v_and_b32 v12, 6, v12
v_xor_b32 v13, v12, v13
v_lshl_add_u32 v11, v13, 4, v11
v_add_u32 v12, 1024, v11
v_add_u32 v13, 2048, v11
v_add_u32 v14, 3072, v11
s_mul_i32 s0, s55, 10368
s_mul_i32 s74, s56, 0
s_add_u32 s0, s0, s74
v_lshrrev_b32 v44, 2, v1
v_min_u32 v44, 8, v44
v_mul_u32_u24 v44, 1152, v44
s_add_u32 s0, s0, 1024
buffer_load_dword v0, v44, s[24:27], s0 offen
s_mul_i32 s0, s55, 8192
s_mul_i32 s74, s56, 1024
s_add_u32 s0, s0, s74
v_and_b32 v44, -8, v1
v_lshlrev_b32 v44, 4, v44
s_add_u32 s0, s0, 0
buffer_load_dword v0, v44, s[16:19], s0 offen
s_add_u32 s0, s0, 524288
buffer_load_dword v0, v44, s[16:19], s0 offen
s_add_u32 s0, s0, 524288
buffer_load_dword v0, v44, s[16:19], s0 offen
s_add_u32 m0, s66, 4096
s_add_u32 s75, s82, 512
buffer_load_dwordx4 v19, s[4:7], s75 offen offset:0 lds
buffer_load_dwordx4 v20, s[4:7], s75 offen offset:1024 lds
buffer_load_dwordx4 v21, s[4:7], s75 offen offset:2048 lds
buffer_load_dwordx4 v22, s[4:7], s75 offen offset:3072 lds
s_waitcnt vmcnt(20)
ds_read_b128 v[112:115], v48 offset:0
ds_read_b128 v[116:119], v49 offset:0
ds_read_b128 v[120:123], v50 offset:0
ds_read_b128 v[124:127], v51 offset:0
s_add_u32 m0, s66, 36864
s_add_u32 s75, s82, 640
buffer_load_dwordx4 v19, s[4:7], s75 offen offset:0 lds
buffer_load_dwordx4 v20, s[4:7], s75 offen offset:1024 lds
buffer_load_dwordx4 v21, s[4:7], s75 offen offset:2048 lds
buffer_load_dwordx4 v22, s[4:7], s75 offen offset:3072 lds
s_waitcnt vmcnt(20)
ds_read_b128 v[128:131], v48 offset:4096
ds_read_b128 v[132:135], v49 offset:4096
ds_read_b128 v[136:139], v50 offset:4096
ds_read_b128 v[140:143], v51 offset:4096
s_waitcnt lgkmcnt(7)
v_dot2c_f32_bf16 v32, s83, v112
v_dot2c_f32_bf16 v36, v112, v112
v_dot2c_f32_bf16 v33, s83, v113
v_dot2c_f32_bf16 v37, v113, v113
v_dot2c_f32_bf16 v34, s83, v114
v_dot2c_f32_bf16 v38, v114, v114
v_dot2c_f32_bf16 v35, s83, v115
v_dot2c_f32_bf16 v39, v115, v115
s_waitcnt lgkmcnt(6)
v_dot2c_f32_bf16 v32, s83, v116
v_dot2c_f32_bf16 v36, v116, v116
v_dot2c_f32_bf16 v33, s83, v117
v_dot2c_f32_bf16 v37, v117, v117
v_dot2c_f32_bf16 v34, s83, v118
v_dot2c_f32_bf16 v38, v118, v118
v_dot2c_f32_bf16 v35, s83, v119
v_dot2c_f32_bf16 v39, v119, v119
s_waitcnt lgkmcnt(5)
v_dot2c_f32_bf16 v32, s83, v120
v_dot2c_f32_bf16 v36, v120, v120
v_dot2c_f32_bf16 v33, s83, v121
v_dot2c_f32_bf16 v37, v121, v121
v_dot2c_f32_bf16 v34, s83, v122
v_dot2c_f32_bf16 v38, v122, v122
v_dot2c_f32_bf16 v35, s83, v123
v_dot2c_f32_bf16 v39, v123, v123
s_waitcnt lgkmcnt(4)
v_dot2c_f32_bf16 v32, s83, v124
v_dot2c_f32_bf16 v36, v124, v124
v_dot2c_f32_bf16 v33, s83, v125
v_dot2c_f32_bf16 v37, v125, v125
v_dot2c_f32_bf16 v34, s83, v126
v_dot2c_f32_bf16 v38, v126, v126
v_dot2c_f32_bf16 v35, s83, v127
v_dot2c_f32_bf16 v39, v127, v127
s_add_u32 m0, s66, 40960
s_add_u32 s75, s82, 768
buffer_load_dwordx4 v19, s[4:7], s75 offen offset:0 lds
buffer_load_dwordx4 v20, s[4:7], s75 offen offset:1024 lds
buffer_load_dwordx4 v21, s[4:7], s75 offen offset:2048 lds
buffer_load_dwordx4 v22, s[4:7], s75 offen offset:3072 lds
s_waitcnt vmcnt(20)
ds_read_b128 v[144:147], v48 offset:8192
ds_read_b128 v[148:151], v49 offset:8192
ds_read_b128 v[152:155], v50 offset:8192
ds_read_b128 v[156:159], v51 offset:8192
s_waitcnt lgkmcnt(4)
v_dot2c_f32_bf16 v32, s83, v128
v_dot2c_f32_bf16 v36, v128, v128
v_dot2c_f32_bf16 v33, s83, v129
v_dot2c_f32_bf16 v37, v129, v129
v_dot2c_f32_bf16 v34, s83, v130
v_dot2c_f32_bf16 v38, v130, v130
v_dot2c_f32_bf16 v35, s83, v131
v_dot2c_f32_bf16 v39, v131, v131
v_dot2c_f32_bf16 v32, s83, v132
v_dot2c_f32_bf16 v36, v132, v132
v_dot2c_f32_bf16 v33, s83, v133
v_dot2c_f32_bf16 v37, v133, v133
v_dot2c_f32_bf16 v34, s83, v134
v_dot2c_f32_bf16 v38, v134, v134
v_dot2c_f32_bf16 v35, s83, v135
v_dot2c_f32_bf16 v39, v135, v135
v_dot2c_f32_bf16 v32, s83, v136
v_dot2c_f32_bf16 v36, v136, v136
v_dot2c_f32_bf16 v33, s83, v137
v_dot2c_f32_bf16 v37, v137, v137
v_dot2c_f32_bf16 v34, s83, v138
v_dot2c_f32_bf16 v38, v138, v138
v_dot2c_f32_bf16 v35, s83, v139
v_dot2c_f32_bf16 v39, v139, v139
v_dot2c_f32_bf16 v32, s83, v140
v_dot2c_f32_bf16 v36, v140, v140
v_dot2c_f32_bf16 v33, s83, v141
v_dot2c_f32_bf16 v37, v141, v141
v_dot2c_f32_bf16 v34, s83, v142
v_dot2c_f32_bf16 v38, v142, v142
v_dot2c_f32_bf16 v35, s83, v143
v_dot2c_f32_bf16 v39, v143, v143
s_add_u32 m0, s66, 73728
s_add_u32 s75, s82, 896
buffer_load_dwordx4 v19, s[4:7], s75 offen offset:0 lds
buffer_load_dwordx4 v20, s[4:7], s75 offen offset:1024 lds
buffer_load_dwordx4 v21, s[4:7], s75 offen offset:2048 lds
buffer_load_dwordx4 v22, s[4:7], s75 offen offset:3072 lds
s_waitcnt vmcnt(20)
ds_read_b128 v[160:163], v52 offset:0
ds_read_b128 v[164:167], v53 offset:0
ds_read_b128 v[168:171], v54 offset:0
ds_read_b128 v[172:175], v55 offset:0
s_waitcnt lgkmcnt(4)
v_dot2c_f32_bf16 v32, s83, v144
v_dot2c_f32_bf16 v36, v144, v144
v_dot2c_f32_bf16 v33, s83, v145
v_dot2c_f32_bf16 v37, v145, v145
v_dot2c_f32_bf16 v34, s83, v146
v_dot2c_f32_bf16 v38, v146, v146
v_dot2c_f32_bf16 v35, s83, v147
v_dot2c_f32_bf16 v39, v147, v147
v_dot2c_f32_bf16 v32, s83, v148
v_dot2c_f32_bf16 v36, v148, v148
v_dot2c_f32_bf16 v33, s83, v149
v_dot2c_f32_bf16 v37, v149, v149
v_dot2c_f32_bf16 v34, s83, v150
v_dot2c_f32_bf16 v38, v150, v150
v_dot2c_f32_bf16 v35, s83, v151
v_dot2c_f32_bf16 v39, v151, v151
v_dot2c_f32_bf16 v32, s83, v152
v_dot2c_f32_bf16 v36, v152, v152
v_dot2c_f32_bf16 v33, s83, v153
v_dot2c_f32_bf16 v37, v153, v153
v_dot2c_f32_bf16 v34, s83, v154
v_dot2c_f32_bf16 v38, v154, v154
v_dot2c_f32_bf16 v35, s83, v155
v_dot2c_f32_bf16 v39, v155, v155
v_dot2c_f32_bf16 v32, s83, v156
v_dot2c_f32_bf16 v36, v156, v156
v_dot2c_f32_bf16 v33, s83, v157
v_dot2c_f32_bf16 v37, v157, v157
v_dot2c_f32_bf16 v34, s83, v158
v_dot2c_f32_bf16 v38, v158, v158
v_dot2c_f32_bf16 v35, s83, v159
v_dot2c_f32_bf16 v39, v159, v159
s_add_u32 m0, s66, 77824
s_add_u32 s75, s82, 1024
buffer_load_dwordx4 v19, s[4:7], s75 offen offset:0 lds
buffer_load_dwordx4 v20, s[4:7], s75 offen offset:1024 lds
buffer_load_dwordx4 v21, s[4:7], s75 offen offset:2048 lds
buffer_load_dwordx4 v22, s[4:7], s75 offen offset:3072 lds
s_waitcnt vmcnt(16)
ds_read_b128 v[176:179], v52 offset:4096
ds_read_b128 v[180:183], v53 offset:4096
ds_read_b128 v[184:187], v54 offset:4096
ds_read_b128 v[188:191], v55 offset:4096
s_waitcnt lgkmcnt(4)
v_dot2c_f32_bf16 v32, s83, v160
v_dot2c_f32_bf16 v36, v160, v160
v_dot2c_f32_bf16 v33, s83, v161
v_dot2c_f32_bf16 v37, v161, v161
v_dot2c_f32_bf16 v34, s83, v162
v_dot2c_f32_bf16 v38, v162, v162
v_dot2c_f32_bf16 v35, s83, v163
v_dot2c_f32_bf16 v39, v163, v163
v_dot2c_f32_bf16 v32, s83, v164
v_dot2c_f32_bf16 v36, v164, v164
v_dot2c_f32_bf16 v33, s83, v165
v_dot2c_f32_bf16 v37, v165, v165
v_dot2c_f32_bf16 v34, s83, v166
v_dot2c_f32_bf16 v38, v166, v166
v_dot2c_f32_bf16 v35, s83, v167
v_dot2c_f32_bf16 v39, v167, v167
v_dot2c_f32_bf16 v32, s83, v168
v_dot2c_f32_bf16 v36, v168, v168
v_dot2c_f32_bf16 v33, s83, v169
v_dot2c_f32_bf16 v37, v169, v169
v_dot2c_f32_bf16 v34, s83, v170
v_dot2c_f32_bf16 v38, v170, v170
v_dot2c_f32_bf16 v35, s83, v171
v_dot2c_f32_bf16 v39, v171, v171
v_dot2c_f32_bf16 v32, s83, v172
v_dot2c_f32_bf16 v36, v172, v172
v_dot2c_f32_bf16 v33, s83, v173
v_dot2c_f32_bf16 v37, v173, v173
v_dot2c_f32_bf16 v34, s83, v174
v_dot2c_f32_bf16 v38, v174, v174
v_dot2c_f32_bf16 v35, s83, v175
v_dot2c_f32_bf16 v39, v175, v175
s_waitcnt vmcnt(12)
ds_read_b128 v[192:195], v52 offset:36864
ds_read_b128 v[196:199], v53 offset:36864
ds_read_b128 v[200:203], v54 offset:36864
ds_read_b128 v[204:207], v55 offset:36864
s_waitcnt lgkmcnt(4)
s_barrier
s_add_u32 m0, s69, 110592
s_add_u32 s75, s58, 0
buffer_load_dwordx4 v15, s[16:19], s75 offen offset:0 lds
buffer_load_dwordx4 v16, s[16:19], s75 offen offset:1024 lds
buffer_load_dwordx4 v17, s[16:19], s75 offen offset:2048 lds
s_add_u32 m0, s69, 122880
s_add_u32 s75, s58, 128
buffer_load_dwordx4 v15, s[16:19], s75 offen offset:0 lds
buffer_load_dwordx4 v16, s[16:19], s75 offen offset:1024 lds
buffer_load_dwordx4 v17, s[16:19], s75 offen offset:2048 lds
v_dot2c_f32_bf16 v32, s83, v176
v_dot2c_f32_bf16 v36, v176, v176
v_dot2c_f32_bf16 v33, s83, v177
v_dot2c_f32_bf16 v37, v177, v177
v_dot2c_f32_bf16 v34, s83, v178
v_dot2c_f32_bf16 v38, v178, v178
v_dot2c_f32_bf16 v35, s83, v179
v_dot2c_f32_bf16 v39, v179, v179
v_dot2c_f32_bf16 v32, s83, v180
v_dot2c_f32_bf16 v36, v180, v180
v_dot2c_f32_bf16 v33, s83, v181
v_dot2c_f32_bf16 v37, v181, v181
v_dot2c_f32_bf16 v34, s83, v182
v_dot2c_f32_bf16 v38, v182, v182
v_dot2c_f32_bf16 v35, s83, v183
v_dot2c_f32_bf16 v39, v183, v183
v_dot2c_f32_bf16 v32, s83, v184
v_dot2c_f32_bf16 v36, v184, v184
v_dot2c_f32_bf16 v33, s83, v185
v_dot2c_f32_bf16 v37, v185, v185
v_dot2c_f32_bf16 v34, s83, v186
v_dot2c_f32_bf16 v38, v186, v186
v_dot2c_f32_bf16 v35, s83, v187
v_dot2c_f32_bf16 v39, v187, v187
v_dot2c_f32_bf16 v32, s83, v188
v_dot2c_f32_bf16 v36, v188, v188
v_dot2c_f32_bf16 v33, s83, v189
v_dot2c_f32_bf16 v37, v189, v189
v_dot2c_f32_bf16 v34, s83, v190
v_dot2c_f32_bf16 v38, v190, v190
v_dot2c_f32_bf16 v35, s83, v191
v_dot2c_f32_bf16 v39, v191, v191
s_waitcnt vmcnt(14)
ds_read_b128 v[208:211], v52 offset:40960
ds_read_b128 v[212:215], v53 offset:40960
ds_read_b128 v[216:219], v54 offset:40960
ds_read_b128 v[220:223], v55 offset:40960
s_add_u32 m0, s69, 135168
s_add_u32 s75, s58, 256
buffer_load_dwordx4 v15, s[16:19], s75 offen offset:0 lds
buffer_load_dwordx4 v16, s[16:19], s75 offen offset:1024 lds
buffer_load_dwordx4 v17, s[16:19], s75 offen offset:2048 lds
s_waitcnt lgkmcnt(4)
v_dot2c_f32_bf16 v32, s83, v192
v_dot2c_f32_bf16 v36, v192, v192
v_dot2c_f32_bf16 v33, s83, v193
v_dot2c_f32_bf16 v37, v193, v193
v_dot2c_f32_bf16 v34, s83, v194
v_dot2c_f32_bf16 v38, v194, v194
v_dot2c_f32_bf16 v35, s83, v195
v_dot2c_f32_bf16 v39, v195, v195
v_dot2c_f32_bf16 v32, s83, v196
v_dot2c_f32_bf16 v36, v196, v196
v_dot2c_f32_bf16 v33, s83, v197
v_dot2c_f32_bf16 v37, v197, v197
v_dot2c_f32_bf16 v34, s83, v198
v_dot2c_f32_bf16 v38, v198, v198
v_dot2c_f32_bf16 v35, s83, v199
v_dot2c_f32_bf16 v39, v199, v199
v_dot2c_f32_bf16 v32, s83, v200
v_dot2c_f32_bf16 v36, v200, v200
v_dot2c_f32_bf16 v33, s83, v201
v_dot2c_f32_bf16 v37, v201, v201
v_dot2c_f32_bf16 v34, s83, v202
v_dot2c_f32_bf16 v38, v202, v202
v_dot2c_f32_bf16 v35, s83, v203
v_dot2c_f32_bf16 v39, v203, v203
v_dot2c_f32_bf16 v32, s83, v204
v_dot2c_f32_bf16 v36, v204, v204
v_dot2c_f32_bf16 v33, s83, v205
v_dot2c_f32_bf16 v37, v205, v205
v_dot2c_f32_bf16 v34, s83, v206
v_dot2c_f32_bf16 v38, v206, v206
v_dot2c_f32_bf16 v35, s83, v207
v_dot2c_f32_bf16 v39, v207, v207
s_waitcnt vmcnt(13)
ds_read_b128 v[224:227], v56 offset:0
ds_read_b128 v[228:231], v57 offset:0
ds_read_b128 v[232:235], v58 offset:0
ds_read_b128 v[236:239], v59 offset:0
s_add_u32 m0, s69, 0
s_add_u32 s75, s58, 786432
buffer_load_dwordx4 v15, s[16:19], s75 offen offset:0 lds
buffer_load_dwordx4 v16, s[16:19], s75 offen offset:1024 lds
buffer_load_dwordx4 v17, s[16:19], s75 offen offset:2048 lds
s_waitcnt lgkmcnt(4)
v_dot2c_f32_bf16 v32, s83, v208
v_dot2c_f32_bf16 v36, v208, v208
v_dot2c_f32_bf16 v33, s83, v209
v_dot2c_f32_bf16 v37, v209, v209
v_dot2c_f32_bf16 v34, s83, v210
v_dot2c_f32_bf16 v38, v210, v210
v_dot2c_f32_bf16 v35, s83, v211
v_dot2c_f32_bf16 v39, v211, v211
v_dot2c_f32_bf16 v32, s83, v212
v_dot2c_f32_bf16 v36, v212, v212
v_dot2c_f32_bf16 v33, s83, v213
v_dot2c_f32_bf16 v37, v213, v213
v_dot2c_f32_bf16 v34, s83, v214
v_dot2c_f32_bf16 v38, v214, v214
v_dot2c_f32_bf16 v35, s83, v215
v_dot2c_f32_bf16 v39, v215, v215
v_dot2c_f32_bf16 v32, s83, v216
v_dot2c_f32_bf16 v36, v216, v216
v_dot2c_f32_bf16 v33, s83, v217
v_dot2c_f32_bf16 v37, v217, v217
v_dot2c_f32_bf16 v34, s83, v218
v_dot2c_f32_bf16 v38, v218, v218
v_dot2c_f32_bf16 v35, s83, v219
v_dot2c_f32_bf16 v39, v219, v219
v_dot2c_f32_bf16 v32, s83, v220
v_dot2c_f32_bf16 v36, v220, v220
v_dot2c_f32_bf16 v33, s83, v221
v_dot2c_f32_bf16 v37, v221, v221
v_dot2c_f32_bf16 v34, s83, v222
v_dot2c_f32_bf16 v38, v222, v222
v_dot2c_f32_bf16 v35, s83, v223
v_dot2c_f32_bf16 v39, v223, v223
s_waitcnt vmcnt(12)
ds_read_b128 v[240:243], v56 offset:4096
ds_read_b128 v[244:247], v57 offset:4096
ds_read_b128 v[248:251], v58 offset:4096
ds_read_b128 v[252:255], v59 offset:4096
s_add_u32 m0, s69, 12288
s_add_u32 s75, s58, 786560
buffer_load_dwordx4 v15, s[16:19], s75 offen offset:0 lds
buffer_load_dwordx4 v16, s[16:19], s75 offen offset:1024 lds
buffer_load_dwordx4 v17, s[16:19], s75 offen offset:2048 lds
s_waitcnt lgkmcnt(4)
v_dot2c_f32_bf16 v32, s83, v224
v_dot2c_f32_bf16 v36, v224, v224
v_dot2c_f32_bf16 v33, s83, v225
v_dot2c_f32_bf16 v37, v225, v225
v_dot2c_f32_bf16 v34, s83, v226
v_dot2c_f32_bf16 v38, v226, v226
v_dot2c_f32_bf16 v35, s83, v227
v_dot2c_f32_bf16 v39, v227, v227
v_dot2c_f32_bf16 v32, s83, v228
v_dot2c_f32_bf16 v36, v228, v228
v_dot2c_f32_bf16 v33, s83, v229
v_dot2c_f32_bf16 v37, v229, v229
v_dot2c_f32_bf16 v34, s83, v230
v_dot2c_f32_bf16 v38, v230, v230
v_dot2c_f32_bf16 v35, s83, v231
v_dot2c_f32_bf16 v39, v231, v231
v_dot2c_f32_bf16 v32, s83, v232
v_dot2c_f32_bf16 v36, v232, v232
v_dot2c_f32_bf16 v33, s83, v233
v_dot2c_f32_bf16 v37, v233, v233
v_dot2c_f32_bf16 v34, s83, v234
v_dot2c_f32_bf16 v38, v234, v234
v_dot2c_f32_bf16 v35, s83, v235
v_dot2c_f32_bf16 v39, v235, v235
v_dot2c_f32_bf16 v32, s83, v236
v_dot2c_f32_bf16 v36, v236, v236
v_dot2c_f32_bf16 v33, s83, v237
v_dot2c_f32_bf16 v37, v237, v237
v_dot2c_f32_bf16 v34, s83, v238
v_dot2c_f32_bf16 v38, v238, v238
v_dot2c_f32_bf16 v35, s83, v239
v_dot2c_f32_bf16 v39, v239, v239
s_add_u32 m0, s69, 24576
s_add_u32 s75, s58, 786688
buffer_load_dwordx4 v15, s[16:19], s75 offen offset:0 lds
buffer_load_dwordx4 v16, s[16:19], s75 offen offset:1024 lds
buffer_load_dwordx4 v17, s[16:19], s75 offen offset:2048 lds
s_waitcnt lgkmcnt(0)
v_dot2c_f32_bf16 v32, s83, v240
v_dot2c_f32_bf16 v36, v240, v240
v_dot2c_f32_bf16 v33, s83, v241
v_dot2c_f32_bf16 v37, v241, v241
v_dot2c_f32_bf16 v34, s83, v242
v_dot2c_f32_bf16 v38, v242, v242
v_dot2c_f32_bf16 v35, s83, v243
v_dot2c_f32_bf16 v39, v243, v243
v_dot2c_f32_bf16 v32, s83, v244
v_dot2c_f32_bf16 v36, v244, v244
v_dot2c_f32_bf16 v33, s83, v245
v_dot2c_f32_bf16 v37, v245, v245
v_dot2c_f32_bf16 v34, s83, v246
v_dot2c_f32_bf16 v38, v246, v246
v_dot2c_f32_bf16 v35, s83, v247
v_dot2c_f32_bf16 v39, v247, v247
v_dot2c_f32_bf16 v32, s83, v248
v_dot2c_f32_bf16 v36, v248, v248
v_dot2c_f32_bf16 v33, s83, v249
v_dot2c_f32_bf16 v37, v249, v249
v_dot2c_f32_bf16 v34, s83, v250
v_dot2c_f32_bf16 v38, v250, v250
v_dot2c_f32_bf16 v35, s83, v251
v_dot2c_f32_bf16 v39, v251, v251
v_dot2c_f32_bf16 v32, s83, v252
v_dot2c_f32_bf16 v36, v252, v252
v_dot2c_f32_bf16 v33, s83, v253
v_dot2c_f32_bf16 v37, v253, v253
v_dot2c_f32_bf16 v34, s83, v254
v_dot2c_f32_bf16 v38, v254, v254
v_dot2c_f32_bf16 v35, s83, v255
v_dot2c_f32_bf16 v39, v255, v255
v_add_f32 v32, v32, v33
s_nop 0
v_add_f32 v34, v34, v35
v_add_f32 v36, v36, v37
v_add_f32 v38, v38, v39
v_add_f32 v32, v32, v34
v_add_f32 v36, v36, v38
v_mov_b32 v33, v32
v_mov_b32 v37, v36
s_nop 0
v_permlane32_swap_b32 v32, v33
v_permlane32_swap_b32 v36, v37
v_add_f32 v32, v32, v33
v_add_f32 v36, v36, v37
v_mul_f32 v24, 0xbae38e39, v32
v_mul_f32 v36, 0x3ae38e39, v36
v_fma_f32 v36, -v24, v24, v36
v_max_f32 v27, 0, v36
v_add_f32 v37, 0x3727c5ac, v27
v_rsq_f32 v25, v37
s_nop 0
v_mul_f32 v26, 0x3e0293ee, v25
v_mul_f32 v29, v24, v26
v_lshlrev_b32 v96, 16, v112
v_and_b32 v97, 0xffff0000, v112
v_lshlrev_b32 v98, 16, v113
v_and_b32 v99, 0xffff0000, v113
v_lshlrev_b32 v100, 16, v114
v_and_b32 v101, 0xffff0000, v114
v_lshlrev_b32 v102, 16, v115
v_and_b32 v103, 0xffff0000, v115
v_fma_f32 v96, v96, v26, v29
v_fma_f32 v97, v97, v26, v29
v_fma_f32 v98, v98, v26, v29
v_fma_f32 v99, v99, v26, v29
v_fma_f32 v100, v100, v26, v29
v_fma_f32 v101, v101, v26, v29
v_fma_f32 v102, v102, v26, v29
v_fma_f32 v103, v103, v26, v29
CV 112,96,97
CV 113,98,99
CV 114,100,101
CV 115,102,103
s_waitcnt vmcnt(9)
s_barrier
R 32,3,45056
R 34,3,45568
R 36,6,45056
R 38,6,45568
R 40,3,57344
R 42,3,57856
R 44,6,57344
R 46,6,57856
R 48,4,4096
R 50,4,4608
R 52,7,4096
R 54,7,4608
R 56,3,47104
R 58,3,47616
s_waitcnt lgkmcnt(12)
v_mfma_f32_32x32x16_bf16 a[0:15], v[32:35], v[112:115], 0
R 60,6,47104
R 62,6,47616
v_lshlrev_b32 v104, 16, v116
v_and_b32 v105, 0xffff0000, v116
v_lshlrev_b32 v106, 16, v117
v_and_b32 v107, 0xffff0000, v117
v_lshlrev_b32 v108, 16, v118
s_add_u32 m0, s69, 36864
s_add_u32 s75, s58, 1572864
s_waitcnt lgkmcnt(12)
v_mfma_f32_32x32x16_bf16 a[16:31], v[36:39], v[112:115], 0
R 32,3,59392
R 34,3,59904
buffer_load_dwordx4 v15, s[16:19], s75 offen offset:0 lds
v_and_b32 v109, 0xffff0000, v118
v_lshlrev_b32 v110, 16, v119
v_and_b32 v111, 0xffff0000, v119
v_fma_f32 v104, v104, v26, v29
v_fma_f32 v105, v105, v26, v29
v_fma_f32 v106, v106, v26, v29
s_waitcnt lgkmcnt(4)
v_mfma_f32_32x32x16_bf16 a[32:47], v[40:43], v[112:115], 0
R 36,6,59392
R 38,6,59904
v_fma_f32 v107, v107, v26, v29
s_mul_i32 s0, s55, 8192
s_mul_i32 s74, s56, 1024
s_add_u32 s0, s0, s74
v_fma_f32 v108, v108, v26, v29
v_fma_f32 v109, v109, v26, v29
v_fma_f32 v110, v110, v26, v29
v_fma_f32 v111, v111, v26, v29
v_mfma_f32_32x32x16_bf16 a[48:63], v[44:47], v[112:115], 0
R 40,4,6144
R 42,4,6656
v_and_b32 v31, -8, v1
CV 116,104,105
CV 117,106,107
CV 118,108,109
v_lshlrev_b32 v31, 4, v31
CV 119,110,111
v_mfma_f32_32x32x16_bf16 a[64:79], v[48:51], v[112:115], 0
R 44,7,6144
R 46,7,6656
buffer_load_dwordx4 v16, s[16:19], s75 offen offset:1024 lds
v_lshlrev_b32 v96, 16, v120
v_and_b32 v97, 0xffff0000, v120
v_lshlrev_b32 v98, 16, v121
s_add_u32 s0, s0, 1572864
v_mfma_f32_32x32x16_bf16 a[80:95], v[52:55], v[112:115], 0
R 48,3,49152
R 50,3,49664
buffer_load_dwordx4 v17, s[16:19], s75 offen offset:2048 lds
buffer_load_dword v0, v31, s[16:19], s0 offen
v_and_b32 v99, 0xffff0000, v121
v_lshlrev_b32 v100, 16, v122
MA 0,56,116
R 52,6,49152
R 54,6,49664
v_and_b32 v101, 0xffff0000, v122
v_lshlrev_b32 v102, 16, v123
v_and_b32 v103, 0xffff0000, v123
s_add_u32 m0, s69, 49152
s_add_u32 s75, s58, 1572992
s_waitcnt lgkmcnt(4)
MA 16,60,116
R 56,3,61440
R 58,3,61952
buffer_load_dwordx4 v15, s[16:19], s75 offen offset:0 lds
v_fma_f32 v96, v96, v26, v29
v_fma_f32 v97, v97, v26, v29
v_fma_f32 v98, v98, v26, v29
v_fma_f32 v99, v99, v26, v29
MA 32,32,116
R 60,6,61440
R 62,6,61952
v_fma_f32 v100, v100, v26, v29
v_fma_f32 v101, v101, v26, v29
v_fma_f32 v102, v102, v26, v29
v_fma_f32 v103, v103, v26, v29
MA 48,36,116
R 32,4,8192
R 34,4,8704
CV 120,96,97
CV 121,98,99
CV 122,100,101
CV 123,102,103
MA 64,40,116
R 36,7,8192
R 38,7,8704
buffer_load_dwordx4 v16, s[16:19], s75 offen offset:1024 lds
v_lshlrev_b32 v104, 16, v124
v_and_b32 v105, 0xffff0000, v124
v_lshlrev_b32 v106, 16, v125
v_and_b32 v107, 0xffff0000, v125
MA 80,44,116
R 40,3,51200
R 42,3,51712
buffer_load_dwordx4 v17, s[16:19], s75 offen offset:2048 lds
v_lshlrev_b32 v108, 16, v126
v_and_b32 v109, 0xffff0000, v126
v_lshlrev_b32 v110, 16, v127
s_waitcnt lgkmcnt(5)
MA 0,48,120
R 44,6,51200
R 46,6,51712
v_and_b32 v111, 0xffff0000, v127
v_fma_f32 v104, v104, v26, v29
v_fma_f32 v105, v105, v26, v29
s_add_u32 m0, s69, 61440
s_add_u32 s75, s58, 1573120
MA 16,52,120
R 48,3,63488
R 50,3,64000
buffer_load_dwordx4 v15, s[16:19], s75 offen offset:0 lds
v_fma_f32 v106, v106, v26, v29
v_fma_f32 v107, v107, v26, v29
v_fma_f32 v108, v108, v26, v29
s_add_u32 s0, s0, 524288
MA 32,56,120
R 52,6,63488
R 54,6,64000
buffer_load_dword v0, v31, s[16:19], s0 offen
v_fma_f32 v109, v109, v26, v29
v_fma_f32 v110, v110, v26, v29
v_fma_f32 v111, v111, v26, v29
MA 48,60,120
R 56,4,10240
R 58,4,10752
CV 124,104,105
CV 125,106,107
CV 126,108,109
CV 127,110,111
s_waitcnt lgkmcnt(5)
MA 64,32,120
R 60,7,10240
R 62,7,10752
buffer_load_dwordx4 v16, s[16:19], s75 offen offset:1024 lds
v_lshlrev_b32 v96, 16, v128
v_and_b32 v97, 0xffff0000, v128
v_lshlrev_b32 v98, 16, v129
MA 80,36,120
R 32,3,53248
R 34,3,53760
buffer_load_dwordx4 v17, s[16:19], s75 offen offset:2048 lds
v_and_b32 v99, 0xffff0000, v129
v_lshlrev_b32 v100, 16, v130
v_and_b32 v101, 0xffff0000, v130
MA 0,40,124
R 36,6,53248
R 38,6,53760
v_lshlrev_b32 v102, 16, v131
v_and_b32 v103, 0xffff0000, v131
v_fma_f32 v96, v96, v26, v29
v_fma_f32 v97, v97, v26, v29
v_fma_f32 v98, v98, v26, v29
MA 16,44,124
R 40,4,0
R 42,4,512
v_fma_f32 v99, v99, v26, v29
v_fma_f32 v100, v100, v26, v29
s_add_u32 m0, s69, 73728
s_add_u32 s75, s58, 2359296
s_waitcnt lgkmcnt(5)
MA 32,48,124
R 44,7,0
R 46,7,512
buffer_load_dwordx4 v15, s[16:19], s75 offen offset:0 lds
v_fma_f32 v101, v101, v26, v29
v_fma_f32 v102, v102, v26, v29
v_fma_f32 v103, v103, v26, v29
MA 48,52,124
R 48,4,12288
R 50,4,12800
CV 128,96,97
CV 129,98,99
CV 130,100,101
CV 131,102,103
MA 64,56,124
R 52,7,12288
R 54,7,12800
v_lshlrev_b32 v104, 16, v132
v_and_b32 v105, 0xffff0000, v132
v_lshlrev_b32 v106, 16, v133
v_and_b32 v107, 0xffff0000, v133
LA_pad1:
s_cbranch_execz LA_pad5
s_add_u32 s0, s0, 524288
MA 80,60,124
R 56,3,55296
R 58,3,55808
buffer_load_dword v0, v31, s[16:19], s0 offen
v_lshlrev_b32 v108, 16, v134
v_and_b32 v109, 0xffff0000, v134
v_lshlrev_b32 v110, 16, v135
v_and_b32 v111, 0xffff0000, v135
s_waitcnt lgkmcnt(4)
MA 0,32,128
R 60,6,55296
R 62,6,55808
v_fma_f32 v104, v104, v26, v29
v_fma_f32 v105, v105, v26, v29
v_fma_f32 v106, v106, v26, v29
v_fma_f32 v107, v107, v26, v29
v_fma_f32 v108, v108, v26, v29
MA 16,36,128
R 32,4,2048
R 34,4,2560
buffer_load_dwordx4 v16, s[16:19], s75 offen offset:1024 lds
v_fma_f32 v109, v109, v26, v29
v_fma_f32 v110, v110, v26, v29
v_fma_f32 v111, v111, v26, v29
CV 132,104,105
MA 32,40,128
s_waitcnt vmcnt(14)
s_barrier
R 36,7,2048
R 38,7,2560
MA 48,44,128
R 40,4,14336
R 42,4,14848
buffer_load_dwordx4 v17, s[16:19], s75 offen offset:2048 lds
CV 133,106,107
CV 134,108,109
CV 135,110,111
MA 64,48,128
R 44,7,14336
R 46,7,14848
v_lshlrev_b32 v96, 16, v136
v_and_b32 v97, 0xffff0000, v136
v_lshlrev_b32 v98, 16, v137
s_add_u32 m0, s69, 86016
s_add_u32 s75, s58, 2359424
s_waitcnt lgkmcnt(6)
MA 80,52,128
R 48,2,0
R 50,2,512
buffer_load_dwordx4 v15, s[16:19], s75 offen offset:0 lds
v_and_b32 v99, 0xffff0000, v137
v_lshlrev_b32 v100, 16, v138
v_and_b32 v101, 0xffff0000, v138
MA 0,56,132
R 52,5,0
R 54,5,512
v_lshlrev_b32 v102, 16, v139
v_and_b32 v103, 0xffff0000, v139
v_fma_f32 v96, v96, v26, v29
v_fma_f32 v97, v97, v26, v29
MA 16,60,132
R 56,2,12288
R 58,2,12800
v_fma_f32 v98, v98, v26, v29
v_fma_f32 v99, v99, v26, v29
v_fma_f32 v100, v100, v26, v29
v_fma_f32 v101, v101, v26, v29
MA 32,32,132
R 60,5,12288
R 62,5,12800
v_fma_f32 v102, v102, v26, v29
v_fma_f32 v103, v103, v26, v29
CV 136,96,97
s_add_u32 s0, s0, 524288
s_waitcnt lgkmcnt(6)
MA 48,36,132
R 32,2,24576
R 34,2,25088
buffer_load_dword v0, v31, s[16:19], s0 offen
CV 137,98,99
CV 138,100,101
CV 139,102,103
MA 64,40,132
R 36,5,24576
R 38,5,25088
v_lshlrev_b32 v104, 16, v140
v_and_b32 v105, 0xffff0000, v140
v_lshlrev_b32 v106, 16, v141
v_and_b32 v107, 0xffff0000, v141
MA 80,44,132
R 40,2,2048
R 42,2,2560
buffer_load_dwordx4 v16, s[16:19], s75 offen offset:1024 lds
v_lshlrev_b32 v108, 16, v142
v_and_b32 v109, 0xffff0000, v142
v_lshlrev_b32 v110, 16, v143
MA 0,48,136
R 44,5,2048
R 46,5,2560
v_and_b32 v111, 0xffff0000, v143
v_fma_f32 v104, v104, v26, v29
v_fma_f32 v105, v105, v26, v29
v_fma_f32 v106, v106, v26, v29
v_fma_f32 v107, v107, v26, v29
s_waitcnt lgkmcnt(5)
MA 16,52,136
R 48,2,14336
R 50,2,14848
buffer_load_dwordx4 v17, s[16:19], s75 offen offset:2048 lds
v_fma_f32 v108, v108, v26, v29
v_fma_f32 v109, v109, v26, v29
v_fma_f32 v110, v110, v26, v29
MA 32,56,136
R 52,5,14336
R 54,5,14848
v_fma_f32 v111, v111, v26, v29
CV 140,104,105
s_add_u32 m0, s69, 98304
s_add_u32 s75, s58, 2359552
MA 48,60,136
R 56,2,26624
R 58,2,27136
buffer_load_dwordx4 v15, s[16:19], s75 offen offset:0 lds
CV 141,106,107
CV 142,108,109
CV 143,110,111
MA 64,32,136
R 60,5,26624
R 62,5,27136
v_lshlrev_b32 v96, 16, v144
v_and_b32 v97, 0xffff0000, v144
v_lshlrev_b32 v98, 16, v145
v_and_b32 v99, 0xffff0000, v145
s_waitcnt lgkmcnt(6)
MA 80,36,136
R 32,2,4096
R 34,2,4608
v_lshlrev_b32 v100, 16, v146
v_and_b32 v101, 0xffff0000, v146
v_lshlrev_b32 v102, 16, v147
s_add_u32 s0, s0, 524288
MA 0,40,140
R 36,5,4096
R 38,5,4608
buffer_load_dword v0, v31, s[16:19], s0 offen
v_and_b32 v103, 0xffff0000, v147
v_fma_f32 v96, v96, v26, v29
v_fma_f32 v97, v97, v26, v29
MA 16,44,140
R 40,2,16384
R 42,2,16896
v_fma_f32 v98, v98, v26, v29
v_fma_f32 v99, v99, v26, v29
v_fma_f32 v100, v100, v26, v29
v_fma_f32 v101, v101, v26, v29
MA 32,48,140
R 44,5,16384
R 46,5,16896
v_fma_f32 v102, v102, v26, v29
v_fma_f32 v103, v103, v26, v29
CV 144,96,97
s_waitcnt lgkmcnt(6)
MA 48,52,140
R 48,2,28672
R 50,2,29184
buffer_load_dwordx4 v16, s[16:19], s75 offen offset:1024 lds
CV 145,98,99
CV 146,100,101
CV 147,102,103
MA 64,56,140
R 52,5,28672
R 54,5,29184
v_lshlrev_b32 v104, 16, v148
v_and_b32 v105, 0xffff0000, v148
v_lshlrev_b32 v106, 16, v149
v_and_b32 v107, 0xffff0000, v149
v_lshlrev_b32 v108, 16, v150
MA 80,60,140
R 56,2,6144
R 58,2,6656
buffer_load_dwordx4 v17, s[16:19], s75 offen offset:2048 lds
v_and_b32 v109, 0xffff0000, v150
v_lshlrev_b32 v110, 16, v151
v_and_b32 v111, 0xffff0000, v151
v_fma_f32 v104, v104, v26, v29
MA 0,32,144
R 60,5,6144
R 62,5,6656
v_fma_f32 v105, v105, v26, v29
v_fma_f32 v106, v106, v26, v29
v_fma_f32 v107, v107, v26, v29
v_fma_f32 v108, v108, v26, v29
v_fma_f32 v109, v109, v26, v29
s_waitcnt lgkmcnt(4)
MA 16,36,144
s_waitcnt vmcnt(12)
s_barrier
R 32,2,18432
R 34,2,18944
MA 32,40,144
R 36,5,18432
R 38,5,18944
v_fma_f32 v110, v110, v26, v29
v_fma_f32 v111, v111, v26, v29
CV 148,104,105
s_add_u32 s0, s0, 524288
s_add_u32 m0, s69, 110592
s_add_u32 s75, s58, 3145728
MA 48,44,144
R 40,2,30720
R 42,2,31232
buffer_load_dword v0, v31, s[16:19], s0 offen
buffer_load_dwordx4 v15, s[16:19], s75 offen offset:0 lds
CV 149,106,107
CV 150,108,109
CV 151,110,111
MA 64,48,144
R 44,5,30720
R 46,5,31232
v_lshlrev_b32 v96, 16, v152
v_and_b32 v97, 0xffff0000, v152
v_lshlrev_b32 v98, 16, v153
v_and_b32 v99, 0xffff0000, v153
MA 80,52,144
R 48,2,8192
R 50,2,8704
v_lshlrev_b32 v100, 16, v154
v_and_b32 v101, 0xffff0000, v154
v_lshlrev_b32 v102, 16, v155
s_waitcnt lgkmcnt(6)
MA 0,56,148
R 52,5,8192
R 54,5,8704
v_and_b32 v103, 0xffff0000, v155
v_fma_f32 v96, v96, v26, v29
v_fma_f32 v97, v97, v26, v29
v_fma_f32 v98, v98, v26, v29
MA 16,60,148
R 56,2,20480
R 58,2,20992
v_fma_f32 v99, v99, v26, v29
v_fma_f32 v100, v100, v26, v29
v_fma_f32 v101, v101, v26, v29
MA 32,32,148
R 60,5,20480
R 62,5,20992
v_fma_f32 v102, v102, v26, v29
v_fma_f32 v103, v103, v26, v29
CV 152,96,97
CV 153,98,99
MA 48,36,148
R 32,2,32768
R 34,2,33280
buffer_load_dwordx4 v16, s[16:19], s75 offen offset:1024 lds
CV 154,100,101
CV 155,102,103
s_waitcnt lgkmcnt(6)
MA 64,40,148
R 36,5,32768
R 38,5,33280
v_lshlrev_b32 v104, 16, v156
v_and_b32 v105, 0xffff0000, v156
v_lshlrev_b32 v106, 16, v157
v_and_b32 v107, 0xffff0000, v157
v_lshlrev_b32 v108, 16, v158
MA 80,44,148
R 40,2,10240
R 42,2,10752
v_and_b32 v109, 0xffff0000, v158
v_lshlrev_b32 v110, 16, v159
v_and_b32 v111, 0xffff0000, v159
v_fma_f32 v104, v104, v26, v29
v_fma_f32 v105, v105, v26, v29
MA 0,48,152
R 44,5,10240
R 46,5,10752
buffer_load_dwordx4 v17, s[16:19], s75 offen offset:2048 lds
v_fma_f32 v106, v106, v26, v29
v_fma_f32 v107, v107, v26, v29
v_fma_f32 v108, v108, v26, v29
v_fma_f32 v109, v109, v26, v29
MA 16,52,152
R 48,2,22528
R 50,2,23040
v_fma_f32 v110, v110, v26, v29
v_fma_f32 v111, v111, v26, v29
CV 156,104,105
s_add_u32 m0, s69, 122880
s_add_u32 s75, s58, 3145856
s_waitcnt lgkmcnt(4)
MA 32,56,152
R 52,5,22528
R 54,5,23040
buffer_load_dwordx4 v15, s[16:19], s75 offen offset:0 lds
s_mul_i32 s0, s55, 10368
s_mul_i32 s74, s56, 128
s_add_u32 s0, s0, s74
CV 157,106,107
MA 48,60,152
R 56,2,34816
R 58,2,35328
CV 158,108,109
v_lshrrev_b32 v31, 2, v1
v_min_u32 v31, 8, v31
CV 159,110,111
v_mul_u32_u24 v31, 1152, v31
MA 64,32,152
R 60,5,34816
R 62,5,35328
v_lshlrev_b32 v96, 16, v160
v_and_b32 v97, 0xffff0000, v160
v_lshlrev_b32 v98, 16, v161
s_add_u32 s0, s0, 0
MA 80,36,152
R 32,2,36864
R 34,2,37376
buffer_load_dword v0, v31, s[28:31], s0 offen
v_and_b32 v99, 0xffff0000, v161
v_lshlrev_b32 v100, 16, v162
v_and_b32 v101, 0xffff0000, v162
MA 0,40,156
R 36,5,36864
R 38,5,37376
v_lshlrev_b32 v102, 16, v163
v_and_b32 v103, 0xffff0000, v163
v_fma_f32 v96, v96, v26, v29
v_fma_f32 v97, v97, v26, v29
s_waitcnt lgkmcnt(6)
MA 16,44,156
R 40,2,49152
R 42,2,49664
v_fma_f32 v98, v98, v26, v29
v_fma_f32 v99, v99, v26, v29
v_fma_f32 v100, v100, v26, v29
v_fma_f32 v101, v101, v26, v29
MA 32,48,156
R 44,5,49152
R 46,5,49664
v_fma_f32 v102, v102, v26, v29
v_fma_f32 v103, v103, v26, v29
CV 160,96,97
MA 48,52,156
R 48,2,61440
R 50,2,61952
buffer_load_dwordx4 v16, s[16:19], s75 offen offset:1024 lds
CV 161,98,99
CV 162,100,101
CV 163,102,103
MA 64,56,156
R 52,5,61440
R 54,5,61952
v_lshlrev_b32 v104, 16, v164
v_and_b32 v105, 0xffff0000, v164
v_lshlrev_b32 v106, 16, v165
v_and_b32 v107, 0xffff0000, v165
v_lshlrev_b32 v108, 16, v166
s_waitcnt lgkmcnt(6)
MA 80,60,156
R 56,2,38912
R 58,2,39424
buffer_load_dwordx4 v17, s[16:19], s75 offen offset:2048 lds
v_and_b32 v109, 0xffff0000, v166
v_lshlrev_b32 v110, 16, v167
v_and_b32 v111, 0xffff0000, v167
v_fma_f32 v104, v104, v26, v29
MA 0,32,160
R 60,5,38912
R 62,5,39424
v_fma_f32 v105, v105, v26, v29
v_fma_f32 v106, v106, v26, v29
v_fma_f32 v107, v107, v26, v29
s_add_u32 m0, s69, 135168
s_add_u32 s75, s58, 3145984
MA 16,36,160
R 32,2,51200
R 34,2,51712
buffer_load_dwordx4 v15, s[16:19], s75 offen offset:0 lds
v_fma_f32 v108, v108, v26, v29
v_fma_f32 v109, v109, v26, v29
v_fma_f32 v110, v110, v26, v29
v_fma_f32 v111, v111, v26, v29
MA 32,40,160
R 36,5,51200
R 38,5,51712
s_mul_i32 s0, s55, 10368
s_mul_i32 s74, s56, 0
s_add_u32 s0, s0, s74
CV 164,104,105
v_lshrrev_b32 v31, 2, v1
s_waitcnt lgkmcnt(4)
MA 48,44,160
R 40,2,63488
R 42,2,64000
CV 165,106,107
v_min_u32 v31, 8, v31
CV 166,108,109
v_mul_u32_u24 v31, 1152, v31
CV 167,110,111
MA 64,48,160
R 44,5,63488
R 46,5,64000
v_lshlrev_b32 v96, 16, v168
v_and_b32 v97, 0xffff0000, v168
v_lshlrev_b32 v98, 16, v169
s_add_u32 s0, s0, 1024
MA 80,52,160
R 48,2,40960
R 50,2,41472
buffer_load_dword v0, v31, s[28:31], s0 offen
v_and_b32 v99, 0xffff0000, v169
v_lshlrev_b32 v100, 16, v170
v_and_b32 v101, 0xffff0000, v170
MA 0,56,164
R 52,5,40960
R 54,5,41472
v_lshlrev_b32 v102, 16, v171
v_and_b32 v103, 0xffff0000, v171
v_fma_f32 v96, v96, v26, v29
v_fma_f32 v97, v97, v26, v29
MA 16,60,164
R 56,2,53248
R 58,2,53760
v_fma_f32 v98, v98, v26, v29
v_fma_f32 v99, v99, v26, v29
v_fma_f32 v100, v100, v26, v29
v_fma_f32 v101, v101, v26, v29
s_waitcnt lgkmcnt(6)
MA 32,32,164
R 60,5,53248
R 62,5,53760
buffer_load_dwordx4 v16, s[16:19], s75 offen offset:1024 lds
v_fma_f32 v102, v102, v26, v29
v_fma_f32 v103, v103, v26, v29
MA 48,36,164
R 32,3,0
R 34,3,512
CV 168,96,97
CV 169,98,99
CV 170,100,101
CV 171,102,103
MA 64,40,164
R 36,6,0
R 38,6,512
buffer_load_dwordx4 v17, s[16:19], s75 offen offset:2048 lds
v_lshlrev_b32 v104, 16, v172
v_and_b32 v105, 0xffff0000, v172
v_lshlrev_b32 v106, 16, v173
v_and_b32 v107, 0xffff0000, v173
MA 80,44,164
R 40,2,43008
R 42,2,43520
v_lshlrev_b32 v108, 16, v174
v_and_b32 v109, 0xffff0000, v174
v_lshlrev_b32 v110, 16, v175
v_and_b32 v111, 0xffff0000, v175
v_fma_f32 v104, v104, v26, v29
s_waitcnt lgkmcnt(4)
MA 0,48,168
R 44,5,43008
R 46,5,43520
v_fma_f32 v105, v105, v26, v29
v_fma_f32 v106, v106, v26, v29
v_fma_f32 v107, v107, v26, v29
v_fma_f32 v108, v108, v26, v29
MA 16,52,168
s_waitcnt vmcnt(12)
s_barrier
R 48,2,55296
R 50,2,55808
MA 32,56,168
R 52,5,55296
R 54,5,55808
v_fma_f32 v109, v109, v26, v29
v_fma_f32 v110, v110, v26, v29
v_fma_f32 v111, v111, v26, v29
CV 172,104,105
s_add_u32 m0, s69, 0
s_add_u32 s75, s58, 3932160
MA 48,60,168
R 56,3,2048
R 58,3,2560
buffer_load_dwordx4 v15, s[16:19], s75 offen offset:0 lds
CV 173,106,107
CV 174,108,109
CV 175,110,111
MA 64,32,168
R 60,6,2048
R 62,6,2560
v_lshlrev_b32 v96, 16, v176
v_and_b32 v97, 0xffff0000, v176
v_lshlrev_b32 v98, 16, v177
v_and_b32 v99, 0xffff0000, v177
s_waitcnt lgkmcnt(4)
MA 80,36,168
R 32,2,45056
R 34,2,45568
v_lshlrev_b32 v100, 16, v178
v_and_b32 v101, 0xffff0000, v178
v_lshlrev_b32 v102, 16, v179
MA 0,40,172
R 36,5,45056
R 38,5,45568
v_and_b32 v103, 0xffff0000, v179
v_fma_f32 v96, v96, v26, v29
v_fma_f32 v97, v97, v26, v29
v_fma_f32 v98, v98, v26, v29
MA 16,44,172
R 40,2,57344
R 42,2,57856
v_fma_f32 v99, v99, v26, v29
v_fma_f32 v100, v100, v26, v29
v_fma_f32 v101, v101, v26, v29
MA 32,48,172
R 44,5,57344
R 46,5,57856
v_fma_f32 v102, v102, v26, v29
v_fma_f32 v103, v103, v26, v29
CV 176,96,97
CV 177,98,99
MA 48,52,172
R 48,3,4096
R 50,3,4608
buffer_load_dwordx4 v16, s[16:19], s75 offen offset:1024 lds
CV 178,100,101
CV 179,102,103
s_waitcnt lgkmcnt(6)
MA 64,56,172
R 52,6,4096
R 54,6,4608
v_lshlrev_b32 v104, 16, v180
v_and_b32 v105, 0xffff0000, v180
v_lshlrev_b32 v106, 16, v181
v_and_b32 v107, 0xffff0000, v181
MA 80,60,172
R 56,2,47104
R 58,2,47616
v_lshlrev_b32 v108, 16, v182
v_and_b32 v109, 0xffff0000, v182
v_lshlrev_b32 v110, 16, v183
v_and_b32 v111, 0xffff0000, v183
MA 0,32,176
R 60,5,47104
R 62,5,47616
buffer_load_dwordx4 v17, s[16:19], s75 offen offset:2048 lds
v_fma_f32 v104, v104, v26, v29
v_fma_f32 v105, v105, v26, v29
v_fma_f32 v106, v106, v26, v29
MA 16,36,176
R 32,2,59392
R 34,2,59904
v_fma_f32 v107, v107, v26, v29
v_fma_f32 v108, v108, v26, v29
LA_pad2:
s_cbranch_execz LA_pad6
s_add_u32 m0, s69, 12288
s_add_u32 s75, s58, 3932288
s_waitcnt lgkmcnt(6)
MA 32,40,176
R 36,5,59392
R 38,5,59904
buffer_load_dwordx4 v15, s[16:19], s75 offen offset:0 lds
v_fma_f32 v109, v109, v26, v29
v_fma_f32 v110, v110, v26, v29
v_fma_f32 v111, v111, v26, v29
MA 48,44,176
R 40,3,6144
R 42,3,6656
CV 180,104,105
CV 181,106,107
CV 182,108,109
CV 183,110,111
MA 64,48,176
R 44,6,6144
R 46,6,6656
v_lshlrev_b32 v96, 16, v184
v_and_b32 v97, 0xffff0000, v184
v_lshlrev_b32 v98, 16, v185
v_and_b32 v99, 0xffff0000, v185
MA 80,52,176
R 48,3,8192
R 50,3,8704
v_lshlrev_b32 v100, 16, v186
v_and_b32 v101, 0xffff0000, v186
v_lshlrev_b32 v102, 16, v187
s_waitcnt lgkmcnt(6)
MA 0,56,180
R 52,6,8192
R 54,6,8704
v_and_b32 v103, 0xffff0000, v187
v_fma_f32 v96, v96, v26, v29
v_fma_f32 v97, v97, v26, v29
v_fma_f32 v98, v98, v26, v29
s_add_u32 s100, s100, 28672
s_addc_u32 s101, s101, 0
MA 16,60,180
R 56,3,20480
R 58,3,20992
global_load_dword v0, v23, s[100:101]
v_fma_f32 v99, v99, v26, v29
v_fma_f32 v100, v100, v26, v29
v_fma_f32 v101, v101, v26, v29
MA 32,32,180
R 60,6,20480
R 62,6,20992
v_fma_f32 v102, v102, v26, v29
v_fma_f32 v103, v103, v26, v29
CV 184,96,97
CV 185,98,99
MA 48,36,180
R 32,3,32768
R 34,3,33280
buffer_load_dwordx4 v16, s[16:19], s75 offen offset:1024 lds
CV 186,100,101
CV 187,102,103
s_waitcnt lgkmcnt(6)
MA 64,40,180
R 36,6,32768
R 38,6,33280
v_lshlrev_b32 v104, 16, v188
v_and_b32 v105, 0xffff0000, v188
v_lshlrev_b32 v106, 16, v189
v_and_b32 v107, 0xffff0000, v189
MA 80,44,180
R 40,3,10240
R 42,3,10752
buffer_load_dwordx4 v17, s[16:19], s75 offen offset:2048 lds
v_lshlrev_b32 v108, 16, v190
v_and_b32 v109, 0xffff0000, v190
v_lshlrev_b32 v110, 16, v191
MA 0,48,184
R 44,6,10240
R 46,6,10752
v_and_b32 v111, 0xffff0000, v191
v_fma_f32 v104, v104, v26, v29
v_fma_f32 v105, v105, v26, v29
s_add_u32 m0, s69, 24576
s_add_u32 s75, s58, 3932416
MA 16,52,184
R 48,3,22528
R 50,3,23040
buffer_load_dwordx4 v15, s[16:19], s75 offen offset:0 lds
v_fma_f32 v106, v106, v26, v29
v_fma_f32 v107, v107, v26, v29
s_waitcnt lgkmcnt(6)
MA 32,56,184
R 52,6,22528
R 54,6,23040
v_fma_f32 v108, v108, v26, v29
v_fma_f32 v109, v109, v26, v29
v_fma_f32 v110, v110, v26, v29
v_fma_f32 v111, v111, v26, v29
MA 48,60,184
R 56,3,34816
R 58,3,35328
CV 188,104,105
CV 189,106,107
CV 190,108,109
CV 191,110,111
MA 64,32,184
R 60,6,34816
R 62,6,35328
v_lshlrev_b32 v96, 16, v192
v_and_b32 v97, 0xffff0000, v192
v_lshlrev_b32 v98, 16, v193
v_and_b32 v99, 0xffff0000, v193
MA 80,36,184
R 32,3,12288
R 34,3,12800
v_lshlrev_b32 v100, 16, v194
v_and_b32 v101, 0xffff0000, v194
v_lshlrev_b32 v102, 16, v195
s_waitcnt lgkmcnt(6)
MA 0,40,188
R 36,6,12288
R 38,6,12800
v_and_b32 v103, 0xffff0000, v195
v_fma_f32 v96, v96, v26, v29
v_fma_f32 v97, v97, v26, v29
v_fma_f32 v98, v98, v26, v29
MA 16,44,188
R 40,3,24576
R 42,3,25088
v_fma_f32 v99, v99, v26, v29
v_fma_f32 v100, v100, v26, v29
v_fma_f32 v101, v101, v26, v29
MA 32,48,188
R 44,6,24576
R 46,6,25088
buffer_load_dwordx4 v16, s[16:19], s75 offen offset:1024 lds
v_fma_f32 v102, v102, v26, v29
v_fma_f32 v103, v103, v26, v29
CV 192,96,97
MA 48,52,188
R 48,3,36864
R 50,3,37376
CV 193,98,99
CV 194,100,101
CV 195,102,103
s_waitcnt lgkmcnt(6)
MA 64,56,188
R 52,6,36864
R 54,6,37376
buffer_load_dwordx4 v17, s[16:19], s75 offen offset:2048 lds
v_lshlrev_b32 v104, 16, v196
v_and_b32 v105, 0xffff0000, v196
v_lshlrev_b32 v106, 16, v197
v_and_b32 v107, 0xffff0000, v197
MA 80,60,188
R 56,3,14336
R 58,3,14848
v_lshlrev_b32 v108, 16, v198
v_and_b32 v109, 0xffff0000, v198
v_lshlrev_b32 v110, 16, v199
v_and_b32 v111, 0xffff0000, v199
v_fma_f32 v104, v104, v26, v29
MA 0,32,192
R 60,6,14336
R 62,6,14848
v_fma_f32 v105, v105, v26, v29
v_fma_f32 v106, v106, v26, v29
v_fma_f32 v107, v107, v26, v29
v_fma_f32 v108, v108, v26, v29
MA 16,36,192
s_waitcnt vmcnt(10)
s_barrier
R 32,3,26624
R 34,3,27136
s_waitcnt lgkmcnt(5)
MA 32,40,192
R 36,6,26624
R 38,6,27136
v_fma_f32 v109, v109, v26, v29
v_fma_f32 v110, v110, v26, v29
v_fma_f32 v111, v111, v26, v29
CV 196,104,105
s_add_u32 m0, s67, 36864
s_add_u32 s75, s59, 0
MA 48,44,192
R 40,3,38912
R 42,3,39424
buffer_load_dwordx4 v15, s[16:19], s75 offen offset:0 lds
CV 197,106,107
CV 198,108,109
CV 199,110,111
MA 64,48,192
R 44,6,38912
R 46,6,39424
v_lshlrev_b32 v96, 16, v200
v_and_b32 v97, 0xffff0000, v200
v_lshlrev_b32 v98, 16, v201
v_and_b32 v99, 0xffff0000, v201
MA 80,52,192
R 48,3,16384
R 50,3,16896
v_lshlrev_b32 v100, 16, v202
v_and_b32 v101, 0xffff0000, v202
v_lshlrev_b32 v102, 16, v203
s_waitcnt lgkmcnt(6)
MA 0,56,196
R 52,6,16384
R 54,6,16896
v_and_b32 v103, 0xffff0000, v203
v_fma_f32 v96, v96, v26, v29
v_fma_f32 v97, v97, v26, v29
v_fma_f32 v98, v98, v26, v29
MA 16,60,196
R 56,3,28672
R 58,3,29184
v_fma_f32 v99, v99, v26, v29
v_fma_f32 v100, v100, v26, v29
v_fma_f32 v101, v101, v26, v29
MA 32,32,196
R 60,6,28672
R 62,6,29184
v_fma_f32 v102, v102, v26, v29
v_fma_f32 v103, v103, v26, v29
CV 200,96,97
CV 201,98,99
MA 48,36,196
R 32,3,40960
R 34,3,41472
buffer_load_dwordx4 v16, s[16:19], s75 offen offset:1024 lds
CV 202,100,101
CV 203,102,103
s_waitcnt lgkmcnt(6)
MA 64,40,196
R 36,6,40960
R 38,6,41472
v_lshlrev_b32 v104, 16, v204
v_and_b32 v105, 0xffff0000, v204
v_lshlrev_b32 v106, 16, v205
v_and_b32 v107, 0xffff0000, v205
MA 80,44,196
R 40,3,18432
R 42,3,18944
v_lshlrev_b32 v108, 16, v206
v_and_b32 v109, 0xffff0000, v206
v_lshlrev_b32 v110, 16, v207
v_and_b32 v111, 0xffff0000, v207
MA 0,48,200
R 44,6,18432
R 46,6,18944
buffer_load_dwordx4 v17, s[16:19], s75 offen offset:2048 lds
v_fma_f32 v104, v104, v26, v29
v_fma_f32 v105, v105, v26, v29
v_fma_f32 v106, v106, v26, v29
MA 16,52,200
R 48,3,30720
R 50,3,31232
v_fma_f32 v107, v107, v26, v29
v_fma_f32 v108, v108, v26, v29
v_fma_f32 v109, v109, v26, v29
v_fma_f32 v110, v110, v26, v29
s_waitcnt lgkmcnt(6)
MA 32,56,200
R 52,6,30720
R 54,6,31232
buffer_load_dwordx4 v18, s[16:19], s75 offen offset:3072 lds
v_fma_f32 v111, v111, v26, v29
CV 204,104,105
CV 205,106,107
MA 48,60,200
R 56,3,43008
R 58,3,43520
CV 206,108,109
CV 207,110,111
s_add_u32 m0, s67, 40960
s_add_u32 s75, s59, 262144
MA 64,32,200
R 60,6,43008
R 62,6,43520
buffer_load_dwordx4 v15, s[16:19], s75 offen offset:0 lds
v_lshlrev_b32 v96, 16, v208
v_and_b32 v97, 0xffff0000, v208
v_lshlrev_b32 v98, 16, v209
MA 80,36,200
R 32,3,45056
R 34,3,45568
v_and_b32 v99, 0xffff0000, v209
v_lshlrev_b32 v100, 16, v210
v_and_b32 v101, 0xffff0000, v210
s_waitcnt lgkmcnt(6)
MA 0,40,204
R 36,6,45056
R 38,6,45568
v_lshlrev_b32 v102, 16, v211
v_and_b32 v103, 0xffff0000, v211
v_fma_f32 v96, v96, v26, v29
v_fma_f32 v97, v97, v26, v29
MA 16,44,204
R 40,3,57344
R 42,3,57856
v_fma_f32 v98, v98, v26, v29
v_fma_f32 v99, v99, v26, v29
v_fma_f32 v100, v100, v26, v29
MA 32,48,204
R 44,6,57344
R 46,6,57856
v_fma_f32 v101, v101, v26, v29
v_fma_f32 v102, v102, v26, v29
v_fma_f32 v103, v103, v26, v29
CV 208,96,97
MA 48,52,204
R 48,4,4096
R 50,4,4608
CV 209,98,99
CV 210,100,101
CV 211,102,103
s_waitcnt lgkmcnt(6)
MA 64,56,204
R 52,7,4096
R 54,7,4608
v_lshlrev_b32 v104, 16, v212
v_and_b32 v105, 0xffff0000, v212
v_lshlrev_b32 v106, 16, v213
v_and_b32 v107, 0xffff0000, v213
MA 80,60,204
R 56,3,47104
R 58,3,47616
buffer_load_dwordx4 v16, s[16:19], s75 offen offset:1024 lds
v_lshlrev_b32 v108, 16, v214
v_and_b32 v109, 0xffff0000, v214
v_lshlrev_b32 v110, 16, v215
MA 0,32,208
R 60,6,47104
R 62,6,47616
v_and_b32 v111, 0xffff0000, v215
v_fma_f32 v104, v104, v26, v29
v_fma_f32 v105, v105, v26, v29
v_fma_f32 v106, v106, v26, v29
MA 16,36,208
R 32,3,59392
R 34,3,59904
buffer_load_dwordx4 v17, s[16:19], s75 offen offset:2048 lds
v_fma_f32 v107, v107, v26, v29
v_fma_f32 v108, v108, v26, v29
v_fma_f32 v109, v109, v26, v29
s_waitcnt lgkmcnt(6)
MA 32,40,208
R 36,6,59392
R 38,6,59904
v_fma_f32 v110, v110, v26, v29
v_fma_f32 v111, v111, v26, v29
CV 212,104,105
MA 48,44,208
R 40,4,6144
R 42,4,6656
buffer_load_dwordx4 v18, s[16:19], s75 offen offset:3072 lds
CV 213,106,107
CV 214,108,109
CV 215,110,111
MA 64,48,208
R 44,7,6144
R 46,7,6656
v_lshlrev_b32 v96, 16, v216
v_and_b32 v97, 0xffff0000, v216
v_lshlrev_b32 v98, 16, v217
v_and_b32 v99, 0xffff0000, v217
MA 80,52,208
R 48,3,49152
R 50,3,49664
v_lshlrev_b32 v100, 16, v218
v_and_b32 v101, 0xffff0000, v218
s_add_u32 m0, s67, 45056
s_add_u32 s75, s59, 524288
s_waitcnt lgkmcnt(6)
MA 0,56,212
R 52,6,49152
R 54,6,49664
buffer_load_dwordx4 v15, s[16:19], s75 offen offset:0 lds
v_lshlrev_b32 v102, 16, v219
v_and_b32 v103, 0xffff0000, v219
v_fma_f32 v96, v96, v26, v29
MA 16,60,212
R 56,3,61440
R 58,3,61952
v_fma_f32 v97, v97, v26, v29
v_fma_f32 v98, v98, v26, v29
v_fma_f32 v99, v99, v26, v29
v_fma_f32 v100, v100, v26, v29
MA 32,32,212
R 60,6,61440
R 62,6,61952
v_fma_f32 v101, v101, v26, v29
v_fma_f32 v102, v102, v26, v29
v_fma_f32 v103, v103, v26, v29
CV 216,96,97
MA 48,36,212
R 32,4,8192
R 34,4,8704
CV 217,98,99
CV 218,100,101
CV 219,102,103
s_waitcnt lgkmcnt(6)
MA 64,40,212
R 36,7,8192
R 38,7,8704
v_lshlrev_b32 v104, 16, v220
v_and_b32 v105, 0xffff0000, v220
v_lshlrev_b32 v106, 16, v221
v_and_b32 v107, 0xffff0000, v221
v_lshlrev_b32 v108, 16, v222
MA 80,44,212
R 40,3,51200
R 42,3,51712
v_and_b32 v109, 0xffff0000, v222
v_lshlrev_b32 v110, 16, v223
v_and_b32 v111, 0xffff0000, v223
v_fma_f32 v104, v104, v26, v29
MA 0,48,216
R 44,6,51200
R 46,6,51712
v_fma_f32 v105, v105, v26, v29
v_fma_f32 v106, v106, v26, v29
v_fma_f32 v107, v107, v26, v29
v_fma_f32 v108, v108, v26, v29
v_fma_f32 v109, v109, v26, v29
MA 16,52,216
s_waitcnt vmcnt(9)
s_barrier
R 48,3,63488
R 50,3,64000
s_waitcnt lgkmcnt(5)
MA 32,56,216
R 52,6,63488
R 54,6,64000
v_fma_f32 v110, v110, v26, v29
v_fma_f32 v111, v111, v26, v29
CV 220,104,105
s_add_u32 m0, s67, 73728
s_add_u32 s75, s59, 1179648
MA 48,60,216
R 56,4,10240
R 58,4,10752
buffer_load_dwordx4 v15, s[16:19], s75 offen offset:0 lds
CV 221,106,107
CV 222,108,109
CV 223,110,111
MA 64,32,216
R 60,7,10240
R 62,7,10752
v_lshlrev_b32 v96, 16, v224
v_and_b32 v97, 0xffff0000, v224
v_lshlrev_b32 v98, 16, v225
v_and_b32 v99, 0xffff0000, v225
MA 80,36,216
R 32,3,53248
R 34,3,53760
v_lshlrev_b32 v100, 16, v226
v_and_b32 v101, 0xffff0000, v226
v_lshlrev_b32 v102, 16, v227
s_waitcnt lgkmcnt(6)
MA 0,40,220
R 36,6,53248
R 38,6,53760
v_and_b32 v103, 0xffff0000, v227
v_fma_f32 v96, v96, v26, v29
v_fma_f32 v97, v97, v26, v29
v_fma_f32 v98, v98, v26, v29
MA 16,44,220
R 40,4,0
R 42,4,512
v_fma_f32 v99, v99, v26, v29
v_fma_f32 v100, v100, v26, v29
v_fma_f32 v101, v101, v26, v29
MA 32,48,220
R 44,7,0
R 46,7,512
v_fma_f32 v102, v102, v26, v29
v_fma_f32 v103, v103, v26, v29
CV 224,96,97
CV 225,98,99
MA 48,52,220
R 48,4,12288
R 50,4,12800
buffer_load_dwordx4 v16, s[16:19], s75 offen offset:1024 lds
CV 226,100,101
CV 227,102,103
s_waitcnt lgkmcnt(6)
MA 64,56,220
R 52,7,12288
R 54,7,12800
v_lshlrev_b32 v104, 16, v228
v_and_b32 v105, 0xffff0000, v228
v_lshlrev_b32 v106, 16, v229
v_and_b32 v107, 0xffff0000, v229
v_lshlrev_b32 v108, 16, v230
MA 80,60,220
R 56,3,55296
R 58,3,55808
v_and_b32 v109, 0xffff0000, v230
v_lshlrev_b32 v110, 16, v231
v_and_b32 v111, 0xffff0000, v231
v_fma_f32 v104, v104, v26, v29
v_fma_f32 v105, v105, v26, v29
MA 0,32,224
R 60,6,55296
R 62,6,55808
buffer_load_dwordx4 v17, s[16:19], s75 offen offset:2048 lds
v_fma_f32 v106, v106, v26, v29
v_fma_f32 v107, v107, v26, v29
v_fma_f32 v108, v108, v26, v29
MA 16,36,224
R 32,4,2048
R 34,4,2560
v_fma_f32 v109, v109, v26, v29
v_fma_f32 v110, v110, v26, v29
v_fma_f32 v111, v111, v26, v29
CV 228,104,105
CV 229,106,107
s_waitcnt lgkmcnt(4)
MA 32,40,224
R 36,7,2048
R 38,7,2560
buffer_load_dwordx4 v18, s[16:19], s75 offen offset:3072 lds
s_mul_i32 s0, s55, 1024
s_mul_i32 s74, s56, 1048576
s_add_u32 s0, s0, s74
CV 230,108,109
MA 48,44,224
R 40,4,14336
R 42,4,14848
v_and_b32 v31, -8, v1
CV 231,110,111
v_lshlrev_b32 v31, 4, v31
s_add_u32 m0, s67, 77824
s_add_u32 s75, s59, 1441792
MA 64,48,224
R 44,7,14336
R 46,7,14848
buffer_load_dwordx4 v15, s[16:19], s75 offen offset:0 lds
v_lshlrev_b32 v96, 16, v232
v_and_b32 v97, 0xffff0000, v232
s_add_u32 s0, s0, 393216
MA 80,52,224
R 48,2,0
R 50,2,512
buffer_load_dword v0, v31, s[8:11], s0 offen
v_lshlrev_b32 v98, 16, v233
v_and_b32 v99, 0xffff0000, v233
v_lshlrev_b32 v100, 16, v234
MA 0,56,228
R 52,5,0
R 54,5,512
v_and_b32 v101, 0xffff0000, v234
LA_pad3:
s_cbranch_execz LA_pad7
v_lshlrev_b32 v102, 16, v235
v_and_b32 v103, 0xffff0000, v235
v_fma_f32 v96, v96, v26, v29
s_waitcnt lgkmcnt(6)
MA 16,60,228
R 56,2,12288
R 58,2,12800
v_fma_f32 v97, v97, v26, v29
v_fma_f32 v98, v98, v26, v29
v_fma_f32 v99, v99, v26, v29
v_fma_f32 v100, v100, v26, v29
MA 32,32,228
R 60,5,12288
R 62,5,12800
v_fma_f32 v101, v101, v26, v29
v_fma_f32 v102, v102, v26, v29
v_fma_f32 v103, v103, v26, v29
MA 48,36,228
R 32,2,24576
R 34,2,25088
CV 232,96,97
CV 233,98,99
CV 234,100,101
CV 235,102,103
MA 64,40,228
R 36,5,24576
R 38,5,25088
v_lshlrev_b32 v104, 16, v236
v_and_b32 v105, 0xffff0000, v236
v_lshlrev_b32 v106, 16, v237
v_and_b32 v107, 0xffff0000, v237
s_waitcnt lgkmcnt(6)
MA 80,44,228
R 40,2,2048
R 42,2,2560
buffer_load_dwordx4 v16, s[16:19], s75 offen offset:1024 lds
v_lshlrev_b32 v108, 16, v238
v_and_b32 v109, 0xffff0000, v238
v_lshlrev_b32 v110, 16, v239
s_add_u32 s100, s100, 4096
s_addc_u32 s101, s101, 0
MA 0,48,232
R 44,5,2048
R 46,5,2560
global_load_dword v0, v23, s[100:101]
v_and_b32 v111, 0xffff0000, v239
v_fma_f32 v104, v104, v26, v29
v_fma_f32 v105, v105, v26, v29
v_fma_f32 v106, v106, v26, v29
MA 16,52,232
R 48,2,14336
R 50,2,14848
buffer_load_dwordx4 v17, s[16:19], s75 offen offset:2048 lds
v_fma_f32 v107, v107, v26, v29
v_fma_f32 v108, v108, v26, v29
v_fma_f32 v109, v109, v26, v29
MA 32,56,232
R 52,5,14336
R 54,5,14848
v_fma_f32 v110, v110, v26, v29
v_fma_f32 v111, v111, v26, v29
CV 236,104,105
s_waitcnt lgkmcnt(6)
MA 48,60,232
R 56,2,26624
R 58,2,27136
buffer_load_dwordx4 v18, s[16:19], s75 offen offset:3072 lds
CV 237,106,107
CV 238,108,109
CV 239,110,111
MA 64,32,232
R 60,5,26624
R 62,5,27136
v_lshlrev_b32 v96, 16, v240
v_and_b32 v97, 0xffff0000, v240
v_lshlrev_b32 v98, 16, v241
v_and_b32 v99, 0xffff0000, v241
MA 80,36,232
R 32,2,4096
R 34,2,4608
v_lshlrev_b32 v100, 16, v242
v_and_b32 v101, 0xffff0000, v242
s_add_u32 m0, s67, 81920
s_add_u32 s75, s59, 1703936
MA 0,40,236
R 36,5,4096
R 38,5,4608
buffer_load_dwordx4 v15, s[16:19], s75 offen offset:0 lds
v_lshlrev_b32 v102, 16, v243
v_and_b32 v103, 0xffff0000, v243
v_fma_f32 v96, v96, v26, v29
s_waitcnt lgkmcnt(6)
MA 16,44,236
R 40,2,16384
R 42,2,16896
v_fma_f32 v97, v97, v26, v29
v_fma_f32 v98, v98, v26, v29
v_fma_f32 v99, v99, v26, v29
v_fma_f32 v100, v100, v26, v29
MA 32,48,236
R 44,5,16384
R 46,5,16896
v_fma_f32 v101, v101, v26, v29
v_fma_f32 v102, v102, v26, v29
v_fma_f32 v103, v103, v26, v29
CV 240,96,97
MA 48,52,236
R 48,2,28672
R 50,2,29184
CV 241,98,99
CV 242,100,101
CV 243,102,103
MA 64,56,236
R 52,5,28672
R 54,5,29184
v_lshlrev_b32 v104, 16, v244
v_and_b32 v105, 0xffff0000, v244
v_lshlrev_b32 v106, 16, v245
v_and_b32 v107, 0xffff0000, v245
v_lshlrev_b32 v108, 16, v246
s_waitcnt lgkmcnt(6)
MA 80,60,236
R 56,2,6144
R 58,2,6656
v_and_b32 v109, 0xffff0000, v246
v_lshlrev_b32 v110, 16, v247
v_and_b32 v111, 0xffff0000, v247
v_fma_f32 v104, v104, v26, v29
MA 0,32,240
R 60,5,6144
R 62,5,6656
v_fma_f32 v105, v105, v26, v29
v_fma_f32 v106, v106, v26, v29
v_fma_f32 v107, v107, v26, v29
v_fma_f32 v108, v108, v26, v29
v_fma_f32 v109, v109, v26, v29
MA 16,36,240
s_waitcnt vmcnt(11)
s_barrier
R 32,2,18432
R 34,2,18944
MA 32,40,240
R 36,5,18432
R 38,5,18944
v_fma_f32 v110, v110, v26, v29
v_fma_f32 v111, v111, v26, v29
CV 244,104,105
s_add_u32 m0, s67, 110592
s_add_u32 s75, s59, 2359296
s_waitcnt lgkmcnt(4)
MA 48,44,240
R 40,2,30720
R 42,2,31232
buffer_load_dwordx4 v15, s[16:19], s75 offen offset:0 lds
CV 245,106,107
CV 246,108,109
CV 247,110,111
MA 64,48,240
R 44,5,30720
R 46,5,31232
v_lshlrev_b32 v96, 16, v248
v_and_b32 v97, 0xffff0000, v248
v_lshlrev_b32 v98, 16, v249
v_and_b32 v99, 0xffff0000, v249
MA 80,52,240
R 48,2,8192
R 50,2,8704
v_lshlrev_b32 v100, 16, v250
v_and_b32 v101, 0xffff0000, v250
v_lshlrev_b32 v102, 16, v251
MA 0,56,244
R 52,5,8192
R 54,5,8704
v_and_b32 v103, 0xffff0000, v251
v_fma_f32 v96, v96, v26, v29
v_fma_f32 v97, v97, v26, v29
v_fma_f32 v98, v98, v26, v29
MA 16,60,244
R 56,2,20480
R 58,2,20992
v_fma_f32 v99, v99, v26, v29
v_fma_f32 v100, v100, v26, v29
v_fma_f32 v101, v101, v26, v29
s_waitcnt lgkmcnt(6)
MA 32,32,244
R 60,5,20480
R 62,5,20992
v_fma_f32 v102, v102, v26, v29
v_fma_f32 v103, v103, v26, v29
CV 248,96,97
CV 249,98,99
MA 48,36,244
R 32,2,32768
R 34,2,33280
buffer_load_dwordx4 v16, s[16:19], s75 offen offset:1024 lds
CV 250,100,101
CV 251,102,103
MA 64,40,244
R 36,5,32768
R 38,5,33280
v_lshlrev_b32 v104, 16, v252
v_and_b32 v105, 0xffff0000, v252
v_lshlrev_b32 v106, 16, v253
v_and_b32 v107, 0xffff0000, v253
MA 80,44,244
R 40,2,10240
R 42,2,10752
v_lshlrev_b32 v108, 16, v254
v_and_b32 v109, 0xffff0000, v254
v_lshlrev_b32 v110, 16, v255
v_and_b32 v111, 0xffff0000, v255
s_waitcnt lgkmcnt(6)
MA 0,48,248
R 44,5,10240
R 46,5,10752
buffer_load_dwordx4 v17, s[16:19], s75 offen offset:2048 lds
v_fma_f32 v104, v104, v26, v29
v_fma_f32 v105, v105, v26, v29
v_fma_f32 v106, v106, v26, v29
MA 16,52,248
R 48,2,22528
R 50,2,23040
v_fma_f32 v107, v107, v26, v29
v_fma_f32 v108, v108, v26, v29
v_fma_f32 v109, v109, v26, v29
v_fma_f32 v110, v110, v26, v29
MA 32,56,248
R 52,5,22528
R 54,5,23040
buffer_load_dwordx4 v18, s[16:19], s75 offen offset:3072 lds
v_fma_f32 v111, v111, v26, v29
CV 252,104,105
CV 253,106,107
MA 48,60,248
R 56,2,34816
R 58,2,35328
CV 254,108,109
CV 255,110,111
s_add_u32 m0, s67, 114688
s_add_u32 s75, s59, 2621440
s_waitcnt lgkmcnt(6)
MA 64,32,248
R 60,5,34816
R 62,5,35328
buffer_load_dwordx4 v15, s[16:19], s75 offen offset:0 lds
MA 80,36,248
R 32,2,36864
R 34,2,37376
buffer_load_dword v0, v31, s[12:15], s0 offen
MA 0,40,252
R 36,5,36864
R 38,5,37376
MA 16,44,252
R 40,2,55296
R 42,2,55808
s_waitcnt lgkmcnt(6)
MA 32,48,252
R 44,5,55296
R 46,5,55808
MA 48,52,252
R 48,2,38912
R 50,2,39424
MA 64,56,252
R 52,5,38912
R 54,5,39424
MA 80,60,252
R 56,2,57344
R 58,2,57856
buffer_load_dwordx4 v16, s[16:19], s75 offen offset:1024 lds
s_waitcnt lgkmcnt(7)
v_mfma_f32_32x32x16_bf16 v[80:95], v[32:35], v[112:115], 0
R 60,5,57344
R 62,5,57856
v_mfma_f32_32x32x16_bf16 v[96:111], v[36:39], v[112:115], 0
R 32,2,40960
R 34,2,41472
buffer_load_dwordx4 v17, s[16:19], s75 offen offset:2048 lds
v_mfma_f32_32x32x16_bf16 a[192:207], v[40:43], v[112:115], 0
R 36,5,40960
R 38,5,41472
v_accvgpr_read_b32 v64, a0
v_accvgpr_read_b32 v65, a1
v_accvgpr_read_b32 v66, a2
s_waitcnt lgkmcnt(6)
v_mfma_f32_32x32x16_bf16 a[208:223], v[44:47], v[112:115], 0
R 40,2,59392
R 42,2,59904
buffer_load_dwordx4 v18, s[16:19], s75 offen offset:3072 lds
v_accvgpr_read_b32 v67, a3
MV 80,48,116
R 44,5,59392
R 46,5,59904
v_accvgpr_read_b32 v68, a4
v_accvgpr_read_b32 v69, a5
MV 96,52,116
R 48,2,43008
R 50,2,43520
v_accvgpr_read_b32 v70, a6
s_add_u32 m0, s67, 118784
s_add_u32 s75, s59, 2883584
MA 192,56,116
R 52,5,43008
R 54,5,43520
buffer_load_dwordx4 v15, s[16:19], s75 offen offset:0 lds
v_accvgpr_read_b32 v71, a7
s_waitcnt lgkmcnt(6)
MA 208,60,116
R 56,2,61440
R 58,2,61952
v_accvgpr_read_b32 v72, a8
v_accvgpr_read_b32 v73, a9
v_accvgpr_read_b32 v74, a10
MV 80,32,120
R 60,5,61440
R 62,5,61952
v_accvgpr_read_b32 v75, a11
v_accvgpr_read_b32 v76, a12
MV 96,36,120
R 32,2,45056
R 34,2,45568
v_accvgpr_read_b32 v77, a13
v_accvgpr_read_b32 v78, a14
MA 192,40,120
R 36,5,45056
R 38,5,45568
v_accvgpr_read_b32 v79, a15
CV 64,64,65
CV 65,66,67
s_waitcnt lgkmcnt(6)
MA 208,44,120
R 40,2,63488
R 42,2,64000
CV 66,68,69
CV 67,70,71
MV 80,48,124
R 44,5,63488
R 46,5,64000
CV 68,72,73
CV 69,74,75
MV 96,52,124
s_waitcnt vmcnt(10)
s_barrier
R 48,2,47104
R 50,2,47616
MA 192,56,124
R 52,5,47104
R 54,5,47616
CV 70,76,77
s_add_u32 m0, s67, 0
s_add_u32 s75, s59, 3538944
s_waitcnt lgkmcnt(6)
MA 208,60,124
R 56,3,0
R 58,3,512
buffer_load_dwordx4 v15, s[16:19], s75 offen offset:0 lds
CV 71,78,79
MV 80,32,128
R 60,6,0
R 62,6,512
v_permlane16_swap_b32 v64, v68
v_min_u32 v115, 2, v1
v_permlane16_swap_b32 v65, v69
MV 96,36,128
R 32,2,49152
R 34,2,49664
v_add_u32 v115, s54, v115
v_subrev_u32 v115, 1, v115
MA 192,40,128
R 36,5,49152
R 38,5,49664
v_permlane16_swap_b32 v66, v70
v_max_i32 v115, 0, v115
s_waitcnt lgkmcnt(6)
MA 208,44,128
R 40,3,2048
R 42,3,2560
v_permlane16_swap_b32 v67, v71
v_min_i32 v115, 15, v115
MV 80,48,132
R 44,6,2048
R 46,6,2560
v_accvgpr_write_b32 a128, v64
v_lshlrev_b32 v115, 2, v115
v_accvgpr_write_b32 a129, v65
MV 96,52,132
R 48,2,51200
R 50,2,51712
buffer_load_dwordx4 v16, s[16:19], s75 offen offset:1024 lds
v_accvgpr_write_b32 a130, v66
MA 192,56,132
R 52,5,51200
R 54,5,51712
v_accvgpr_write_b32 a131, v67
v_accvgpr_write_b32 a132, v68
s_waitcnt lgkmcnt(6)
MA 208,60,132
R 56,3,4096
R 58,3,4608
v_accvgpr_write_b32 a133, v69
v_accvgpr_write_b32 a134, v70
v_accvgpr_write_b32 a135, v71
MV 80,32,136
R 60,6,4096
R 62,6,4608
buffer_load_dword v31, v115, s[44:47], 0 offen sc1
buffer_load_dwordx4 v17, s[16:19], s75 offen offset:2048 lds
MV 96,36,136
R 32,2,53248
R 34,2,53760
v_accvgpr_read_b32 v64, a16
v_accvgpr_read_b32 v65, a17
MA 192,40,136
R 36,5,53248
R 38,5,53760
buffer_load_dwordx4 v18, s[16:19], s75 offen offset:3072 lds
v_accvgpr_read_b32 v66, a18
v_accvgpr_read_b32 v67, a19
s_waitcnt lgkmcnt(6)
MA 208,44,136
R 40,3,6144
R 42,3,6656
s_add_u32 m0, s67, 4096
s_add_u32 s75, s59, 3801088
MV 80,48,140
R 44,6,6144
R 46,6,6656
buffer_load_dwordx4 v15, s[16:19], s75 offen offset:0 lds
v_accvgpr_read_b32 v68, a20
v_accvgpr_read_b32 v69, a21
MV 96,52,140
R 48,3,8192
R 50,3,8704
v_accvgpr_read_b32 v70, a22
v_accvgpr_read_b32 v71, a23
MA 192,56,140
R 52,6,8192
R 54,6,8704
v_accvgpr_read_b32 v72, a24
v_lshrrev_b32 v120, 3, v1
s_waitcnt lgkmcnt(6)
MA 208,60,140
R 56,3,26624
R 58,3,27136
v_accvgpr_read_b32 v73, a25
v_accvgpr_read_b32 v74, a26
v_accvgpr_read_b32 v75, a27
MV 80,32,144
R 60,6,26624
R 62,6,27136
v_accvgpr_read_b32 v76, a28
v_accvgpr_read_b32 v77, a29
MV 96,36,144
R 32,3,10240
R 34,3,10752
v_xor_b32 v120, v120, v1
v_accvgpr_read_b32 v78, a30
MA 192,40,144
R 36,6,10240
R 38,6,10752
v_accvgpr_read_b32 v79, a31
CV 64,64,65
CV 65,66,67
s_waitcnt lgkmcnt(6)
MA 208,44,144
R 40,3,28672
R 42,3,29184
buffer_load_dwordx4 v16, s[16:19], s75 offen offset:1024 lds
CV 66,68,69
MV 80,48,148
R 44,6,28672
R 46,6,29184
CV 67,70,71
v_and_b32 v121, 2, v120
MV 96,52,148
R 48,3,12288
R 50,3,12800
buffer_load_dwordx4 v17, s[16:19], s75 offen offset:2048 lds
CV 68,72,73
MA 192,56,148
R 52,6,12288
R 54,6,12800
CV 69,74,75
CV 70,76,77
CV 71,78,79
s_waitcnt lgkmcnt(6)
MA 208,60,148
R 56,3,30720
R 58,3,31232
buffer_load_dwordx4 v18, s[16:19], s75 offen offset:3072 lds
v_permlane16_swap_b32 v64, v68
MV 80,32,152
R 60,6,30720
R 62,6,31232
v_permlane16_swap_b32 v65, v69
v_permlane16_swap_b32 v66, v70
MV 96,36,152
R 32,3,14336
R 34,3,14848
v_permlane16_swap_b32 v67, v71
s_add_u32 m0, s67, 8192
s_add_u32 s75, s59, 4063232
MA 192,40,152
R 36,6,14336
R 38,6,14848
buffer_load_dwordx4 v15, s[16:19], s75 offen offset:0 lds
v_accvgpr_write_b32 a136, v64
v_accvgpr_write_b32 a137, v65
s_waitcnt lgkmcnt(6)
MA 208,44,152
R 40,3,32768
R 42,3,33280
v_lshlrev_b32 v121, 4, v121
v_accvgpr_write_b32 a138, v66
MV 80,48,156
R 44,6,32768
R 46,6,33280
v_accvgpr_write_b32 a139, v67
v_accvgpr_write_b32 a140, v68
MV 96,52,156
R 48,3,16384
R 50,3,16896
v_accvgpr_write_b32 a141, v69
v_accvgpr_write_b32 a142, v70
MA 192,56,156
R 52,6,16384
R 54,6,16896
s_waitcnt vmcnt(7)
v_cmp_ne_u32 vcc, 0x10000, v31
s_nop 1
s_cbranch_vccnz LA_poll0
LA_ok0:
s_waitcnt lgkmcnt(6)
MA 208,60,156
R 56,3,34816
R 58,3,35328
v_and_b32 v120, 4, v120
v_accvgpr_write_b32 a143, v71
v_accvgpr_read_b32 v64, a32
MV 80,32,160
R 60,6,34816
R 62,6,35328
v_accvgpr_read_b32 v65, a33
v_accvgpr_read_b32 v66, a34
MV 96,36,160
s_barrier
R 32,3,18432
R 34,3,18944
MA 192,40,160
R 36,6,18432
LA_pad4:
s_cbranch_execz LA_pad8
R 38,6,18944
s_mul_i32 s0, s55, 9216
s_mul_i32 s74, s56, 1152
s_add_u32 s0, s0, s74
v_lshrrev_b32 v31, 2, v1
s_waitcnt lgkmcnt(6)
MA 208,44,160
R 40,3,36864
R 42,3,37376
v_lshrrev_b32 v17, 3, v1
v_min_u32 v31, 8, v31
v_lshlrev_b32 v31, 7, v31
MV 80,48,164
R 44,6,36864
R 46,6,37376
v_mul_u32_u24 v15, 256, v17
v_and_b32 v17, 2, v17
s_add_u32 s0, s0, 0
MV 96,52,164
R 48,3,20480
R 50,3,20992
buffer_load_dword v0, v31, s[32:35], s0 offen
v_lshrrev_b32 v18, 5, v1
v_or_b32 v17, v17, v18
MA 192,56,164
R 52,6,20480
R 54,6,20992
v_and_b32 v18, 7, v1
v_lshl_add_u32 v121, v120, 2, v121
v_xor_b32 v18, v17, v18
s_waitcnt lgkmcnt(6)
MA 208,60,164
R 56,3,38912
R 58,3,39424
v_lshlrev_b32 v18, 4, v18
v_xor_b32 v17, 64, v18
v_add_u32 v16, v15, v17
s_add_u32 s100, s100, 4096
s_addc_u32 s101, s101, 0
MV 80,32,168
R 60,6,38912
R 62,6,39424
global_load_dword v0, v23, s[100:101]
v_add_u32 v15, v15, v18
v_add_u32 v16, 1024, v16
MV 96,36,168
R 32,3,22528
R 34,3,23040
v_add_u32 v17, 2048, v15
v_and_b32 v120, 8, v1
v_add_u32 v18, 2048, v16
MA 192,40,168
R 36,6,22528
R 38,6,23040
v_accvgpr_read_b32 v67, a35
s_add_u32 m0, s68, 36864
s_add_u32 s75, s60, 4294959104
s_waitcnt lgkmcnt(6)
MA 208,44,168
R 40,3,40960
R 42,3,41472
buffer_load_dwordx4 v15, s[8:11], s75 offen offset:0 lds
v_accvgpr_read_b32 v68, a36
MV 80,48,172
R 44,6,40960
R 46,6,41472
v_accvgpr_read_b32 v69, a37
v_accvgpr_read_b32 v70, a38
v_accvgpr_read_b32 v71, a39
MV 96,52,172
R 48,3,24576
R 50,3,25088
v_accvgpr_read_b32 v72, a40
v_lshl_add_u32 v121, v120, 3, v121
MA 192,56,172
R 52,6,24576
R 54,6,25088
v_accvgpr_read_b32 v73, a41
v_accvgpr_read_b32 v74, a42
s_waitcnt lgkmcnt(6)
MA 208,60,172
R 56,3,43008
R 58,3,43520
v_accvgpr_read_b32 v75, a43
v_accvgpr_read_b32 v76, a44
v_accvgpr_read_b32 v77, a45
MV 80,32,176
R 60,6,43008
R 62,6,43520
v_and_b32 v120, 15, v1
v_accvgpr_read_b32 v78, a46
MV 96,36,176
R 32,3,45056
R 34,3,45568
v_accvgpr_read_b32 v79, a47
CV 64,64,65
MA 192,40,176
R 36,6,45056
R 38,6,45568
CV 65,66,67
CV 66,68,69
v_lshl_add_u32 v112, v120, 7, v121
s_waitcnt lgkmcnt(6)
MA 208,44,176
R 40,3,63488
R 42,3,64000
CV 67,70,71
s_add_u32 s0, s0, 589824
MV 80,48,180
R 44,6,63488
R 46,6,64000
buffer_load_dword v0, v31, s[32:35], s0 offen
CV 68,72,73
MV 96,52,180
R 48,3,47104
R 50,3,47616
CV 69,74,75
CV 70,76,77
CV 71,78,79
MA 192,56,180
R 52,6,47104
R 54,6,47616
v_permlane16_swap_b32 v64, v68
v_permlane16_swap_b32 v65, v69
s_waitcnt lgkmcnt(6)
MA 208,60,180
R 56,4,0
R 58,4,512
v_permlane16_swap_b32 v66, v70
v_xor_b32 v113, 64, v112
MV 80,32,184
R 60,7,0
R 62,7,512
buffer_load_dwordx4 v16, s[8:11], s75 offen offset:1024 lds
v_permlane16_swap_b32 v67, v71
v_accvgpr_write_b32 a144, v64
MV 96,36,184
R 32,3,49152
R 34,3,49664
v_accvgpr_write_b32 a145, v65
v_accvgpr_write_b32 a146, v66
MA 192,40,184
R 36,6,49152
R 38,6,49664
v_accvgpr_write_b32 a147, v67
v_accvgpr_write_b32 a148, v68
s_waitcnt lgkmcnt(6)
MA 208,44,184
R 40,4,2048
R 42,4,2560
v_accvgpr_write_b32 a149, v69
v_add_u32 v116, 0x10000, v112
v_accvgpr_write_b32 a150, v70
MV 80,48,188
R 44,7,2048
R 46,7,2560
buffer_load_dwordx4 v17, s[8:11], s75 offen offset:2048 lds
v_accvgpr_write_b32 a151, v71
MV 96,52,188
R 48,3,51200
R 50,3,51712
v_accvgpr_read_b32 v64, a48
v_accvgpr_read_b32 v65, a49
MA 192,56,188
R 52,6,51200
R 54,6,51712
v_accvgpr_read_b32 v66, a50
v_add_u32 v117, 0x10000, v113
v_accvgpr_read_b32 v67, a51
s_waitcnt lgkmcnt(6)
MA 208,60,188
R 56,4,4096
R 58,4,4608
v_accvgpr_read_b32 v68, a52
v_accvgpr_read_b32 v69, a53
MV 80,32,192
R 60,7,4096
R 62,7,4608
buffer_load_dwordx4 v18, s[8:11], s75 offen offset:3072 lds
v_accvgpr_read_b32 v70, a54
MV 96,36,192
R 32,3,53248
R 34,3,53760
v_accvgpr_read_b32 v71, a55
v_accvgpr_read_b32 v72, a56
MA 192,40,192
R 36,6,53248
R 38,6,53760
v_accvgpr_read_b32 v73, a57
v_and_b32 v19, 3, v1
v_accvgpr_read_b32 v74, a58
s_waitcnt lgkmcnt(6)
MA 208,44,192
R 40,4,6144
R 42,4,6656
v_accvgpr_read_b32 v75, a59
s_add_u32 s0, s0, 589824
MV 80,48,196
R 44,7,6144
R 46,7,6656
buffer_load_dword v0, v31, s[32:35], s0 offen
v_accvgpr_read_b32 v76, a60
v_accvgpr_read_b32 v77, a61
MV 96,52,196
s_waitcnt vmcnt(8)
s_barrier
R 48,3,55296
R 50,3,55808
MA 192,56,196
R 52,6,55296
R 54,6,55808
s_add_u32 m0, s68, 73728
s_add_u32 s75, s60, 8192
s_waitcnt lgkmcnt(6)
MA 208,60,196
R 56,4,8192
R 58,4,8704
buffer_load_dwordx4 v15, s[8:11], s75 offen offset:0 lds
v_accvgpr_read_b32 v78, a62
v_accvgpr_read_b32 v79, a63
MV 80,32,200
R 60,7,8192
R 62,7,8704
CV 64,64,65
CV 65,66,67
MV 96,36,200
R 32,3,57344
R 34,3,57856
CV 66,68,69
v_lshlrev_b32 v19, 3, v19
MA 192,40,200
R 36,6,57344
R 38,6,57856
CV 67,70,71
CV 68,72,73
CV 69,74,75
s_waitcnt lgkmcnt(6)
MA 208,44,200
R 40,4,10240
R 42,4,10752
CV 70,76,77
CV 71,78,79
MV 80,48,204
R 44,7,10240
R 46,7,10752
v_permlane16_swap_b32 v64, v68
v_and_b32 v20, 60, v1
MV 96,52,204
R 48,3,59392
R 50,3,59904
v_permlane16_swap_b32 v65, v69
v_permlane16_swap_b32 v66, v70
v_permlane16_swap_b32 v67, v71
MA 192,56,204
R 52,6,59392
R 54,6,59904
v_accvgpr_write_b32 a152, v64
v_accvgpr_write_b32 a153, v65
s_waitcnt lgkmcnt(6)
MA 208,60,204
R 56,4,12288
R 58,4,12800
buffer_load_dwordx4 v16, s[8:11], s75 offen offset:1024 lds
v_accvgpr_write_b32 a154, v66
MV 80,32,208
R 60,7,12288
R 62,7,12800
v_lshl_add_u32 v19, v20, 5, v19
v_accvgpr_write_b32 a155, v67
v_accvgpr_write_b32 a156, v68
MV 96,36,208
R 32,3,61440
R 34,3,61952
v_accvgpr_write_b32 a157, v69
v_accvgpr_write_b32 a158, v70
MA 192,40,208
R 36,6,61440
R 38,6,61952
buffer_load_dwordx4 v17, s[8:11], s75 offen offset:2048 lds
v_accvgpr_write_b32 a159, v71
s_waitcnt lgkmcnt(6)
MA 208,44,208
R 40,4,14336
R 42,4,14848
v_accvgpr_read_b32 v64, a64
v_accvgpr_read_b32 v65, a65
s_add_u32 s0, s0, 589824
MV 80,48,212
R 44,7,14336
R 46,7,14848
buffer_load_dword v0, v31, s[32:35], s0 offen
v_accvgpr_read_b32 v66, a66
MV 96,52,212
R 48,2,0
R 50,2,512
buffer_load_dwordx4 v18, s[8:11], s75 offen offset:3072 lds
v_accvgpr_read_b32 v67, a67
MA 192,56,212
R 52,5,0
R 54,5,512
v_accvgpr_read_b32 v68, a68
v_and_b32 v20, 24, v1
v_accvgpr_read_b32 v69, a69
s_waitcnt lgkmcnt(6)
MA 208,60,212
R 56,2,18432
R 58,2,18944
s_add_u32 m0, s68, 90112
s_add_u32 s75, s61, 0
MV 80,32,216
R 60,5,18432
R 62,5,18944
buffer_load_dwordx4 v11, s[12:15], s75 offen offset:0 lds
v_accvgpr_read_b32 v70, a70
v_accvgpr_read_b32 v71, a71
MV 96,36,216
R 32,2,2048
R 34,2,2560
v_accvgpr_read_b32 v72, a72
v_accvgpr_read_b32 v73, a73
MA 192,40,216
R 36,5,2048
R 38,5,2560
v_accvgpr_read_b32 v74, a74
v_accvgpr_read_b32 v75, a75
s_waitcnt lgkmcnt(6)
MA 208,44,216
R 40,2,20480
R 42,2,20992
v_accvgpr_read_b32 v76, a76
v_lshl_add_u32 v19, v20, 2, v19
v_accvgpr_read_b32 v77, a77
MV 80,48,220
R 44,5,20480
R 46,5,20992
v_accvgpr_read_b32 v78, a78
v_accvgpr_read_b32 v79, a79
MV 96,52,220
R 48,2,4096
R 50,2,4608
CV 64,64,65
v_xor_b32 v20, 32, v19
MA 192,56,220
R 52,5,4096
R 54,5,4608
CV 65,66,67
CV 66,68,69
CV 67,70,71
s_waitcnt lgkmcnt(6)
MA 208,60,220
R 56,2,22528
R 58,2,23040
CV 68,72,73
CV 69,74,75
MV 80,32,224
R 60,5,22528
R 62,5,23040
buffer_load_dwordx4 v12, s[12:15], s75 offen offset:1024 lds
CV 70,76,77
MV 96,36,224
R 32,2,6144
R 34,2,6656
CV 71,78,79
v_xor_b32 v21, 64, v19
MA 192,40,224
R 36,5,6144
R 38,5,6656
v_permlane16_swap_b32 v64, v68
v_permlane16_swap_b32 v65, v69
v_permlane16_swap_b32 v66, v70
s_waitcnt lgkmcnt(6)
MA 208,44,224
R 40,2,24576
R 42,2,25088
buffer_load_dwordx4 v13, s[12:15], s75 offen offset:2048 lds
s_add_u32 s0, s0, 589824
MV 80,48,228
R 44,5,24576
R 46,5,25088
buffer_load_dword v0, v31, s[32:35], s0 offen
v_permlane16_swap_b32 v67, v71
v_accvgpr_write_b32 a160, v64
MV 96,52,228
R 48,2,8192
R 50,2,8704
v_accvgpr_write_b32 a161, v65
v_accvgpr_write_b32 a162, v66
MA 192,56,228
R 52,5,8192
R 54,5,8704
buffer_load_dwordx4 v14, s[12:15], s75 offen offset:3072 lds
v_accvgpr_write_b32 a163, v67
s_waitcnt lgkmcnt(6)
MA 208,60,228
R 56,2,26624
R 58,2,27136
v_xor_b32 v22, 96, v19
v_accvgpr_write_b32 a164, v68
v_accvgpr_write_b32 a165, v69
MV 80,32,232
R 60,5,26624
R 62,5,27136
v_accvgpr_write_b32 a166, v70
v_accvgpr_write_b32 a167, v71
MV 96,36,232
s_waitcnt vmcnt(11)
s_barrier
R 32,2,10240
R 34,2,10752
MA 192,40,232
R 36,5,10240
R 38,5,10752
v_accvgpr_read_b32 v64, a80
s_add_u32 m0, s68, 110592
s_add_u32 s75, s60, 24576
s_waitcnt lgkmcnt(6)
MA 208,44,232
R 40,2,28672
R 42,2,29184
buffer_load_dwordx4 v15, s[8:11], s75 offen offset:0 lds
v_accvgpr_read_b32 v65, a81
MV 80,48,236
R 44,5,28672
R 46,5,29184
v_mov_b32 v124, 0x3f803f80
v_accvgpr_read_b32 v66, a82
MV 96,52,236
R 48,2,12288
R 50,2,12800
v_accvgpr_read_b32 v67, a83
v_mov_b32 v125, 0x3f803f80
v_accvgpr_read_b32 v68, a84
MA 192,56,236
R 52,5,12288
R 54,5,12800
v_accvgpr_read_b32 v69, a85
v_accvgpr_read_b32 v70, a86
s_waitcnt lgkmcnt(6)
MA 208,60,236
R 56,2,30720
R 58,2,31232
v_mov_b32 v126, 0x3f803f80
v_accvgpr_read_b32 v71, a87
MV 80,32,240
R 60,5,30720
R 62,5,31232
v_accvgpr_read_b32 v72, a88
v_mov_b32 v127, 0x3f803f80
v_accvgpr_read_b32 v73, a89
MV 96,36,240
R 32,2,14336
R 34,2,14848
buffer_load_dwordx4 v16, s[8:11], s75 offen offset:1024 lds
v_accvgpr_read_b32 v74, a90
MA 192,40,240
R 36,5,14336
R 38,5,14848
v_accvgpr_read_b32 v75, a91
s_add_u32 s0, s0, 589824
s_waitcnt lgkmcnt(6)
MA 208,44,240
R 40,2,32768
R 42,2,33280
buffer_load_dword v0, v31, s[32:35], s0 offen
buffer_load_dwordx4 v17, s[8:11], s75 offen offset:2048 lds
v_accvgpr_read_b32 v76, a92
MV 80,48,244
R 44,5,32768
R 46,5,33280
v_accvgpr_read_b32 v77, a93
v_accvgpr_read_b32 v78, a94
MV 96,52,244
R 48,2,16384
R 50,2,16896
buffer_load_dwordx4 v18, s[8:11], s75 offen offset:3072 lds
v_accvgpr_read_b32 v79, a95
MA 192,56,244
R 52,5,16384
R 54,5,16896
CV 64,64,65
s_add_u32 m0, s68, 126976
s_add_u32 s75, s61, 16384
s_waitcnt lgkmcnt(6)
MA 208,60,244
R 56,2,34816
R 58,2,35328
buffer_load_dwordx4 v11, s[12:15], s75 offen offset:0 lds
CV 65,66,67
MV 80,32,248
R 60,5,34816
R 62,5,35328
CV 66,68,69
CV 67,70,71
CV 68,72,73
MV 96,36,248
ds_read_b128 v[32:35], v112 offset:45056
CV 69,74,75
CV 70,76,77
CV 71,78,79
MA 192,40,248
ds_read_b128 v[36:39], v112 offset:47104
v_permlane16_swap_b32 v64, v68
v_permlane16_swap_b32 v65, v69
v_permlane16_swap_b32 v66, v70
s_waitcnt lgkmcnt(4)
MA 208,44,248
ds_read_b128 v[40:43], v113 offset:45056
v_permlane16_swap_b32 v67, v71
v_accvgpr_write_b32 a168, v64
v_accvgpr_write_b32 a169, v65
v_accvgpr_write_b32 a170, v66
MV 80,48,252
ds_read_b128 v[44:47], v113 offset:47104
v_accvgpr_write_b32 a171, v67
v_accvgpr_write_b32 a172, v68
v_accvgpr_write_b32 a173, v69
MV 96,52,252
ds_read_b128 v[48:51], v112 offset:49152
buffer_load_dwordx4 v12, s[12:15], s75 offen offset:1024 lds
v_accvgpr_write_b32 a174, v70
v_accvgpr_write_b32 a175, v71
MA 192,56,252
ds_read_b128 v[52:55], v112 offset:51200
s_waitcnt lgkmcnt(3)
MA 208,60,252
ds_read_b128 v[56:59], v113 offset:49152
buffer_load_dwordx4 v13, s[12:15], s75 offen offset:2048 lds
v_mfma_f32_16x16x32_bf16 v[128:131], v[32:35], a[128:131], 0
CV 80,80,81
v_add_u32 v3, 0x10000, v19
CV 81,82,83
v_add_u32 v2, 0x10000, v20
v_mfma_f32_16x16x32_bf16 v[136:139], v[32:35], a[132:135], 0
CV 82,84,85
v_add_u32 v4, 0x10000, v21
CV 83,86,87
v_mfma_f32_16x16x32_bf16 v[144:147], v[32:35], a[160:163], 0
ds_read_b128 v[60:63], v113 offset:51200
buffer_load_dwordx4 v14, s[12:15], s75 offen offset:3072 lds
CV 84,88,89
CV 85,90,91
v_mfma_f32_16x16x32_bf16 v[152:155], v[32:35], a[164:167], 0
v_add_u32 v5, 0x10000, v22
CV 86,92,93
CV 87,94,95
v_mfma_f32_16x16x32_bf16 v[132:135], v[36:39], a[128:131], 0
LA_pad5:
s_cbranch_execz LA_pad9
v_permlane16_swap_b32 v80, v84
v_add_u32 v6, 0x20000, v19
v_permlane16_swap_b32 v81, v85
v_mfma_f32_16x16x32_bf16 v[140:143], v[36:39], a[132:135], 0
v_permlane16_swap_b32 v82, v86
v_add_u32 v7, 0x20000, v20
v_permlane16_swap_b32 v83, v87
s_add_u32 s0, s0, 589824
v_mfma_f32_16x16x32_bf16 v[148:151], v[36:39], a[160:163], 0
s_waitcnt vmcnt(9)
s_barrier
ds_read_b128 v[32:35], v116 offset:8192
buffer_load_dword v0, v31, s[32:35], s0 offen
v_mfma_f32_16x16x32_bf16 v[156:159], v[36:39], a[164:167], 0
NA 128,40,136
ds_read_b128 v[36:39], v117 offset:8192
v_accvgpr_write_b32 a176, v80
v_accvgpr_write_b32 a177, v81
NA 136,40,140
v_accvgpr_write_b32 a178, v82
v_accvgpr_write_b32 a179, v83
s_add_u32 m0, s68, 0
s_add_u32 s75, s60, 40960
NA 144,40,168
buffer_load_dwordx4 v15, s[8:11], s75 offen offset:0 lds
v_accvgpr_write_b32 a180, v84
v_add_u32 v8, 0x20000, v21
v_accvgpr_write_b32 a181, v85
NA 152,40,172
v_accvgpr_write_b32 a182, v86
v_add_u32 v9, 0x20000, v22
v_accvgpr_write_b32 a183, v87
s_waitcnt lgkmcnt(1)
NA 132,44,136
CV 96,96,97
CV 97,98,99
NA 140,44,140
CV 98,100,101
CV 99,102,103
NA 148,44,168
ds_read_b128 v[40:43], v116 offset:12288
CV 100,104,105
NA 156,44,172
CV 101,106,107
CV 102,108,109
NA 128,48,144
ds_read_b128 v[44:47], v117 offset:12288
CV 103,110,111
NA 136,48,148
v_permlane16_swap_b32 v96, v100
v_permlane16_swap_b32 v97, v101
s_add_u32 s100, s100, 4096
s_addc_u32 s101, s101, 0
NA 144,48,176
global_load_dword v0, v23, s[100:101]
v_permlane16_swap_b32 v98, v102
v_permlane16_swap_b32 v99, v103
NA 152,48,180
v_accvgpr_write_b32 a184, v96
v_accvgpr_write_b32 a185, v97
NA 132,52,144
v_accvgpr_write_b32 a186, v98
v_accvgpr_write_b32 a187, v99
NA 140,52,148
v_accvgpr_write_b32 a188, v100
NA 148,52,176
ds_read_b128 v[48:51], v116 offset:10240
v_accvgpr_write_b32 a189, v101
NA 156,52,180
v_accvgpr_write_b32 a190, v102
v_accvgpr_write_b32 a191, v103
NA 128,56,152
ds_read_b128 v[52:55], v117 offset:10240
NA 136,56,156
NA 144,56,184
NA 152,56,188
NA 132,60,152
NA 140,60,156
NA 148,60,184
ds_read_b128 v[56:59], v116 offset:14336
buffer_load_dwordx4 v16, s[8:11], s75 offen offset:1024 lds
NA 156,60,188
v_mfma_f32_16x16x32_bf16 v[184:187], v[32:35], a[164:167], 0
ds_read_b128 v[60:63], v117 offset:14336
v_max3_f32 v64, v128, v129, v130
v_max3_f32 v64, v64, v131, v132
v_max3_f32 v64, v64, v133, v134
v_max_f32 v64, v64, v135
v_max3_f32 v68, v136, v137, v138
s_waitcnt lgkmcnt(2)
NA 184,36,172
v_max3_f32 v68, v68, v139, v140
v_max3_f32 v68, v68, v141, v142
v_max_f32 v68, v68, v143
v_max3_f32 v72, v144, v145, v146
v_max3_f32 v72, v72, v147, v148
v_mfma_f32_16x16x32_bf16 v[176:179], v[32:35], a[160:163], 0
v_max3_f32 v72, v72, v149, v150
v_max_f32 v72, v72, v151
v_max3_f32 v76, v152, v153, v154
v_max3_f32 v76, v76, v155, v156
v_max3_f32 v76, v76, v157, v158
v_max_f32 v76, v76, v159
NA 176,36,168
v_mov_b32 v65, v64
v_mov_b32 v69, v68
v_mov_b32 v73, v72
v_mov_b32 v77, v76
v_permlane16_swap_b32 v64, v65
v_mfma_f32_16x16x32_bf16 v[168:171], v[32:35], a[132:135], 0
buffer_load_dwordx4 v17, s[8:11], s75 offen offset:2048 lds
v_permlane16_swap_b32 v68, v69
v_permlane16_swap_b32 v72, v73
v_permlane16_swap_b32 v76, v77
v_max_f32 v64, v64, v65
NA 168,36,140
v_max_f32 v68, v68, v69
v_max_f32 v72, v72, v73
v_max_f32 v76, v76, v77
v_mov_b32 v65, v64
s_add_u32 s0, s0, 589824
v_mfma_f32_16x16x32_bf16 v[160:163], v[32:35], a[128:131], 0
buffer_load_dword v0, v31, s[32:35], s0 offen
v_mov_b32 v69, v68
v_mov_b32 v73, v72
v_mov_b32 v77, v76
v_permlane32_swap_b32 v64, v65
v_permlane32_swap_b32 v68, v69
NA 160,36,136
v_permlane32_swap_b32 v72, v73
v_permlane32_swap_b32 v76, v77
v_min_f32 v64, -v64, -v65
v_min_f32 v68, -v68, -v69
v_min_f32 v72, -v72, -v73
NA 160,40,144
R 32,3,24576
v_min_f32 v76, -v76, -v77
v_add_f32 v128, v128, v64
v_add_f32 v129, v129, v64
v_add_f32 v130, v130, v64
v_add_f32 v131, v131, v64
NA 160,44,152
v_exp_f32 v128, v128
v_exp_f32 v129, v129
v_exp_f32 v130, v130
NA 168,40,148
R 34,3,26624
buffer_load_dwordx4 v18, s[8:11], s75 offen offset:3072 lds
v_exp_f32 v131, v131
CV 128,128,129
NA 168,44,156
R 36,2,24576
CV 129,130,131
v_add_f32 v132, v132, v64
v_add_f32 v133, v133, v64
NA 176,40,176
R 38,2,26624
v_add_f32 v134, v134, v64
v_add_f32 v135, v135, v64
v_exp_f32 v132, v132
NA 176,44,184
v_exp_f32 v133, v133
v_exp_f32 v134, v134
v_exp_f32 v135, v135
NA 184,40,180
CV 130,132,133
CV 131,134,135
v_add_f32 v136, v136, v68
v_add_f32 v137, v137, v68
v_add_f32 v138, v138, v68
v_add_f32 v139, v139, v68
NA 184,44,188
v_exp_f32 v136, v136
v_exp_f32 v137, v137
v_exp_f32 v138, v138
v_mfma_f32_16x16x32_bf16 v[188:191], v[48:51], a[164:167], 0
R 40,4,24576
v_exp_f32 v139, v139
CV 136,136,137
CV 137,138,139
NA 188,52,172
v_add_f32 v140, v140, v68
v_add_f32 v141, v141, v68
v_add_f32 v142, v142, v68
s_add_u32 m0, s68, 16384
s_add_u32 s75, s61, 32768
v_mfma_f32_16x16x32_bf16 v[180:183], v[48:51], a[160:163], 0
R 42,4,26624
buffer_load_dwordx4 v11, s[12:15], s75 offen offset:0 lds
v_add_f32 v143, v143, v68
v_exp_f32 v140, v140
NA 180,52,168
R 44,5,24576
v_exp_f32 v141, v141
v_exp_f32 v142, v142
v_mfma_f32_16x16x32_bf16 v[172:175], v[48:51], a[132:135], 0
R 46,5,26624
v_exp_f32 v143, v143
CV 138,140,141
CV 139,142,143
v_add_f32 v144, v144, v72
NA 172,52,140
v_add_f32 v145, v145, v72
v_add_f32 v146, v146, v72
v_add_f32 v147, v147, v72
v_exp_f32 v144, v144
v_mfma_f32_16x16x32_bf16 v[164:167], v[48:51], a[128:131], 0
v_exp_f32 v145, v145
v_exp_f32 v146, v146
v_exp_f32 v147, v147
NA 164,52,136
CV 144,144,145
CV 145,146,147
v_add_f32 v148, v148, v72
v_add_f32 v149, v149, v72
v_add_f32 v150, v150, v72
s_waitcnt lgkmcnt(1)
NA 164,56,144
v_add_f32 v151, v151, v72
v_exp_f32 v148, v148
v_exp_f32 v149, v149
NA 164,60,152
v_exp_f32 v150, v150
v_exp_f32 v151, v151
CV 146,148,149
NA 172,56,148
R 48,3,32768
CV 147,150,151
v_add_f32 v152, v152, v76
v_add_f32 v153, v153, v76
v_add_f32 v154, v154, v76
v_add_f32 v155, v155, v76
NA 172,60,156
v_exp_f32 v152, v152
v_exp_f32 v153, v153
v_exp_f32 v154, v154
NA 180,56,176
R 50,3,34816
v_exp_f32 v155, v155
CV 152,152,153
CV 153,154,155
v_add_f32 v156, v156, v76
NA 180,60,184
v_add_f32 v157, v157, v76
v_add_f32 v158, v158, v76
v_add_f32 v159, v159, v76
v_exp_f32 v156, v156
NA 188,56,180
R 52,2,32768
v_exp_f32 v157, v157
v_exp_f32 v158, v158
NA 188,60,188
v_exp_f32 v159, v159
CV 154,156,157
CV 155,158,159
v_mfma_f32_16x16x32_bf16 a[0:3], v[32:35], v[128:131], 0
R 54,2,34816
v_add_f32 v160, v160, v64
v_add_f32 v161, v161, v64
v_mfma_f32_16x16x32_bf16 a[8:11], v[32:35], v[136:139], 0
v_add_f32 v162, v162, v64
v_add_f32 v163, v163, v64
v_mfma_f32_16x16x32_bf16 a[64:67], v[32:35], v[144:147], 0
R 56,4,32768
v_exp_f32 v160, v160
v_mfma_f32_16x16x32_bf16 a[72:75], v[32:35], v[152:155], 0
v_mov_b32 v65, v64
v_exp_f32 v161, v161
v_mfma_f32_16x16x32_bf16 a[4:7], v[36:39], v[128:131], 0
R 58,4,34816
v_mfma_f32_16x16x32_bf16 a[12:15], v[36:39], v[136:139], 0
v_exp_f32 v162, v162
s_add_u32 s0, s0, 589824
v_mfma_f32_16x16x32_bf16 a[68:71], v[36:39], v[144:147], 0
R 60,5,32768
buffer_load_dword v0, v31, s[32:35], s0 offen
buffer_load_dwordx4 v12, s[12:15], s75 offen offset:1024 lds
v_mfma_f32_16x16x32_bf16 a[76:79], v[36:39], v[152:155], 0
v_exp_f32 v163, v163
v_mfma_f32_16x16x32_bf16 a[16:19], v[40:43], v[128:131], 0
R 62,5,34816
CV 160,160,161
CV 161,162,163
v_mfma_f32_16x16x32_bf16 a[24:27], v[40:43], v[136:139], 0
v_add_f32 v164, v164, v64
v_add_f32 v165, v165, v64
v_mfma_f32_16x16x32_bf16 a[80:83], v[40:43], v[144:147], 0
ds_read_b128 v[32:35], v116 offset:16384
v_add_f32 v166, v166, v64
v_add_f32 v167, v167, v64
v_mfma_f32_16x16x32_bf16 a[88:91], v[40:43], v[152:155], 0
ds_read_b128 v[36:39], v117 offset:16384
v_exp_f32 v164, v164
s_waitcnt lgkmcnt(3)
v_mfma_f32_16x16x32_bf16 a[20:23], v[44:47], v[128:131], 0
buffer_load_dwordx4 v13, s[12:15], s75 offen offset:2048 lds
v_mov_b32 v66, v64
v_mfma_f32_16x16x32_bf16 a[28:31], v[44:47], v[136:139], 0
v_exp_f32 v165, v165
v_mfma_f32_16x16x32_bf16 a[84:87], v[44:47], v[144:147], 0
v_mov_b32 v67, v64
v_exp_f32 v166, v166
v_mfma_f32_16x16x32_bf16 a[92:95], v[44:47], v[152:155], 0
v_mov_b32 v69, v68
v_mfma_f32_16x16x32_bf16 v[80:83], v[124:127], v[128:131], 0
v_exp_f32 v167, v167
v_mov_b32 v70, v68
v_mfma_f32_16x16x32_bf16 v[84:87], v[124:127], v[136:139], 0
CV 162,164,165
CV 163,166,167
v_mfma_f32_16x16x32_bf16 v[88:91], v[124:127], v[144:147], 0
ds_read_b128 v[40:43], v116 offset:20480
buffer_load_dwordx4 v14, s[12:15], s75 offen offset:3072 lds
v_add_f32 v168, v168, v68
v_mfma_f32_16x16x32_bf16 v[92:95], v[124:127], v[152:155], 0
ds_read_b128 v[44:47], v117 offset:20480
v_add_f32 v169, v169, v68
v_mfma_f32_16x16x32_bf16 a[32:35], v[48:51], v[128:131], 0
v_mov_b32 v71, v68
v_add_f32 v170, v170, v68
v_add_f32 v171, v171, v68
v_mfma_f32_16x16x32_bf16 a[40:43], v[48:51], v[136:139], 0
v_mov_b32 v73, v72
v_exp_f32 v168, v168
v_mfma_f32_16x16x32_bf16 a[96:99], v[48:51], v[144:147], 0
v_mov_b32 v74, v72
v_exp_f32 v169, v169
v_mfma_f32_16x16x32_bf16 a[104:107], v[48:51], v[152:155], 0
v_exp_f32 v170, v170
v_mfma_f32_16x16x32_bf16 a[36:39], v[52:55], v[128:131], 0
v_mov_b32 v75, v72
v_mov_b32 v77, v76
v_mfma_f32_16x16x32_bf16 a[44:47], v[52:55], v[136:139], 0
v_exp_f32 v171, v171
v_mfma_f32_16x16x32_bf16 a[100:103], v[52:55], v[144:147], 0
s_waitcnt vmcnt(12)
s_barrier
ds_read_b128 v[48:51], v116 offset:18432
v_mfma_f32_16x16x32_bf16 a[108:111], v[52:55], v[152:155], 0
v_mfma_f32_16x16x32_bf16 a[48:51], v[56:59], v[128:131], 0
ds_read_b128 v[52:55], v117 offset:18432
CV 168,168,169
v_mfma_f32_16x16x32_bf16 a[56:59], v[56:59], v[136:139], 0
CV 169,170,171
s_add_u32 m0, s68, 36864
s_add_u32 s75, s60, 57344
v_mfma_f32_16x16x32_bf16 a[112:115], v[56:59], v[144:147], 0
buffer_load_dwordx4 v15, s[8:11], s75 offen offset:0 lds
v_add_f32 v172, v172, v68
v_add_f32 v173, v173, v68
v_mfma_f32_16x16x32_bf16 a[120:123], v[56:59], v[152:155], 0
v_mov_b32 v78, v76
v_add_f32 v174, v174, v68
s_waitcnt lgkmcnt(2)
v_mfma_f32_16x16x32_bf16 a[52:55], v[60:63], v[128:131], 0
v_add_f32 v175, v175, v68
v_exp_f32 v172, v172
v_mfma_f32_16x16x32_bf16 a[60:63], v[60:63], v[136:139], 0
v_mov_b32 v79, v76
v_mfma_f32_16x16x32_bf16 a[116:119], v[60:63], v[144:147], 0
ds_read_b128 v[56:59], v116 offset:22528
v_exp_f32 v173, v173
v_mfma_f32_16x16x32_bf16 a[124:127], v[60:63], v[152:155], 0
v_exp_f32 v174, v174
v_mfma_f32_16x16x32_bf16 v[152:155], v[32:35], a[164:167], v[76:79]
ds_read_b128 v[60:63], v117 offset:22528
v_exp_f32 v175, v175
NA 152,36,172
CV 170,172,173
CV 171,174,175
v_mfma_f32_16x16x32_bf16 v[144:147], v[32:35], a[160:163], v[72:75]
v_add_f32 v176, v176, v72
v_add_f32 v177, v177, v72
v_add_f32 v178, v178, v72
NA 144,36,168
v_add_f32 v179, v179, v72
v_exp_f32 v176, v176
v_mfma_f32_16x16x32_bf16 v[136:139], v[32:35], a[132:135], v[68:71]
v_exp_f32 v177, v177
NA 136,36,140
v_exp_f32 v178, v178
v_mfma_f32_16x16x32_bf16 v[128:131], v[32:35], a[128:131], v[64:67]
v_exp_f32 v179, v179
CV 176,176,177
NA 128,36,136
CV 177,178,179
v_add_f32 v180, v180, v72
NA 128,40,144
R 32,3,28672
v_add_f32 v181, v181, v72
NA 128,44,152
v_add_f32 v182, v182, v72
v_add_f32 v183, v183, v72
NA 136,40,148
R 34,3,30720
v_exp_f32 v180, v180
NA 136,44,156
R 36,2,28672
v_exp_f32 v181, v181
NA 144,40,176
R 38,2,30720
v_exp_f32 v182, v182
NA 144,44,184
v_exp_f32 v183, v183
NA 152,40,180
CV 178,180,181
CV 179,182,183
NA 152,44,188
v_add_f32 v184, v184, v76
v_add_f32 v185, v185, v76
s_waitcnt lgkmcnt(2)
v_mfma_f32_16x16x32_bf16 v[156:159], v[48:51], a[164:167], v[76:79]
R 40,4,28672
v_add_f32 v186, v186, v76
v_add_f32 v187, v187, v76
NA 156,52,172
v_exp_f32 v184, v184
v_mfma_f32_16x16x32_bf16 v[148:151], v[48:51], a[160:163], v[72:75]
R 42,4,30720
v_exp_f32 v185, v185
NA 148,52,168
R 44,5,28672
v_exp_f32 v186, v186
v_mfma_f32_16x16x32_bf16 v[140:143], v[48:51], a[132:135], v[68:71]
R 46,5,30720
NA 140,52,140
v_exp_f32 v187, v187
v_mfma_f32_16x16x32_bf16 v[132:135], v[48:51], a[128:131], v[64:67]
CV 184,184,185
CV 185,186,187
v_add_f32 v188, v188, v76
NA 132,52,136
v_add_f32 v189, v189, v76
v_add_f32 v190, v190, v76
NA 132,56,144
v_add_f32 v191, v191, v76
v_exp_f32 v188, v188
NA 132,60,152
v_exp_f32 v189, v189
NA 140,56,148
R 48,3,36864
buffer_load_dwordx4 v16, s[8:11], s75 offen offset:1024 lds
v_exp_f32 v190, v190
NA 140,60,156
v_exp_f32 v191, v191
NA 148,56,176
R 50,3,38912
s_mul_i32 s0, s55, 1024
s_mul_i32 s74, s56, 663552
s_add_u32 s0, s0, s74
NA 148,60,184
NA 156,56,180
R 52,2,36864
CV 186,188,189
v_and_b32 v114, -8, v1
NA 156,60,188
CV 187,190,191
v_lshlrev_b32 v114, 4, v114
NC 0,32,160
R 54,2,38912
NC 8,32,168
v_exp_f32 v128, v128
s_add_u32 s0, s0, 0
NC 64,32,176
R 56,4,36864
buffer_load_dword v0, v114, s[36:39], s0 offen
NC 72,32,184
v_exp_f32 v129, v129
s_waitcnt lgkmcnt(3)
NC 4,36,160
R 58,4,38912
NC 12,36,168
v_exp_f32 v130, v130
NC 68,36,176
R 60,5,36864
buffer_load_dwordx4 v17, s[8:11], s75 offen offset:2048 lds
NC 76,36,184
v_exp_f32 v131, v131
NC 16,40,160
R 62,5,38912
CV 128,128,129
NC 24,40,168
CV 129,130,131
NC 80,40,176
ds_read_b128 v[32:35], v116 offset:45056
v_exp_f32 v132, v132
NC 88,40,184
ds_read_b128 v[36:39], v117 offset:45056
NC 20,44,160
v_exp_f32 v133, v133
NC 28,44,168
v_exp_f32 v134, v134
NC 84,44,176
v_exp_f32 v135, v135
NC 92,44,184
CV 130,132,133
NV 80,124,160
buffer_load_dwordx4 v18, s[8:11], s75 offen offset:3072 lds
CV 131,134,135
NV 84,124,168
v_exp_f32 v136, v136
NV 88,124,176
ds_read_b128 v[40:43], v116 offset:49152
v_exp_f32 v137, v137
NV 92,124,184
ds_read_b128 v[44:47], v117 offset:49152
NC 32,48,160
v_exp_f32 v138, v138
NC 40,48,168
v_exp_f32 v139, v139
NC 96,48,176
CV 136,136,137
NC 104,48,184
CV 137,138,139
s_add_u32 s0, s0, 65536
s_waitcnt lgkmcnt(2)
NC 36,52,160
buffer_load_dword v0, v114, s[36:39], s0 offen
NC 44,52,168
v_exp_f32 v140, v140
NC 100,52,176
ds_read_b128 v[48:51], v116 offset:47104
v_exp_f32 v141, v141
NC 108,52,184
s_add_u32 m0, s68, 53248
s_add_u32 s75, s61, 49152
NC 48,56,160
ds_read_b128 v[52:55], v117 offset:47104
buffer_load_dwordx4 v11, s[12:15], s75 offen offset:0 lds
NC 56,56,168
v_exp_f32 v142, v142
NC 112,56,176
v_accvgpr_read_b32 v96, a192
NC 120,56,184
v_exp_f32 v143, v143
NC 52,60,160
v_accvgpr_read_b32 v97, a193
CV 138,140,141
NC 60,60,168
CV 139,142,143
NC 116,60,176
ds_read_b128 v[56:59], v116 offset:51200
v_exp_f32 v144, v144
NC 124,60,184
v_exp_f32 v145, v145
v_mfma_f32_16x16x32_bf16 v[184:187], v[32:35], a[164:167], v[76:79]
ds_read_b128 v[60:63], v117 offset:51200
NA 184,36,172
v_exp_f32 v146, v146
v_mfma_f32_16x16x32_bf16 v[176:179], v[32:35], a[160:163], v[72:75]
v_accvgpr_read_b32 v98, a194
NA 176,36,168
v_exp_f32 v147, v147
v_mfma_f32_16x16x32_bf16 v[168:171], v[32:35], a[132:135], v[68:71]
CV 144,144,145
v_accvgpr_read_b32 v99, a195
NA 168,36,140
CV 145,146,147
v_mfma_f32_16x16x32_bf16 v[160:163], v[32:35], a[128:131], v[64:67]
v_exp_f32 v148, v148
v_accvgpr_read_b32 v100, a196
NA 160,36,136
v_exp_f32 v149, v149
s_waitcnt lgkmcnt(0)
NA 160,40,144
R 32,3,61440
NA 160,44,152
v_exp_f32 v150, v150
NA 168,40,148
R 34,3,63488
s_add_u32 s0, s0, 65536
NA 168,44,156
R 36,2,61440
NA 176,40,176
R 38,2,63488
buffer_load_dword v0, v114, s[36:39], s0 offen
NA 176,44,184
v_exp_f32 v151, v151
NA 184,40,180
CV 146,148,149
v_accvgpr_read_b32 v101, a197
CV 147,150,151
NA 184,44,188
v_exp_f32 v152, v152
v_mfma_f32_16x16x32_bf16 v[188:191], v[48:51], a[164:167], v[76:79]
R 40,4,61440
NA 188,52,172
v_exp_f32 v153, v153
v_mfma_f32_16x16x32_bf16 v[180:183], v[48:51], a[160:163], v[72:75]
R 42,4,63488
v_exp_f32 v154, v154
NA 180,52,168
R 44,5,61440
v_mfma_f32_16x16x32_bf16 v[172:175], v[48:51], a[132:135], v[68:71]
R 46,5,63488
NA 172,52,140
v_exp_f32 v155, v155
v_mfma_f32_16x16x32_bf16 v[164:167], v[48:51], a[128:131], v[64:67]
CV 152,152,153
v_accvgpr_read_b32 v102, a198
NA 164,52,136
CV 153,154,155
NA 164,56,144
buffer_load_dwordx4 v12, s[12:15], s75 offen offset:1024 lds
v_exp_f32 v156, v156
NA 164,60,152
v_exp_f32 v157, v157
NA 172,56,148
R 48,6,4096
NA 172,60,156
v_exp_f32 v158, v158
NA 180,56,176
R 50,6,6144
NA 180,60,184
v_exp_f32 v159, v159
NA 188,56,180
R 52,7,4096
CV 154,156,157
NA 188,60,188
CV 155,158,159
s_waitcnt lgkmcnt(3)
NC 0,32,128
R 54,7,6144
NC 8,32,136
LA_pad6:
s_cbranch_execz LA_pad10
v_exp_f32 v160, v160
s_add_u32 s0, s0, 65536
NC 64,32,144
R 56,8,4096
buffer_load_dword v0, v114, s[36:39], s0 offen
NC 72,32,152
v_exp_f32 v161, v161
NC 4,36,128
R 58,8,6144
buffer_load_dwordx4 v13, s[12:15], s75 offen offset:2048 lds
NC 12,36,136
v_exp_f32 v162, v162
NC 68,36,144
R 60,9,4096
NC 76,36,152
v_exp_f32 v163, v163
NC 16,40,128
R 62,9,6144
CV 160,160,161
CV 161,162,163
NC 24,40,136
v_exp_f32 v164, v164
NC 80,40,144
ds_read_b128 v[32:35], v116 offset:53248
v_exp_f32 v165, v165
NC 88,40,152
ds_read_b128 v[36:39], v117 offset:53248
NC 20,44,128
v_exp_f32 v166, v166
NC 28,44,136
v_accvgpr_read_b32 v103, a199
NC 84,44,144
buffer_load_dwordx4 v14, s[12:15], s75 offen offset:3072 lds
NC 92,44,152
v_exp_f32 v167, v167
s_add_u32 s100, s100, 4096
s_addc_u32 s101, s101, 0
NV 80,124,128
global_load_dword v0, v23, s[100:101]
CV 162,164,165
CV 163,166,167
v_accvgpr_read_b32 v104, a200
NV 84,124,136
v_exp_f32 v168, v168
NV 88,124,144
ds_read_b128 v[40:43], v116 offset:57344
NV 92,124,152
ds_read_b128 v[44:47], v117 offset:57344
s_waitcnt lgkmcnt(2)
NC 32,48,128
v_exp_f32 v169, v169
NC 40,48,136
v_exp_f32 v170, v170
v_accvgpr_read_b32 v105, a201
NC 96,48,144
v_exp_f32 v171, v171
NC 104,48,152
v_accvgpr_read_b32 v106, a202
NC 36,52,128
CV 168,168,169
CV 169,170,171
NC 44,52,136
v_exp_f32 v172, v172
s_add_u32 s0, s0, 65536
NC 100,52,144
s_waitcnt vmcnt(13)
s_barrier
ds_read_b128 v[48:51], v116 offset:55296
buffer_load_dword v0, v114, s[36:39], s0 offen
NC 108,52,152
NC 48,56,128
ds_read_b128 v[52:55], v117 offset:55296
NC 56,56,136
s_add_u32 m0, s68, 73728
s_add_u32 s75, s60, 73728
NC 112,56,144
buffer_load_dwordx4 v15, s[8:11], s75 offen offset:0 lds
v_exp_f32 v173, v173
NC 120,56,152
v_exp_f32 v174, v174
NC 52,60,128
v_exp_f32 v175, v175
NC 60,60,136
v_accvgpr_read_b32 v107, a203
NC 116,60,144
ds_read_b128 v[56:59], v116 offset:59392
CV 170,172,173
NC 124,60,152
CV 171,174,175
v_mfma_f32_16x16x32_bf16 v[152:155], v[32:35], a[164:167], v[76:79]
ds_read_b128 v[60:63], v117 offset:59392
v_exp_f32 v176, v176
NA 152,36,172
v_exp_f32 v177, v177
v_mfma_f32_16x16x32_bf16 v[144:147], v[32:35], a[160:163], v[72:75]
v_exp_f32 v178, v178
NA 144,36,168
v_accvgpr_read_b32 v108, a204
v_mfma_f32_16x16x32_bf16 v[136:139], v[32:35], a[132:135], v[68:71]
v_exp_f32 v179, v179
NA 136,36,140
v_accvgpr_read_b32 v109, a205
v_mfma_f32_16x16x32_bf16 v[128:131], v[32:35], a[128:131], v[64:67]
CV 176,176,177
CV 177,178,179
NA 128,36,136
v_exp_f32 v180, v180
v_accvgpr_read_b32 v110, a206
s_waitcnt lgkmcnt(0)
NA 128,40,144
R 32,6,0
NA 128,44,152
v_exp_f32 v181, v181
NA 136,40,148
R 34,6,2048
v_exp_f32 v182, v182
NA 136,44,156
R 36,7,0
NA 144,40,176
R 38,7,2048
NA 144,44,184
v_exp_f32 v183, v183
s_add_u32 s0, s0, 65536
NA 152,40,180
buffer_load_dword v0, v114, s[36:39], s0 offen
CV 178,180,181
NA 152,44,188
CV 179,182,183
v_mfma_f32_16x16x32_bf16 v[156:159], v[48:51], a[164:167], v[76:79]
R 40,8,0
NA 156,52,172
v_exp_f32 v184, v184
v_mfma_f32_16x16x32_bf16 v[148:151], v[48:51], a[160:163], v[72:75]
R 42,8,2048
v_exp_f32 v185, v185
NA 148,52,168
R 44,9,0
v_mfma_f32_16x16x32_bf16 v[140:143], v[48:51], a[132:135], v[68:71]
R 46,9,2048
v_exp_f32 v186, v186
NA 140,52,140
v_exp_f32 v187, v187
v_mfma_f32_16x16x32_bf16 v[132:135], v[48:51], a[128:131], v[64:67]
CV 184,184,185
NA 132,52,136
v_accvgpr_read_b32 v111, a207
NA 132,56,144
CV 185,186,187
v_exp_f32 v188, v188
NA 132,60,152
v_exp_f32 v189, v189
NA 140,56,148
R 48,6,8192
buffer_load_dwordx4 v16, s[8:11], s75 offen offset:1024 lds
NA 140,60,156
v_exp_f32 v190, v190
NA 148,56,176
R 50,6,10240
NA 148,60,184
v_exp_f32 v191, v191
NA 156,56,180
R 52,7,8192
CV 186,188,189
NA 156,60,188
CV 187,190,191
s_waitcnt lgkmcnt(3)
NC 0,32,160
R 54,7,10240
v_exp_f32 v128, v128
NC 8,32,168
v_exp_f32 v129, v129
NC 64,32,176
R 56,8,8192
NC 72,32,184
v_exp_f32 v130, v130
s_add_u32 s0, s0, 65536
NC 4,36,160
R 58,8,10240
buffer_load_dword v0, v114, s[36:39], s0 offen
NC 12,36,168
v_exp_f32 v131, v131
NC 68,36,176
R 60,9,8192
buffer_load_dwordx4 v17, s[8:11], s75 offen offset:2048 lds
NC 76,36,184
NC 16,40,160
R 62,9,10240
CV 128,128,129
CV 129,130,131
NC 24,40,168
v_exp_f32 v132, v132
NC 80,40,176
ds_read_b128 v[32:35], v112 offset:0
v_exp_f32 v133, v133
NC 88,40,184
ds_read_b128 v[36:39], v113 offset:0
NC 20,44,160
CV 96,96,97
NC 28,44,168
v_exp_f32 v134, v134
NC 84,44,176
CV 97,98,99
NC 92,44,184
v_exp_f32 v135, v135
NV 80,124,160
buffer_load_dwordx4 v18, s[8:11], s75 offen offset:3072 lds
CV 130,132,133
CV 131,134,135
NV 84,124,168
v_exp_f32 v136, v136
NV 88,124,176
ds_read_b128 v[40:43], v112 offset:4096
NV 92,124,184
ds_read_b128 v[44:47], v113 offset:4096
s_waitcnt lgkmcnt(2)
NC 32,48,160
v_exp_f32 v137, v137
CV 98,100,101
NC 40,48,168
v_exp_f32 v138, v138
NC 96,48,176
CV 99,102,103
NC 104,48,184
v_exp_f32 v139, v139
NC 36,52,160
CV 136,136,137
CV 100,104,105
CV 137,138,139
NC 44,52,168
v_exp_f32 v140, v140
NC 100,52,176
ds_read_b128 v[48:51], v112 offset:2048
s_add_u32 s0, s0, 65536
s_add_u32 m0, s68, 90112
s_add_u32 s75, s61, 65536
NC 108,52,184
NC 48,56,160
ds_read_b128 v[52:55], v113 offset:2048
buffer_load_dword v0, v114, s[36:39], s0 offen
buffer_load_dwordx4 v11, s[12:15], s75 offen offset:0 lds
NC 56,56,168
NC 112,56,176
v_exp_f32 v141, v141
NC 120,56,184
CV 101,106,107
NC 52,60,160
v_exp_f32 v142, v142
CV 102,108,109
NC 60,60,168
v_exp_f32 v143, v143
NC 116,60,176
ds_read_b128 v[56:59], v112 offset:6144
CV 138,140,141
NC 124,60,184
CV 139,142,143
v_mfma_f32_16x16x32_bf16 v[184:187], v[32:35], a[164:167], v[76:79]
ds_read_b128 v[60:63], v113 offset:6144
v_exp_f32 v144, v144
NA 184,36,172
v_exp_f32 v145, v145
v_mfma_f32_16x16x32_bf16 v[176:179], v[32:35], a[160:163], v[72:75]
CV 103,110,111
NA 176,36,168
v_exp_f32 v146, v146
v_mfma_f32_16x16x32_bf16 v[168:171], v[32:35], a[132:135], v[68:71]
v_exp_f32 v147, v147
NA 168,36,140
v_permlane16_swap_b32 v96, v100
v_mfma_f32_16x16x32_bf16 v[160:163], v[32:35], a[128:131], v[64:67]
CV 144,144,145
CV 145,146,147
v_permlane16_swap_b32 v97, v101
NA 160,36,136
v_exp_f32 v148, v148
s_waitcnt lgkmcnt(0)
NA 160,40,144
R 32,19,16384
NA 160,44,152
v_exp_f32 v149, v149
NA 168,40,148
R 34,19,18432
v_exp_f32 v150, v150
NA 168,44,156
R 36,20,16384
NA 176,40,176
R 38,20,18432
NA 176,44,184
v_exp_f32 v151, v151
NA 184,40,180
CV 146,148,149
CV 147,150,151
NA 184,44,188
v_exp_f32 v152, v152
s_add_u32 s0, s0, 65536
v_mfma_f32_16x16x32_bf16 v[188:191], v[48:51], a[164:167], v[76:79]
R 40,21,16384
buffer_load_dword v0, v114, s[36:39], s0 offen
NA 188,52,172
v_mfma_f32_16x16x32_bf16 v[180:183], v[48:51], a[160:163], v[72:75]
R 42,21,18432
v_exp_f32 v153, v153
NA 180,52,168
R 44,22,16384
v_mfma_f32_16x16x32_bf16 v[172:175], v[48:51], a[132:135], v[68:71]
R 46,22,18432
v_exp_f32 v154, v154
NA 172,52,140
v_exp_f32 v155, v155
v_mfma_f32_16x16x32_bf16 v[164:167], v[48:51], a[128:131], v[64:67]
v_permlane16_swap_b32 v98, v102
NA 164,52,136
CV 152,152,153
NA 164,56,144
buffer_load_dwordx4 v12, s[12:15], s75 offen offset:1024 lds
CV 153,154,155
NA 164,60,152
v_exp_f32 v156, v156
NA 172,56,148
R 48,19,24576
v_exp_f32 v157, v157
NA 172,60,156
v_exp_f32 v158, v158
NA 180,56,176
R 50,19,26624
NA 180,60,184
v_exp_f32 v159, v159
NA 188,56,180
R 52,20,24576
CV 154,156,157
NA 188,60,188
CV 155,158,159
s_waitcnt lgkmcnt(3)
NC 0,32,128
R 54,20,26624
v_exp_f32 v160, v160
NC 8,32,136
v_exp_f32 v161, v161
NC 64,32,144
R 56,21,24576
NC 72,32,152
v_exp_f32 v162, v162
NC 4,36,128
R 58,21,26624
buffer_load_dwordx4 v13, s[12:15], s75 offen offset:2048 lds
NC 12,36,136
v_exp_f32 v163, v163
s_add_u32 s0, s0, 65536
NC 68,36,144
R 60,22,24576
buffer_load_dword v0, v114, s[36:39], s0 offen
NC 76,36,152
CV 160,160,161
NC 16,40,128
R 62,22,26624
CV 161,162,163
NC 24,40,136
v_exp_f32 v164, v164
NC 80,40,144
ds_read_b128 v[32:35], v112 offset:8192
v_exp_f32 v165, v165
NC 88,40,152
ds_read_b128 v[36:39], v113 offset:8192
NC 20,44,128
v_exp_f32 v166, v166
NC 28,44,136
v_permlane16_swap_b32 v99, v103
NC 84,44,144
buffer_load_dwordx4 v14, s[12:15], s75 offen offset:3072 lds
v_exp_f32 v167, v167
NC 92,44,152
CV 162,164,165
NV 80,124,128
CV 163,166,167
v_exp_f32 v168, v168
NV 84,124,136
v_accvgpr_write_b32 a192, v96
NV 88,124,144
ds_read_b128 v[40:43], v112 offset:12288
v_exp_f32 v169, v169
NV 92,124,152
ds_read_b128 v[44:47], v113 offset:12288
s_waitcnt lgkmcnt(2)
NC 32,48,128
v_exp_f32 v170, v170
v_accvgpr_write_b32 a193, v97
NC 40,48,136
v_exp_f32 v171, v171
NC 96,48,144
CV 168,168,169
v_accvgpr_write_b32 a194, v98
NC 104,48,152
CV 169,170,171
NC 36,52,128
v_exp_f32 v172, v172
v_accvgpr_write_b32 a195, v99
NC 44,52,136
v_exp_f32 v173, v173
NC 100,52,144
s_waitcnt vmcnt(15)
s_barrier
ds_read_b128 v[48:51], v112 offset:10240
NC 108,52,152
NC 48,56,128
ds_read_b128 v[52:55], v113 offset:10240
s_add_u32 s0, s0, 65536
s_add_u32 m0, s68, 110592
s_add_u32 s75, s60, 90112
NC 56,56,136
NC 112,56,144
buffer_load_dword v0, v114, s[36:39], s0 offen
buffer_load_dwordx4 v15, s[8:11], s75 offen offset:0 lds
NC 120,56,152
v_exp_f32 v174, v174
NC 52,60,128
v_exp_f32 v175, v175
NC 60,60,136
v_accvgpr_write_b32 a196, v100
NC 116,60,144
ds_read_b128 v[56:59], v112 offset:14336
CV 170,172,173
CV 171,174,175
NC 124,60,152
v_exp_f32 v176, v176
v_mfma_f32_16x16x32_bf16 v[152:155], v[32:35], a[164:167], v[76:79]
ds_read_b128 v[60:63], v113 offset:14336
NA 152,36,172
v_exp_f32 v177, v177
v_mfma_f32_16x16x32_bf16 v[144:147], v[32:35], a[160:163], v[72:75]
v_exp_f32 v178, v178
v_accvgpr_write_b32 a197, v101
NA 144,36,168
v_exp_f32 v179, v179
v_mfma_f32_16x16x32_bf16 v[136:139], v[32:35], a[132:135], v[68:71]
CV 176,176,177
NA 136,36,140
v_accvgpr_write_b32 a198, v102
v_mfma_f32_16x16x32_bf16 v[128:131], v[32:35], a[128:131], v[64:67]
CV 177,178,179
v_exp_f32 v180, v180
NA 128,36,136
v_accvgpr_write_b32 a199, v103
s_waitcnt lgkmcnt(0)
NA 128,40,144
R 32,19,20480
v_exp_f32 v181, v181
NA 128,44,152
v_exp_f32 v182, v182
NA 136,40,148
R 34,19,22528
v_exp_f32 v183, v183
NA 136,44,156
R 36,20,20480
NA 144,40,176
R 38,20,22528
CV 178,180,181
NA 144,44,184
CV 179,182,183
NA 152,40,180
v_exp_f32 v184, v184
NA 152,44,188
v_exp_f32 v185, v185
v_mfma_f32_16x16x32_bf16 v[156:159], v[48:51], a[164:167], v[76:79]
R 40,21,20480
v_exp_f32 v186, v186
NA 156,52,172
v_exp_f32 v187, v187
v_mfma_f32_16x16x32_bf16 v[148:151], v[48:51], a[160:163], v[72:75]
R 42,21,22528
NA 148,52,168
R 44,22,20480
v_mfma_f32_16x16x32_bf16 v[140:143], v[48:51], a[132:135], v[68:71]
R 46,22,22528
CV 184,184,185
CV 185,186,187
NA 140,52,140
v_exp_f32 v188, v188
v_mfma_f32_16x16x32_bf16 v[132:135], v[48:51], a[128:131], v[64:67]
v_accvgpr_read_b32 v96, a208
NA 132,52,136
v_exp_f32 v189, v189
NA 132,56,144
v_accvgpr_read_b32 v97, a209
v_exp_f32 v190, v190
NA 132,60,152
v_exp_f32 v191, v191
NA 140,56,148
R 48,19,28672
buffer_load_dwordx4 v16, s[8:11], s75 offen offset:1024 lds
NA 140,60,156
CV 186,188,189
NA 148,56,176
R 50,19,30720
s_mul_i32 s0, s55, 1024
s_mul_i32 s74, s56, 1048576
s_add_u32 s0, s0, s74
NA 148,60,184
NA 156,56,180
R 52,20,28672
CV 187,190,191
NA 156,60,188
v_and_b32 v114, -8, v1
v_lshlrev_b32 v114, 4, v114
s_waitcnt lgkmcnt(3)
NC 0,32,160
R 54,20,30720
NC 8,32,168
v_exp_f32 v128, v128
s_add_u32 s0, s0, 917504
NC 64,32,176
R 56,21,28672
buffer_load_dword v0, v114, s[8:11], s0 offen
NC 72,32,184
v_exp_f32 v129, v129
NC 4,36,160
R 58,21,30720
NC 12,36,168
v_exp_f32 v130, v130
NC 68,36,176
R 60,22,28672
buffer_load_dwordx4 v17, s[8:11], s75 offen offset:2048 lds
NC 76,36,184
v_exp_f32 v131, v131
NC 16,40,160
R 62,22,30720
CV 128,128,129
CV 129,130,131
NC 24,40,168
v_exp_f32 v132, v132
NC 80,40,176
ds_read_b128 v[32:35], v112 offset:36864
NC 88,40,184
ds_read_b128 v[36:39], v113 offset:36864
NC 20,44,160
v_exp_f32 v133, v133
v_accvgpr_read_b32 v98, a210
NC 28,44,168
v_exp_f32 v134, v134
NC 84,44,176
v_accvgpr_read_b32 v99, a211
NC 92,44,184
v_exp_f32 v135, v135
NV 80,124,160
buffer_load_dwordx4 v18, s[8:11], s75 offen offset:3072 lds
CV 130,132,133
NV 84,124,168
CV 131,134,135
NV 88,124,176
ds_read_b128 v[40:43], v112 offset:40960
v_exp_f32 v136, v136
NV 92,124,184
ds_read_b128 v[44:47], v113 offset:40960
s_waitcnt lgkmcnt(2)
NC 32,48,160
v_exp_f32 v137, v137
NC 40,48,168
v_accvgpr_read_b32 v100, a212
NC 96,48,176
v_exp_f32 v138, v138
v_accvgpr_read_b32 v101, a213
NC 104,48,184
v_exp_f32 v139, v139
NC 36,52,160
v_accvgpr_read_b32 v102, a214
CV 136,136,137
NC 44,52,168
CV 137,138,139
NC 100,52,176
ds_read_b128 v[48:51], v112 offset:38912
v_exp_f32 v140, v140
NC 108,52,184
s_add_u32 m0, s68, 126976
s_add_u32 s75, s61, 81920
NC 48,56,160
ds_read_b128 v[52:55], v113 offset:38912
buffer_load_dwordx4 v11, s[12:15], s75 offen offset:0 lds
NC 56,56,168
NC 112,56,176
LA_pad7:
s_cbranch_execz LA_pad11
v_exp_f32 v141, v141
v_accvgpr_read_b32 v103, a215
NC 120,56,184
v_exp_f32 v142, v142
NC 52,60,160
v_accvgpr_read_b32 v104, a216
NC 60,60,168
v_exp_f32 v143, v143
NC 116,60,176
ds_read_b128 v[56:59], v112 offset:43008
CV 138,140,141
NC 124,60,184
CV 139,142,143
v_mfma_f32_16x16x32_bf16 v[184:187], v[32:35], a[164:167], v[76:79]
ds_read_b128 v[60:63], v113 offset:43008
v_exp_f32 v144, v144
NA 184,36,172
v_exp_f32 v145, v145
v_mfma_f32_16x16x32_bf16 v[176:179], v[32:35], a[160:163], v[72:75]
v_accvgpr_read_b32 v105, a217
NA 176,36,168
v_exp_f32 v146, v146
v_mfma_f32_16x16x32_bf16 v[168:171], v[32:35], a[132:135], v[68:71]
v_exp_f32 v147, v147
NA 168,36,140
v_accvgpr_read_b32 v106, a218
v_mfma_f32_16x16x32_bf16 v[160:163], v[32:35], a[128:131], v[64:67]
CV 144,144,145
CV 145,146,147
v_accvgpr_read_b32 v107, a219
NA 160,36,136
v_exp_f32 v148, v148
s_waitcnt lgkmcnt(0)
NA 160,40,144
R 32,19,53248
NA 160,44,152
v_exp_f32 v149, v149
NA 168,40,148
R 34,19,55296
v_exp_f32 v150, v150
NA 168,44,156
R 36,20,53248
s_add_u32 s100, s100, 4096
s_addc_u32 s101, s101, 0
NA 176,40,176
R 38,20,55296
global_load_dword v0, v23, s[100:101]
NA 176,44,184
v_exp_f32 v151, v151
NA 184,40,180
CV 146,148,149
CV 147,150,151
NA 184,44,188
v_accvgpr_read_b32 v108, a220
v_mfma_f32_16x16x32_bf16 v[188:191], v[48:51], a[164:167], v[76:79]
R 40,21,53248
v_exp_f32 v152, v152
NA 188,52,172
v_exp_f32 v153, v153
v_mfma_f32_16x16x32_bf16 v[180:183], v[48:51], a[160:163], v[72:75]
R 42,21,55296
v_exp_f32 v154, v154
NA 180,52,168
R 44,22,53248
v_mfma_f32_16x16x32_bf16 v[172:175], v[48:51], a[132:135], v[68:71]
R 46,22,55296
NA 172,52,140
v_exp_f32 v155, v155
v_mfma_f32_16x16x32_bf16 v[164:167], v[48:51], a[128:131], v[64:67]
CV 152,152,153
v_accvgpr_read_b32 v109, a221
NA 164,52,136
CV 153,154,155
NA 164,56,144
buffer_load_dwordx4 v12, s[12:15], s75 offen offset:1024 lds
NA 164,60,152
v_exp_f32 v156, v156
NA 172,56,148
R 48,19,61440
v_exp_f32 v157, v157
NA 172,60,156
v_exp_f32 v158, v158
NA 180,56,176
R 50,19,63488
NA 180,60,184
v_exp_f32 v159, v159
NA 188,56,180
R 52,20,61440
CV 154,156,157
NA 188,60,188
CV 155,158,159
s_waitcnt lgkmcnt(3)
NC 0,32,128
R 54,20,63488
v_exp_f32 v160, v160
NC 8,32,136
v_exp_f32 v161, v161
NC 64,32,144
R 56,21,61440
NC 72,32,152
v_exp_f32 v162, v162
NC 4,36,128
R 58,21,63488
buffer_load_dwordx4 v13, s[12:15], s75 offen offset:2048 lds
NC 12,36,136
v_exp_f32 v163, v163
NC 68,36,144
R 60,22,61440
CV 160,160,161
NC 76,36,152
CV 161,162,163
NC 16,40,128
R 62,22,63488
v_exp_f32 v164, v164
NC 24,40,136
v_exp_f32 v165, v165
NC 80,40,144
ds_read_b128 v[32:35], v112 offset:45056
buffer_load_dword v0, v114, s[12:15], s0 offen
NC 88,40,152
ds_read_b128 v[36:39], v113 offset:45056
NC 20,44,128
v_exp_f32 v166, v166
NC 28,44,136
v_accvgpr_read_b32 v110, a222
NC 84,44,144
buffer_load_dwordx4 v14, s[12:15], s75 offen offset:3072 lds
NC 92,44,152
v_exp_f32 v167, v167
NV 80,124,128
CV 162,164,165
CV 163,166,167
NV 84,124,136
v_exp_f32 v168, v168
v_accvgpr_read_b32 v111, a223
NV 88,124,144
ds_read_b128 v[40:43], v112 offset:49152
v_exp_f32 v169, v169
NV 92,124,152
ds_read_b128 v[44:47], v113 offset:49152
s_waitcnt lgkmcnt(2)
NC 32,48,128
v_exp_f32 v170, v170
NC 40,48,136
NC 96,48,144
v_exp_f32 v171, v171
NC 104,48,152
CV 96,96,97
CV 168,168,169
NC 36,52,128
CV 97,98,99
CV 169,170,171
NC 44,52,136
v_exp_f32 v172, v172
NC 100,52,144
s_waitcnt vmcnt(12)
s_barrier
ds_read_b128 v[48:51], v112 offset:47104
NC 108,52,152
NC 48,56,128
ds_read_b128 v[52:55], v113 offset:47104
v_exp_f32 v173, v173
NC 56,56,136
s_add_u32 m0, s68, 0
s_add_u32 s75, s60, 106496
NC 112,56,144
buffer_load_dwordx4 v15, s[8:11], s75 offen offset:0 lds
NC 120,56,152
v_exp_f32 v174, v174
NC 52,60,128
CV 98,100,101
NC 60,60,136
v_exp_f32 v175, v175
NC 116,60,144
ds_read_b128 v[56:59], v112 offset:51200
CV 170,172,173
CV 171,174,175
NC 124,60,152
v_exp_f32 v176, v176
v_mfma_f32_16x16x32_bf16 v[152:155], v[32:35], a[164:167], v[76:79]
ds_read_b128 v[60:63], v113 offset:51200
NA 152,36,172
v_exp_f32 v177, v177
v_mfma_f32_16x16x32_bf16 v[144:147], v[32:35], a[160:163], v[72:75]
CV 99,102,103
NA 144,36,168
v_exp_f32 v178, v178
v_mfma_f32_16x16x32_bf16 v[136:139], v[32:35], a[132:135], v[68:71]
v_exp_f32 v179, v179
NA 136,36,140
CV 100,104,105
CV 176,176,177
v_mfma_f32_16x16x32_bf16 v[128:131], v[32:35], a[128:131], v[64:67]
CV 177,178,179
CV 101,106,107
NA 128,36,136
v_exp_f32 v180, v180
s_waitcnt lgkmcnt(0)
NA 128,40,144
R 32,19,57344
NA 128,44,152
v_exp_f32 v181, v181
NA 136,40,148
R 34,19,59392
v_exp_f32 v182, v182
NA 136,44,156
R 36,20,57344
NA 144,40,176
R 38,20,59392
NA 144,44,184
v_exp_f32 v183, v183
NA 152,40,180
CV 178,180,181
CV 102,108,109
CV 179,182,183
NA 152,44,188
v_exp_f32 v184, v184
v_mfma_f32_16x16x32_bf16 v[156:159], v[48:51], a[164:167], v[76:79]
R 40,21,57344
NA 156,52,172
v_exp_f32 v185, v185
v_mfma_f32_16x16x32_bf16 v[148:151], v[48:51], a[160:163], v[72:75]
R 42,21,59392
v_exp_f32 v186, v186
NA 148,52,168
R 44,22,57344
v_mfma_f32_16x16x32_bf16 v[140:143], v[48:51], a[132:135], v[68:71]
R 46,22,59392
NA 140,52,140
v_exp_f32 v187, v187
v_mfma_f32_16x16x32_bf16 v[132:135], v[48:51], a[128:131], v[64:67]
CV 184,184,185
CV 103,110,111
CV 185,186,187
NA 132,52,136
v_exp_f32 v188, v188
NA 132,56,144
v_permlane16_swap_b32 v96, v100
NA 132,60,152
v_exp_f32 v189, v189
NA 140,56,148
R 48,3,0
buffer_load_dwordx4 v16, s[8:11], s75 offen offset:1024 lds
NA 140,60,156
v_exp_f32 v190, v190
NA 148,56,176
R 50,3,2048
NA 148,60,184
v_exp_f32 v191, v191
NA 156,56,180
R 52,2,0
CV 186,188,189
NA 156,60,188
CV 187,190,191
s_waitcnt lgkmcnt(3)
NC 0,32,160
R 54,2,2048
v_exp_f32 v128, v128
NC 8,32,168
v_exp_f32 v129, v129
NC 64,32,176
R 56,4,0
NC 72,32,184
v_exp_f32 v130, v130
NC 4,36,160
R 58,4,2048
NC 12,36,168
v_exp_f32 v131, v131
NC 68,36,176
R 60,5,0
buffer_load_dwordx4 v17, s[8:11], s75 offen offset:2048 lds
NC 76,36,184
CV 128,128,129
NC 16,40,160
R 62,5,2048
CV 129,130,131
NC 24,40,168
v_exp_f32 v132, v132
NC 80,40,176
ds_read_b128 v[32:35], v116 offset:8192
v_exp_f32 v133, v133
NC 88,40,184
ds_read_b128 v[36:39], v117 offset:8192
NC 20,44,160
v_exp_f32 v134, v134
NC 28,44,168
v_permlane16_swap_b32 v97, v101
NC 84,44,176
v_exp_f32 v135, v135
NC 92,44,184
v_permlane16_swap_b32 v98, v102
CV 130,132,133
NV 80,124,160
buffer_load_dwordx4 v18, s[8:11], s75 offen offset:3072 lds
CV 131,134,135
NV 84,124,168
v_exp_f32 v136, v136
NV 88,124,176
ds_read_b128 v[40:43], v116 offset:12288
v_exp_f32 v137, v137
NV 92,124,184
ds_read_b128 v[44:47], v117 offset:12288
s_waitcnt lgkmcnt(2)
NC 32,48,160
v_exp_f32 v138, v138
NC 40,48,168
v_permlane16_swap_b32 v99, v103
NC 96,48,176
v_exp_f32 v139, v139
NC 104,48,184
v_accvgpr_write_b32 a200, v96
NC 36,52,160
CV 136,136,137
CV 137,138,139
NC 44,52,168
v_accvgpr_write_b32 a201, v97
NC 100,52,176
ds_read_b128 v[48:51], v116 offset:10240
v_exp_f32 v140, v140
NC 108,52,184
s_add_u32 m0, s68, 16384
s_add_u32 s75, s61, 98304
NC 48,56,160
ds_read_b128 v[52:55], v117 offset:10240
buffer_load_dwordx4 v11, s[12:15], s75 offen offset:0 lds
NC 56,56,168
v_exp_f32 v141, v141
NC 112,56,176
v_exp_f32 v142, v142
NC 120,56,184
v_accvgpr_write_b32 a202, v98
NC 52,60,160
v_exp_f32 v143, v143
NC 60,60,168
v_accvgpr_write_b32 a203, v99
NC 116,60,176
ds_read_b128 v[56:59], v116 offset:14336
CV 138,140,141
CV 139,142,143
NC 124,60,184
v_exp_f32 v144, v144
v_mfma_f32_16x16x32_bf16 v[184:187], v[32:35], a[164:167], v[76:79]
ds_read_b128 v[60:63], v117 offset:14336
NA 184,36,172
v_exp_f32 v145, v145
v_mfma_f32_16x16x32_bf16 v[176:179], v[32:35], a[160:163], v[72:75]
v_exp_f32 v146, v146
NA 176,36,168
v_exp_f32 v147, v147
v_mfma_f32_16x16x32_bf16 v[168:171], v[32:35], a[132:135], v[68:71]
v_accvgpr_write_b32 a204, v100
NA 168,36,140
CV 144,144,145
v_mfma_f32_16x16x32_bf16 v[160:163], v[32:35], a[128:131], v[64:67]
v_accvgpr_write_b32 a205, v101
CV 145,146,147
NA 160,36,136
v_exp_f32 v148, v148
s_waitcnt lgkmcnt(0)
NA 160,40,144
R 32,3,24576
NA 160,44,152
v_exp_f32 v149, v149
NA 168,40,148
R 34,3,26624
v_exp_f32 v150, v150
NA 168,44,156
R 36,2,24576
NA 176,40,176
R 38,2,26624
NA 176,44,184
v_exp_f32 v151, v151
NA 184,40,180
CV 146,148,149
v_accvgpr_write_b32 a206, v102
CV 147,150,151
NA 184,44,188
v_exp_f32 v152, v152
v_mfma_f32_16x16x32_bf16 v[188:191], v[48:51], a[164:167], v[76:79]
R 40,4,24576
NA 188,52,172
v_exp_f32 v153, v153
v_mfma_f32_16x16x32_bf16 v[180:183], v[48:51], a[160:163], v[72:75]
R 42,4,26624
v_exp_f32 v154, v154
NA 180,52,168
R 44,5,24576
v_mfma_f32_16x16x32_bf16 v[172:175], v[48:51], a[132:135], v[68:71]
R 46,5,26624
NA 172,52,140
v_exp_f32 v155, v155
v_mfma_f32_16x16x32_bf16 v[164:167], v[48:51], a[128:131], v[64:67]
v_accvgpr_write_b32 a207, v103
CV 152,152,153
NA 164,52,136
CV 153,154,155
NA 164,56,144
buffer_load_dwordx4 v12, s[12:15], s75 offen offset:1024 lds
v_exp_f32 v156, v156
NA 164,60,152
v_exp_f32 v157, v157
NA 172,56,148
R 48,3,32768
NA 172,60,156
v_exp_f32 v158, v158
NA 180,56,176
R 50,3,34816
NA 180,60,184
v_exp_f32 v159, v159
NA 188,56,180
R 52,2,32768
CV 154,156,157
NA 188,60,188
CV 155,158,159
s_waitcnt lgkmcnt(3)
NC 0,32,128
R 54,2,34816
v_exp_f32 v160, v160
NC 8,32,136
v_exp_f32 v161, v161
NC 64,32,144
R 56,4,32768
NC 72,32,152
v_exp_f32 v162, v162
NC 4,36,128
R 58,4,34816
buffer_load_dwordx4 v13, s[12:15], s75 offen offset:2048 lds
NC 12,36,136
NC 68,36,144
R 60,5,32768
NC 76,36,152
v_exp_f32 v163, v163
NC 16,40,128
R 62,5,34816
CV 160,160,161
CV 161,162,163
NC 24,40,136
v_exp_f32 v164, v164
NC 80,40,144
ds_read_b128 v[32:35], v116 offset:16384
NC 88,40,152
ds_read_b128 v[36:39], v117 offset:16384
NC 20,44,128
v_exp_f32 v165, v165
NC 28,44,136
v_exp_f32 v166, v166
NC 84,44,144
buffer_load_dwordx4 v14, s[12:15], s75 offen offset:3072 lds
NC 92,44,152
v_exp_f32 v167, v167
NV 80,124,128
CV 162,164,165
CV 163,166,167
NV 84,124,136
v_exp_f32 v168, v168
NV 88,124,144
ds_read_b128 v[40:43], v116 offset:20480
NV 92,124,152
ds_read_b128 v[44:47], v117 offset:20480
s_waitcnt lgkmcnt(2)
NC 32,48,128
v_exp_f32 v169, v169
NC 40,48,136
v_exp_f32 v170, v170
NC 96,48,144
v_exp_f32 v171, v171
NC 104,48,152
CV 168,168,169
NC 36,52,128
CV 169,170,171
NC 44,52,136
v_exp_f32 v172, v172
NC 100,52,144
s_waitcnt vmcnt(8)
s_barrier
ds_read_b128 v[48:51], v116 offset:18432
NC 108,52,152
NC 48,56,128
ds_read_b128 v[52:55], v117 offset:18432
v_exp_f32 v173, v173
NC 56,56,136
s_add_u32 m0, s68, 36864
s_add_u32 s75, s62, 0
NC 112,56,144
buffer_load_dwordx4 v15, s[8:11], s75 offen offset:0 lds
NC 120,56,152
v_exp_f32 v174, v174
NC 52,60,128
v_exp_f32 v175, v175
NC 60,60,136
NC 116,60,144
ds_read_b128 v[56:59], v116 offset:22528
CV 170,172,173
CV 171,174,175
NC 124,60,152
v_exp_f32 v176, v176
v_mfma_f32_16x16x32_bf16 v[152:155], v[32:35], a[164:167], v[76:79]
ds_read_b128 v[60:63], v117 offset:22528
NA 152,36,172
v_exp_f32 v177, v177
v_mfma_f32_16x16x32_bf16 v[144:147], v[32:35], a[160:163], v[72:75]
v_exp_f32 v178, v178
NA 144,36,168
v_mfma_f32_16x16x32_bf16 v[136:139], v[32:35], a[132:135], v[68:71]
v_exp_f32 v179, v179
NA 136,36,140
CV 176,176,177
CV 177,178,179
v_mfma_f32_16x16x32_bf16 v[128:131], v[32:35], a[128:131], v[64:67]
v_exp_f32 v180, v180
NA 128,36,136
v_exp_f32 v181, v181
s_waitcnt lgkmcnt(0)
NA 128,40,144
R 32,3,28672
NA 128,44,152
v_exp_f32 v182, v182
NA 136,40,148
R 34,3,30720
NA 136,44,156
R 36,2,28672
NA 144,40,176
R 38,2,30720
v_exp_f32 v183, v183
NA 144,44,184
CV 178,180,181
NA 152,40,180
CV 179,182,183
NA 152,44,188
v_exp_f32 v184, v184
v_mfma_f32_16x16x32_bf16 v[156:159], v[48:51], a[164:167], v[76:79]
R 40,4,28672
NA 156,52,172
v_exp_f32 v185, v185
v_mfma_f32_16x16x32_bf16 v[148:151], v[48:51], a[160:163], v[72:75]
R 42,4,30720
v_exp_f32 v186, v186
NA 148,52,168
R 44,5,28672
v_mfma_f32_16x16x32_bf16 v[140:143], v[48:51], a[132:135], v[68:71]
R 46,5,30720
NA 140,52,140
v_exp_f32 v187, v187
v_mfma_f32_16x16x32_bf16 v[132:135], v[48:51], a[128:131], v[64:67]
CV 184,184,185
CV 185,186,187
NA 132,52,136
v_exp_f32 v188, v188
NA 132,56,144
v_exp_f32 v189, v189
NA 132,60,152
NA 140,56,148
R 48,3,36864
buffer_load_dwordx4 v16, s[8:11], s75 offen offset:1024 lds
NA 140,60,156
v_exp_f32 v190, v190
NA 148,56,176
R 50,3,38912
NA 148,60,184
v_exp_f32 v191, v191
NA 156,56,180
R 52,2,36864
CV 186,188,189
NA 156,60,188
CV 187,190,191
s_waitcnt lgkmcnt(3)
NC 0,32,160
R 54,2,38912
NC 8,32,168
v_exp_f32 v128, v128
NC 64,32,176
R 56,4,36864
v_exp_f32 v129, v129
NC 72,32,184
v_exp_f32 v130, v130
NC 4,36,160
R 58,4,38912
NC 12,36,168
v_exp_f32 v131, v131
NC 68,36,176
R 60,5,36864
buffer_load_dwordx4 v17, s[8:11], s75 offen offset:2048 lds
LA_pad8:
s_cbranch_execz LA_pad12
NC 76,36,184
NC 16,40,160
R 62,5,38912
CV 128,128,129
NC 24,40,168
CV 129,130,131
NC 80,40,176
ds_read_b128 v[32:35], v116 offset:45056
v_exp_f32 v132, v132
NC 88,40,184
ds_read_b128 v[36:39], v117 offset:45056
NC 20,44,160
v_exp_f32 v133, v133
NC 28,44,168
v_exp_f32 v134, v134
NC 84,44,176
v_exp_f32 v135, v135
NC 92,44,184
NV 80,124,160
buffer_load_dwordx4 v18, s[8:11], s75 offen offset:3072 lds
CV 130,132,133
NV 84,124,168
CV 131,134,135
NV 88,124,176
ds_read_b128 v[40:43], v116 offset:49152
v_exp_f32 v136, v136
NV 92,124,184
ds_read_b128 v[44:47], v117 offset:49152
s_waitcnt lgkmcnt(2)
NC 32,48,160
v_exp_f32 v137, v137
NC 40,48,168
v_exp_f32 v138, v138
NC 96,48,176
v_exp_f32 v139, v139
NC 104,48,184
NC 36,52,160
CV 136,136,137
CV 137,138,139
NC 44,52,168
v_exp_f32 v140, v140
s_add_u32 s100, s100, 4096
s_addc_u32 s101, s101, 0
NC 100,52,176
ds_read_b128 v[48:51], v116 offset:47104
global_load_dword v0, v23, s[100:101]
NC 108,52,184
s_add_u32 m0, s68, 53248
s_add_u32 s75, s61, 114688
NC 48,56,160
ds_read_b128 v[52:55], v117 offset:47104
buffer_load_dwordx4 v11, s[12:15], s75 offen offset:0 lds
NC 56,56,168
v_exp_f32 v141, v141
NC 112,56,176
v_exp_f32 v142, v142
NC 120,56,184
NC 52,60,160
v_exp_f32 v143, v143
NC 60,60,168
CV 138,140,141
CV 139,142,143
NC 116,60,176
ds_read_b128 v[56:59], v116 offset:51200
NC 124,60,184
v_exp_f32 v144, v144
v_mfma_f32_16x16x32_bf16 v[184:187], v[32:35], a[164:167], v[76:79]
ds_read_b128 v[60:63], v117 offset:51200
NA 184,36,172
v_exp_f32 v145, v145
v_mfma_f32_16x16x32_bf16 v[176:179], v[32:35], a[160:163], v[72:75]
v_exp_f32 v146, v146
NA 176,36,168
v_exp_f32 v147, v147
v_mfma_f32_16x16x32_bf16 v[168:171], v[32:35], a[132:135], v[68:71]
CV 144,144,145
NA 168,36,140
CV 145,146,147
v_mfma_f32_16x16x32_bf16 v[160:163], v[32:35], a[128:131], v[64:67]
v_exp_f32 v148, v148
NA 160,36,136
v_exp_f32 v149, v149
s_waitcnt lgkmcnt(0)
NA 160,40,144
R 32,3,61440
NA 160,44,152
v_exp_f32 v150, v150
NA 168,40,148
R 34,3,63488
v_exp_f32 v151, v151
NA 168,44,156
R 36,2,61440
NA 176,40,176
R 38,2,63488
NA 176,44,184
CV 146,148,149
NA 184,40,180
CV 147,150,151
NA 184,44,188
v_exp_f32 v152, v152
v_mfma_f32_16x16x32_bf16 v[188:191], v[48:51], a[164:167], v[76:79]
R 40,4,61440
v_exp_f32 v153, v153
NA 188,52,172
v_exp_f32 v154, v154
v_mfma_f32_16x16x32_bf16 v[180:183], v[48:51], a[160:163], v[72:75]
R 42,4,63488
NA 180,52,168
R 44,5,61440
v_mfma_f32_16x16x32_bf16 v[172:175], v[48:51], a[132:135], v[68:71]
R 46,5,63488
NA 172,52,140
v_exp_f32 v155, v155
v_mfma_f32_16x16x32_bf16 v[164:167], v[48:51], a[128:131], v[64:67]
CV 152,152,153
CV 153,154,155
NA 164,52,136
v_exp_f32 v156, v156
NA 164,56,144
buffer_load_dwordx4 v12, s[12:15], s75 offen offset:1024 lds
NA 164,60,152
v_exp_f32 v157, v157
NA 172,56,148
R 48,6,4096
NA 172,60,156
v_exp_f32 v158, v158
NA 180,56,176
R 50,6,6144
NA 180,60,184
v_exp_f32 v159, v159
NA 188,56,180
R 52,7,4096
CV 154,156,157
NA 188,60,188
CV 155,158,159
s_waitcnt lgkmcnt(3)
NC 0,32,128
R 54,7,6144
v_exp_f32 v160, v160
NC 8,32,136
v_exp_f32 v161, v161
NC 64,32,144
R 56,8,4096
NC 72,32,152
v_exp_f32 v162, v162
NC 4,36,128
R 58,8,6144
buffer_load_dwordx4 v13, s[12:15], s75 offen offset:2048 lds
NC 12,36,136
NC 68,36,144
R 60,9,4096
v_exp_f32 v163, v163
NC 76,36,152
CV 160,160,161
NC 16,40,128
R 62,9,6144
CV 161,162,163
NC 24,40,136
v_exp_f32 v164, v164
NC 80,40,144
ds_read_b128 v[32:35], v116 offset:53248
NC 88,40,152
ds_read_b128 v[36:39], v117 offset:53248
NC 20,44,128
v_exp_f32 v165, v165
NC 28,44,136
v_exp_f32 v166, v166
NC 84,44,144
buffer_load_dwordx4 v14, s[12:15], s75 offen offset:3072 lds
NC 92,44,152
v_exp_f32 v167, v167
NV 80,124,128
CV 162,164,165
s_sub_u32 s71, s80, 42598432
v_mov_b32 v115, s71
NV 84,124,136
CV 163,166,167
NV 88,124,144
ds_read_b128 v[40:43], v116 offset:57344
v_exp_f32 v168, v168
NV 92,124,152
ds_read_b128 v[44:47], v117 offset:57344
s_waitcnt lgkmcnt(2)
NC 32,48,128
v_exp_f32 v169, v169
NC 40,48,136
NC 96,48,144
v_exp_f32 v170, v170
NC 104,48,152
v_exp_f32 v171, v171
NC 36,52,128
CV 168,168,169
CV 169,170,171
NC 44,52,136
v_exp_f32 v172, v172
NC 100,52,144
s_waitcnt vmcnt(9)
s_barrier
ds_read_b128 v[48:51], v116 offset:55296
NC 108,52,152
NC 48,56,128
ds_read_b128 v[52:55], v117 offset:55296
NC 56,56,136
s_add_u32 m0, s68, 73728
s_add_u32 s75, s60, 532480
NC 112,56,144
buffer_load_dwordx4 v15, s[8:11], s75 offen offset:0 lds
NC 120,56,152
v_exp_f32 v173, v173
NC 52,60,128
v_exp_f32 v174, v174
NC 60,60,136
v_exp_f32 v175, v175
NC 116,60,144
ds_read_b128 v[56:59], v116 offset:59392
CV 170,172,173
NC 124,60,152
CV 171,174,175
v_mfma_f32_16x16x32_bf16 v[152:155], v[32:35], a[164:167], v[76:79]
ds_read_b128 v[60:63], v117 offset:59392
NA 152,36,172
v_exp_f32 v176, v176
v_mfma_f32_16x16x32_bf16 v[144:147], v[32:35], a[160:163], v[72:75]
v_exp_f32 v177, v177
NA 144,36,168
v_exp_f32 v178, v178
v_mfma_f32_16x16x32_bf16 v[136:139], v[32:35], a[132:135], v[68:71]
v_exp_f32 v179, v179
NA 136,36,140
CV 176,176,177
v_mfma_f32_16x16x32_bf16 v[128:131], v[32:35], a[128:131], v[64:67]
CV 177,178,179
NA 128,36,136
v_exp_f32 v180, v180
s_waitcnt lgkmcnt(0)
NA 128,40,144
R 32,6,0
v_exp_f32 v181, v181
NA 128,44,152
v_exp_f32 v182, v182
NA 136,40,148
R 34,6,2048
NA 136,44,156
R 36,7,0
NA 144,40,176
R 38,7,2048
NA 144,44,184
v_exp_f32 v183, v183
NA 152,40,180
CV 178,180,181
CV 179,182,183
NA 152,44,188
v_exp_f32 v184, v184
v_mfma_f32_16x16x32_bf16 v[156:159], v[48:51], a[164:167], v[76:79]
R 40,8,0
NA 156,52,172
v_exp_f32 v185, v185
v_mfma_f32_16x16x32_bf16 v[148:151], v[48:51], a[160:163], v[72:75]
R 42,8,2048
v_exp_f32 v186, v186
NA 148,52,168
R 44,9,0
v_mfma_f32_16x16x32_bf16 v[140:143], v[48:51], a[132:135], v[68:71]
R 46,9,2048
NA 140,52,140
v_exp_f32 v187, v187
v_mfma_f32_16x16x32_bf16 v[132:135], v[48:51], a[128:131], v[64:67]
CV 184,184,185
CV 185,186,187
NA 132,52,136
v_exp_f32 v188, v188
NA 132,56,144
v_exp_f32 v189, v189
NA 132,60,152
NA 140,56,148
R 48,6,8192
buffer_load_dwordx4 v16, s[8:11], s75 offen offset:1024 lds
NA 140,60,156
v_exp_f32 v190, v190
NA 148,56,176
R 50,6,10240
NA 148,60,184
v_exp_f32 v191, v191
NA 156,56,180
R 52,7,8192
CV 186,188,189
NA 156,60,188
CV 187,190,191
s_waitcnt lgkmcnt(3)
NC 0,32,160
R 54,7,10240
NC 8,32,168
v_exp_f32 v128, v128
NC 64,32,176
R 56,8,8192
v_exp_f32 v129, v129
NC 72,32,184
v_exp_f32 v130, v130
NC 4,36,160
R 58,8,10240
NC 12,36,168
v_exp_f32 v131, v131
NC 68,36,176
R 60,9,8192
buffer_load_dwordx4 v17, s[8:11], s75 offen offset:2048 lds
NC 76,36,184
NC 16,40,160
R 62,9,10240
CV 128,128,129
NC 24,40,168
CV 129,130,131
NC 80,40,176
ds_read_b128 v[32:35], v112 offset:0
v_exp_f32 v132, v132
NC 88,40,184
ds_read_b128 v[36:39], v113 offset:0
NC 20,44,160
v_exp_f32 v133, v133
NC 28,44,168
v_exp_f32 v134, v134
NC 84,44,176
v_exp_f32 v135, v135
NC 92,44,184
NV 80,124,160
buffer_load_dwordx4 v18, s[8:11], s75 offen offset:3072 lds
CV 130,132,133
NV 84,124,168
CV 131,134,135
NV 88,124,176
ds_read_b128 v[40:43], v112 offset:4096
v_exp_f32 v136, v136
NV 92,124,184
ds_read_b128 v[44:47], v113 offset:4096
s_waitcnt lgkmcnt(2)
NC 32,48,160
v_exp_f32 v137, v137
NC 40,48,168
v_exp_f32 v138, v138
NC 96,48,176
v_exp_f32 v139, v139
NC 104,48,184
NC 36,52,160
CV 136,136,137
CV 137,138,139
NC 44,52,168
v_exp_f32 v140, v140
NC 100,52,176
ds_read_b128 v[48:51], v112 offset:2048
NC 108,52,184
s_add_u32 m0, s68, 90112
s_add_u32 s75, s61, 524288
NC 48,56,160
ds_read_b128 v[52:55], v113 offset:2048
buffer_load_dwordx4 v11, s[12:15], s75 offen offset:0 lds
NC 56,56,168
v_exp_f32 v141, v141
NC 112,56,176
v_exp_f32 v142, v142
NC 120,56,184
NC 52,60,160
v_exp_f32 v143, v143
NC 60,60,168
CV 138,140,141
CV 139,142,143
NC 116,60,176
ds_read_b128 v[56:59], v112 offset:6144
NC 124,60,184
v_exp_f32 v144, v144
v_mfma_f32_16x16x32_bf16 v[184:187], v[32:35], a[164:167], v[76:79]
ds_read_b128 v[60:63], v113 offset:6144
NA 184,36,172
v_exp_f32 v145, v145
v_mfma_f32_16x16x32_bf16 v[176:179], v[32:35], a[160:163], v[72:75]
v_exp_f32 v146, v146
NA 176,36,168
v_exp_f32 v147, v147
v_mfma_f32_16x16x32_bf16 v[168:171], v[32:35], a[132:135], v[68:71]
CV 144,144,145
NA 168,36,140
CV 145,146,147
v_mfma_f32_16x16x32_bf16 v[160:163], v[32:35], a[128:131], v[64:67]
v_exp_f32 v148, v148
NA 160,36,136
v_exp_f32 v149, v149
s_waitcnt lgkmcnt(0)
NA 160,40,144
R 32,19,16384
NA 160,44,152
v_exp_f32 v150, v150
NA 168,40,148
R 34,19,18432
v_exp_f32 v151, v151
NA 168,44,156
R 36,20,16384
NA 176,40,176
R 38,20,18432
NA 176,44,184
CV 146,148,149
NA 184,40,180
CV 147,150,151
NA 184,44,188
v_exp_f32 v152, v152
v_mfma_f32_16x16x32_bf16 v[188:191], v[48:51], a[164:167], v[76:79]
R 40,21,16384
v_exp_f32 v153, v153
NA 188,52,172
v_exp_f32 v154, v154
v_mfma_f32_16x16x32_bf16 v[180:183], v[48:51], a[160:163], v[72:75]
R 42,21,18432
NA 180,52,168
R 44,22,16384
v_mfma_f32_16x16x32_bf16 v[172:175], v[48:51], a[132:135], v[68:71]
R 46,22,18432
NA 172,52,140
v_exp_f32 v155, v155
v_mfma_f32_16x16x32_bf16 v[164:167], v[48:51], a[128:131], v[64:67]
CV 152,152,153
CV 153,154,155
NA 164,52,136
v_exp_f32 v156, v156
NA 164,56,144
buffer_load_dwordx4 v12, s[12:15], s75 offen offset:1024 lds
NA 164,60,152
v_exp_f32 v157, v157
NA 172,56,148
R 48,19,24576
NA 172,60,156
v_exp_f32 v158, v158
NA 180,56,176
R 50,19,26624
NA 180,60,184
v_exp_f32 v159, v159
NA 188,56,180
R 52,20,24576
CV 154,156,157
NA 188,60,188
CV 155,158,159
s_waitcnt lgkmcnt(3)
NC 0,32,128
R 54,20,26624
v_exp_f32 v160, v160
NC 8,32,136
v_exp_f32 v161, v161
NC 64,32,144
R 56,21,24576
NC 72,32,152
v_exp_f32 v162, v162
NC 4,36,128
R 58,21,26624
buffer_load_dwordx4 v13, s[12:15], s75 offen offset:2048 lds
NC 12,36,136
NC 68,36,144
R 60,22,24576
NC 76,36,152
v_exp_f32 v163, v163
NC 16,40,128
R 62,22,26624
CV 160,160,161
CV 161,162,163
NC 24,40,136
v_exp_f32 v164, v164
NC 80,40,144
ds_read_b128 v[32:35], v112 offset:8192
NC 88,40,152
ds_read_b128 v[36:39], v113 offset:8192
NC 20,44,128
v_exp_f32 v165, v165
NC 28,44,136
v_exp_f32 v166, v166
NC 84,44,144
buffer_load_dwordx4 v14, s[12:15], s75 offen offset:3072 lds
NC 92,44,152
v_exp_f32 v167, v167
NV 80,124,128
CV 162,164,165
CV 163,166,167
NV 84,124,136
v_exp_f32 v168, v168
NV 88,124,144
ds_read_b128 v[40:43], v112 offset:12288
NV 92,124,152
ds_read_b128 v[44:47], v113 offset:12288
s_waitcnt lgkmcnt(2)
NC 32,48,128
v_exp_f32 v169, v169
NC 40,48,136
v_exp_f32 v170, v170
NC 96,48,144
v_exp_f32 v171, v171
NC 104,48,152
CV 168,168,169
NC 36,52,128
CV 169,170,171
NC 44,52,136
v_exp_f32 v172, v172
NC 100,52,144
s_waitcnt vmcnt(8)
s_barrier
ds_read_b128 v[48:51], v112 offset:10240
NC 108,52,152
NC 48,56,128
ds_read_b128 v[52:55], v113 offset:10240
v_exp_f32 v173, v173
NC 56,56,136
s_add_u32 m0, s68, 110592
s_add_u32 s75, s60, 548864
NC 112,56,144
buffer_load_dwordx4 v15, s[8:11], s75 offen offset:0 lds
NC 120,56,152
v_exp_f32 v174, v174
NC 52,60,128
v_exp_f32 v175, v175
NC 60,60,136
NC 116,60,144
ds_read_b128 v[56:59], v112 offset:14336
CV 170,172,173
CV 171,174,175
NC 124,60,152
v_exp_f32 v176, v176
v_mfma_f32_16x16x32_bf16 v[152:155], v[32:35], a[164:167], v[76:79]
ds_read_b128 v[60:63], v113 offset:14336
NA 152,36,172
v_exp_f32 v177, v177
v_mfma_f32_16x16x32_bf16 v[144:147], v[32:35], a[160:163], v[72:75]
v_exp_f32 v178, v178
NA 144,36,168
v_mfma_f32_16x16x32_bf16 v[136:139], v[32:35], a[132:135], v[68:71]
v_exp_f32 v179, v179
NA 136,36,140
CV 176,176,177
CV 177,178,179
v_mfma_f32_16x16x32_bf16 v[128:131], v[32:35], a[128:131], v[64:67]
v_exp_f32 v180, v180
NA 128,36,136
v_exp_f32 v181, v181
s_waitcnt lgkmcnt(0)
NA 128,40,144
R 32,19,20480
NA 128,44,152
v_exp_f32 v182, v182
NA 136,40,148
R 34,19,22528
NA 136,44,156
R 36,20,20480
NA 144,40,176
R 38,20,22528
v_exp_f32 v183, v183
NA 144,44,184
CV 178,180,181
NA 152,40,180
CV 179,182,183
NA 152,44,188
v_exp_f32 v184, v184
v_mfma_f32_16x16x32_bf16 v[156:159], v[48:51], a[164:167], v[76:79]
R 40,21,20480
NA 156,52,172
v_exp_f32 v185, v185
v_mfma_f32_16x16x32_bf16 v[148:151], v[48:51], a[160:163], v[72:75]
R 42,21,22528
v_exp_f32 v186, v186
NA 148,52,168
R 44,22,20480
v_mfma_f32_16x16x32_bf16 v[140:143], v[48:51], a[132:135], v[68:71]
R 46,22,22528
NA 140,52,140
v_exp_f32 v187, v187
v_mfma_f32_16x16x32_bf16 v[132:135], v[48:51], a[128:131], v[64:67]
CV 184,184,185
CV 185,186,187
NA 132,52,136
v_exp_f32 v188, v188
NA 132,56,144
v_exp_f32 v189, v189
NA 132,60,152
NA 140,56,148
R 48,19,28672
buffer_load_dwordx4 v16, s[8:11], s75 offen offset:1024 lds
NA 140,60,156
v_exp_f32 v190, v190
NA 148,56,176
R 50,19,30720
LA_pad9:
s_cbranch_execz LA_ret
NA 148,60,184
v_exp_f32 v191, v191
NA 156,56,180
R 52,20,28672
CV 186,188,189
NA 156,60,188
CV 187,190,191
s_waitcnt lgkmcnt(3)
NC 0,32,160
R 54,20,30720
v_exp_f32 v128, v128
NC 8,32,168
v_exp_f32 v129, v129
NC 64,32,176
R 56,21,28672
NC 72,32,184
v_exp_f32 v130, v130
NC 4,36,160
R 58,21,30720
NC 12,36,168
v_exp_f32 v131, v131
NC 68,36,176
R 60,22,28672
buffer_load_dwordx4 v17, s[8:11], s75 offen offset:2048 lds
NC 76,36,184
CV 128,128,129
NC 16,40,160
R 62,22,30720
CV 129,130,131
NC 24,40,168
v_exp_f32 v132, v132
NC 80,40,176
ds_read_b128 v[32:35], v112 offset:36864
s_mov_b32 s81, 42614784
NC 88,40,184
ds_read_b128 v[36:39], v113 offset:36864
NC 20,44,160
buffer_load_dword v31, v115, s[48:51], s81 offen sc1
v_exp_f32 v133, v133
NC 28,44,168
v_exp_f32 v134, v134
NC 84,44,176
v_exp_f32 v135, v135
NC 92,44,184
s_add_u32 s100, s100, 4096
s_addc_u32 s101, s101, 0
NV 80,124,160
global_load_dword v0, v23, s[100:101]
buffer_load_dwordx4 v18, s[8:11], s75 offen offset:3072 lds
CV 130,132,133
CV 131,134,135
NV 84,124,168
v_exp_f32 v136, v136
NV 88,124,176
ds_read_b128 v[40:43], v112 offset:40960
NV 92,124,184
ds_read_b128 v[44:47], v113 offset:40960
s_waitcnt lgkmcnt(2)
NC 32,48,160
v_exp_f32 v137, v137
NC 40,48,168
v_exp_f32 v138, v138
NC 96,48,176
v_exp_f32 v139, v139
NC 104,48,184
CV 136,136,137
NC 36,52,160
CV 137,138,139
NC 44,52,168
v_exp_f32 v140, v140
NC 100,52,176
ds_read_b128 v[48:51], v112 offset:38912
v_exp_f32 v141, v141
NC 108,52,184
s_add_u32 m0, s68, 126976
s_add_u32 s75, s61, 540672
NC 48,56,160
ds_read_b128 v[52:55], v113 offset:38912
buffer_load_dwordx4 v11, s[12:15], s75 offen offset:0 lds
NC 56,56,168
v_exp_f32 v142, v142
NC 112,56,176
v_exp_f32 v143, v143
NC 120,56,184
NC 52,60,160
CV 138,140,141
CV 139,142,143
NC 60,60,168
v_exp_f32 v144, v144
NC 116,60,176
ds_read_b128 v[56:59], v112 offset:43008
NC 124,60,184
v_exp_f32 v145, v145
v_mfma_f32_16x16x32_bf16 v[184:187], v[32:35], a[164:167], v[76:79]
ds_read_b128 v[60:63], v113 offset:43008
v_exp_f32 v146, v146
NA 184,36,172
v_exp_f32 v147, v147
v_mfma_f32_16x16x32_bf16 v[176:179], v[32:35], a[160:163], v[72:75]
CV 144,144,145
NA 176,36,168
CV 145,146,147
v_mfma_f32_16x16x32_bf16 v[168:171], v[32:35], a[132:135], v[68:71]
v_exp_f32 v148, v148
NA 168,36,140
v_exp_f32 v149, v149
v_mfma_f32_16x16x32_bf16 v[160:163], v[32:35], a[128:131], v[64:67]
v_exp_f32 v150, v150
NA 160,36,136
v_exp_f32 v151, v151
s_waitcnt lgkmcnt(0)
NA 160,40,144
R 32,19,53248
NA 160,44,152
CV 146,148,149
NA 168,40,148
R 34,19,55296
CV 147,150,151
NA 168,44,156
R 36,20,53248
v_exp_f32 v152, v152
NA 176,40,176
R 38,20,55296
NA 176,44,184
v_exp_f32 v153, v153
NA 184,40,180
v_exp_f32 v154, v154
NA 184,44,188
v_exp_f32 v155, v155
v_mfma_f32_16x16x32_bf16 v[188:191], v[48:51], a[164:167], v[76:79]
R 40,21,53248
s_waitcnt vmcnt(3)
v_cmp_ne_u32 vcc, 0x10000, v31
s_nop 1
s_cbranch_vccnz LA_poll1
LA_ok1:
NA 188,52,172
v_mfma_f32_16x16x32_bf16 v[180:183], v[48:51], a[160:163], v[72:75]
R 42,21,55296
s_add_u32 s83, s78, 4849664
NA 180,52,168
R 44,22,53248
v_mfma_f32_16x16x32_bf16 v[172:175], v[48:51], a[132:135], v[68:71]
R 46,22,55296
buffer_load_dwordx4 a[208:211], v23, s[48:51], s83 offen offset:0 sc1
NA 172,52,140
CV 152,152,153
v_mfma_f32_16x16x32_bf16 v[164:167], v[48:51], a[128:131], v[64:67]
CV 153,154,155
NA 164,52,136
v_exp_f32 v156, v156
NA 164,56,144
buffer_load_dwordx4 v12, s[12:15], s75 offen offset:1024 lds
v_exp_f32 v157, v157
NA 164,60,152
v_exp_f32 v158, v158
NA 172,56,148
R 48,19,61440
buffer_load_dwordx4 a[212:215], v23, s[48:51], s83 offen offset:1024 sc1
NA 172,60,156
NA 180,56,176
R 50,19,63488
v_exp_f32 v159, v159
NA 180,60,184
CV 154,156,157
NA 188,56,180
R 52,20,61440
buffer_load_dwordx4 a[216:219], v23, s[48:51], s83 offen offset:2048 sc1
NA 188,60,188
CV 155,158,159
s_waitcnt lgkmcnt(3)
NC 0,32,128
R 54,20,63488
v_exp_f32 v160, v160
NC 8,32,136
v_exp_f32 v161, v161
v_exp_f32 v162, v162
NC 64,32,144
R 56,21,61440
buffer_load_dwordx4 a[220:223], v23, s[48:51], s83 offen offset:3072 sc1
v_exp_f32 v163, v163
NC 72,32,152
CV 160,160,161
CV 161,162,163
NC 4,36,128
R 58,21,63488
buffer_load_dwordx4 v13, s[12:15], s75 offen offset:2048 lds
v_exp_f32 v164, v164
NC 12,36,136
v_exp_f32 v165, v165
s_add_u32 s83, s78, 4853760
NC 68,36,144
R 60,22,61440
buffer_load_dwordx4 a[224:227], v23, s[48:51], s83 offen offset:0 sc1
v_exp_f32 v166, v166
NC 76,36,152
v_exp_f32 v167, v167
NC 16,40,128
R 62,22,63488
CV 162,164,165
CV 163,166,167
NC 24,40,136
v_exp_f32 v168, v168
v_exp_f32 v169, v169
NC 80,40,144
R 32,19,57344
v_exp_f32 v170, v170
NC 88,40,152
v_exp_f32 v171, v171
CV 168,168,169
NC 20,44,128
R 34,19,59392
CV 169,170,171
v_exp_f32 v172, v172
NC 28,44,136
v_exp_f32 v173, v173
NC 84,44,144
R 36,20,57344
buffer_load_dwordx4 a[228:231], v23, s[48:51], s83 offen offset:1024 sc1
buffer_load_dwordx4 v14, s[12:15], s75 offen offset:3072 lds
NC 92,44,152
v_exp_f32 v174, v174
v_exp_f32 v175, v175
NV 80,124,128
R 38,20,59392
CV 170,172,173
CV 171,174,175
NV 84,124,136
v_exp_f32 v176, v176
v_exp_f32 v177, v177
NV 88,124,144
R 40,21,57344
buffer_load_dwordx4 a[232:235], v23, s[48:51], s83 offen offset:2048 sc1
v_exp_f32 v178, v178
NV 92,124,152
v_exp_f32 v179, v179
s_waitcnt lgkmcnt(2)
NC 32,48,128
R 42,21,59392
CV 176,176,177
CV 177,178,179
NC 40,48,136
v_exp_f32 v180, v180
NC 96,48,144
R 44,22,57344
buffer_load_dwordx4 a[236:239], v23, s[48:51], s83 offen offset:3072 sc1
v_exp_f32 v181, v181
NC 104,48,152
v_exp_f32 v182, v182
v_exp_f32 v183, v183
NC 36,52,128
R 46,22,59392
CV 178,180,181
CV 179,182,183
NC 44,52,136
v_exp_f32 v184, v184
s_add_u32 s83, s78, 4857856
NC 100,52,144
s_barrier
buffer_load_dwordx4 a[240:243], v23, s[48:51], s83 offen offset:0 sc1
NC 108,52,152
NC 48,56,128
v_exp_f32 v185, v185
NC 56,56,136
v_exp_f32 v186, v186
s_add_u32 m0, s68, 0
s_add_u32 s75, s60, 565248
NC 112,56,144
R 48,3,0
buffer_load_dwordx4 v15, s[8:11], s75 offen offset:0 lds
v_exp_f32 v187, v187
NC 120,56,152
CV 184,184,185
CV 185,186,187
v_exp_f32 v188, v188
NC 52,60,128
R 50,3,2048
v_exp_f32 v189, v189
NC 60,60,136
v_exp_f32 v190, v190
NC 116,60,144
R 52,2,0
buffer_load_dwordx4 a[244:247], v23, s[48:51], s83 offen offset:1024 sc1
v_exp_f32 v191, v191
NC 124,60,152
CV 186,188,189
CV 187,190,191
NC 0,32,160
R 54,2,2048
NC 8,32,168
NC 64,32,176
R 56,4,0
buffer_load_dwordx4 a[248:251], v23, s[48:51], s83 offen offset:2048 sc1
NC 72,32,184
s_waitcnt lgkmcnt(3)
NC 4,36,160
R 58,4,2048
NC 12,36,168
NC 68,36,176
R 60,5,0
buffer_load_dwordx4 a[252:255], v23, s[48:51], s83 offen offset:3072 sc1
NC 76,36,184
NC 16,40,160
R 62,5,2048
NC 24,40,168
NC 80,40,176
ds_read_b128 v[32:35], v112 offset:45056
NC 88,40,184
NC 20,44,160
NC 28,44,168
NC 84,44,176
ds_read_b128 v[36:39], v112 offset:47104
NC 92,44,184
NV 80,124,160
NV 84,124,168
NV 88,124,176
ds_read_b128 v[40:43], v113 offset:45056
NV 92,124,184
NC 32,48,160
NC 40,48,168
NC 96,48,176
ds_read_b128 v[44:47], v113 offset:47104
NC 104,48,184
s_waitcnt lgkmcnt(2)
NC 36,52,160
NC 44,52,168
NC 100,52,176
ds_read_b128 v[48:51], v112 offset:49152
buffer_load_dwordx4 v16, s[8:11], s75 offen offset:1024 lds
NC 108,52,184
NC 48,56,160
NC 56,56,168
NC 112,56,176
ds_read_b128 v[52:55], v112 offset:51200
NC 120,56,184
NC 52,60,160
NC 60,60,168
NC 116,60,176
ds_read_b128 v[56:59], v113 offset:49152
NC 124,60,184
v_mov_b32 v24, v80
v_mov_b32 v25, v84
v_mov_b32 v26, v88
v_mov_b32 v27, v92
v_add_f32 v80, v24, v25
v_add_f32 v81, v26, v27
v_add_f32 v80, v80, v81
v_cmp_ngt_f32 vcc, 0x49800000, v80
s_nop 1
s_cbranch_vccnz LA_slow0
LA_slowret0:
v_rcp_f32 v120, v24
v_rcp_f32 v121, v25
v_rcp_f32 v122, v26
v_rcp_f32 v123, v27
v_mfma_f32_16x16x32_bf16 v[128:131], v[32:35], a[192:195], 0
v_mfma_f32_16x16x32_bf16 v[136:139], v[32:35], a[196:199], 0
s_waitcnt vmcnt(10)
v_mfma_f32_16x16x32_bf16 v[144:147], v[32:35], a[224:227], 0
ds_read_b128 v[60:63], v113 offset:51200
buffer_load_dwordx4 v17, s[8:11], s75 offen offset:2048 lds
v_accvgpr_read_b32 v96, a0
s_waitcnt vmcnt(10)
v_mfma_f32_16x16x32_bf16 v[152:155], v[32:35], a[228:231], 0
v_accvgpr_read_b32 v97, a1
v_accvgpr_read_b32 v98, a2
v_accvgpr_read_b32 v99, a3
v_mfma_f32_16x16x32_bf16 v[132:135], v[36:39], a[192:195], 0
v_mul_f32 v96, v96, v120
v_mul_f32 v97, v97, v120
v_mul_f32 v98, v98, v120
v_mul_f32 v99, v99, v120
v_mfma_f32_16x16x32_bf16 v[140:143], v[36:39], a[196:199], 0
CV 192,96,97
CV 193,98,99
v_accvgpr_read_b32 v100, a4
v_mfma_f32_16x16x32_bf16 v[148:151], v[36:39], a[224:227], 0
ds_read_b128 v[32:35], v116 offset:8192
v_accvgpr_read_b32 v101, a5
v_accvgpr_read_b32 v102, a6
v_mfma_f32_16x16x32_bf16 v[156:159], v[36:39], a[228:231], 0
v_accvgpr_read_b32 v103, a7
v_mul_f32 v100, v100, v120
v_mul_f32 v101, v101, v120
s_waitcnt lgkmcnt(1)
NA 128,40,200
ds_read_b128 v[36:39], v117 offset:8192
v_mul_f32 v102, v102, v120
v_mul_f32 v103, v103, v120
NA 136,40,204
CV 194,100,101
CV 195,102,103
v_accvgpr_read_b32 v96, a8
s_waitcnt vmcnt(8)
NA 144,40,232
v_accvgpr_read_b32 v97, a9
v_accvgpr_read_b32 v98, a10
v_accvgpr_read_b32 v99, a11
s_waitcnt vmcnt(7)
NA 152,40,236
v_mul_f32 v96, v96, v121
v_mul_f32 v97, v97, v121
v_mul_f32 v98, v98, v121
NA 132,44,200
buffer_load_dwordx4 v18, s[8:11], s75 offen offset:3072 lds
v_mul_f32 v99, v99, v121
CV 196,96,97
NA 140,44,204
CV 197,98,99
v_accvgpr_read_b32 v100, a12
v_accvgpr_read_b32 v101, a13
NA 148,44,232
ds_read_b128 v[40:43], v116 offset:12288
v_accvgpr_read_b32 v102, a14
v_accvgpr_read_b32 v103, a15
NA 156,44,236
v_mul_f32 v100, v100, v121
v_mul_f32 v101, v101, v121
v_mul_f32 v102, v102, v121
NA 128,48,208
ds_read_b128 v[44:47], v117 offset:12288
v_mul_f32 v103, v103, v121
CV 198,100,101
CV 199,102,103
NA 136,48,212
v_accvgpr_read_b32 v96, a16
v_accvgpr_read_b32 v97, a17
v_accvgpr_read_b32 v98, a18
s_waitcnt vmcnt(7)
NA 144,48,240
v_accvgpr_read_b32 v99, a19
v_mul_f32 v96, v96, v120
v_mul_f32 v97, v97, v120
s_waitcnt vmcnt(5)
NA 152,48,244
v_mul_f32 v98, v98, v120
v_mul_f32 v99, v99, v120
CV 200,96,97
NA 132,52,208
CV 201,98,99
v_accvgpr_read_b32 v100, a20
v_accvgpr_read_b32 v101, a21
NA 140,52,212
v_accvgpr_read_b32 v102, a22
v_accvgpr_read_b32 v103, a23
v_mul_f32 v100, v100, v120
NA 148,52,240
ds_read_b128 v[48:51], v116 offset:10240
v_mul_f32 v101, v101, v120
v_mul_f32 v102, v102, v120
NA 156,52,244
v_mul_f32 v103, v103, v120
CV 202,100,101
s_add_u32 m0, s68, 16384
s_add_u32 s75, s61, 557056
NA 128,56,216
ds_read_b128 v[52:55], v117 offset:10240
buffer_load_dwordx4 v11, s[12:15], s75 offen offset:0 lds
CV 203,102,103
NA 136,56,220
v_accvgpr_read_b32 v96, a24
v_accvgpr_read_b32 v97, a25
v_accvgpr_read_b32 v98, a26
s_waitcnt vmcnt(5)
NA 144,56,248
v_accvgpr_read_b32 v99, a27
v_mul_f32 v96, v96, v121
v_mul_f32 v97, v97, v121
s_waitcnt vmcnt(4)
NA 152,56,252
v_mul_f32 v98, v98, v121
v_mul_f32 v99, v99, v121
CV 204,96,97
NA 132,60,216
CV 205,98,99
v_accvgpr_read_b32 v100, a28
v_accvgpr_read_b32 v101, a29
NA 140,60,220
v_accvgpr_read_b32 v102, a30
v_accvgpr_read_b32 v103, a31
v_mul_f32 v100, v100, v121
NA 148,60,248
ds_read_b128 v[56:59], v116 offset:14336
v_mul_f32 v101, v101, v121
v_mul_f32 v102, v102, v121
NA 156,60,252
v_mul_f32 v103, v103, v121
CV 206,100,101
CV 207,102,103
s_waitcnt lgkmcnt(1)
v_mfma_f32_16x16x32_bf16 v[184:187], v[32:35], a[228:231], 0
ds_read_b128 v[60:63], v117 offset:14336
v_accvgpr_read_b32 v96, a32
v_max3_f32 v64, v128, v129, v130
v_max3_f32 v64, v64, v131, v132
v_accvgpr_read_b32 v97, a33
v_max3_f32 v64, v64, v133, v134
v_max_f32 v64, v64, v135
v_accvgpr_read_b32 v98, a34
NA 184,36,236
v_max3_f32 v68, v136, v137, v138
v_accvgpr_read_b32 v99, a35
v_max3_f32 v68, v68, v139, v140
v_max3_f32 v68, v68, v141, v142
v_mul_f32 v96, v96, v120
v_max_f32 v68, v68, v143
v_max3_f32 v72, v144, v145, v146
v_mul_f32 v97, v97, v120
v_mfma_f32_16x16x32_bf16 v[176:179], v[32:35], a[224:227], 0
v_max3_f32 v72, v72, v147, v148
v_mul_f32 v98, v98, v120
v_max3_f32 v72, v72, v149, v150
v_max_f32 v72, v72, v151
v_mul_f32 v99, v99, v120
v_max3_f32 v76, v152, v153, v154
v_max3_f32 v76, v76, v155, v156
CV 208,96,97
NA 176,36,232
v_max3_f32 v76, v76, v157, v158
CV 209,98,99
v_max_f32 v76, v76, v159
v_mov_b32 v65, v64
v_accvgpr_read_b32 v100, a36
v_mov_b32 v69, v68
v_accvgpr_read_b32 v101, a37
v_mov_b32 v73, v72
v_mfma_f32_16x16x32_bf16 v[168:171], v[32:35], a[196:199], 0
v_mov_b32 v77, v76
v_accvgpr_read_b32 v102, a38
v_permlane16_swap_b32 v64, v65
v_accvgpr_read_b32 v103, a39
v_permlane16_swap_b32 v68, v69
v_permlane16_swap_b32 v72, v73
v_mul_f32 v100, v100, v120
v_permlane16_swap_b32 v76, v77
NA 168,36,204
v_mul_f32 v101, v101, v120
v_max_f32 v64, v64, v65
v_max_f32 v68, v68, v69
v_mul_f32 v102, v102, v120
v_max_f32 v72, v72, v73
v_max_f32 v76, v76, v77
v_mul_f32 v103, v103, v120
v_mfma_f32_16x16x32_bf16 v[160:163], v[32:35], a[192:195], 0
v_mov_b32 v65, v64
CV 210,100,101
v_mov_b32 v69, v68
v_mov_b32 v73, v72
CV 211,102,103
v_mov_b32 v77, v76
v_accvgpr_read_b32 v96, a40
v_permlane32_swap_b32 v64, v65
NA 160,36,200
v_permlane32_swap_b32 v68, v69
v_accvgpr_read_b32 v97, a41
v_permlane32_swap_b32 v72, v73
v_accvgpr_read_b32 v98, a42
v_permlane32_swap_b32 v76, v77
v_min_f32 v64, -v64, -v65
v_accvgpr_read_b32 v99, a43
v_min_f32 v68, -v68, -v69
NA 160,40,208
R 32,3,24576
v_min_f32 v72, -v72, -v73
s_mul_i32 s0, s55, 1024
s_mul_i32 s74, s56, 589824
s_add_u32 s0, s0, s74
v_min_f32 v76, -v76, -v77
v_mul_f32 v96, v96, v121
v_add_f32 v128, v128, v64
v_add_f32 v129, v129, v64
NA 160,44,216
v_add_f32 v130, v130, v64
v_add_f32 v131, v131, v64
v_exp_f32 v128, v128
v_mul_f32 v97, v97, v121
v_exp_f32 v129, v129
v_and_b32 v114, -8, v1
NA 168,40,212
R 34,3,26624
v_exp_f32 v130, v130
v_mul_f32 v98, v98, v121
v_exp_f32 v131, v131
v_mul_f32 v99, v99, v121
CV 128,128,129
NA 168,44,220
R 36,2,24576
v_lshlrev_b32 v114, 4, v114
CV 129,130,131
v_add_f32 v132, v132, v64
CV 212,96,97
v_add_f32 v133, v133, v64
v_add_f32 v134, v134, v64
NA 176,40,240
R 38,2,26624
v_add_f32 v135, v135, v64
CV 213,98,99
v_exp_f32 v132, v132
v_accvgpr_read_b32 v100, a44
v_exp_f32 v133, v133
NA 176,44,248
v_accvgpr_read_b32 v101, a45
v_exp_f32 v134, v134
v_accvgpr_read_b32 v102, a46
v_exp_f32 v135, v135
v_accvgpr_read_b32 v103, a47
s_add_u32 s0, s0, 0
NA 184,40,244
LA_pad10:
s_cbranch_execz LA_ret
buffer_load_dword v0, v114, s[20:23], s0 offen
CV 130,132,133
CV 131,134,135
v_mul_f32 v100, v100, v121
v_add_f32 v136, v136, v68
v_add_f32 v137, v137, v68
v_mul_f32 v101, v101, v121
v_add_f32 v138, v138, v68
NA 184,44,252
v_mul_f32 v102, v102, v121
v_add_f32 v139, v139, v68
v_exp_f32 v136, v136
v_mul_f32 v103, v103, v121
v_exp_f32 v137, v137
CV 214,100,101
v_mfma_f32_16x16x32_bf16 v[188:191], v[48:51], a[228:231], 0
R 40,4,24576
v_exp_f32 v138, v138
CV 215,102,103
v_exp_f32 v139, v139
v_accvgpr_read_b32 v96, a48
CV 136,136,137
NA 188,52,236
v_accvgpr_read_b32 v97, a49
CV 137,138,139
v_add_f32 v140, v140, v68
v_accvgpr_read_b32 v98, a50
v_add_f32 v141, v141, v68
v_accvgpr_read_b32 v99, a51
v_add_f32 v142, v142, v68
v_mfma_f32_16x16x32_bf16 v[180:183], v[48:51], a[224:227], 0
R 42,4,26624
v_add_f32 v143, v143, v68
v_exp_f32 v140, v140
v_mul_f32 v96, v96, v120
v_exp_f32 v141, v141
v_mul_f32 v97, v97, v120
NA 180,52,232
R 44,5,24576
v_exp_f32 v142, v142
v_mul_f32 v98, v98, v120
v_exp_f32 v143, v143
v_mul_f32 v99, v99, v120
CV 138,140,141
v_mfma_f32_16x16x32_bf16 v[172:175], v[48:51], a[196:199], 0
R 46,5,26624
CV 139,142,143
CV 216,96,97
v_add_f32 v144, v144, v72
v_add_f32 v145, v145, v72
CV 217,98,99
v_add_f32 v146, v146, v72
v_accvgpr_read_b32 v100, a52
v_add_f32 v147, v147, v72
NA 172,52,204
v_exp_f32 v144, v144
v_accvgpr_read_b32 v101, a53
v_exp_f32 v145, v145
v_accvgpr_read_b32 v102, a54
v_exp_f32 v146, v146
v_mfma_f32_16x16x32_bf16 v[164:167], v[48:51], a[192:195], 0
v_accvgpr_read_b32 v103, a55
v_mul_f32 v100, v100, v120
v_exp_f32 v147, v147
v_mul_f32 v101, v101, v120
CV 144,144,145
v_mul_f32 v102, v102, v120
CV 145,146,147
NA 164,52,200
v_add_f32 v148, v148, v72
v_mul_f32 v103, v103, v120
v_add_f32 v149, v149, v72
CV 218,100,101
v_add_f32 v150, v150, v72
CV 219,102,103
v_add_f32 v151, v151, v72
s_waitcnt lgkmcnt(0)
NA 164,56,208
buffer_load_dwordx4 v12, s[12:15], s75 offen offset:1024 lds
v_exp_f32 v148, v148
v_accvgpr_read_b32 v96, a56
v_exp_f32 v149, v149
v_accvgpr_read_b32 v97, a57
NA 164,60,216
v_exp_f32 v150, v150
v_accvgpr_read_b32 v98, a58
v_exp_f32 v151, v151
v_accvgpr_read_b32 v99, a59
CV 146,148,149
v_mul_f32 v96, v96, v121
NA 172,56,212
R 48,3,32768
CV 147,150,151
v_add_f32 v152, v152, v76
v_mul_f32 v97, v97, v121
v_add_f32 v153, v153, v76
v_add_f32 v154, v154, v76
v_mul_f32 v98, v98, v121
v_add_f32 v155, v155, v76
v_mul_f32 v99, v99, v121
NA 172,60,220
v_exp_f32 v152, v152
CV 220,96,97
v_exp_f32 v153, v153
CV 221,98,99
v_exp_f32 v154, v154
s_add_u32 s100, s100, 4096
s_addc_u32 s101, s101, 0
NA 180,56,240
R 50,3,34816
global_load_dword v0, v23, s[100:101]
v_accvgpr_read_b32 v100, a60
v_exp_f32 v155, v155
v_accvgpr_read_b32 v101, a61
CV 152,152,153
CV 153,154,155
v_accvgpr_read_b32 v102, a62
NA 180,60,248
v_add_f32 v156, v156, v76
v_add_f32 v157, v157, v76
v_accvgpr_read_b32 v103, a63
v_add_f32 v158, v158, v76
v_mul_f32 v100, v100, v121
v_add_f32 v159, v159, v76
v_exp_f32 v156, v156
NA 188,56,244
R 52,2,32768
v_mul_f32 v101, v101, v121
v_exp_f32 v157, v157
v_mul_f32 v102, v102, v121
v_exp_f32 v158, v158
NA 188,60,252
v_mul_f32 v103, v103, v121
v_exp_f32 v159, v159
CV 222,100,101
CV 154,156,157
CV 223,102,103
CV 155,158,159
v_mfma_f32_16x16x32_bf16 a[128:131], v[32:35], v[128:131], 0
R 54,2,34816
v_add_f32 v160, v160, v64
v_add_f32 v161, v161, v64
v_mfma_f32_16x16x32_bf16 a[136:139], v[32:35], v[136:139], 0
v_add_f32 v162, v162, v64
v_add_f32 v163, v163, v64
v_mfma_f32_16x16x32_bf16 a[0:3], v[32:35], v[144:147], 0
R 56,4,32768
v_exp_f32 v160, v160
v_mfma_f32_16x16x32_bf16 a[8:11], v[32:35], v[152:155], 0
v_mov_b32 v65, v64
v_exp_f32 v161, v161
v_mfma_f32_16x16x32_bf16 a[132:135], v[36:39], v[128:131], 0
R 58,4,34816
buffer_load_dwordx4 v13, s[12:15], s75 offen offset:2048 lds
v_mfma_f32_16x16x32_bf16 a[140:143], v[36:39], v[136:139], 0
v_exp_f32 v162, v162
v_mfma_f32_16x16x32_bf16 a[4:7], v[36:39], v[144:147], 0
R 60,5,32768
v_exp_f32 v163, v163
v_mfma_f32_16x16x32_bf16 a[12:15], v[36:39], v[152:155], 0
v_mov_b32 v66, v64
v_mfma_f32_16x16x32_bf16 a[144:147], v[40:43], v[128:131], 0
R 62,5,34816
CV 160,160,161
CV 161,162,163
v_mfma_f32_16x16x32_bf16 a[152:155], v[40:43], v[136:139], 0
v_add_f32 v164, v164, v64
v_add_f32 v165, v165, v64
v_mfma_f32_16x16x32_bf16 a[16:19], v[40:43], v[144:147], 0
ds_read_b128 v[32:35], v116 offset:16384
v_add_f32 v166, v166, v64
v_add_f32 v167, v167, v64
v_mfma_f32_16x16x32_bf16 a[24:27], v[40:43], v[152:155], 0
ds_read_b128 v[36:39], v117 offset:16384
v_exp_f32 v164, v164
v_mfma_f32_16x16x32_bf16 a[148:151], v[44:47], v[128:131], 0
v_mov_b32 v67, v64
v_exp_f32 v165, v165
v_mfma_f32_16x16x32_bf16 a[156:159], v[44:47], v[136:139], 0
v_mov_b32 v69, v68
v_mfma_f32_16x16x32_bf16 a[20:23], v[44:47], v[144:147], 0
buffer_load_dwordx4 v14, s[12:15], s75 offen offset:3072 lds
v_exp_f32 v166, v166
v_mfma_f32_16x16x32_bf16 a[28:31], v[44:47], v[152:155], 0
v_exp_f32 v167, v167
v_mfma_f32_16x16x32_bf16 v[80:83], v[124:127], v[128:131], 0
v_mov_b32 v70, v68
CV 162,164,165
v_mfma_f32_16x16x32_bf16 v[84:87], v[124:127], v[136:139], 0
v_mov_b32 v71, v68
CV 163,166,167
v_mfma_f32_16x16x32_bf16 v[88:91], v[124:127], v[144:147], 0
ds_read_b128 v[40:43], v116 offset:20480
v_add_f32 v168, v168, v68
v_mfma_f32_16x16x32_bf16 v[92:95], v[124:127], v[152:155], 0
ds_read_b128 v[44:47], v117 offset:20480
v_add_f32 v169, v169, v68
s_add_u32 s0, s0, 65536
s_waitcnt lgkmcnt(2)
v_mfma_f32_16x16x32_bf16 a[160:163], v[48:51], v[128:131], 0
buffer_load_dword v0, v114, s[20:23], s0 offen
v_add_f32 v170, v170, v68
v_add_f32 v171, v171, v68
v_mfma_f32_16x16x32_bf16 a[168:171], v[48:51], v[136:139], 0
v_mov_b32 v73, v72
v_exp_f32 v168, v168
v_mfma_f32_16x16x32_bf16 a[32:35], v[48:51], v[144:147], 0
v_mov_b32 v74, v72
v_mfma_f32_16x16x32_bf16 a[40:43], v[48:51], v[152:155], 0
v_exp_f32 v169, v169
v_mfma_f32_16x16x32_bf16 a[164:167], v[52:55], v[128:131], 0
v_mov_b32 v75, v72
v_exp_f32 v170, v170
v_mfma_f32_16x16x32_bf16 a[172:175], v[52:55], v[136:139], 0
v_mov_b32 v77, v76
v_exp_f32 v171, v171
v_mfma_f32_16x16x32_bf16 a[36:39], v[52:55], v[144:147], 0
s_barrier
ds_read_b128 v[48:51], v116 offset:18432
v_mfma_f32_16x16x32_bf16 a[44:47], v[52:55], v[152:155], 0
v_mfma_f32_16x16x32_bf16 a[176:179], v[56:59], v[128:131], 0
ds_read_b128 v[52:55], v117 offset:18432
CV 168,168,169
v_mfma_f32_16x16x32_bf16 a[184:187], v[56:59], v[136:139], 0
s_add_u32 m0, s68, 36864
s_add_u32 s75, s60, 581632
v_mfma_f32_16x16x32_bf16 a[48:51], v[56:59], v[144:147], 0
buffer_load_dwordx4 v15, s[8:11], s75 offen offset:0 lds
CV 169,170,171
v_add_f32 v172, v172, v68
v_mfma_f32_16x16x32_bf16 a[56:59], v[56:59], v[152:155], 0
v_mov_b32 v78, v76
v_add_f32 v173, v173, v68
v_mfma_f32_16x16x32_bf16 a[180:183], v[60:63], v[128:131], 0
v_add_f32 v174, v174, v68
v_add_f32 v175, v175, v68
v_mov_b32 v79, v76
v_mfma_f32_16x16x32_bf16 a[188:191], v[60:63], v[136:139], 0
v_exp_f32 v172, v172
v_mfma_f32_16x16x32_bf16 a[52:55], v[60:63], v[144:147], 0
ds_read_b128 v[56:59], v116 offset:22528
v_exp_f32 v173, v173
v_mfma_f32_16x16x32_bf16 a[60:63], v[60:63], v[152:155], 0
v_exp_f32 v174, v174
v_mfma_f32_16x16x32_bf16 v[152:155], v[32:35], a[228:231], v[76:79]
ds_read_b128 v[60:63], v117 offset:22528
v_exp_f32 v175, v175
NA 152,36,236
CV 170,172,173
v_mfma_f32_16x16x32_bf16 v[144:147], v[32:35], a[224:227], v[72:75]
CV 171,174,175
v_add_f32 v176, v176, v72
v_add_f32 v177, v177, v72
NA 144,36,232
v_add_f32 v178, v178, v72
v_add_f32 v179, v179, v72
v_mfma_f32_16x16x32_bf16 v[136:139], v[32:35], a[196:199], v[68:71]
v_exp_f32 v176, v176
v_exp_f32 v177, v177
NA 136,36,204
v_exp_f32 v178, v178
v_mfma_f32_16x16x32_bf16 v[128:131], v[32:35], a[192:195], v[64:67]
v_exp_f32 v179, v179
NA 128,36,200
CV 176,176,177
s_waitcnt lgkmcnt(0)
NA 128,40,208
R 32,3,28672
CV 177,178,179
v_add_f32 v180, v180, v72
NA 128,44,216
v_add_f32 v181, v181, v72
v_add_f32 v182, v182, v72
NA 136,40,212
R 34,3,30720
v_add_f32 v183, v183, v72
NA 136,44,220
R 36,2,28672
v_exp_f32 v180, v180
NA 144,40,240
R 38,2,30720
v_exp_f32 v181, v181
NA 144,44,248
v_exp_f32 v182, v182
NA 152,40,244
v_exp_f32 v183, v183
NA 152,44,252
CV 178,180,181
CV 179,182,183
v_mfma_f32_16x16x32_bf16 v[156:159], v[48:51], a[228:231], v[76:79]
R 40,4,28672
v_add_f32 v184, v184, v76
v_add_f32 v185, v185, v76
NA 156,52,236
v_add_f32 v186, v186, v76
v_add_f32 v187, v187, v76
v_mfma_f32_16x16x32_bf16 v[148:151], v[48:51], a[224:227], v[72:75]
R 42,4,30720
v_exp_f32 v184, v184
NA 148,52,232
R 44,5,28672
v_exp_f32 v185, v185
v_mfma_f32_16x16x32_bf16 v[140:143], v[48:51], a[196:199], v[68:71]
R 46,5,30720
NA 140,52,204
v_exp_f32 v186, v186
v_mfma_f32_16x16x32_bf16 v[132:135], v[48:51], a[192:195], v[64:67]
v_exp_f32 v187, v187
NA 132,52,200
CV 184,184,185
CV 185,186,187
s_add_u32 s0, s0, 65536
NA 132,56,208
buffer_load_dword v0, v114, s[20:23], s0 offen
v_add_f32 v188, v188, v76
v_add_f32 v189, v189, v76
NA 132,60,216
v_add_f32 v190, v190, v76
v_add_f32 v191, v191, v76
NA 140,56,212
R 48,3,36864
buffer_load_dwordx4 v16, s[8:11], s75 offen offset:1024 lds
v_exp_f32 v188, v188
NA 140,60,220
v_exp_f32 v189, v189
NA 148,56,240
R 50,3,38912
v_exp_f32 v190, v190
NA 148,60,248
v_exp_f32 v191, v191
NA 156,56,244
R 52,2,36864
CV 186,188,189
NA 156,60,252
CV 187,190,191
s_waitcnt lgkmcnt(2)
NC 128,32,160
R 54,2,38912
v_exp_f32 v128, v128
NC 136,32,168
v_exp_f32 v129, v129
NC 0,32,176
R 56,4,36864
NC 8,32,184
v_exp_f32 v130, v130
NC 132,36,160
R 58,4,38912
v_exp_f32 v131, v131
NC 140,36,168
CV 128,128,129
NC 4,36,176
R 60,5,36864
buffer_load_dwordx4 v17, s[8:11], s75 offen offset:2048 lds
NC 12,36,184
CV 129,130,131
NC 144,40,160
R 62,5,38912
v_exp_f32 v132, v132
NC 152,40,168
v_exp_f32 v133, v133
NC 16,40,176
ds_read_b128 v[32:35], v116 offset:45056
v_exp_f32 v134, v134
NC 24,40,184
ds_read_b128 v[36:39], v117 offset:45056
NC 148,44,160
v_accvgpr_read_b32 v96, a64
v_exp_f32 v135, v135
NC 156,44,168
v_accvgpr_read_b32 v97, a65
NC 20,44,176
CV 130,132,133
NC 28,44,184
v_accvgpr_read_b32 v98, a66
NV 80,124,160
buffer_load_dwordx4 v18, s[8:11], s75 offen offset:3072 lds
CV 131,134,135
NV 84,124,168
v_exp_f32 v136, v136
NV 88,124,176
ds_read_b128 v[40:43], v116 offset:49152
v_exp_f32 v137, v137
NV 92,124,184
ds_read_b128 v[44:47], v117 offset:49152
s_waitcnt lgkmcnt(2)
NC 160,48,160
v_exp_f32 v138, v138
v_accvgpr_read_b32 v99, a67
NC 168,48,168
v_exp_f32 v139, v139
NC 32,48,176
v_mul_f32 v96, v96, v122
v_mul_f32 v97, v97, v122
NC 40,48,184
CV 136,136,137
NC 164,52,160
CV 137,138,139
v_exp_f32 v140, v140
NC 172,52,168
v_mul_f32 v98, v98, v122
NC 36,52,176
ds_read_b128 v[48:51], v116 offset:47104
v_exp_f32 v141, v141
NC 44,52,184
s_add_u32 m0, s68, 53248
s_add_u32 s75, s61, 573440
NC 176,56,160
ds_read_b128 v[52:55], v117 offset:47104
buffer_load_dwordx4 v11, s[12:15], s75 offen offset:0 lds
NC 184,56,168
NC 48,56,176
v_exp_f32 v142, v142
NC 56,56,184
v_exp_f32 v143, v143
s_add_u32 s0, s0, 65536
NC 180,60,160
buffer_load_dword v0, v114, s[20:23], s0 offen
v_mul_f32 v99, v99, v122
NC 188,60,168
CV 138,140,141
NC 52,60,176
ds_read_b128 v[56:59], v116 offset:51200
CV 139,142,143
NC 60,60,184
v_exp_f32 v144, v144
v_mfma_f32_16x16x32_bf16 v[184:187], v[32:35], a[228:231], v[76:79]
ds_read_b128 v[60:63], v117 offset:51200
v_exp_f32 v145, v145
NA 184,36,236
v_exp_f32 v146, v146
v_mfma_f32_16x16x32_bf16 v[176:179], v[32:35], a[224:227], v[72:75]
CV 224,96,97
NA 176,36,232
v_exp_f32 v147, v147
v_mfma_f32_16x16x32_bf16 v[168:171], v[32:35], a[196:199], v[68:71]
CV 225,98,99
CV 144,144,145
NA 168,36,204
v_accvgpr_read_b32 v100, a68
v_mfma_f32_16x16x32_bf16 v[160:163], v[32:35], a[192:195], v[64:67]
CV 145,146,147
v_exp_f32 v148, v148
NA 160,36,200
v_accvgpr_read_b32 v101, a69
s_waitcnt lgkmcnt(0)
NA 160,40,208
R 32,3,61440
v_exp_f32 v149, v149
NA 160,44,216
v_exp_f32 v150, v150
NA 168,40,212
R 34,3,63488
v_exp_f32 v151, v151
NA 168,44,220
R 36,2,61440
NA 176,40,240
R 38,2,63488
NA 176,44,248
v_accvgpr_read_b32 v102, a70
NA 184,40,244
CV 146,148,149
CV 147,150,151
v_accvgpr_read_b32 v103, a71
NA 184,44,252
v_exp_f32 v152, v152
v_mfma_f32_16x16x32_bf16 v[188:191], v[48:51], a[228:231], v[76:79]
R 40,4,61440
NA 188,52,236
v_exp_f32 v153, v153
v_mfma_f32_16x16x32_bf16 v[180:183], v[48:51], a[224:227], v[72:75]
R 42,4,63488
v_exp_f32 v154, v154
NA 180,52,232
R 44,5,61440
v_mfma_f32_16x16x32_bf16 v[172:175], v[48:51], a[196:199], v[68:71]
R 46,5,63488
NA 172,52,204
v_exp_f32 v155, v155
v_mfma_f32_16x16x32_bf16 v[164:167], v[48:51], a[192:195], v[64:67]
CV 152,152,153
v_mul_f32 v100, v100, v122
NA 164,52,200
CV 153,154,155
v_mul_f32 v101, v101, v122
NA 164,56,208
buffer_load_dwordx4 v12, s[12:15], s75 offen offset:1024 lds
v_exp_f32 v156, v156
NA 164,60,216
v_exp_f32 v157, v157
NA 172,56,212
R 48,6,4096
NA 172,60,220
v_exp_f32 v158, v158
NA 180,56,240
R 50,6,6144
NA 180,60,248
v_exp_f32 v159, v159
NA 188,56,244
R 52,7,4096
CV 154,156,157
NA 188,60,252
v_mul_f32 v102, v102, v122
CV 155,158,159
s_waitcnt lgkmcnt(3)
NC 128,32,128
R 54,7,6144
v_exp_f32 v160, v160
NC 136,32,136
v_exp_f32 v161, v161
NC 0,32,144
R 56,8,4096
NC 8,32,152
v_exp_f32 v162, v162
s_add_u32 s0, s0, 65536
NC 132,36,128
R 58,8,6144
buffer_load_dword v0, v114, s[20:23], s0 offen
buffer_load_dwordx4 v13, s[12:15], s75 offen offset:2048 lds
NC 140,36,136
NC 4,36,144
R 60,9,4096
v_exp_f32 v163, v163
NC 12,36,152
CV 160,160,161
NC 144,40,128
R 62,9,6144
CV 161,162,163
NC 152,40,136
v_exp_f32 v164, v164
NC 16,40,144
ds_read_b128 v[32:35], v116 offset:53248
v_exp_f32 v165, v165
NC 24,40,152
ds_read_b128 v[36:39], v117 offset:53248
NC 148,44,128
v_mul_f32 v103, v103, v122
v_exp_f32 v166, v166
NC 156,44,136
CV 226,100,101
NC 20,44,144
buffer_load_dwordx4 v14, s[12:15], s75 offen offset:3072 lds
v_exp_f32 v167, v167
NC 28,44,152
CV 162,164,165
NV 80,124,128
CV 163,166,167
CV 227,102,103
NV 84,124,136
v_exp_f32 v168, v168
NV 88,124,144
ds_read_b128 v[40:43], v116 offset:57344
v_exp_f32 v169, v169
NV 92,124,152
ds_read_b128 v[44:47], v117 offset:57344
s_waitcnt lgkmcnt(2)
NC 160,48,128
v_accvgpr_read_b32 v96, a72
v_exp_f32 v170, v170
NC 168,48,136
v_accvgpr_read_b32 v97, a73
NC 32,48,144
v_exp_f32 v171, v171
NC 40,48,152
v_accvgpr_read_b32 v98, a74
NC 164,52,128
CV 168,168,169
CV 169,170,171
v_accvgpr_read_b32 v99, a75
NC 172,52,136
v_exp_f32 v172, v172
NC 36,52,144
s_waitcnt vmcnt(12)
s_barrier
ds_read_b128 v[48:51], v116 offset:55296
NC 44,52,152
NC 176,56,128
ds_read_b128 v[52:55], v117 offset:55296
v_exp_f32 v173, v173
NC 184,56,136
s_add_u32 m0, s68, 73728
s_add_u32 s75, s60, 598016
NC 48,56,144
buffer_load_dwordx4 v15, s[8:11], s75 offen offset:0 lds
NC 56,56,152
v_exp_f32 v174, v174
NC 180,60,128
v_mul_f32 v96, v96, v123
v_exp_f32 v175, v175
NC 188,60,136
v_mul_f32 v97, v97, v123
NC 52,60,144
ds_read_b128 v[56:59], v116 offset:59392
CV 170,172,173
NC 60,60,152
CV 171,174,175
v_mfma_f32_16x16x32_bf16 v[152:155], v[32:35], a[228:231], v[76:79]
ds_read_b128 v[60:63], v117 offset:59392
v_exp_f32 v176, v176
NA 152,36,236
v_exp_f32 v177, v177
v_mfma_f32_16x16x32_bf16 v[144:147], v[32:35], a[224:227], v[72:75]
v_mul_f32 v98, v98, v123
NA 144,36,232
v_exp_f32 v178, v178
v_mfma_f32_16x16x32_bf16 v[136:139], v[32:35], a[196:199], v[68:71]
v_exp_f32 v179, v179
NA 136,36,204
v_mul_f32 v99, v99, v123
s_add_u32 s0, s0, 65536
v_mfma_f32_16x16x32_bf16 v[128:131], v[32:35], a[192:195], v[64:67]
buffer_load_dword v0, v114, s[20:23], s0 offen
CV 176,176,177
CV 177,178,179
NA 128,36,200
v_exp_f32 v180, v180
s_waitcnt lgkmcnt(0)
NA 128,40,208
R 32,6,0
NA 128,44,216
v_exp_f32 v181, v181
NA 136,40,212
R 34,6,2048
v_exp_f32 v182, v182
NA 136,44,220
LA_pad11:
s_cbranch_execz LA_ret
R 36,7,0
NA 144,40,240
R 38,7,2048
CV 228,96,97
NA 144,44,248
v_exp_f32 v183, v183
NA 152,40,244
CV 178,180,181
CV 179,182,183
CV 229,98,99
NA 152,44,252
v_exp_f32 v184, v184
v_mfma_f32_16x16x32_bf16 v[156:159], v[48:51], a[228:231], v[76:79]
R 40,8,0
NA 156,52,236
v_exp_f32 v185, v185
v_mfma_f32_16x16x32_bf16 v[148:151], v[48:51], a[224:227], v[72:75]
R 42,8,2048
v_exp_f32 v186, v186
NA 148,52,232
R 44,9,0
v_mfma_f32_16x16x32_bf16 v[140:143], v[48:51], a[196:199], v[68:71]
R 46,9,2048
v_exp_f32 v187, v187
NA 140,52,204
v_accvgpr_read_b32 v100, a76
v_mfma_f32_16x16x32_bf16 v[132:135], v[48:51], a[192:195], v[64:67]
CV 184,184,185
CV 185,186,187
v_accvgpr_read_b32 v101, a77
NA 132,52,200
v_exp_f32 v188, v188
NA 132,56,208
v_accvgpr_read_b32 v102, a78
NA 132,60,216
v_exp_f32 v189, v189
NA 140,56,212
R 48,6,8192
buffer_load_dwordx4 v16, s[8:11], s75 offen offset:1024 lds
NA 140,60,220
v_exp_f32 v190, v190
NA 148,56,240
R 50,6,10240
NA 148,60,248
v_exp_f32 v191, v191
NA 156,56,244
R 52,7,8192
CV 186,188,189
NA 156,60,252
v_accvgpr_read_b32 v103, a79
CV 187,190,191
s_add_u32 s100, s100, 4096
s_addc_u32 s101, s101, 0
s_waitcnt lgkmcnt(3)
NC 128,32,160
R 54,7,10240
global_load_dword v0, v23, s[100:101]
v_exp_f32 v128, v128
NC 136,32,168
v_exp_f32 v129, v129
NC 0,32,176
R 56,8,8192
NC 8,32,184
v_exp_f32 v130, v130
NC 132,36,160
R 58,8,10240
v_exp_f32 v131, v131
NC 140,36,168
CV 128,128,129
NC 4,36,176
R 60,9,8192
buffer_load_dwordx4 v17, s[8:11], s75 offen offset:2048 lds
CV 129,130,131
NC 12,36,184
v_exp_f32 v132, v132
NC 144,40,160
R 62,9,10240
NC 152,40,168
v_mul_f32 v100, v100, v123
NC 16,40,176
ds_read_b128 v[32:35], v112 offset:0
v_exp_f32 v133, v133
NC 24,40,184
ds_read_b128 v[36:39], v113 offset:0
NC 148,44,160
v_exp_f32 v134, v134
NC 156,44,168
v_exp_f32 v135, v135
s_add_u32 s0, s0, 65536
NC 20,44,176
buffer_load_dword v0, v114, s[20:23], s0 offen
CV 130,132,133
NC 28,44,184
CV 131,134,135
NV 80,124,160
buffer_load_dwordx4 v18, s[8:11], s75 offen offset:3072 lds
v_mul_f32 v101, v101, v123
NV 84,124,168
v_exp_f32 v136, v136
NV 88,124,176
ds_read_b128 v[40:43], v112 offset:4096
v_exp_f32 v137, v137
NV 92,124,184
ds_read_b128 v[44:47], v113 offset:4096
s_waitcnt lgkmcnt(2)
NC 160,48,160
v_exp_f32 v138, v138
v_mul_f32 v102, v102, v123
NC 168,48,168
v_exp_f32 v139, v139
NC 32,48,176
v_mul_f32 v103, v103, v123
NC 40,48,184
CV 136,136,137
NC 164,52,160
CV 137,138,139
CV 230,100,101
NC 172,52,168
v_exp_f32 v140, v140
CV 231,102,103
NC 36,52,176
ds_read_b128 v[48:51], v112 offset:2048
v_exp_f32 v141, v141
NC 44,52,184
s_add_u32 m0, s68, 90112
s_add_u32 s75, s61, 589824
NC 176,56,160
ds_read_b128 v[52:55], v113 offset:2048
buffer_load_dwordx4 v11, s[12:15], s75 offen offset:0 lds
NC 184,56,168
NC 48,56,176
v_exp_f32 v142, v142
NC 56,56,184
v_exp_f32 v143, v143
v_accvgpr_read_b32 v96, a80
NC 180,60,160
CV 138,140,141
v_accvgpr_read_b32 v97, a81
NC 188,60,168
CV 139,142,143
NC 52,60,176
ds_read_b128 v[56:59], v112 offset:6144
v_exp_f32 v144, v144
NC 60,60,184
v_exp_f32 v145, v145
v_mfma_f32_16x16x32_bf16 v[184:187], v[32:35], a[228:231], v[76:79]
ds_read_b128 v[60:63], v113 offset:6144
v_accvgpr_read_b32 v98, a82
NA 184,36,236
v_exp_f32 v146, v146
v_mfma_f32_16x16x32_bf16 v[176:179], v[32:35], a[224:227], v[72:75]
v_exp_f32 v147, v147
NA 176,36,232
v_accvgpr_read_b32 v99, a83
v_mfma_f32_16x16x32_bf16 v[168:171], v[32:35], a[196:199], v[68:71]
CV 144,144,145
v_mul_f32 v96, v96, v122
NA 168,36,204
CV 145,146,147
v_mfma_f32_16x16x32_bf16 v[160:163], v[32:35], a[192:195], v[64:67]
v_exp_f32 v148, v148
v_mul_f32 v97, v97, v122
NA 160,36,200
v_exp_f32 v149, v149
s_waitcnt lgkmcnt(0)
NA 160,40,208
R 32,19,16384
v_mul_f32 v98, v98, v122
NA 160,44,216
v_exp_f32 v150, v150
NA 168,40,212
R 34,19,18432
v_exp_f32 v151, v151
NA 168,44,220
R 36,20,16384
NA 176,40,240
R 38,20,18432
CV 146,148,149
NA 176,44,248
CV 147,150,151
NA 184,40,244
v_exp_f32 v152, v152
NA 184,44,252
v_mul_f32 v99, v99, v122
v_mfma_f32_16x16x32_bf16 v[188:191], v[48:51], a[228:231], v[76:79]
R 40,21,16384
NA 188,52,236
v_exp_f32 v153, v153
s_add_u32 s0, s0, 65536
v_mfma_f32_16x16x32_bf16 v[180:183], v[48:51], a[224:227], v[72:75]
R 42,21,18432
buffer_load_dword v0, v114, s[20:23], s0 offen
NA 180,52,232
R 44,22,16384
v_exp_f32 v154, v154
v_mfma_f32_16x16x32_bf16 v[172:175], v[48:51], a[196:199], v[68:71]
R 46,22,18432
NA 172,52,204
v_exp_f32 v155, v155
v_mfma_f32_16x16x32_bf16 v[164:167], v[48:51], a[192:195], v[64:67]
CV 232,96,97
CV 152,152,153
NA 164,52,200
CV 153,154,155
CV 233,98,99
NA 164,56,208
buffer_load_dwordx4 v12, s[12:15], s75 offen offset:1024 lds
v_exp_f32 v156, v156
NA 164,60,216
v_exp_f32 v157, v157
NA 172,56,212
R 48,19,24576
NA 172,60,220
v_exp_f32 v158, v158
NA 180,56,240
R 50,19,26624
v_exp_f32 v159, v159
NA 180,60,248
v_accvgpr_read_b32 v100, a84
NA 188,56,244
R 52,20,24576
CV 154,156,157
NA 188,60,252
CV 155,158,159
s_waitcnt lgkmcnt(3)
NC 128,32,128
R 54,20,26624
v_exp_f32 v160, v160
NC 136,32,136
v_exp_f32 v161, v161
NC 0,32,144
R 56,21,24576
NC 8,32,152
v_exp_f32 v162, v162
NC 132,36,128
R 58,21,26624
buffer_load_dwordx4 v13, s[12:15], s75 offen offset:2048 lds
NC 140,36,136
v_exp_f32 v163, v163
NC 4,36,144
R 60,22,24576
CV 160,160,161
NC 12,36,152
v_accvgpr_read_b32 v101, a85
CV 161,162,163
NC 144,40,128
R 62,22,26624
v_exp_f32 v164, v164
NC 152,40,136
v_exp_f32 v165, v165
NC 16,40,144
ds_read_b128 v[32:35], v112 offset:8192
NC 24,40,152
ds_read_b128 v[36:39], v113 offset:8192
NC 148,44,128
v_exp_f32 v166, v166
v_accvgpr_read_b32 v102, a86
NC 156,44,136
v_exp_f32 v167, v167
NC 20,44,144
buffer_load_dwordx4 v14, s[12:15], s75 offen offset:3072 lds
CV 162,164,165
NC 28,44,152
CV 163,166,167
NV 80,124,128
v_accvgpr_read_b32 v103, a87
v_exp_f32 v168, v168
NV 84,124,136
v_mul_f32 v100, v100, v122
NV 88,124,144
ds_read_b128 v[40:43], v112 offset:12288
v_exp_f32 v169, v169
NV 92,124,152
ds_read_b128 v[44:47], v113 offset:12288
s_waitcnt lgkmcnt(2)
NC 160,48,128
v_exp_f32 v170, v170
v_mul_f32 v101, v101, v122
NC 168,48,136
v_exp_f32 v171, v171
NC 32,48,144
v_mul_f32 v102, v102, v122
CV 168,168,169
NC 40,48,152
CV 169,170,171
NC 164,52,128
v_exp_f32 v172, v172
NC 172,52,136
v_mul_f32 v103, v103, v122
s_add_u32 s0, s0, 65536
NC 36,52,144
s_waitcnt vmcnt(12)
s_barrier
ds_read_b128 v[48:51], v112 offset:10240
buffer_load_dword v0, v114, s[20:23], s0 offen
NC 44,52,152
NC 176,56,128
ds_read_b128 v[52:55], v113 offset:10240
v_exp_f32 v173, v173
NC 184,56,136
s_add_u32 m0, s68, 110592
s_add_u32 s75, s60, 614400
NC 48,56,144
buffer_load_dwordx4 v15, s[8:11], s75 offen offset:0 lds
NC 56,56,152
v_exp_f32 v174, v174
NC 180,60,128
v_exp_f32 v175, v175
NC 188,60,136
CV 234,100,101
CV 170,172,173
NC 52,60,144
ds_read_b128 v[56:59], v112 offset:14336
CV 171,174,175
CV 235,102,103
NC 60,60,152
v_exp_f32 v176, v176
v_mfma_f32_16x16x32_bf16 v[152:155], v[32:35], a[228:231], v[76:79]
ds_read_b128 v[60:63], v113 offset:14336
NA 152,36,236
v_exp_f32 v177, v177
v_mfma_f32_16x16x32_bf16 v[144:147], v[32:35], a[224:227], v[72:75]
v_exp_f32 v178, v178
NA 144,36,232
v_accvgpr_read_b32 v96, a88
v_mfma_f32_16x16x32_bf16 v[136:139], v[32:35], a[196:199], v[68:71]
v_exp_f32 v179, v179
NA 136,36,204
v_accvgpr_read_b32 v97, a89
CV 176,176,177
v_mfma_f32_16x16x32_bf16 v[128:131], v[32:35], a[192:195], v[64:67]
v_accvgpr_read_b32 v98, a90
CV 177,178,179
NA 128,36,200
v_exp_f32 v180, v180
v_accvgpr_read_b32 v99, a91
s_waitcnt lgkmcnt(0)
NA 128,40,208
R 32,19,20480
NA 128,44,216
v_exp_f32 v181, v181
NA 136,40,212
R 34,19,22528
v_exp_f32 v182, v182
NA 136,44,220
R 36,20,20480
NA 144,40,240
R 38,20,22528
v_exp_f32 v183, v183
NA 144,44,248
CV 178,180,181
NA 152,40,244
v_mul_f32 v96, v96, v123
CV 179,182,183
NA 152,44,252
v_exp_f32 v184, v184
v_mfma_f32_16x16x32_bf16 v[156:159], v[48:51], a[228:231], v[76:79]
R 40,21,20480
v_mul_f32 v97, v97, v123
NA 156,52,236
v_exp_f32 v185, v185
v_mfma_f32_16x16x32_bf16 v[148:151], v[48:51], a[224:227], v[72:75]
R 42,21,22528
v_exp_f32 v186, v186
NA 148,52,232
R 44,22,20480
v_mfma_f32_16x16x32_bf16 v[140:143], v[48:51], a[196:199], v[68:71]
R 46,22,22528
NA 140,52,204
v_exp_f32 v187, v187
v_mfma_f32_16x16x32_bf16 v[132:135], v[48:51], a[192:195], v[64:67]
CV 184,184,185
v_mul_f32 v98, v98, v123
CV 185,186,187
NA 132,52,200
v_exp_f32 v188, v188
NA 132,56,208
v_mul_f32 v99, v99, v123
v_exp_f32 v189, v189
NA 132,60,216
CV 236,96,97
NA 140,56,212
R 48,19,28672
buffer_load_dwordx4 v16, s[8:11], s75 offen offset:1024 lds
NA 140,60,220
v_exp_f32 v190, v190
NA 148,56,240
R 50,19,30720
NA 148,60,248
v_exp_f32 v191, v191
NA 156,56,244
R 52,20,28672
CV 186,188,189
NA 156,60,252
CV 187,190,191
s_waitcnt lgkmcnt(3)
NC 128,32,160
R 54,20,30720
v_exp_f32 v128, v128
NC 136,32,168
v_exp_f32 v129, v129
NC 0,32,176
R 56,21,28672
CV 237,98,99
NC 8,32,184
v_exp_f32 v130, v130
NC 132,36,160
R 58,21,30720
NC 140,36,168
v_exp_f32 v131, v131
NC 4,36,176
R 60,22,28672
buffer_load_dwordx4 v17, s[8:11], s75 offen offset:2048 lds
NC 12,36,184
CV 128,128,129
NC 144,40,160
R 62,22,30720
CV 129,130,131
NC 152,40,168
v_exp_f32 v132, v132
NC 16,40,176
ds_read_b128 v[32:35], v112 offset:36864
v_exp_f32 v133, v133
NC 24,40,184
ds_read_b128 v[36:39], v113 offset:36864
NC 148,44,160
v_exp_f32 v134, v134
v_accvgpr_read_b32 v100, a92
NC 156,44,168
v_exp_f32 v135, v135
NC 20,44,176
v_accvgpr_read_b32 v101, a93
NC 28,44,184
v_accvgpr_read_b32 v102, a94
NV 80,124,160
buffer_load_dwordx4 v18, s[8:11], s75 offen offset:3072 lds
CV 130,132,133
CV 131,134,135
NV 84,124,168
v_exp_f32 v136, v136
NV 88,124,176
ds_read_b128 v[40:43], v112 offset:40960
v_exp_f32 v137, v137
NV 92,124,184
ds_read_b128 v[44:47], v113 offset:40960
s_waitcnt lgkmcnt(2)
NC 160,48,160
v_accvgpr_read_b32 v103, a95
NC 168,48,168
v_exp_f32 v138, v138
NC 32,48,176
v_exp_f32 v139, v139
NC 40,48,184
v_mul_f32 v100, v100, v123
CV 136,136,137
NC 164,52,160
v_mul_f32 v101, v101, v123
CV 137,138,139
NC 172,52,168
v_mul_f32 v102, v102, v123
NC 36,52,176
ds_read_b128 v[48:51], v112 offset:38912
v_exp_f32 v140, v140
NC 44,52,184
s_add_u32 m0, s68, 126976
s_add_u32 s75, s61, 606208
NC 176,56,160
ds_read_b128 v[52:55], v113 offset:38912
buffer_load_dwordx4 v11, s[12:15], s75 offen offset:0 lds
NC 184,56,168
v_exp_f32 v141, v141
NC 48,56,176
v_exp_f32 v142, v142
NC 56,56,184
v_mul_f32 v103, v103, v123
NC 180,60,160
v_exp_f32 v143, v143
NC 188,60,168
CV 238,100,101
CV 138,140,141
NC 52,60,176
ds_read_b128 v[56:59], v112 offset:43008
CV 139,142,143
NC 60,60,184
v_exp_f32 v144, v144
CV 239,102,103
v_mfma_f32_16x16x32_bf16 v[184:187], v[32:35], a[228:231], v[76:79]
ds_read_b128 v[60:63], v113 offset:43008
NA 184,36,236
v_exp_f32 v145, v145
v_mfma_f32_16x16x32_bf16 v[176:179], v[32:35], a[224:227], v[72:75]
v_exp_f32 v146, v146
NA 176,36,232
v_accvgpr_read_b32 v96, a96
v_mfma_f32_16x16x32_bf16 v[168:171], v[32:35], a[196:199], v[68:71]
v_exp_f32 v147, v147
NA 168,36,204
v_accvgpr_read_b32 v97, a97
CV 144,144,145
v_mfma_f32_16x16x32_bf16 v[160:163], v[32:35], a[192:195], v[64:67]
v_accvgpr_read_b32 v98, a98
CV 145,146,147
NA 160,36,200
v_exp_f32 v148, v148
v_accvgpr_read_b32 v99, a99
s_waitcnt lgkmcnt(0)
NA 160,40,208
R 32,19,53248
NA 160,44,216
v_exp_f32 v149, v149
NA 168,40,212
R 34,19,55296
v_exp_f32 v150, v150
NA 168,44,220
R 36,20,53248
NA 176,40,240
R 38,20,55296
NA 176,44,248
v_exp_f32 v151, v151
NA 184,40,244
CV 146,148,149
v_mul_f32 v96, v96, v122
CV 147,150,151
NA 184,44,252
v_exp_f32 v152, v152
v_mfma_f32_16x16x32_bf16 v[188:191], v[48:51], a[228:231], v[76:79]
R 40,21,53248
v_mul_f32 v97, v97, v122
NA 188,52,236
v_exp_f32 v153, v153
v_mfma_f32_16x16x32_bf16 v[180:183], v[48:51], a[224:227], v[72:75]
R 42,21,55296
v_exp_f32 v154, v154
NA 180,52,232
R 44,22,53248
v_mfma_f32_16x16x32_bf16 v[172:175], v[48:51], a[196:199], v[68:71]
R 46,22,55296
NA 172,52,204
v_exp_f32 v155, v155
v_mfma_f32_16x16x32_bf16 v[164:167], v[48:51], a[192:195], v[64:67]
CV 152,152,153
v_mul_f32 v98, v98, v122
NA 164,52,200
CV 153,154,155
NA 164,56,208
buffer_load_dwordx4 v12, s[12:15], s75 offen offset:1024 lds
v_exp_f32 v156, v156
NA 164,60,216
v_exp_f32 v157, v157
NA 172,56,212
R 48,19,61440
v_mul_f32 v99, v99, v122
NA 172,60,220
v_exp_f32 v158, v158
NA 180,56,240
R 50,19,63488
NA 180,60,248
v_exp_f32 v159, v159
NA 188,56,244
R 52,20,61440
CV 154,156,157
NA 188,60,252
CV 155,158,159
s_waitcnt lgkmcnt(3)
NC 128,32,128
R 54,20,63488
v_exp_f32 v160, v160
NC 136,32,136
CV 240,96,97
NC 0,32,144
R 56,21,61440
v_exp_f32 v161, v161
NC 8,32,152
v_exp_f32 v162, v162
NC 132,36,128
R 58,21,63488
buffer_load_dwordx4 v13, s[12:15], s75 offen offset:2048 lds
NC 140,36,136
v_exp_f32 v163, v163
NC 4,36,144
R 60,22,61440
CV 160,160,161
NC 12,36,152
CV 161,162,163
LA_pad12:
s_cbranch_execz LA_ret
NC 144,40,128
R 62,22,63488
v_exp_f32 v164, v164
NC 152,40,136
v_exp_f32 v165, v165
NC 16,40,144
ds_read_b128 v[32:35], v112 offset:45056
NC 24,40,152
ds_read_b128 v[36:39], v113 offset:45056
NC 148,44,128
v_exp_f32 v166, v166
NC 156,44,136
CV 241,98,99
v_accvgpr_read_b32 v100, a100
NC 20,44,144
buffer_load_dwordx4 v14, s[12:15], s75 offen offset:3072 lds
v_exp_f32 v167, v167
NC 28,44,152
CV 162,164,165
NV 80,124,128
CV 163,166,167
v_exp_f32 v168, v168
NV 84,124,136
v_accvgpr_read_b32 v101, a101
NV 88,124,144
ds_read_b128 v[40:43], v112 offset:49152
v_exp_f32 v169, v169
NV 92,124,152
ds_read_b128 v[44:47], v113 offset:49152
s_waitcnt lgkmcnt(2)
NC 160,48,128
v_exp_f32 v170, v170
v_accvgpr_read_b32 v102, a102
NC 168,48,136
v_exp_f32 v171, v171
NC 32,48,144
v_accvgpr_read_b32 v103, a103
v_mul_f32 v100, v100, v122
NC 40,48,152
CV 168,168,169
NC 164,52,128
CV 169,170,171
v_mul_f32 v101, v101, v122
NC 172,52,136
v_exp_f32 v172, v172
NC 36,52,144
s_waitcnt vmcnt(9)
s_barrier
ds_read_b128 v[48:51], v112 offset:47104
NC 44,52,152
NC 176,56,128
ds_read_b128 v[52:55], v113 offset:47104
v_exp_f32 v173, v173
NC 184,56,136
s_add_u32 m0, s68, 0
s_add_u32 s75, s60, 630784
s_add_u32 s100, s100, 4096
s_addc_u32 s101, s101, 0
NC 48,56,144
global_load_dword v0, v23, s[100:101]
buffer_load_dwordx4 v15, s[8:11], s75 offen offset:0 lds
NC 56,56,152
v_exp_f32 v174, v174
NC 180,60,128
v_mul_f32 v102, v102, v122
v_exp_f32 v175, v175
NC 188,60,136
CV 170,172,173
NC 52,60,144
ds_read_b128 v[56:59], v112 offset:51200
v_mul_f32 v103, v103, v122
NC 60,60,152
CV 171,174,175
v_mfma_f32_16x16x32_bf16 v[152:155], v[32:35], a[228:231], v[76:79]
ds_read_b128 v[60:63], v113 offset:51200
v_exp_f32 v176, v176
NA 152,36,236
v_exp_f32 v177, v177
v_mfma_f32_16x16x32_bf16 v[144:147], v[32:35], a[224:227], v[72:75]
CV 242,100,101
NA 144,36,232
v_exp_f32 v178, v178
v_mfma_f32_16x16x32_bf16 v[136:139], v[32:35], a[196:199], v[68:71]
CV 243,102,103
v_exp_f32 v179, v179
NA 136,36,204
v_accvgpr_read_b32 v96, a104
v_mfma_f32_16x16x32_bf16 v[128:131], v[32:35], a[192:195], v[64:67]
s_mov_b64 exec, 0
s_cmp_eq_u32 s52, 0
s_cbranch_scc1 LA_pad13
s_cmp_eq_u32 s52, 1
s_cbranch_scc1 LA_pad14
s_cmp_eq_u32 s52, 2
s_cbranch_scc1 LA_pad15
s_branch LA_pad16
LA_cr0:
s_mov_b64 exec, -1
CV 176,176,177
CV 177,178,179
v_accvgpr_read_b32 v97, a105
NA 128,36,200
v_exp_f32 v180, v180
s_waitcnt lgkmcnt(0)
NA 128,40,208
R 32,19,57344
NA 128,44,216
v_exp_f32 v181, v181
NA 136,40,212
R 34,19,59392
v_exp_f32 v182, v182
NA 136,44,220
R 36,20,57344
NA 144,40,240
R 38,20,59392
NA 144,44,248
v_exp_f32 v183, v183
NA 152,40,244
CV 178,180,181
v_accvgpr_read_b32 v98, a106
NA 152,44,252
CV 179,182,183
v_accvgpr_read_b32 v99, a107
v_mfma_f32_16x16x32_bf16 v[156:159], v[48:51], a[228:231], v[76:79]
R 40,21,57344
v_exp_f32 v184, v184
NA 156,52,236
v_exp_f32 v185, v185
v_mfma_f32_16x16x32_bf16 v[148:151], v[48:51], a[224:227], v[72:75]
R 42,21,59392
v_exp_f32 v186, v186
NA 148,52,232
R 44,22,57344
v_mfma_f32_16x16x32_bf16 v[140:143], v[48:51], a[196:199], v[68:71]
R 46,22,59392
NA 140,52,204
v_exp_f32 v187, v187
v_mfma_f32_16x16x32_bf16 v[132:135], v[48:51], a[192:195], v[64:67]
CV 184,184,185
v_mul_f32 v96, v96, v123
CV 185,186,187
NA 132,52,200
v_exp_f32 v188, v188
NA 132,56,208
v_mul_f32 v97, v97, v123
v_mul_f32 v98, v98, v123
NA 132,60,216
v_exp_f32 v189, v189
NA 140,56,212
R 48,3,0
buffer_load_dwordx4 v16, s[8:11], s75 offen offset:1024 lds
NA 140,60,220
v_exp_f32 v190, v190
NA 148,56,240
R 50,3,2048
NA 148,60,248
v_exp_f32 v191, v191
NA 156,56,244
R 52,2,0
CV 186,188,189
NA 156,60,252
CV 187,190,191
s_waitcnt lgkmcnt(3)
NC 128,32,160
R 54,2,2048
v_exp_f32 v128, v128
NC 136,32,168
v_mul_f32 v99, v99, v123
NC 0,32,176
R 56,4,0
v_exp_f32 v129, v129
NC 8,32,184
v_exp_f32 v130, v130
NC 132,36,160
R 58,4,2048
NC 140,36,168
v_exp_f32 v131, v131
NC 4,36,176
R 60,5,0
buffer_load_dwordx4 v17, s[8:11], s75 offen offset:2048 lds
NC 12,36,184
CV 128,128,129
NC 144,40,160
R 62,5,2048
CV 129,130,131
NC 152,40,168
v_exp_f32 v132, v132
NC 16,40,176
ds_read_b128 v[32:35], v116 offset:8192
v_exp_f32 v133, v133
NC 24,40,184
ds_read_b128 v[36:39], v117 offset:8192
NC 148,44,160
CV 244,96,97
v_exp_f32 v134, v134
NC 156,44,168
CV 245,98,99
NC 20,44,176
v_exp_f32 v135, v135
NC 28,44,184
v_accvgpr_read_b32 v100, a108
NV 80,124,160
buffer_load_dwordx4 v18, s[8:11], s75 offen offset:3072 lds
CV 130,132,133
CV 131,134,135
NV 84,124,168
v_exp_f32 v136, v136
NV 88,124,176
ds_read_b128 v[40:43], v116 offset:12288
v_exp_f32 v137, v137
NV 92,124,184
ds_read_b128 v[44:47], v117 offset:12288
s_waitcnt lgkmcnt(2)
NC 160,48,160
v_accvgpr_read_b32 v101, a109
NC 168,48,168
v_exp_f32 v138, v138
NC 32,48,176
v_accvgpr_read_b32 v102, a110
v_exp_f32 v139, v139
NC 40,48,184
v_accvgpr_read_b32 v103, a111
NC 164,52,160
CV 136,136,137
v_mul_f32 v100, v100, v123
NC 172,52,168
CV 137,138,139
NC 36,52,176
ds_read_b128 v[48:51], v116 offset:10240
v_exp_f32 v140, v140
NC 44,52,184
s_add_u32 m0, s68, 16384
s_add_u32 s75, s61, 622592
NC 176,56,160
ds_read_b128 v[52:55], v117 offset:10240
buffer_load_dwordx4 v11, s[12:15], s75 offen offset:0 lds
NC 184,56,168
v_exp_f32 v141, v141
NC 48,56,176
v_exp_f32 v142, v142
NC 56,56,184
v_mul_f32 v101, v101, v123
NC 180,60,160
v_exp_f32 v143, v143
NC 188,60,168
v_mul_f32 v102, v102, v123
CV 138,140,141
NC 52,60,176
ds_read_b128 v[56:59], v116 offset:14336
v_mul_f32 v103, v103, v123
CV 139,142,143
NC 60,60,184
v_exp_f32 v144, v144
v_mfma_f32_16x16x32_bf16 v[184:187], v[32:35], a[228:231], v[76:79]
ds_read_b128 v[60:63], v117 offset:14336
NA 184,36,236
v_exp_f32 v145, v145
v_mfma_f32_16x16x32_bf16 v[176:179], v[32:35], a[224:227], v[72:75]
v_exp_f32 v146, v146
NA 176,36,232
CV 246,100,101
v_mfma_f32_16x16x32_bf16 v[168:171], v[32:35], a[196:199], v[68:71]
v_exp_f32 v147, v147
NA 168,36,204
CV 247,102,103
v_accvgpr_read_b32 v96, a112
v_mfma_f32_16x16x32_bf16 v[160:163], v[32:35], a[192:195], v[64:67]
CV 144,144,145
CV 145,146,147
v_accvgpr_read_b32 v97, a113
NA 160,36,200
v_exp_f32 v148, v148
s_waitcnt lgkmcnt(0)
NA 160,40,208
R 32,3,24576
NA 160,44,216
v_exp_f32 v149, v149
NA 168,40,212
R 34,3,26624
v_exp_f32 v150, v150
NA 168,44,220
R 36,2,24576
NA 176,40,240
R 38,2,26624
NA 176,44,248
v_exp_f32 v151, v151
NA 184,40,244
v_accvgpr_read_b32 v98, a114
CV 146,148,149
NA 184,44,252
CV 147,150,151
v_accvgpr_read_b32 v99, a115
v_mfma_f32_16x16x32_bf16 v[188:191], v[48:51], a[228:231], v[76:79]
R 40,4,24576
v_exp_f32 v152, v152
NA 188,52,236
v_exp_f32 v153, v153
v_mfma_f32_16x16x32_bf16 v[180:183], v[48:51], a[224:227], v[72:75]
R 42,4,26624
v_exp_f32 v154, v154
NA 180,52,232
R 44,5,24576
v_mfma_f32_16x16x32_bf16 v[172:175], v[48:51], a[196:199], v[68:71]
R 46,5,26624
NA 172,52,204
v_exp_f32 v155, v155
v_mfma_f32_16x16x32_bf16 v[164:167], v[48:51], a[192:195], v[64:67]
v_mul_f32 v96, v96, v122
CV 152,152,153
NA 164,52,200
CV 153,154,155
NA 164,56,208
buffer_load_dwordx4 v12, s[12:15], s75 offen offset:1024 lds
v_exp_f32 v156, v156
NA 164,60,216
v_mul_f32 v97, v97, v122
NA 172,56,212
R 48,3,32768
v_exp_f32 v157, v157
NA 172,60,220
v_exp_f32 v158, v158
NA 180,56,240
R 50,3,34816
NA 180,60,248
v_exp_f32 v159, v159
NA 188,56,244
R 52,2,32768
CV 154,156,157
NA 188,60,252
CV 155,158,159
s_waitcnt lgkmcnt(3)
NC 128,32,128
R 54,2,34816
v_mul_f32 v98, v98, v122
NC 136,32,136
v_exp_f32 v160, v160
NC 0,32,144
R 56,4,32768
v_exp_f32 v161, v161
NC 8,32,152
v_exp_f32 v162, v162
NC 132,36,128
R 58,4,34816
buffer_load_dwordx4 v13, s[12:15], s75 offen offset:2048 lds
NC 140,36,136
v_exp_f32 v163, v163
NC 4,36,144
R 60,5,32768
CV 160,160,161
NC 12,36,152
CV 161,162,163
NC 144,40,128
R 62,5,34816
v_exp_f32 v164, v164
NC 152,40,136
v_mul_f32 v99, v99, v122
NC 16,40,144
ds_read_b128 v[32:35], v116 offset:16384
v_exp_f32 v165, v165
NC 24,40,152
ds_read_b128 v[36:39], v117 offset:16384
NC 148,44,128
v_exp_f32 v166, v166
NC 156,44,136
CV 248,96,97
NC 20,44,144
buffer_load_dwordx4 v14, s[12:15], s75 offen offset:3072 lds
v_exp_f32 v167, v167
NC 28,44,152
CV 162,164,165
NV 80,124,128
CV 163,166,167
CV 249,98,99
NV 84,124,136
v_exp_f32 v168, v168
NV 88,124,144
ds_read_b128 v[40:43], v116 offset:20480
v_exp_f32 v169, v169
NV 92,124,152
ds_read_b128 v[44:47], v117 offset:20480
s_waitcnt lgkmcnt(2)
NC 160,48,128
v_accvgpr_read_b32 v100, a116
v_exp_f32 v170, v170
NC 168,48,136
v_accvgpr_read_b32 v101, a117
NC 32,48,144
v_exp_f32 v171, v171
NC 40,48,152
v_accvgpr_read_b32 v102, a118
CV 168,168,169
NC 164,52,128
CV 169,170,171
v_accvgpr_read_b32 v103, a119
NC 172,52,136
v_exp_f32 v172, v172
NC 36,52,144
s_waitcnt vmcnt(9)
s_barrier
ds_read_b128 v[48:51], v116 offset:18432
NC 44,52,152
NC 176,56,128
ds_read_b128 v[52:55], v117 offset:18432
v_exp_f32 v173, v173
NC 184,56,136
s_add_u32 m0, s68, 36864
s_add_u32 s75, s60, 647168
NC 48,56,144
buffer_load_dwordx4 v15, s[8:11], s75 offen offset:0 lds
NC 56,56,152
v_exp_f32 v174, v174
NC 180,60,128
v_mul_f32 v100, v100, v122
v_exp_f32 v175, v175
NC 188,60,136
v_mul_f32 v101, v101, v122
NC 52,60,144
ds_read_b128 v[56:59], v116 offset:22528
CV 170,172,173
NC 60,60,152
CV 171,174,175
v_mfma_f32_16x16x32_bf16 v[152:155], v[32:35], a[228:231], v[76:79]
ds_read_b128 v[60:63], v117 offset:22528
v_exp_f32 v176, v176
NA 152,36,236
v_exp_f32 v177, v177
v_mfma_f32_16x16x32_bf16 v[144:147], v[32:35], a[224:227], v[72:75]
v_mul_f32 v102, v102, v122
NA 144,36,232
v_exp_f32 v178, v178
v_mfma_f32_16x16x32_bf16 v[136:139], v[32:35], a[196:199], v[68:71]
v_mul_f32 v103, v103, v122
v_exp_f32 v179, v179
NA 136,36,204
CV 250,100,101
v_mfma_f32_16x16x32_bf16 v[128:131], v[32:35], a[192:195], v[64:67]
CV 176,176,177
CV 177,178,179
CV 251,102,103
NA 128,36,200
v_exp_f32 v180, v180
s_waitcnt lgkmcnt(0)
NA 128,40,208
R 32,3,28672
NA 128,44,216
v_exp_f32 v181, v181
NA 136,40,212
R 34,3,30720
v_exp_f32 v182, v182
NA 136,44,220
R 36,2,28672
NA 144,40,240
R 38,2,30720
v_exp_f32 v183, v183
NA 144,44,248
v_accvgpr_read_b32 v96, a120
NA 152,40,244
CV 178,180,181
CV 179,182,183
NA 152,44,252
v_accvgpr_read_b32 v97, a121
v_mfma_f32_16x16x32_bf16 v[156:159], v[48:51], a[228:231], v[76:79]
R 40,4,28672
v_exp_f32 v184, v184
NA 156,52,236
v_exp_f32 v185, v185
v_mfma_f32_16x16x32_bf16 v[148:151], v[48:51], a[224:227], v[72:75]
R 42,4,30720
v_exp_f32 v186, v186
NA 148,52,232
R 44,5,28672
v_mfma_f32_16x16x32_bf16 v[140:143], v[48:51], a[196:199], v[68:71]
R 46,5,30720
NA 140,52,204
v_exp_f32 v187, v187
v_mfma_f32_16x16x32_bf16 v[132:135], v[48:51], a[192:195], v[64:67]
v_accvgpr_read_b32 v98, a122
CV 184,184,185
NA 132,52,200
CV 185,186,187
v_accvgpr_read_b32 v99, a123
NA 132,56,208
v_exp_f32 v188, v188
v_mul_f32 v96, v96, v123
NA 132,60,216
v_exp_f32 v189, v189
NA 140,56,212
R 48,3,36864
buffer_load_dwordx4 v16, s[8:11], s75 offen offset:1024 lds
NA 140,60,220
v_exp_f32 v190, v190
NA 148,56,240
R 50,3,38912
NA 148,60,248
v_exp_f32 v191, v191
NA 156,56,244
R 52,2,36864
CV 186,188,189
NA 156,60,252
CV 187,190,191
s_waitcnt lgkmcnt(3)
NC 128,32,160
R 54,2,38912
v_exp_f32 v128, v128
NC 136,32,168
v_mul_f32 v97, v97, v123
NC 0,32,176
R 56,4,36864
v_exp_f32 v129, v129
NC 8,32,184
v_exp_f32 v130, v130
NC 132,36,160
R 58,4,38912
NC 140,36,168
v_exp_f32 v131, v131
NC 4,36,176
R 60,5,36864
buffer_load_dwordx4 v17, s[8:11], s75 offen offset:2048 lds
NC 12,36,184
CV 128,128,129
NC 144,40,160
R 62,5,38912
CV 129,130,131
NC 152,40,168
v_exp_f32 v132, v132
v_mul_f32 v98, v98, v123
NC 16,40,176
ds_read_b128 v[32:35], v116 offset:45056
NC 24,40,184
ds_read_b128 v[36:39], v117 offset:45056
NC 148,44,160
v_exp_f32 v133, v133
v_mul_f32 v99, v99, v123
NC 156,44,168
v_exp_f32 v134, v134
NC 20,44,176
CV 252,96,97
NC 28,44,184
v_exp_f32 v135, v135
NV 80,124,160
buffer_load_dwordx4 v18, s[8:11], s75 offen offset:3072 lds
CV 130,132,133
NV 84,124,168
CV 131,134,135
NV 88,124,176
ds_read_b128 v[40:43], v116 offset:49152
v_exp_f32 v136, v136
NV 92,124,184
ds_read_b128 v[44:47], v117 offset:49152
s_waitcnt lgkmcnt(2)
NC 160,48,160
CV 253,98,99
v_exp_f32 v137, v137
NC 168,48,168
v_accvgpr_read_b32 v100, a124
NC 32,48,176
v_exp_f32 v138, v138
NC 40,48,184
v_accvgpr_read_b32 v101, a125
NC 164,52,160
v_exp_f32 v139, v139
NC 172,52,168
v_accvgpr_read_b32 v102, a126
CV 136,136,137
NC 36,52,176
ds_read_b128 v[48:51], v116 offset:47104
CV 137,138,139
NC 44,52,184
s_add_u32 m0, s68, 53248
s_add_u32 s75, s61, 638976
NC 176,56,160
ds_read_b128 v[52:55], v117 offset:47104
buffer_load_dwordx4 v11, s[12:15], s75 offen offset:0 lds
NC 184,56,168
v_exp_f32 v140, v140
NC 48,56,176
v_exp_f32 v141, v141
NC 56,56,184
v_accvgpr_read_b32 v103, a127
NC 180,60,160
v_exp_f32 v142, v142
NC 188,60,168
v_mul_f32 v100, v100, v123
v_mul_f32 v101, v101, v123
NC 52,60,176
ds_read_b128 v[56:59], v116 offset:51200
v_exp_f32 v143, v143
NC 60,60,184
CV 138,140,141
v_mfma_f32_16x16x32_bf16 v[184:187], v[32:35], a[228:231], v[76:79]
ds_read_b128 v[60:63], v117 offset:51200
CV 139,142,143
LA_pad13:
s_cbranch_execz LA_cr0
NA 184,36,236
v_exp_f32 v144, v144
v_mfma_f32_16x16x32_bf16 v[176:179], v[32:35], a[224:227], v[72:75]
v_mul_f32 v102, v102, v123
NA 176,36,232
v_exp_f32 v145, v145
v_mfma_f32_16x16x32_bf16 v[168:171], v[32:35], a[196:199], v[68:71]
v_mul_f32 v103, v103, v123
v_exp_f32 v146, v146
NA 168,36,204
CV 254,100,101
v_mfma_f32_16x16x32_bf16 v[160:163], v[32:35], a[192:195], v[64:67]
v_exp_f32 v147, v147
NA 160,36,200
CV 255,102,103
s_waitcnt lgkmcnt(0)
NA 160,40,208
R 32,3,61440
CV 144,144,145
CV 145,146,147
NA 160,44,216
v_exp_f32 v148, v148
NA 168,40,212
R 34,3,63488
v_exp_f32 v149, v149
NA 168,44,220
R 36,2,61440
NA 176,40,240
R 38,2,63488
NA 176,44,248
v_exp_f32 v150, v150
NA 184,40,244
v_exp_f32 v151, v151
NA 184,44,252
CV 146,148,149
v_mfma_f32_16x16x32_bf16 v[188:191], v[48:51], a[228:231], v[76:79]
R 40,4,61440
CV 147,150,151
NA 188,52,236
v_exp_f32 v152, v152
v_mfma_f32_16x16x32_bf16 v[180:183], v[48:51], a[224:227], v[72:75]
R 42,4,63488
v_exp_f32 v153, v153
NA 180,52,232
R 44,5,61440
v_mfma_f32_16x16x32_bf16 v[172:175], v[48:51], a[196:199], v[68:71]
R 46,5,63488
NA 172,52,204
v_exp_f32 v154, v154
v_mfma_f32_16x16x32_bf16 v[164:167], v[48:51], a[192:195], v[64:67]
v_exp_f32 v155, v155
NA 164,52,200
CV 152,152,153
CV 153,154,155
NA 164,56,208
buffer_load_dwordx4 v12, s[12:15], s75 offen offset:1024 lds
NA 164,60,216
v_exp_f32 v156, v156
NA 172,56,212
R 48,6,4096
v_exp_f32 v157, v157
NA 172,60,220
v_exp_f32 v158, v158
s_add_u32 s100, s100, 4096
s_addc_u32 s101, s101, 0
NA 180,56,240
R 50,6,6144
global_load_dword v0, v23, s[100:101]
NA 180,60,248
v_exp_f32 v159, v159
NA 188,56,244
R 52,7,4096
CV 154,156,157
NA 188,60,252
CV 155,158,159
s_waitcnt lgkmcnt(2)
NC 128,32,128
R 54,7,6144
v_exp_f32 v160, v160
NC 136,32,136
v_exp_f32 v161, v161
NC 0,32,144
R 56,8,4096
NC 8,32,152
v_exp_f32 v162, v162
NC 132,36,128
R 58,8,6144
buffer_load_dwordx4 v13, s[12:15], s75 offen offset:2048 lds
NC 140,36,136
v_exp_f32 v163, v163
NC 4,36,144
R 60,9,4096
NC 12,36,152
CV 160,160,161
NC 144,40,128
R 62,9,6144
CV 161,162,163
NC 152,40,136
v_exp_f32 v164, v164
NC 16,40,144
ds_read_b128 v[32:35], v116 offset:53248
v_exp_f32 v165, v165
NC 24,40,152
ds_read_b128 v[36:39], v117 offset:53248
NC 148,44,128
v_exp_f32 v166, v166
NC 156,44,136
v_exp_f32 v167, v167
NC 20,44,144
buffer_load_dwordx4 v14, s[12:15], s75 offen offset:3072 lds
NC 28,44,152
CV 162,164,165
NV 80,124,128
CV 163,166,167
v_exp_f32 v168, v168
NV 84,124,136
v_exp_f32 v169, v169
NV 88,124,144
ds_read_b128 v[40:43], v116 offset:57344
v_exp_f32 v170, v170
NV 92,124,152
ds_read_b128 v[44:47], v117 offset:57344
s_waitcnt lgkmcnt(2)
NC 160,48,128
v_exp_f32 v171, v171
NC 168,48,136
NC 32,48,144
CV 168,168,169
CV 169,170,171
NC 40,48,152
v_exp_f32 v172, v172
NC 164,52,128
v_exp_f32 v173, v173
NC 172,52,136
v_exp_f32 v174, v174
NC 36,52,144
s_waitcnt vmcnt(9)
s_barrier
ds_read_b128 v[48:51], v116 offset:55296
NC 44,52,152
NC 176,56,128
ds_read_b128 v[52:55], v117 offset:55296
v_lshrrev_b32 v12, 3, v1
NC 184,56,136
v_exp_f32 v175, v175
NC 48,56,144
v_and_b32 v13, 7, v1
NC 56,56,152
CV 170,172,173
NC 180,60,128
v_mul_u32_u24 v11, 1152, v12
CV 171,174,175
v_and_b32 v12, 6, v12
NC 188,60,136
v_exp_f32 v176, v176
NC 52,60,144
ds_read_b128 v[56:59], v116 offset:59392
NC 60,60,152
v_exp_f32 v177, v177
v_mfma_f32_16x16x32_bf16 v[152:155], v[32:35], a[228:231], v[76:79]
ds_read_b128 v[60:63], v117 offset:59392
v_xor_b32 v13, v12, v13
NA 152,36,236
v_exp_f32 v178, v178
v_mfma_f32_16x16x32_bf16 v[144:147], v[32:35], a[224:227], v[72:75]
v_lshl_add_u32 v11, v13, 4, v11
NA 144,36,232
v_exp_f32 v179, v179
v_mfma_f32_16x16x32_bf16 v[136:139], v[32:35], a[196:199], v[68:71]
v_add_u32 v12, 8192, v11
CV 176,176,177
NA 136,36,204
v_add_u32 v13, 16384, v11
v_mfma_f32_16x16x32_bf16 v[128:131], v[32:35], a[192:195], v[64:67]
CV 177,178,179
v_add_u32 v14, 24576, v11
NA 128,36,200
v_exp_f32 v180, v180
s_waitcnt lgkmcnt(0)
NA 128,40,208
R 32,6,0
NA 128,44,216
s_add_u32 m0, s66, 73728
s_add_u32 s75, s63, 0
NA 136,40,212
R 34,6,2048
buffer_load_dwordx4 v11, s[20:23], s75 offen offset:0 lds
NA 136,44,220
R 36,7,0
v_exp_f32 v181, v181
NA 144,40,240
R 38,7,2048
NA 144,44,248
v_exp_f32 v182, v182
NA 152,40,244
v_exp_f32 v183, v183
NA 152,44,252
CV 178,180,181
v_mfma_f32_16x16x32_bf16 v[156:159], v[48:51], a[228:231], v[76:79]
R 40,8,0
CV 179,182,183
NA 156,52,236
v_exp_f32 v184, v184
v_mfma_f32_16x16x32_bf16 v[148:151], v[48:51], a[224:227], v[72:75]
R 42,8,2048
v_exp_f32 v185, v185
NA 148,52,232
R 44,9,0
v_mfma_f32_16x16x32_bf16 v[140:143], v[48:51], a[196:199], v[68:71]
R 46,9,2048
NA 140,52,204
v_exp_f32 v186, v186
v_mfma_f32_16x16x32_bf16 v[132:135], v[48:51], a[192:195], v[64:67]
v_exp_f32 v187, v187
NA 132,52,200
CV 184,184,185
NA 132,56,208
CV 185,186,187
v_exp_f32 v188, v188
NA 132,60,216
v_exp_f32 v189, v189
NA 140,56,212
R 48,6,8192
NA 140,60,220
v_exp_f32 v190, v190
NA 148,56,240
R 50,6,10240
NA 148,60,248
v_exp_f32 v191, v191
NA 156,56,244
R 52,7,8192
CV 186,188,189
NA 156,60,252
CV 187,190,191
s_waitcnt lgkmcnt(3)
NC 128,32,160
R 54,7,10240
v_exp_f32 v128, v128
NC 136,32,168
v_exp_f32 v129, v129
NC 0,32,176
R 56,8,8192
NC 8,32,184
v_exp_f32 v130, v130
NC 132,36,160
R 58,8,10240
NC 140,36,168
v_exp_f32 v131, v131
NC 4,36,176
R 60,9,8192
buffer_load_dwordx4 v12, s[20:23], s75 offen offset:1024 lds
NC 12,36,184
NC 144,40,160
R 62,9,10240
CV 128,128,129
CV 129,130,131
NC 152,40,168
v_exp_f32 v132, v132
NC 16,40,176
ds_read_b128 v[32:35], v112 offset:0
NC 24,40,184
ds_read_b128 v[36:39], v113 offset:0
NC 148,44,160
v_exp_f32 v133, v133
NC 156,44,168
v_exp_f32 v134, v134
NC 20,44,176
v_exp_f32 v135, v135
NC 28,44,184
NV 80,124,160
buffer_load_dwordx4 v13, s[20:23], s75 offen offset:2048 lds
CV 130,132,133
CV 131,134,135
NV 84,124,168
v_exp_f32 v136, v136
NV 88,124,176
ds_read_b128 v[40:43], v112 offset:4096
NV 92,124,184
ds_read_b128 v[44:47], v113 offset:4096
s_waitcnt lgkmcnt(2)
NC 160,48,160
v_exp_f32 v137, v137
NC 168,48,168
v_exp_f32 v138, v138
NC 32,48,176
v_exp_f32 v139, v139
NC 40,48,184
NC 164,52,160
CV 136,136,137
CV 137,138,139
NC 172,52,168
v_exp_f32 v140, v140
NC 36,52,176
ds_read_b128 v[48:51], v112 offset:2048
buffer_load_dwordx4 v14, s[20:23], s75 offen offset:3072 lds
NC 44,52,184
v_exp_f32 v141, v141
NC 176,56,160
ds_read_b128 v[52:55], v113 offset:2048
NC 184,56,168
v_exp_f32 v142, v142
NC 48,56,176
v_exp_f32 v143, v143
NC 56,56,184
NC 180,60,160
CV 138,140,141
CV 139,142,143
NC 188,60,168
v_exp_f32 v144, v144
NC 52,60,176
ds_read_b128 v[56:59], v112 offset:6144
NC 60,60,184
s_add_u32 m0, s66, 77824
s_add_u32 s75, s63, 36864
v_mfma_f32_16x16x32_bf16 v[184:187], v[32:35], a[228:231], v[76:79]
ds_read_b128 v[60:63], v113 offset:6144
buffer_load_dwordx4 v11, s[20:23], s75 offen offset:0 lds
NA 184,36,236
v_exp_f32 v145, v145
v_mfma_f32_16x16x32_bf16 v[176:179], v[32:35], a[224:227], v[72:75]
v_exp_f32 v146, v146
NA 176,36,232
v_exp_f32 v147, v147
v_mfma_f32_16x16x32_bf16 v[168:171], v[32:35], a[196:199], v[68:71]
CV 144,144,145
NA 168,36,204
CV 145,146,147
v_mfma_f32_16x16x32_bf16 v[160:163], v[32:35], a[192:195], v[64:67]
v_exp_f32 v148, v148
NA 160,36,200
v_exp_f32 v149, v149
s_waitcnt lgkmcnt(0)
NA 160,40,208
R 32,19,16384
NA 160,44,216
v_exp_f32 v150, v150
NA 168,40,212
R 34,19,18432
v_exp_f32 v151, v151
NA 168,44,220
R 36,20,16384
NA 176,40,240
R 38,20,18432
NA 176,44,248
CV 146,148,149
NA 184,40,244
CV 147,150,151
NA 184,44,252
v_exp_f32 v152, v152
v_mfma_f32_16x16x32_bf16 v[188:191], v[48:51], a[228:231], v[76:79]
R 40,21,16384
v_exp_f32 v153, v153
NA 188,52,236
v_exp_f32 v154, v154
v_mfma_f32_16x16x32_bf16 v[180:183], v[48:51], a[224:227], v[72:75]
R 42,21,18432
NA 180,52,232
R 44,22,16384
v_mfma_f32_16x16x32_bf16 v[172:175], v[48:51], a[196:199], v[68:71]
R 46,22,18432
NA 172,52,204
v_exp_f32 v155, v155
v_mfma_f32_16x16x32_bf16 v[164:167], v[48:51], a[192:195], v[64:67]
CV 152,152,153
CV 153,154,155
NA 164,52,200
v_exp_f32 v156, v156
NA 164,56,208
v_exp_f32 v157, v157
NA 164,60,216
v_exp_f32 v158, v158
NA 172,56,212
R 48,19,24576
NA 172,60,220
v_exp_f32 v159, v159
NA 180,56,240
R 50,19,26624
buffer_load_dwordx4 v12, s[20:23], s75 offen offset:1024 lds
NA 180,60,248
NA 188,56,244
R 52,20,24576
CV 154,156,157
NA 188,60,252
CV 155,158,159
s_waitcnt lgkmcnt(3)
NC 128,32,128
R 54,20,26624
v_exp_f32 v160, v160
NC 136,32,136
v_exp_f32 v161, v161
NC 0,32,144
R 56,21,24576
NC 8,32,152
v_exp_f32 v162, v162
NC 132,36,128
R 58,21,26624
NC 140,36,136
v_exp_f32 v163, v163
NC 4,36,144
R 60,22,24576
buffer_load_dwordx4 v13, s[20:23], s75 offen offset:2048 lds
NC 12,36,152
NC 144,40,128
R 62,22,26624
CV 160,160,161
CV 161,162,163
NC 152,40,136
v_exp_f32 v164, v164
NC 16,40,144
ds_read_b128 v[32:35], v112 offset:8192
NC 24,40,152
ds_read_b128 v[36:39], v113 offset:8192
NC 148,44,128
v_exp_f32 v165, v165
NC 156,44,136
v_exp_f32 v166, v166
NC 20,44,144
v_exp_f32 v167, v167
NC 28,44,152
CV 162,164,165
NV 80,124,128
buffer_load_dwordx4 v14, s[20:23], s75 offen offset:3072 lds
CV 163,166,167
NV 84,124,136
v_exp_f32 v168, v168
NV 88,124,144
ds_read_b128 v[40:43], v112 offset:12288
NV 92,124,152
ds_read_b128 v[44:47], v113 offset:12288
s_waitcnt lgkmcnt(2)
NC 160,48,128
v_exp_f32 v169, v169
NC 168,48,136
v_exp_f32 v170, v170
NC 32,48,144
v_exp_f32 v171, v171
NC 40,48,152
CV 168,168,169
NC 164,52,128
CV 169,170,171
NC 172,52,136
v_exp_f32 v172, v172
NC 36,52,144
s_waitcnt vmcnt(8)
s_barrier
ds_read_b128 v[48:51], v112 offset:10240
NC 44,52,152
NC 176,56,128
ds_read_b128 v[52:55], v113 offset:10240
v_exp_f32 v173, v173
NC 184,56,136
s_add_u32 m0, s66, 110592
s_add_u32 s75, s63, 294912
NC 48,56,144
buffer_load_dwordx4 v11, s[20:23], s75 offen offset:0 lds
NC 56,56,152
v_exp_f32 v174, v174
NC 180,60,128
v_exp_f32 v175, v175
NC 188,60,136
NC 52,60,144
ds_read_b128 v[56:59], v112 offset:14336
CV 170,172,173
CV 171,174,175
NC 60,60,152
v_exp_f32 v176, v176
v_mfma_f32_16x16x32_bf16 v[152:155], v[32:35], a[228:231], v[76:79]
ds_read_b128 v[60:63], v113 offset:14336
NA 152,36,236
v_exp_f32 v177, v177
v_mfma_f32_16x16x32_bf16 v[144:147], v[32:35], a[224:227], v[72:75]
v_exp_f32 v178, v178
NA 144,36,232
v_mfma_f32_16x16x32_bf16 v[136:139], v[32:35], a[196:199], v[68:71]
v_exp_f32 v179, v179
NA 136,36,204
CV 176,176,177
CV 177,178,179
v_mfma_f32_16x16x32_bf16 v[128:131], v[32:35], a[192:195], v[64:67]
v_exp_f32 v180, v180
NA 128,36,200
v_exp_f32 v181, v181
s_waitcnt lgkmcnt(0)
NA 128,40,208
R 32,19,20480
NA 128,44,216
v_exp_f32 v182, v182
NA 136,40,212
R 34,19,22528
NA 136,44,220
R 36,20,20480
NA 144,40,240
R 38,20,22528
v_exp_f32 v183, v183
NA 144,44,248
CV 178,180,181
NA 152,40,244
CV 179,182,183
NA 152,44,252
v_exp_f32 v184, v184
v_mfma_f32_16x16x32_bf16 v[156:159], v[48:51], a[228:231], v[76:79]
R 40,21,20480
NA 156,52,236
v_exp_f32 v185, v185
v_mfma_f32_16x16x32_bf16 v[148:151], v[48:51], a[224:227], v[72:75]
R 42,21,22528
v_exp_f32 v186, v186
NA 148,52,232
R 44,22,20480
v_mfma_f32_16x16x32_bf16 v[140:143], v[48:51], a[196:199], v[68:71]
R 46,22,22528
NA 140,52,204
v_exp_f32 v187, v187
v_mfma_f32_16x16x32_bf16 v[132:135], v[48:51], a[192:195], v[64:67]
buffer_load_dwordx4 v12, s[20:23], s75 offen offset:1024 lds
CV 184,184,185
NA 132,52,200
CV 185,186,187
NA 132,56,208
v_exp_f32 v188, v188
NA 132,60,216
v_exp_f32 v189, v189
NA 140,56,212
R 48,19,28672
NA 140,60,220
v_exp_f32 v190, v190
NA 148,56,240
R 50,19,30720
NA 148,60,248
v_exp_f32 v191, v191
NA 156,56,244
R 52,20,28672
CV 186,188,189
NA 156,60,252
CV 187,190,191
s_waitcnt lgkmcnt(3)
NC 128,32,160
R 54,20,30720
buffer_load_dwordx4 v13, s[20:23], s75 offen offset:2048 lds
NC 136,32,168
v_exp_f32 v128, v128
NC 0,32,176
R 56,21,28672
NC 8,32,184
v_exp_f32 v129, v129
NC 132,36,160
R 58,21,30720
NC 140,36,168
v_exp_f32 v130, v130
NC 4,36,176
R 60,22,28672
NC 12,36,184
v_exp_f32 v131, v131
NC 144,40,160
R 62,22,30720
CV 128,128,129
NC 152,40,168
CV 129,130,131
NC 16,40,176
ds_read_b128 v[32:35], v112 offset:36864
buffer_load_dwordx4 v14, s[20:23], s75 offen offset:3072 lds
NC 24,40,184
ds_read_b128 v[36:39], v113 offset:36864
v_exp_f32 v132, v132
NC 148,44,160
v_exp_f32 v133, v133
NC 156,44,168
NC 20,44,176
v_exp_f32 v134, v134
NC 28,44,184
v_exp_f32 v135, v135
NV 80,124,160
CV 130,132,133
NV 84,124,168
CV 131,134,135
NV 88,124,176
ds_read_b128 v[40:43], v112 offset:40960
s_add_u32 m0, s66, 114688
s_add_u32 s75, s63, 331776
NV 92,124,184
ds_read_b128 v[44:47], v113 offset:40960
s_waitcnt lgkmcnt(2)
NC 160,48,160
buffer_load_dwordx4 v11, s[20:23], s75 offen offset:0 lds
LA_pad14:
s_cbranch_execz LA_cr0
v_exp_f32 v136, v136
NC 168,48,168
v_exp_f32 v137, v137
NC 32,48,176
v_exp_f32 v138, v138
NC 40,48,184
NC 164,52,160
v_exp_f32 v139, v139
NC 172,52,168
CV 136,136,137
NC 36,52,176
ds_read_b128 v[48:51], v112 offset:38912
CV 137,138,139
NC 44,52,184
v_exp_f32 v140, v140
NC 176,56,160
ds_read_b128 v[52:55], v113 offset:38912
NC 184,56,168
v_exp_f32 v141, v141
NC 48,56,176
v_exp_f32 v142, v142
NC 56,56,184
v_exp_f32 v143, v143
NC 180,60,160
CV 138,140,141
NC 188,60,168
CV 139,142,143
NC 52,60,176
ds_read_b128 v[56:59], v112 offset:43008
NC 60,60,184
v_exp_f32 v144, v144
v_mfma_f32_16x16x32_bf16 v[184:187], v[32:35], a[228:231], v[76:79]
ds_read_b128 v[60:63], v113 offset:43008
v_exp_f32 v145, v145
NA 184,36,236
v_exp_f32 v146, v146
v_mfma_f32_16x16x32_bf16 v[176:179], v[32:35], a[224:227], v[72:75]
v_exp_f32 v147, v147
NA 176,36,232
v_mfma_f32_16x16x32_bf16 v[168:171], v[32:35], a[196:199], v[68:71]
CV 144,144,145
CV 145,146,147
NA 168,36,204
v_exp_f32 v148, v148
v_mfma_f32_16x16x32_bf16 v[160:163], v[32:35], a[192:195], v[64:67]
v_exp_f32 v149, v149
NA 160,36,200
s_waitcnt lgkmcnt(0)
NA 160,40,208
R 32,19,53248
v_exp_f32 v150, v150
NA 160,44,216
v_exp_f32 v151, v151
NA 168,40,212
R 34,19,55296
NA 168,44,220
R 36,20,53248
NA 176,40,240
R 38,20,55296
buffer_load_dwordx4 v12, s[20:23], s75 offen offset:1024 lds
NA 176,44,248
CV 146,148,149
NA 184,40,244
CV 147,150,151
NA 184,44,252
v_exp_f32 v152, v152
s_add_u32 s100, s100, 4096
s_addc_u32 s101, s101, 0
v_mfma_f32_16x16x32_bf16 v[188:191], v[48:51], a[228:231], v[76:79]
R 40,21,53248
global_load_dword v0, v23, s[100:101]
v_exp_f32 v153, v153
NA 188,52,236
v_exp_f32 v154, v154
v_mfma_f32_16x16x32_bf16 v[180:183], v[48:51], a[224:227], v[72:75]
R 42,21,55296
NA 180,52,232
R 44,22,53248
v_mfma_f32_16x16x32_bf16 v[172:175], v[48:51], a[196:199], v[68:71]
R 46,22,55296
NA 172,52,204
v_exp_f32 v155, v155
v_mfma_f32_16x16x32_bf16 v[164:167], v[48:51], a[192:195], v[64:67]
buffer_load_dwordx4 v13, s[20:23], s75 offen offset:2048 lds
CV 152,152,153
NA 164,52,200
CV 153,154,155
NA 164,56,208
v_exp_f32 v156, v156
NA 164,60,216
v_exp_f32 v157, v157
NA 172,56,212
R 48,19,61440
NA 172,60,220
v_exp_f32 v158, v158
NA 180,56,240
R 50,19,63488
NA 180,60,248
v_exp_f32 v159, v159
NA 188,56,244
R 52,20,61440
CV 154,156,157
NA 188,60,252
CV 155,158,159
s_waitcnt lgkmcnt(3)
NC 128,32,128
R 54,20,63488
buffer_load_dwordx4 v14, s[20:23], s75 offen offset:3072 lds
v_exp_f32 v160, v160
NC 136,32,136
v_exp_f32 v161, v161
NC 0,32,144
R 56,21,61440
v_exp_f32 v162, v162
NC 8,32,152
v_exp_f32 v163, v163
CV 160,160,161
NC 132,36,128
R 58,21,63488
CV 161,162,163
v_exp_f32 v164, v164
NC 140,36,136
v_exp_f32 v165, v165
NC 4,36,144
R 60,22,61440
v_exp_f32 v166, v166
NC 12,36,152
v_exp_f32 v167, v167
CV 162,164,165
NC 144,40,128
R 62,22,63488
CV 163,166,167
v_exp_f32 v168, v168
NC 152,40,136
v_exp_f32 v169, v169
NC 16,40,144
s_waitcnt vmcnt(9)
s_barrier
R 32,19,57344
NC 24,40,152
NC 148,44,128
R 34,19,59392
v_exp_f32 v170, v170
NC 156,44,136
v_exp_f32 v171, v171
s_add_u32 m0, s66, 0
s_add_u32 s75, s63, 128
NC 20,44,144
R 36,20,57344
buffer_load_dwordx4 v11, s[20:23], s75 offen offset:0 lds
CV 168,168,169
NC 28,44,152
CV 169,170,171
v_exp_f32 v172, v172
NV 80,124,128
R 38,20,59392
v_exp_f32 v173, v173
NV 84,124,136
v_exp_f32 v174, v174
NV 88,124,144
R 40,21,57344
v_exp_f32 v175, v175
NV 92,124,152
CV 170,172,173
CV 171,174,175
s_waitcnt lgkmcnt(2)
NC 160,48,128
R 42,21,59392
v_exp_f32 v176, v176
NC 168,48,136
v_exp_f32 v177, v177
v_exp_f32 v178, v178
NC 32,48,144
R 44,22,57344
v_exp_f32 v179, v179
NC 40,48,152
CV 176,176,177
CV 177,178,179
NC 164,52,128
R 46,22,59392
v_exp_f32 v180, v180
NC 172,52,136
v_exp_f32 v181, v181
v_exp_f32 v182, v182
NC 36,52,144
v_exp_f32 v183, v183
CV 178,180,181
NC 44,52,152
CV 179,182,183
v_exp_f32 v184, v184
NC 176,56,128
v_exp_f32 v185, v185
v_exp_f32 v186, v186
NC 184,56,136
v_exp_f32 v187, v187
NC 48,56,144
R 48,3,0
CV 184,184,185
CV 185,186,187
NC 56,56,152
v_exp_f32 v188, v188
NC 180,60,128
R 50,3,2048
v_exp_f32 v189, v189
NC 188,60,136
v_exp_f32 v190, v190
NC 52,60,144
R 52,2,0
buffer_load_dwordx4 v12, s[20:23], s75 offen offset:1024 lds
v_exp_f32 v191, v191
NC 60,60,152
CV 186,188,189
CV 187,190,191
NC 128,32,160
R 54,2,2048
NC 136,32,168
NC 0,32,176
R 56,4,0
NC 8,32,184
s_waitcnt lgkmcnt(3)
NC 132,36,160
R 58,4,2048
buffer_load_dwordx4 v13, s[20:23], s75 offen offset:2048 lds
NC 140,36,168
NC 4,36,176
R 60,5,0
NC 12,36,184
NC 144,40,160
R 62,5,2048
NC 152,40,168
NC 16,40,176
buffer_load_dwordx4 v14, s[20:23], s75 offen offset:3072 lds
NC 24,40,184
NC 148,44,160
NC 156,44,168
NC 20,44,176
NC 28,44,184
NV 80,124,160
s_add_u32 m0, s66, 4096
s_add_u32 s75, s63, 36992
NV 84,124,168
NV 88,124,176
buffer_load_dwordx4 v11, s[20:23], s75 offen offset:0 lds
NV 92,124,184
NC 160,48,160
NC 168,48,168
NC 32,48,176
R 32,3,8192
NC 40,48,184
R 34,3,10240
s_waitcnt lgkmcnt(2)
NC 164,52,160
R 36,2,8192
NC 172,52,168
R 38,2,10240
NC 36,52,176
R 40,4,8192
NC 44,52,184
R 42,4,10240
NC 176,56,160
R 44,5,8192
NC 184,56,168
R 46,5,10240
NC 48,56,176
R 48,3,12288
NC 56,56,184
R 50,3,14336
NC 180,60,160
R 52,2,12288
NC 188,60,168
R 54,2,14336
NC 52,60,176
R 56,4,12288
NC 60,60,184
R 58,4,14336
v_mov_b32 v24, v80
v_mov_b32 v25, v84
v_mov_b32 v26, v88
v_mov_b32 v27, v92
v_add_f32 v80, v24, v25
v_add_f32 v81, v26, v27
v_add_f32 v80, v80, v81
v_cmp_ngt_f32 vcc, 0x49800000, v80
s_nop 1
s_cbranch_vccnz LA_slow1
LA_slowret1:
v_rcp_f32 v120, v24
v_rcp_f32 v121, v25
v_rcp_f32 v122, v26
v_rcp_f32 v123, v27
s_waitcnt lgkmcnt(4)
v_mfma_f32_16x16x32_bf16 v[64:67], v[32:35], v[192:195], 0
R 60,5,12288
v_mfma_f32_16x16x32_bf16 v[72:75], v[32:35], v[196:199], 0
R 62,5,14336
v_mfma_f32_16x16x32_bf16 v[68:71], v[36:39], v[192:195], 0
R 32,3,16384
buffer_load_dwordx4 v12, s[20:23], s75 offen offset:1024 lds
v_accvgpr_read_b32 v112, a128
v_accvgpr_read_b32 v113, a129
v_mfma_f32_16x16x32_bf16 v[76:79], v[36:39], v[196:199], 0
R 34,3,18432
v_accvgpr_read_b32 v114, a130
v_accvgpr_read_b32 v115, a131
v_mul_f32 v112, v112, v120
v_mfma_f32_16x16x32_bf16 v[80:83], v[40:43], v[192:195], 0
R 36,2,16384
v_mul_f32 v113, v113, v120
v_mul_f32 v114, v114, v120
v_mul_f32 v115, v115, v120
CV 128,112,113
v_mfma_f32_16x16x32_bf16 v[88:91], v[40:43], v[196:199], 0
R 38,2,18432
CV 129,114,115
v_accvgpr_read_b32 v116, a132
v_accvgpr_read_b32 v117, a133
v_mfma_f32_16x16x32_bf16 v[84:87], v[44:47], v[192:195], 0
R 40,4,16384
v_accvgpr_read_b32 v118, a134
v_accvgpr_read_b32 v119, a135
v_mul_f32 v116, v116, v120
v_mfma_f32_16x16x32_bf16 v[92:95], v[44:47], v[196:199], 0
R 42,4,18432
v_mul_f32 v117, v117, v120
v_mul_f32 v118, v118, v120
v_mul_f32 v119, v119, v120
NV 64,48,200
R 44,5,16384
buffer_load_dwordx4 v13, s[20:23], s75 offen offset:2048 lds
CV 130,116,117
CV 131,118,119
NV 72,48,204
R 46,5,18432
v_accvgpr_read_b32 v112, a136
v_accvgpr_read_b32 v113, a137
v_accvgpr_read_b32 v114, a138
s_waitcnt lgkmcnt(4)
NV 68,52,200
R 48,3,20480
v_accvgpr_read_b32 v115, a139
v_mul_f32 v112, v112, v121
v_mul_f32 v113, v113, v121
NV 76,52,204
R 50,3,22528
v_mul_f32 v114, v114, v121
v_mul_f32 v115, v115, v121
CV 132,112,113
NV 80,56,200
R 52,2,20480
CV 133,114,115
v_accvgpr_read_b32 v116, a140
v_accvgpr_read_b32 v117, a141
NV 88,56,204
R 54,2,22528
v_accvgpr_read_b32 v118, a142
v_accvgpr_read_b32 v119, a143
v_mul_f32 v116, v116, v121
NV 84,60,200
R 56,4,20480
buffer_load_dwordx4 v14, s[20:23], s75 offen offset:3072 lds
v_mul_f32 v117, v117, v121
v_mul_f32 v118, v118, v121
NV 92,60,204
R 58,4,22528
v_mul_f32 v119, v119, v121
CV 134,116,117
CV 135,118,119
NV 64,32,208
R 60,5,20480
v_accvgpr_read_b32 v112, a144
v_accvgpr_read_b32 v113, a145
v_accvgpr_read_b32 v114, a146
v_accvgpr_read_b32 v115, a147
NV 72,32,212
R 62,5,22528
v_mul_f32 v112, v112, v120
v_mul_f32 v113, v113, v120
v_mul_f32 v114, v114, v120
NV 68,36,208
R 32,3,24576
v_mul_f32 v115, v115, v120
CV 136,112,113
CV 137,114,115
v_accvgpr_read_b32 v116, a148
NV 76,36,212
R 34,3,26624
v_accvgpr_read_b32 v117, a149
v_accvgpr_read_b32 v118, a150
v_accvgpr_read_b32 v119, a151
s_waitcnt lgkmcnt(4)
NV 80,40,208
R 36,2,24576
v_mul_f32 v116, v116, v120
v_mul_f32 v117, v117, v120
v_mul_f32 v118, v118, v120
v_mul_f32 v119, v119, v120
NV 88,40,212
R 38,2,26624
CV 138,116,117
CV 139,118,119
v_accvgpr_read_b32 v112, a152
v_accvgpr_read_b32 v113, a153
NV 84,44,208
s_waitcnt vmcnt(8)
s_barrier
R 40,4,24576
NV 92,44,212
R 42,4,26624
NV 64,48,216
R 44,5,24576
v_accvgpr_read_b32 v114, a154
v_accvgpr_read_b32 v115, a155
v_mul_f32 v112, v112, v121
NV 72,48,220
R 46,5,26624
v_mul_f32 v113, v113, v121
v_mul_f32 v114, v114, v121
s_add_u32 m0, s66, 36864
s_add_u32 s75, s63, 295040
NV 68,52,216
R 48,3,28672
buffer_load_dwordx4 v11, s[20:23], s75 offen offset:0 lds
v_mul_f32 v115, v115, v121
CV 140,112,113
CV 141,114,115
NV 76,52,220
R 50,3,30720
v_accvgpr_read_b32 v116, a156
v_accvgpr_read_b32 v117, a157
v_accvgpr_read_b32 v118, a158
NV 80,56,216
R 52,2,28672
v_accvgpr_read_b32 v119, a159
v_mul_f32 v116, v116, v121
v_mul_f32 v117, v117, v121
v_mul_f32 v118, v118, v121
NV 88,56,220
R 54,2,30720
v_mul_f32 v119, v119, v121
CV 142,116,117
CV 143,118,119
s_waitcnt lgkmcnt(4)
NV 84,60,216
R 56,4,28672
v_accvgpr_read_b32 v112, a160
v_accvgpr_read_b32 v113, a161
v_accvgpr_read_b32 v114, a162
NV 92,60,220
R 58,4,30720
v_accvgpr_read_b32 v115, a163
v_mul_f32 v112, v112, v120
v_mul_f32 v113, v113, v120
NV 64,32,224
R 60,5,28672
v_mul_f32 v114, v114, v120
v_mul_f32 v115, v115, v120
CV 144,112,113
NV 72,32,228
R 62,5,30720
CV 145,114,115
v_accvgpr_read_b32 v116, a164
v_accvgpr_read_b32 v117, a165
NV 68,36,224
R 32,3,32768
v_accvgpr_read_b32 v118, a166
v_accvgpr_read_b32 v119, a167
v_mul_f32 v116, v116, v120
NV 76,36,228
R 34,3,34816
v_mul_f32 v117, v117, v120
v_mul_f32 v118, v118, v120
v_mul_f32 v119, v119, v120
NV 80,40,224
R 36,2,32768
CV 146,116,117
CV 147,118,119
v_accvgpr_read_b32 v112, a168
NV 88,40,228
R 38,2,34816
v_accvgpr_read_b32 v113, a169
v_accvgpr_read_b32 v114, a170
v_accvgpr_read_b32 v115, a171
NV 84,44,224
R 40,4,32768
v_mul_f32 v112, v112, v121
v_mul_f32 v113, v113, v121
v_mul_f32 v114, v114, v121
NV 92,44,228
R 42,4,34816
v_mul_f32 v115, v115, v121
CV 148,112,113
CV 149,114,115
s_waitcnt lgkmcnt(4)
NV 64,48,232
R 44,5,32768
buffer_load_dwordx4 v12, s[20:23], s75 offen offset:1024 lds
v_accvgpr_read_b32 v116, a172
v_accvgpr_read_b32 v117, a173
NV 72,48,236
R 46,5,34816
v_accvgpr_read_b32 v118, a174
v_accvgpr_read_b32 v119, a175
NV 68,52,232
R 48,3,36864
v_mul_f32 v116, v116, v121
v_mul_f32 v117, v117, v121
v_mul_f32 v118, v118, v121
NV 76,52,236
R 50,3,38912
v_mul_f32 v119, v119, v121
CV 150,116,117
CV 151,118,119
NV 80,56,232
R 52,2,36864
v_accvgpr_read_b32 v112, a176
v_accvgpr_read_b32 v113, a177
v_accvgpr_read_b32 v114, a178
v_accvgpr_read_b32 v115, a179
NV 88,56,236
R 54,2,38912
v_mul_f32 v112, v112, v120
v_mul_f32 v113, v113, v120
v_mul_f32 v114, v114, v120
NV 84,60,232
R 56,4,36864
buffer_load_dwordx4 v13, s[20:23], s75 offen offset:2048 lds
v_mul_f32 v115, v115, v120
CV 152,112,113
NV 92,60,236
R 58,4,38912
CV 153,114,115
v_accvgpr_read_b32 v116, a180
v_accvgpr_read_b32 v117, a181
NV 64,32,240
R 60,5,36864
v_accvgpr_read_b32 v118, a182
v_accvgpr_read_b32 v119, a183
v_mul_f32 v116, v116, v120
NV 72,32,244
R 62,5,38912
v_mul_f32 v117, v117, v120
v_mul_f32 v118, v118, v120
v_mul_f32 v119, v119, v120
s_waitcnt lgkmcnt(4)
NV 68,36,240
R 32,3,45056
buffer_load_dwordx4 v14, s[20:23], s75 offen offset:3072 lds
CV 154,116,117
CV 155,118,119
v_accvgpr_read_b32 v112, a184
NV 76,36,244
R 34,3,47104
v_accvgpr_read_b32 v113, a185
v_accvgpr_read_b32 v114, a186
v_accvgpr_read_b32 v115, a187
NV 80,40,240
R 36,2,45056
v_mul_f32 v112, v112, v121
v_mul_f32 v113, v113, v121
v_mul_f32 v114, v114, v121
NV 88,40,244
R 38,2,47104
v_mul_f32 v115, v115, v121
CV 156,112,113
CV 157,114,115
NV 84,44,240
R 40,4,45056
v_accvgpr_read_b32 v116, a188
v_accvgpr_read_b32 v117, a189
v_accvgpr_read_b32 v118, a190
NV 92,44,244
R 42,4,47104
v_accvgpr_read_b32 v119, a191
v_mul_f32 v116, v116, v121
s_add_u32 m0, s66, 40960
s_add_u32 s75, s63, 331904
NV 64,48,248
R 44,5,45056
buffer_load_dwordx4 v11, s[20:23], s75 offen offset:0 lds
v_mul_f32 v117, v117, v121
v_mul_f32 v118, v118, v121
NV 72,48,252
R 46,5,47104
v_mul_f32 v119, v119, v121
CV 158,116,117
CV 159,118,119
NV 68,52,248
LA_pad15:
s_cbranch_execz LA_cr0
R 48,3,49152
v_accvgpr_read_b32 v112, a0
v_accvgpr_read_b32 v113, a1
v_accvgpr_read_b32 v114, a2
NV 76,52,252
R 50,3,51200
v_accvgpr_read_b32 v115, a3
v_mul_f32 v112, v112, v122
v_mul_f32 v113, v113, v122
s_waitcnt lgkmcnt(4)
NV 80,56,248
R 52,2,49152
v_mul_f32 v114, v114, v122
v_mul_f32 v115, v115, v122
CV 160,112,113
NV 88,56,252
R 54,2,51200
CV 161,114,115
v_accvgpr_read_b32 v116, a4
v_accvgpr_read_b32 v117, a5
NV 84,60,248
R 56,4,49152
v_accvgpr_read_b32 v118, a6
v_accvgpr_read_b32 v119, a7
v_mul_f32 v116, v116, v122
NV 92,60,252
R 58,4,51200
v_mul_f32 v117, v117, v122
v_mul_f32 v118, v118, v122
v_mul_f32 v119, v119, v122
NV 64,32,128
R 60,5,49152
CV 162,116,117
CV 163,118,119
v_accvgpr_read_b32 v112, a8
NV 72,32,132
R 62,5,51200
v_accvgpr_read_b32 v113, a9
v_accvgpr_read_b32 v114, a10
v_accvgpr_read_b32 v115, a11
NV 68,36,128
R 32,3,53248
v_mul_f32 v112, v112, v123
v_mul_f32 v113, v113, v123
v_mul_f32 v114, v114, v123
NV 76,36,132
R 34,3,55296
v_mul_f32 v115, v115, v123
CV 164,112,113
CV 165,114,115
NV 80,40,128
R 36,2,53248
v_accvgpr_read_b32 v116, a12
v_accvgpr_read_b32 v117, a13
v_accvgpr_read_b32 v118, a14
NV 88,40,132
R 38,2,55296
v_accvgpr_read_b32 v119, a15
v_mul_f32 v116, v116, v123
s_waitcnt lgkmcnt(4)
NV 84,44,128
R 40,4,53248
buffer_load_dwordx4 v12, s[20:23], s75 offen offset:1024 lds
v_mul_f32 v117, v117, v123
v_mul_f32 v118, v118, v123
NV 92,44,132
R 42,4,55296
v_mul_f32 v119, v119, v123
CV 166,116,117
CV 167,118,119
NV 64,48,136
R 44,5,53248
v_accvgpr_read_b32 v112, a16
v_accvgpr_read_b32 v113, a17
v_accvgpr_read_b32 v114, a18
NV 72,48,140
R 46,5,55296
v_accvgpr_read_b32 v115, a19
v_mul_f32 v112, v112, v122
v_mul_f32 v113, v113, v122
NV 68,52,136
R 48,3,57344
v_mul_f32 v114, v114, v122
v_mul_f32 v115, v115, v122
CV 168,112,113
NV 76,52,140
R 50,3,59392
CV 169,114,115
v_accvgpr_read_b32 v116, a20
v_accvgpr_read_b32 v117, a21
NV 80,56,136
R 52,2,57344
buffer_load_dwordx4 v13, s[20:23], s75 offen offset:2048 lds
v_accvgpr_read_b32 v118, a22
v_accvgpr_read_b32 v119, a23
NV 88,56,140
R 54,2,59392
v_mul_f32 v116, v116, v122
v_mul_f32 v117, v117, v122
v_mul_f32 v118, v118, v122
NV 84,60,136
R 56,4,57344
v_mul_f32 v119, v119, v122
CV 170,116,117
CV 171,118,119
NV 92,60,140
R 58,4,59392
v_accvgpr_read_b32 v112, a24
v_accvgpr_read_b32 v113, a25
v_accvgpr_read_b32 v114, a26
s_waitcnt lgkmcnt(4)
NV 64,32,144
R 60,5,57344
buffer_load_dwordx4 v14, s[20:23], s75 offen offset:3072 lds
v_accvgpr_read_b32 v115, a27
v_mul_f32 v112, v112, v123
NV 72,32,148
R 62,5,59392
v_mul_f32 v113, v113, v123
v_mul_f32 v114, v114, v123
v_mul_f32 v115, v115, v123
NV 68,36,144
R 32,3,61440
CV 172,112,113
CV 173,114,115
v_accvgpr_read_b32 v116, a28
NV 76,36,148
R 34,3,63488
v_accvgpr_read_b32 v117, a29
v_accvgpr_read_b32 v118, a30
v_accvgpr_read_b32 v119, a31
NV 80,40,144
R 36,2,61440
v_mul_f32 v116, v116, v123
v_mul_f32 v117, v117, v123
v_mul_f32 v118, v118, v123
NV 88,40,148
R 38,2,63488
v_mul_f32 v119, v119, v123
CV 174,116,117
CV 175,118,119
NV 84,44,144
s_waitcnt vmcnt(8)
s_barrier
R 40,4,61440
NV 92,44,148
R 42,4,63488
NV 64,48,152
R 44,5,61440
v_accvgpr_read_b32 v112, a32
v_accvgpr_read_b32 v113, a33
v_accvgpr_read_b32 v114, a34
v_accvgpr_read_b32 v115, a35
NV 72,48,156
R 46,5,63488
v_mul_f32 v112, v112, v122
v_mul_f32 v113, v113, v122
s_add_u32 m0, s66, 73728
s_add_u32 s75, s63, 256
s_waitcnt lgkmcnt(4)
NV 68,52,152
R 48,6,0
buffer_load_dwordx4 v11, s[20:23], s75 offen offset:0 lds
v_mul_f32 v114, v114, v122
v_mul_f32 v115, v115, v122
CV 176,112,113
NV 76,52,156
R 50,6,2048
CV 177,114,115
v_accvgpr_read_b32 v116, a36
v_accvgpr_read_b32 v117, a37
NV 80,56,152
R 52,7,0
v_accvgpr_read_b32 v118, a38
v_accvgpr_read_b32 v119, a39
v_mul_f32 v116, v116, v122
v_mul_f32 v117, v117, v122
NV 88,56,156
R 54,7,2048
v_mul_f32 v118, v118, v122
v_mul_f32 v119, v119, v122
CV 178,116,117
NV 84,60,152
R 56,8,0
CV 179,118,119
v_accvgpr_read_b32 v112, a40
v_accvgpr_read_b32 v113, a41
v_accvgpr_read_b32 v114, a42
NV 92,60,156
R 58,8,2048
v_accvgpr_read_b32 v115, a43
v_mul_f32 v112, v112, v123
v_mul_f32 v113, v113, v123
NV 64,32,160
R 60,9,0
v_mul_f32 v114, v114, v123
v_mul_f32 v115, v115, v123
CV 180,112,113
CV 181,114,115
NV 72,32,164
R 62,9,2048
v_accvgpr_read_b32 v116, a44
v_accvgpr_read_b32 v117, a45
v_accvgpr_read_b32 v118, a46
NV 68,36,160
R 32,6,4096
v_accvgpr_read_b32 v119, a47
v_mul_f32 v116, v116, v123
v_mul_f32 v117, v117, v123
v_mul_f32 v118, v118, v123
NV 76,36,164
R 34,6,6144
v_mul_f32 v119, v119, v123
CV 182,116,117
CV 183,118,119
s_waitcnt lgkmcnt(4)
NV 80,40,160
R 36,7,4096
v_accvgpr_read_b32 v112, a48
v_accvgpr_read_b32 v113, a49
v_accvgpr_read_b32 v114, a50
NV 88,40,164
R 38,7,6144
v_accvgpr_read_b32 v115, a51
v_mul_f32 v112, v112, v122
v_mul_f32 v113, v113, v122
NV 84,44,160
R 40,8,4096
v_mul_f32 v114, v114, v122
v_mul_f32 v115, v115, v122
CV 184,112,113
NV 92,44,164
R 42,8,6144
CV 185,114,115
v_accvgpr_read_b32 v116, a52
v_accvgpr_read_b32 v117, a53
NV 64,48,168
R 44,9,4096
buffer_load_dwordx4 v12, s[20:23], s75 offen offset:1024 lds
v_accvgpr_read_b32 v118, a54
v_accvgpr_read_b32 v119, a55
NV 72,48,172
R 46,9,6144
v_mul_f32 v116, v116, v122
v_mul_f32 v117, v117, v122
v_mul_f32 v118, v118, v122
NV 68,52,168
R 48,6,8192
v_mul_f32 v119, v119, v122
CV 186,116,117
CV 187,118,119
NV 76,52,172
R 50,6,10240
v_accvgpr_read_b32 v112, a56
v_accvgpr_read_b32 v113, a57
v_accvgpr_read_b32 v114, a58
NV 80,56,168
R 52,7,8192
v_accvgpr_read_b32 v115, a59
v_mul_f32 v112, v112, v123
v_mul_f32 v113, v113, v123
NV 88,56,172
R 54,7,10240
v_mul_f32 v114, v114, v123
v_mul_f32 v115, v115, v123
CV 188,112,113
s_waitcnt lgkmcnt(4)
NV 84,60,168
R 56,8,8192
buffer_load_dwordx4 v13, s[20:23], s75 offen offset:2048 lds
CV 189,114,115
v_accvgpr_read_b32 v116, a60
NV 92,60,172
R 58,8,10240
v_accvgpr_read_b32 v117, a61
v_accvgpr_read_b32 v118, a62
v_accvgpr_read_b32 v119, a63
NV 64,32,176
R 60,9,8192
v_mul_f32 v116, v116, v123
v_mul_f32 v117, v117, v123
v_mul_f32 v118, v118, v123
NV 72,32,180
R 62,9,10240
v_mul_f32 v119, v119, v123
CV 190,116,117
CV 191,118,119
NV 68,36,176
R 32,19,0
buffer_load_dwordx4 v14, s[20:23], s75 offen offset:3072 lds
NV 76,36,180
R 34,19,2048
NV 80,40,176
R 36,19,4096
NV 88,40,180
R 38,19,6144
NV 84,44,176
R 40,19,8192
s_add_u32 m0, s66, 77824
s_add_u32 s75, s63, 37120
NV 92,44,180
R 42,19,10240
s_waitcnt lgkmcnt(6)
NV 64,48,184
R 44,19,12288
buffer_load_dwordx4 v11, s[20:23], s75 offen offset:0 lds
NV 72,48,188
R 46,19,14336
NV 68,52,184
R 48,19,16384
NV 76,52,188
R 50,19,18432
NV 80,56,184
R 52,19,20480
NV 88,56,188
R 54,19,22528
NV 84,60,184
R 56,19,24576
NV 92,60,188
R 58,19,26624
s_waitcnt lgkmcnt(7)
v_mfma_f32_16x16x32_bf16 v[96:99], v[32:35], v[192:195], 0
R 60,19,28672
v_mfma_f32_16x16x32_bf16 v[104:107], v[32:35], v[196:199], 0
R 62,19,30720
NV 104,36,204
R 32,20,0
NV 96,36,200
R 34,20,2048
NV 96,40,208
R 36,20,4096
s_lshr_b32 s73, s52, 1
s_and_b32 s74, s52, 1
s_lshl_b32 s85, s74, 9
s_and_b32 s72, s53, 1
s_lshl_b32 s72, s72, 7
s_add_u32 s85, s85, s72
NV 104,40,212
R 38,20,6144
s_waitcnt lgkmcnt(6)
NV 104,44,220
R 40,20,8192
buffer_load_dwordx4 v12, s[20:23], s75 offen offset:1024 lds
s_and_b32 s72, s53, 2
s_lshl_b32 s72, s72, 9
s_add_u32 s85, s85, s72
s_lshl_b32 s72, s73, 11
s_add_u32 s85, s85, s72
s_lshr_b32 s71, s53, 2
NV 96,44,216
R 42,20,10240
NV 96,48,224
R 44,20,12288
s_lshl_b32 s72, s54, 5
s_add_u32 s72, s72, s71
s_mul_i32 s84, s72, 36864
s_add_u32 s84, s84, s85
s_lshl_b32 s72, s54, 2
s_add_u32 s72, s72, s71
NV 104,48,228
R 46,20,14336
NV 104,52,236
R 48,20,16384
s_lshl_b32 s88, s72, 7
s_mul_i32 s72, s72, 36864
s_add_u32 s85, s85, s72
s_add_u32 s85, s85, 2359296
s_lshl_b32 s72, s54, 4
s_add_u32 s72, s72, s53
NV 96,52,232
R 50,20,18432
NV 96,56,240
R 52,20,20480
buffer_load_dwordx4 v13, s[20:23], s75 offen offset:2048 lds
s_mul_i32 s86, s72, 9216
s_lshl_b32 s73, s73, 6
s_lshl_b32 s74, s74, 4
s_add_u32 s87, s73, s74
s_lshl_b32 s79, s52, 10
NV 104,56,244
R 54,20,22528
s_waitcnt lgkmcnt(5)
NV 104,60,252
R 56,20,24576
CV 64,64,65
NV 96,60,248
R 58,20,26624
CV 65,66,67
v_mfma_f32_16x16x32_bf16 v[100:103], v[32:35], v[192:195], 0
R 60,20,28672
buffer_load_dwordx4 v14, s[20:23], s75 offen offset:3072 lds
v_mfma_f32_16x16x32_bf16 v[108:111], v[32:35], v[196:199], 0
R 62,20,30720
v_and_b32 v25, 7, v1
NV 108,36,204
R 32,21,0
CV 66,68,69
NV 100,36,200
R 34,21,2048
v_and_b32 v29, 8, v1
NV 100,40,208
R 36,21,4096
CV 67,70,71
NV 108,40,212
R 38,21,6144
s_add_u32 s76, s78, 4849664
s_waitcnt lgkmcnt(6)
NV 108,44,220
s_waitcnt vmcnt(8)
s_barrier
R 40,21,8192
buffer_store_dwordx4 v[64:67], v23, s[48:51], s76 offen offset:0 sc1
NV 100,44,216
R 42,21,10240
NV 100,48,224
R 44,21,12288
s_add_u32 m0, s66, 110592
s_add_u32 s75, s63, 295168
NV 108,48,228
R 46,21,14336
NV 108,52,236
R 48,21,16384
buffer_load_dwordx4 v11, s[20:23], s75 offen offset:0 lds
NV 100,52,232
R 50,21,18432
v_lshrrev_b32 v28, 4, v1
NV 100,56,240
R 52,21,20480
v_lshlrev_b32 v18, 4, v25
NV 108,56,244
R 54,21,22528
v_lshl_add_u32 v18, v29, 5, v18
s_waitcnt lgkmcnt(6)
NV 108,60,252
R 56,21,24576
v_mul_u32_u24 v15, 294912, v28
NV 100,60,248
R 58,21,26624
v_add_u32 v15, v15, v18
v_mfma_f32_16x16x32_bf16 v[112:115], v[32:35], v[192:195], 0
R 60,21,28672
v_add_u32 v16, 0x1000, v15
v_mfma_f32_16x16x32_bf16 v[120:123], v[32:35], v[196:199], 0
R 62,21,30720
NV 120,36,204
R 32,22,0
v_lshl_add_u32 v18, v28, 12, v18
NV 112,36,200
R 34,22,2048
v_mul_u32_u24 v17, 1152, v25
NV 112,40,208
R 36,22,4096
CV 68,72,73
NV 120,40,212
R 38,22,6144
CV 69,74,75
s_waitcnt lgkmcnt(6)
NV 120,44,220
R 40,22,8192
v_add3_u32 v17, v17, v29, s87
NV 112,44,216
R 42,22,10240
CV 70,76,77
NV 112,48,224
R 44,22,12288
buffer_load_dwordx4 v12, s[20:23], s75 offen offset:1024 lds
NV 120,48,228
R 46,22,14336
v_lshl_add_u32 v17, v28, 5, v17
NV 120,52,236
R 48,22,16384
CV 71,78,79
NV 112,52,232
R 50,22,18432
v_and_b32 v25, 32, v1
NV 112,56,240
R 52,22,20480
buffer_store_dwordx4 v[68:71], v23, s[48:51], s76 offen offset:1024 sc1
NV 120,56,244
R 54,22,22528
s_waitcnt lgkmcnt(6)
NV 120,60,252
R 56,22,24576
buffer_load_dwordx4 v13, s[20:23], s75 offen offset:2048 lds
NV 112,60,248
R 58,22,26624
v_mfma_f32_16x16x32_bf16 v[116:119], v[32:35], v[192:195], 0
R 60,22,28672
v_lshl_add_u32 v17, v25, 1, v17
v_mfma_f32_16x16x32_bf16 v[124:127], v[32:35], v[196:199], 0
R 62,22,30720
v_add_u32 v26, 147456, v17
NV 124,36,204
R 32,19,36864
buffer_load_dwordx4 v14, s[20:23], s75 offen offset:3072 lds
NV 116,36,200
R 34,19,38912
v_lshlrev_b32 v25, 26, v25
NV 116,40,208
R 36,19,40960
v_or_b32 v27, v25, v17
NV 124,40,212
R 38,19,43008
v_mov_b32 v25, 2147483648
s_waitcnt lgkmcnt(6)
NV 124,44,220
R 40,19,45056
s_add_u32 m0, s66, 114688
s_add_u32 s75, s63, 332032
NV 116,44,216
R 42,19,47104
NV 116,48,224
R 44,19,49152
buffer_load_dwordx4 v11, s[20:23], s75 offen offset:0 lds
v_cmp_gt_u32 vcc, 16, v1
s_nop 1
v_cndmask_b32 v28, v25, v18, vcc
NV 124,48,228
R 46,19,51200
NV 124,52,236
R 48,19,53248
v_and_b32 v24, 15, v1
NV 116,52,232
R 50,19,55296
NV 116,56,240
R 52,19,57344
CV 80,80,81
NV 124,56,244
R 54,19,59392
s_waitcnt lgkmcnt(6)
NV 124,60,252
R 56,19,61440
v_lshl_add_u32 v24, v24, 2, s88
NV 116,60,248
R 58,19,63488
CV 81,82,83
NV 96,32,128
R 60,3,0
CV 82,84,85
NV 104,32,132
R 62,3,2048
NV 104,36,140
R 32,20,36864
CV 83,86,87
NV 96,36,136
R 34,20,38912
NV 96,40,144
R 36,20,40960
NV 104,40,148
R 38,20,43008
s_waitcnt lgkmcnt(6)
NV 104,44,156
R 40,20,45056
buffer_load_dwordx4 v12, s[20:23], s75 offen offset:1024 lds
buffer_store_dwordx4 v[80:83], v23, s[48:51], s76 offen offset:2048 sc1
NV 96,44,152
R 42,20,47104
NV 96,48,160
R 44,20,49152
NV 104,48,164
R 46,20,51200
NV 104,52,172
R 48,20,53248
NV 96,52,168
R 50,20,55296
NV 96,56,176
R 52,20,57344
buffer_load_dwordx4 v13, s[20:23], s75 offen offset:2048 lds
NV 104,56,180
R 54,20,59392
s_waitcnt lgkmcnt(7)
NV 104,60,188
R 56,20,61440
LA_pad16:
s_cbranch_execz LA_cr0
NV 96,60,184
R 58,20,63488
NV 100,32,128
R 60,2,0
buffer_load_dwordx4 v14, s[20:23], s75 offen offset:3072 lds
NV 108,32,132
R 62,2,2048
NV 108,36,140
R 32,21,36864
NV 100,36,136
R 34,21,38912
s_waitcnt lgkmcnt(6)
NV 100,40,144
R 36,21,40960
CV 84,88,89
NV 108,40,148
R 38,21,43008
NV 108,44,156
s_waitcnt vmcnt(11)
s_barrier
R 40,21,45056
NV 100,44,152
R 42,21,47104
NV 100,48,160
R 44,21,49152
s_add_u32 m0, s66, 0
s_add_u32 s75, s63, 384
NV 108,48,164
R 46,21,51200
NV 108,52,172
R 48,21,53248
buffer_load_dwordx4 v11, s[20:23], s75 offen offset:0 lds
NV 100,52,168
R 50,21,55296
s_waitcnt lgkmcnt(6)
NV 100,56,176
R 52,21,57344
CV 85,90,91
NV 108,56,180
R 54,21,59392
NV 108,60,188
R 56,21,61440
CV 86,92,93
NV 100,60,184
R 58,21,63488
NV 112,32,128
R 60,4,0
CV 87,94,95
NV 120,32,132
R 62,4,2048
NV 120,36,140
R 32,22,36864
NV 112,36,136
R 34,22,38912
s_waitcnt lgkmcnt(6)
NV 112,40,144
R 36,22,40960
buffer_store_dwordx4 v[84:87], v23, s[48:51], s76 offen offset:3072 sc1
NV 120,40,148
R 38,22,43008
NV 120,44,156
R 40,22,45056
NV 112,44,152
R 42,22,47104
NV 112,48,160
R 44,22,49152
buffer_load_dwordx4 v12, s[20:23], s75 offen offset:1024 lds
NV 120,48,164
R 46,22,51200
NV 120,52,172
R 48,22,53248
NV 112,52,168
R 50,22,55296
s_waitcnt lgkmcnt(7)
NV 112,56,176
R 52,22,57344
NV 120,56,180
R 54,22,59392
NV 120,60,188
R 56,22,61440
buffer_load_dwordx4 v13, s[20:23], s75 offen offset:2048 lds
NV 112,60,184
R 58,22,63488
NV 116,32,128
R 60,5,0
NV 124,32,132
R 62,5,2048
s_waitcnt lgkmcnt(6)
NV 124,36,140
R 32,3,8192
buffer_load_dwordx4 v14, s[20:23], s75 offen offset:3072 lds
NV 116,36,136
R 34,3,10240
NV 116,40,144
R 36,3,12288
NV 124,40,148
R 38,3,14336
NV 124,44,156
s_mov_b64 exec, 0
s_cmp_eq_u32 s52, 0
s_cbranch_scc1 LA_pad17
s_cmp_eq_u32 s52, 1
s_cbranch_scc1 LA_pad18
s_cmp_eq_u32 s52, 2
s_cbranch_scc1 LA_pad19
s_branch LA_pad20
LA_cr1:
s_mov_b64 exec, -1
R 40,3,16384
s_add_u32 m0, s66, 4096
s_add_u32 s75, s63, 37248
NV 116,44,152
R 42,3,18432
NV 116,48,160
R 44,3,20480
buffer_load_dwordx4 v11, s[20:23], s75 offen offset:0 lds
NV 124,48,164
R 46,3,22528
s_waitcnt lgkmcnt(6)
NV 124,52,172
R 48,3,24576
NV 116,52,168
R 50,3,26624
NV 116,56,176
R 52,3,28672
NV 124,56,180
R 54,3,30720
NV 124,60,188
R 56,3,32768
NV 116,60,184
R 58,3,34816
v_mfma_f32_16x16x32_bf16 v[64:67], v[32:35], v[192:195], 0
R 60,3,36864
v_mfma_f32_16x16x32_bf16 v[72:75], v[32:35], v[196:199], 0
R 62,3,38912
s_waitcnt lgkmcnt(7)
NV 72,36,204
R 32,2,8192
NV 64,36,200
R 34,2,10240
NV 64,40,208
R 36,2,12288
NV 72,40,212
R 38,2,14336
NV 72,44,220
R 40,2,16384
buffer_load_dwordx4 v12, s[20:23], s75 offen offset:1024 lds
NV 64,44,216
R 42,2,18432
s_waitcnt lgkmcnt(6)
NV 64,48,224
R 44,2,20480
CV 96,96,97
NV 72,48,228
R 46,2,22528
CV 97,98,99
NV 72,52,236
R 48,2,24576
CV 98,100,101
NV 64,52,232
R 50,2,26624
NV 64,56,240
R 52,2,28672
buffer_load_dwordx4 v13, s[20:23], s75 offen offset:2048 lds
NV 72,56,244
R 54,2,30720
NV 72,60,252
R 56,2,32768
CV 99,102,103
NV 64,60,248
R 58,2,34816
s_waitcnt lgkmcnt(6)
v_mfma_f32_16x16x32_bf16 v[68:71], v[32:35], v[192:195], 0
R 60,2,36864
buffer_load_dwordx4 v14, s[20:23], s75 offen offset:3072 lds
v_mfma_f32_16x16x32_bf16 v[76:79], v[32:35], v[196:199], 0
R 62,2,38912
NV 76,36,204
R 32,4,8192
s_add_u32 s76, s78, 4853760
NV 68,36,200
R 34,4,10240
NV 68,40,208
R 36,4,12288
buffer_store_dwordx4 v[96:99], v23, s[48:51], s76 offen offset:0 sc1
NV 76,40,212
R 38,4,14336
NV 76,44,220
s_waitcnt vmcnt(10)
s_barrier
R 40,4,16384
NV 68,44,216
R 42,4,18432
s_waitcnt lgkmcnt(6)
NV 68,48,224
R 44,4,20480
s_add_u32 m0, s66, 36864
s_add_u32 s75, s63, 295296
NV 76,48,228
R 46,4,22528
NV 76,52,236
R 48,4,24576
buffer_load_dwordx4 v11, s[20:23], s75 offen offset:0 lds
NV 68,52,232
R 50,4,26624
NV 68,56,240
R 52,4,28672
NV 76,56,244
R 54,4,30720
NV 76,60,252
R 56,4,32768
NV 68,60,248
R 58,4,34816
s_waitcnt lgkmcnt(7)
v_mfma_f32_16x16x32_bf16 v[80:83], v[32:35], v[192:195], 0
R 60,4,36864
v_mfma_f32_16x16x32_bf16 v[88:91], v[32:35], v[196:199], 0
R 62,4,38912
NV 88,36,204
R 32,5,8192
CV 100,104,105
NV 80,36,200
R 34,5,10240
CV 101,106,107
NV 80,40,208
R 36,5,12288
CV 102,108,109
NV 88,40,212
R 38,5,14336
s_waitcnt lgkmcnt(6)
NV 88,44,220
R 40,5,16384
CV 103,110,111
NV 80,44,216
R 42,5,18432
NV 80,48,224
R 44,5,20480
buffer_load_dwordx4 v12, s[20:23], s75 offen offset:1024 lds
NV 88,48,228
R 46,5,22528
NV 88,52,236
R 48,5,24576
NV 80,52,232
R 50,5,26624
NV 80,56,240
R 52,5,28672
buffer_store_dwordx4 v[100:103], v23, s[48:51], s76 offen offset:1024 sc1
NV 88,56,244
R 54,5,30720
s_waitcnt lgkmcnt(6)
NV 88,60,252
R 56,5,32768
buffer_load_dwordx4 v13, s[20:23], s75 offen offset:2048 lds
NV 80,60,248
R 58,5,34816
v_mfma_f32_16x16x32_bf16 v[84:87], v[32:35], v[192:195], 0
R 60,5,36864
v_mfma_f32_16x16x32_bf16 v[92:95], v[32:35], v[196:199], 0
R 62,5,38912
NV 92,36,204
R 32,3,45056
buffer_load_dwordx4 v14, s[20:23], s75 offen offset:3072 lds
NV 84,36,200
R 34,3,47104
NV 84,40,208
R 36,3,49152
NV 92,40,212
R 38,3,51200
s_waitcnt lgkmcnt(7)
NV 92,44,220
R 40,3,53248
s_add_u32 m0, s66, 40960
s_add_u32 s75, s63, 332160
NV 84,44,216
R 42,3,55296
NV 84,48,224
R 44,3,57344
buffer_load_dwordx4 v11, s[20:23], s75 offen offset:0 lds
NV 92,48,228
R 46,3,59392
NV 92,52,236
R 48,3,61440
NV 84,52,232
R 50,3,63488
s_waitcnt lgkmcnt(6)
NV 84,56,240
R 52,6,0
CV 112,112,113
NV 92,56,244
R 54,6,2048
NV 92,60,252
R 56,6,4096
CV 113,114,115
NV 84,60,248
R 58,6,6144
NV 64,32,128
R 60,6,8192
CV 114,116,117
NV 72,32,132
R 62,6,10240
NV 72,36,140
R 32,2,45056
CV 115,118,119
NV 64,36,136
R 34,2,47104
s_waitcnt lgkmcnt(6)
NV 64,40,144
R 36,2,49152
NV 72,40,148
R 38,2,51200
NV 72,44,156
R 40,2,53248
buffer_load_dwordx4 v12, s[20:23], s75 offen offset:1024 lds
buffer_store_dwordx4 v[112:115], v23, s[48:51], s76 offen offset:2048 sc1
NV 64,44,152
R 42,2,55296
NV 64,48,160
R 44,2,57344
NV 72,48,164
R 46,2,59392
NV 72,52,172
R 48,2,61440
NV 64,52,168
R 50,2,63488
s_waitcnt lgkmcnt(6)
NV 64,56,176
R 52,7,0
buffer_load_dwordx4 v13, s[20:23], s75 offen offset:2048 lds
NV 72,56,180
R 54,7,2048
NV 72,60,188
R 56,7,4096
NV 64,60,184
R 58,7,6144
NV 68,32,128
R 60,7,8192
buffer_load_dwordx4 v14, s[20:23], s75 offen offset:3072 lds
NV 76,32,132
R 62,7,10240
NV 76,36,140
R 32,4,45056
NV 68,36,136
R 34,4,47104
s_waitcnt lgkmcnt(7)
NV 68,40,144
R 36,4,49152
CV 116,120,121
NV 76,40,148
R 38,4,51200
NV 76,44,156
s_waitcnt vmcnt(11)
s_barrier
R 40,4,53248
NV 68,44,152
R 42,4,55296
NV 68,48,160
R 44,4,57344
s_add_u32 m0, s66, 73728
s_add_u32 s75, s63, 512
NV 76,48,164
R 46,4,59392
s_waitcnt lgkmcnt(6)
NV 76,52,172
R 48,4,61440
buffer_load_dwordx4 v11, s[20:23], s75 offen offset:0 lds
NV 68,52,168
R 50,4,63488
NV 68,56,176
R 52,8,0
CV 117,122,123
NV 76,56,180
R 54,8,2048
NV 76,60,188
R 56,8,4096
CV 118,124,125
NV 68,60,184
R 58,8,6144
NV 80,32,128
R 60,8,8192
CV 119,126,127
NV 88,32,132
R 62,8,10240
s_waitcnt lgkmcnt(6)
NV 88,36,140
R 32,5,45056
NV 80,36,136
R 34,5,47104
NV 80,40,144
R 36,5,49152
buffer_store_dwordx4 v[116:119], v23, s[48:51], s76 offen offset:3072 sc1
NV 88,40,148
R 38,5,51200
NV 88,44,156
R 40,5,53248
NV 80,44,152
R 42,5,55296
NV 80,48,160
R 44,5,57344
buffer_load_dwordx4 v12, s[20:23], s75 offen offset:1024 lds
NV 88,48,164
R 46,5,59392
s_waitcnt lgkmcnt(6)
NV 88,52,172
R 48,5,61440
NV 80,52,168
R 50,5,63488
NV 80,56,176
R 52,9,0
NV 88,56,180
R 54,9,2048
NV 88,60,188
R 56,9,4096
buffer_load_dwordx4 v13, s[20:23], s75 offen offset:2048 lds
NV 80,60,184
R 58,9,6144
NV 84,32,128
R 60,9,8192
NV 92,32,132
R 62,9,10240
s_waitcnt lgkmcnt(7)
NV 92,36,140
R 32,19,0
buffer_load_dwordx4 v14, s[20:23], s75 offen offset:3072 lds
NV 84,36,136
R 34,19,2048
NV 84,40,144
R 36,19,4096
NV 92,40,148
R 38,19,6144
NV 92,44,156
R 40,19,8192
s_add_u32 m0, s66, 77824
s_add_u32 s75, s63, 37376
NV 84,44,152
R 42,19,10240
s_waitcnt lgkmcnt(6)
NV 84,48,160
R 44,19,12288
buffer_load_dwordx4 v11, s[20:23], s75 offen offset:0 lds
NV 92,48,164
R 46,19,14336
NV 92,52,172
R 48,19,16384
NV 84,52,168
R 50,19,18432
NV 84,56,176
R 52,19,20480
NV 92,56,180
R 54,19,22528
NV 92,60,188
R 56,19,24576
NV 84,60,184
R 58,19,26624
s_waitcnt lgkmcnt(7)
v_mfma_f32_16x16x32_bf16 v[96:99], v[32:35], v[192:195], 0
R 60,19,28672
v_mfma_f32_16x16x32_bf16 v[104:107], v[32:35], v[196:199], 0
R 62,19,30720
NV 104,36,204
R 32,20,0
NV 96,36,200
R 34,20,2048
NV 96,40,208
R 36,20,4096
NV 104,40,212
R 38,20,6144
s_waitcnt lgkmcnt(6)
NV 104,44,220
R 40,20,8192
buffer_load_dwordx4 v12, s[20:23], s75 offen offset:1024 lds
NV 96,44,216
R 42,20,10240
CV 64,64,65
NV 96,48,224
R 44,20,12288
CV 65,66,67
NV 104,48,228
R 46,20,14336
NV 104,52,236
R 48,20,16384
CV 66,68,69
NV 96,52,232
R 50,20,18432
NV 96,56,240
R 52,20,20480
buffer_load_dwordx4 v13, s[20:23], s75 offen offset:2048 lds
NV 104,56,244
R 54,20,22528
CV 67,70,71
s_waitcnt lgkmcnt(6)
NV 104,60,252
R 56,20,24576
s_add_u32 s76, s78, 4857856
NV 96,60,248
R 58,20,26624
v_mfma_f32_16x16x32_bf16 v[100:103], v[32:35], v[192:195], 0
R 60,20,28672
buffer_load_dwordx4 v14, s[20:23], s75 offen offset:3072 lds
buffer_store_dwordx4 v[64:67], v23, s[48:51], s76 offen offset:0 sc1
v_mfma_f32_16x16x32_bf16 v[108:111], v[32:35], v[196:199], 0
R 62,20,30720
NV 108,36,204
R 32,21,0
NV 100,36,200
R 34,21,2048
NV 100,40,208
R 36,21,4096
NV 108,40,212
R 38,21,6144
s_waitcnt lgkmcnt(6)
NV 108,44,220
s_waitcnt vmcnt(10)
s_barrier
R 40,21,8192
NV 100,44,216
R 42,21,10240
NV 100,48,224
R 44,21,12288
s_add_u32 m0, s66, 110592
s_add_u32 s75, s63, 295424
NV 108,48,228
R 46,21,14336
NV 108,52,236
R 48,21,16384
buffer_load_dwordx4 v11, s[20:23], s75 offen offset:0 lds
NV 100,52,232
R 50,21,18432
NV 100,56,240
R 52,21,20480
NV 108,56,244
R 54,21,22528
s_waitcnt lgkmcnt(6)
NV 108,60,252
R 56,21,24576
CV 68,72,73
NV 100,60,248
LA_pad17:
s_cbranch_execz LA_cr1
R 58,21,26624
v_mfma_f32_16x16x32_bf16 v[112:115], v[32:35], v[192:195], 0
R 60,21,28672
CV 69,74,75
v_mfma_f32_16x16x32_bf16 v[120:123], v[32:35], v[196:199], 0
R 62,21,30720
NV 120,36,204
R 32,22,0
CV 70,76,77
NV 112,36,200
R 34,22,2048
NV 112,40,208
R 36,22,4096
CV 71,78,79
NV 120,40,212
R 38,22,6144
s_waitcnt lgkmcnt(6)
NV 120,44,220
R 40,22,8192
buffer_store_dwordx4 v[68:71], v23, s[48:51], s76 offen offset:1024 sc1
NV 112,44,216
R 42,22,10240
NV 112,48,224
R 44,22,12288
buffer_load_dwordx4 v12, s[20:23], s75 offen offset:1024 lds
NV 120,48,228
R 46,22,14336
NV 120,52,236
R 48,22,16384
s_add_u32 s74, s80, 24576
s_waitcnt vmcnt(11)
NV 112,52,232
R 50,22,18432
NV 112,56,240
R 52,22,20480
buffer_store_dword v3, v30, s[48:51], s74 offen sc1
NV 120,56,244
R 54,22,22528
s_waitcnt lgkmcnt(6)
NV 120,60,252
R 56,22,24576
buffer_load_dwordx4 v13, s[20:23], s75 offen offset:2048 lds
NV 112,60,248
R 58,22,26624
v_mfma_f32_16x16x32_bf16 v[116:119], v[32:35], v[192:195], 0
R 60,22,28672
v_mfma_f32_16x16x32_bf16 v[124:127], v[32:35], v[196:199], 0
R 62,22,30720
NV 124,36,204
R 32,19,36864
buffer_load_dwordx4 v14, s[20:23], s75 offen offset:3072 lds
NV 116,36,200
R 34,19,38912
NV 116,40,208
R 36,19,40960
NV 124,40,212
R 38,19,43008
s_waitcnt lgkmcnt(7)
NV 124,44,220
R 40,19,45056
s_add_u32 m0, s66, 114688
s_add_u32 s75, s63, 332288
NV 116,44,216
R 42,19,47104
NV 116,48,224
R 44,19,49152
buffer_load_dwordx4 v11, s[20:23], s75 offen offset:0 lds
NV 124,48,228
R 46,19,51200
NV 124,52,236
R 48,19,53248
NV 116,52,232
R 50,19,55296
s_waitcnt lgkmcnt(6)
NV 116,56,240
R 52,19,57344
CV 80,80,81
NV 124,56,244
R 54,19,59392
NV 124,60,252
R 56,19,61440
CV 81,82,83
NV 116,60,248
R 58,19,63488
NV 96,32,128
R 60,3,0
CV 82,84,85
NV 104,32,132
R 62,3,2048
NV 104,36,140
R 32,20,36864
CV 83,86,87
NV 96,36,136
R 34,20,38912
s_waitcnt lgkmcnt(6)
NV 96,40,144
R 36,20,40960
NV 104,40,148
R 38,20,43008
NV 104,44,156
R 40,20,45056
buffer_load_dwordx4 v12, s[20:23], s75 offen offset:1024 lds
buffer_store_dwordx4 v[80:83], v23, s[48:51], s76 offen offset:2048 sc1
NV 96,44,152
R 42,20,47104
NV 96,48,160
R 44,20,49152
NV 104,48,164
R 46,20,51200
NV 104,52,172
R 48,20,53248
NV 96,52,168
R 50,20,55296
s_waitcnt lgkmcnt(6)
NV 96,56,176
R 52,20,57344
buffer_load_dwordx4 v13, s[20:23], s75 offen offset:2048 lds
NV 104,56,180
R 54,20,59392
NV 104,60,188
R 56,20,61440
NV 96,60,184
R 58,20,63488
NV 100,32,128
R 60,2,0
buffer_load_dwordx4 v14, s[20:23], s75 offen offset:3072 lds
NV 108,32,132
R 62,2,2048
NV 108,36,140
R 32,21,36864
NV 100,36,136
R 34,21,38912
s_waitcnt lgkmcnt(7)
NV 100,40,144
R 36,21,40960
CV 84,88,89
NV 108,40,148
R 38,21,43008
NV 108,44,156
s_waitcnt vmcnt(12)
s_barrier
R 40,21,45056
NV 100,44,152
R 42,21,47104
NV 100,48,160
R 44,21,49152
s_add_u32 m0, s66, 0
s_add_u32 s75, s63, 640
NV 108,48,164
R 46,21,51200
s_waitcnt lgkmcnt(6)
NV 108,52,172
R 48,21,53248
buffer_load_dwordx4 v11, s[20:23], s75 offen offset:0 lds
NV 100,52,168
R 50,21,55296
NV 100,56,176
R 52,21,57344
CV 85,90,91
NV 108,56,180
R 54,21,59392
NV 108,60,188
R 56,21,61440
CV 86,92,93
NV 100,60,184
R 58,21,63488
NV 112,32,128
R 60,4,0
CV 87,94,95
NV 120,32,132
R 62,4,2048
s_waitcnt lgkmcnt(6)
NV 120,36,140
R 32,22,36864
NV 112,36,136
R 34,22,38912
NV 112,40,144
R 36,22,40960
buffer_store_dwordx4 v[84:87], v23, s[48:51], s76 offen offset:3072 sc1
NV 120,40,148
R 38,22,43008
NV 120,44,156
R 40,22,45056
NV 112,44,152
R 42,22,47104
NV 112,48,160
R 44,22,49152
buffer_load_dwordx4 v12, s[20:23], s75 offen offset:1024 lds
NV 120,48,164
R 46,22,51200
s_waitcnt lgkmcnt(6)
NV 120,52,172
R 48,22,53248
NV 112,52,168
R 50,22,55296
NV 112,56,176
R 52,22,57344
NV 120,56,180
R 54,22,59392
NV 120,60,188
R 56,22,61440
buffer_load_dwordx4 v13, s[20:23], s75 offen offset:2048 lds
NV 112,60,184
R 58,22,63488
NV 116,32,128
R 60,5,0
NV 124,32,132
R 62,5,2048
s_waitcnt lgkmcnt(7)
NV 124,36,140
R 32,3,8192
buffer_load_dwordx4 v14, s[20:23], s75 offen offset:3072 lds
NV 116,36,136
R 34,3,10240
NV 116,40,144
R 36,3,12288
NV 124,40,148
R 38,3,14336
NV 124,44,156
R 40,3,16384
s_add_u32 m0, s66, 4096
s_add_u32 s75, s63, 37504
NV 116,44,152
R 42,3,18432
s_waitcnt lgkmcnt(6)
NV 116,48,160
R 44,3,20480
buffer_load_dwordx4 v11, s[20:23], s75 offen offset:0 lds
NV 124,48,164
R 46,3,22528
NV 124,52,172
R 48,3,24576
NV 116,52,168
R 50,3,26624
NV 116,56,176
R 52,3,28672
NV 124,56,180
R 54,3,30720
NV 124,60,188
R 56,3,32768
NV 116,60,184
R 58,3,34816
s_waitcnt lgkmcnt(7)
v_mfma_f32_16x16x32_bf16 v[64:67], v[32:35], v[192:195], 0
R 60,3,36864
v_mfma_f32_16x16x32_bf16 v[72:75], v[32:35], v[196:199], 0
R 62,3,38912
NV 72,36,204
R 32,2,8192
NV 64,36,200
R 34,2,10240
NV 64,40,208
R 36,2,12288
NV 72,40,212
R 38,2,14336
s_waitcnt lgkmcnt(6)
NV 72,44,220
R 40,2,16384
buffer_load_dwordx4 v12, s[20:23], s75 offen offset:1024 lds
NV 64,44,216
R 42,2,18432
NV 64,48,224
R 44,2,20480
CV 96,96,97
NV 72,48,228
R 46,2,22528
CV 97,98,99
NV 72,52,236
R 48,2,24576
CV 98,100,101
NV 64,52,232
R 50,2,26624
NV 64,56,240
R 52,2,28672
buffer_load_dwordx4 v13, s[20:23], s75 offen offset:2048 lds
NV 72,56,244
R 54,2,30720
s_waitcnt lgkmcnt(6)
NV 72,60,252
R 56,2,32768
CV 99,102,103
NV 64,60,248
R 58,2,34816
v_mfma_f32_16x16x32_bf16 v[68:71], v[32:35], v[192:195], 0
R 60,2,36864
buffer_load_dwordx4 v14, s[20:23], s75 offen offset:3072 lds
v_mfma_f32_16x16x32_bf16 v[76:79], v[32:35], v[196:199], 0
R 62,2,38912
NV 76,36,204
R 32,4,8192
s_add_u32 s76, s78, 4861952
NV 68,36,200
R 34,4,10240
NV 68,40,208
R 36,4,12288
buffer_store_dwordx4 v[96:99], v23, s[48:51], s76 offen offset:0 sc1
NV 76,40,212
R 38,4,14336
s_waitcnt lgkmcnt(6)
NV 76,44,220
s_waitcnt vmcnt(10)
s_barrier
R 40,4,16384
NV 68,44,216
R 42,4,18432
NV 68,48,224
R 44,4,20480
s_add_u32 m0, s66, 36864
s_add_u32 s75, s63, 295552
NV 76,48,228
R 46,4,22528
NV 76,52,236
R 48,4,24576
buffer_load_dwordx4 v11, s[20:23], s75 offen offset:0 lds
NV 68,52,232
R 50,4,26624
NV 68,56,240
R 52,4,28672
NV 76,56,244
R 54,4,30720
s_waitcnt lgkmcnt(6)
NV 76,60,252
R 56,4,32768
NV 68,60,248
R 58,4,34816
v_mfma_f32_16x16x32_bf16 v[80:83], v[32:35], v[192:195], 0
R 60,4,36864
v_mfma_f32_16x16x32_bf16 v[88:91], v[32:35], v[196:199], 0
R 62,4,38912
NV 88,36,204
R 32,5,8192
CV 100,104,105
NV 80,36,200
R 34,5,10240
CV 101,106,107
NV 80,40,208
R 36,5,12288
CV 102,108,109
NV 88,40,212
R 38,5,14336
s_waitcnt lgkmcnt(6)
NV 88,44,220
R 40,5,16384
CV 103,110,111
NV 80,44,216
R 42,5,18432
NV 80,48,224
R 44,5,20480
buffer_load_dwordx4 v12, s[20:23], s75 offen offset:1024 lds
NV 88,48,228
R 46,5,22528
NV 88,52,236
R 48,5,24576
NV 80,52,232
R 50,5,26624
NV 80,56,240
R 52,5,28672
buffer_store_dwordx4 v[100:103], v23, s[48:51], s76 offen offset:1024 sc1
NV 88,56,244
R 54,5,30720
s_waitcnt lgkmcnt(6)
NV 88,60,252
R 56,5,32768
buffer_load_dwordx4 v13, s[20:23], s75 offen offset:2048 lds
NV 80,60,248
R 58,5,34816
v_mfma_f32_16x16x32_bf16 v[84:87], v[32:35], v[192:195], 0
R 60,5,36864
v_mfma_f32_16x16x32_bf16 v[92:95], v[32:35], v[196:199], 0
R 62,5,38912
NV 92,36,204
R 32,3,45056
buffer_load_dwordx4 v14, s[20:23], s75 offen offset:3072 lds
NV 84,36,200
R 34,3,47104
NV 84,40,208
R 36,3,49152
NV 92,40,212
R 38,3,51200
s_waitcnt lgkmcnt(7)
NV 92,44,220
R 40,3,53248
s_add_u32 m0, s66, 40960
s_add_u32 s75, s63, 332416
NV 84,44,216
R 42,3,55296
NV 84,48,224
R 44,3,57344
buffer_load_dwordx4 v11, s[20:23], s75 offen offset:0 lds
NV 92,48,228
R 46,3,59392
NV 92,52,236
R 48,3,61440
NV 84,52,232
R 50,3,63488
s_waitcnt lgkmcnt(6)
NV 84,56,240
R 52,6,0
CV 112,112,113
NV 92,56,244
R 54,6,2048
NV 92,60,252
R 56,6,4096
CV 113,114,115
NV 84,60,248
R 58,6,6144
NV 64,32,128
R 60,6,8192
CV 114,116,117
NV 72,32,132
R 62,6,10240
CV 115,118,119
NV 72,36,140
R 32,2,45056
NV 64,36,136
R 34,2,47104
s_waitcnt lgkmcnt(6)
NV 64,40,144
R 36,2,49152
buffer_store_dwordx4 v[112:115], v23, s[48:51], s76 offen offset:2048 sc1
NV 72,40,148
R 38,2,51200
NV 72,44,156
R 40,2,53248
buffer_load_dwordx4 v12, s[20:23], s75 offen offset:1024 lds
NV 64,44,152
R 42,2,55296
s_mov_b32 s81, 42622976
NV 64,48,160
R 44,2,57344
buffer_load_dword v31, v24, s[48:51], s81 offen sc1
NV 72,48,164
R 46,2,59392
NV 72,52,172
R 48,2,61440
NV 64,52,168
R 50,2,63488
s_waitcnt lgkmcnt(6)
NV 64,56,176
R 52,7,0
buffer_load_dwordx4 v13, s[20:23], s75 offen offset:2048 lds
NV 72,56,180
R 54,7,2048
NV 72,60,188
R 56,7,4096
NV 64,60,184
R 58,7,6144
NV 68,32,128
R 60,7,8192
buffer_load_dwordx4 v14, s[20:23], s75 offen offset:3072 lds
NV 76,32,132
R 62,7,10240
NV 76,36,140
R 32,4,45056
NV 68,36,136
R 34,4,47104
s_waitcnt lgkmcnt(7)
NV 68,40,144
R 36,4,49152
CV 116,120,121
NV 76,40,148
R 38,4,51200
NV 76,44,156
s_waitcnt vmcnt(12)
s_barrier
R 40,4,53248
NV 68,44,152
R 42,4,55296
NV 68,48,160
R 44,4,57344
s_add_u32 m0, s66, 73728
s_add_u32 s75, s63, 768
NV 76,48,164
R 46,4,59392
s_waitcnt lgkmcnt(6)
NV 76,52,172
R 48,4,61440
buffer_load_dwordx4 v11, s[20:23], s75 offen offset:0 lds
NV 68,52,168
R 50,4,63488
NV 68,56,176
R 52,8,0
CV 117,122,123
NV 76,56,180
R 54,8,2048
NV 76,60,188
R 56,8,4096
CV 118,124,125
NV 68,60,184
R 58,8,6144
NV 80,32,128
R 60,8,8192
CV 119,126,127
NV 88,32,132
R 62,8,10240
s_waitcnt lgkmcnt(6)
NV 88,36,140
R 32,5,45056
NV 80,36,136
R 34,5,47104
NV 80,40,144
R 36,5,49152
buffer_store_dwordx4 v[116:119], v23, s[48:51], s76 offen offset:3072 sc1
NV 88,40,148
R 38,5,51200
NV 88,44,156
R 40,5,53248
NV 80,44,152
R 42,5,55296
NV 80,48,160
R 44,5,57344
buffer_load_dwordx4 v12, s[20:23], s75 offen offset:1024 lds
NV 88,48,164
R 46,5,59392
s_waitcnt lgkmcnt(6)
NV 88,52,172
R 48,5,61440
NV 80,52,168
R 50,5,63488
NV 80,56,176
R 52,9,0
NV 88,56,180
R 54,9,2048
NV 88,60,188
R 56,9,4096
buffer_load_dwordx4 v13, s[20:23], s75 offen offset:2048 lds
NV 80,60,184
R 58,9,6144
NV 84,32,128
LA_pad18:
s_cbranch_execz LA_cr1
R 60,9,8192
NV 92,32,132
R 62,9,10240
s_waitcnt lgkmcnt(7)
NV 92,36,140
R 32,19,0
buffer_load_dwordx4 v14, s[20:23], s75 offen offset:3072 lds
NV 84,36,136
R 34,19,2048
NV 84,40,144
R 36,19,4096
NV 92,40,148
R 38,19,6144
NV 92,44,156
R 40,19,8192
s_add_u32 m0, s66, 77824
s_add_u32 s75, s63, 37632
NV 84,44,152
R 42,19,10240
s_waitcnt lgkmcnt(6)
NV 84,48,160
R 44,19,12288
buffer_load_dwordx4 v11, s[20:23], s75 offen offset:0 lds
s_waitcnt vmcnt(8)
v_cmp_ne_u32 vcc, 0x10000, v31
s_nop 1
s_cbranch_vccnz LA_poll2
LA_ok2:
NV 92,48,164
R 46,19,14336
NV 92,52,172
R 48,19,16384
s_add_u32 s0, s84, 4849664
NV 84,52,168
R 50,19,18432
NV 84,56,176
R 52,19,20480
buffer_load_dwordx4 a[0:3], v15, s[48:51], s0 offen sc1
NV 92,56,180
R 54,19,22528
NV 92,60,188
R 56,19,24576
NV 84,60,184
R 58,19,26624
s_waitcnt lgkmcnt(6)
v_mfma_f32_16x16x32_bf16 v[96:99], v[32:35], v[192:195], 0
R 60,19,28672
v_mfma_f32_16x16x32_bf16 v[104:107], v[32:35], v[196:199], 0
R 62,19,30720
NV 104,36,204
R 32,20,0
NV 96,36,200
R 34,20,2048
NV 96,40,208
R 36,20,4096
NV 104,40,212
R 38,20,6144
NV 104,44,220
R 40,20,8192
buffer_load_dwordx4 v12, s[20:23], s75 offen offset:1024 lds
NV 96,44,216
R 42,20,10240
CV 64,64,65
s_waitcnt lgkmcnt(6)
NV 96,48,224
R 44,20,12288
CV 65,66,67
NV 104,48,228
R 46,20,14336
NV 104,52,236
R 48,20,16384
CV 66,68,69
NV 96,52,232
R 50,20,18432
NV 96,56,240
R 52,20,20480
buffer_load_dwordx4 v13, s[20:23], s75 offen offset:2048 lds
NV 104,56,244
R 54,20,22528
CV 67,70,71
NV 104,60,252
R 56,20,24576
s_add_u32 s76, s78, 4866048
NV 96,60,248
R 58,20,26624
s_waitcnt lgkmcnt(6)
v_mfma_f32_16x16x32_bf16 v[100:103], v[32:35], v[192:195], 0
R 60,20,28672
buffer_load_dwordx4 a[4:7], v16, s[48:51], s0 offen sc1
buffer_load_dwordx4 v14, s[20:23], s75 offen offset:3072 lds
buffer_store_dwordx4 v[64:67], v23, s[48:51], s76 offen offset:0 sc1
v_mfma_f32_16x16x32_bf16 v[108:111], v[32:35], v[196:199], 0
R 62,20,30720
NV 108,36,204
R 32,21,0
NV 100,36,200
R 34,21,2048
NV 100,40,208
R 36,21,4096
NV 108,40,212
R 38,21,6144
NV 108,44,220
s_waitcnt vmcnt(12)
s_barrier
R 40,21,8192
NV 100,44,216
R 42,21,10240
s_waitcnt lgkmcnt(6)
NV 100,48,224
R 44,21,12288
s_add_u32 s0, s84, 4997120
s_add_u32 m0, s66, 110592
s_add_u32 s75, s63, 295680
NV 108,48,228
R 46,21,14336
NV 108,52,236
R 48,21,16384
buffer_load_dwordx4 a[8:11], v15, s[48:51], s0 offen sc1
buffer_load_dwordx4 v11, s[20:23], s75 offen offset:0 lds
NV 100,52,232
R 50,21,18432
NV 100,56,240
R 52,21,20480
NV 108,56,244
R 54,21,22528
NV 108,60,252
R 56,21,24576
CV 68,72,73
NV 100,60,248
R 58,21,26624
s_waitcnt lgkmcnt(6)
v_mfma_f32_16x16x32_bf16 v[112:115], v[32:35], v[192:195], 0
R 60,21,28672
CV 69,74,75
v_mfma_f32_16x16x32_bf16 v[120:123], v[32:35], v[196:199], 0
R 62,21,30720
NV 120,36,204
R 32,22,0
CV 70,76,77
NV 112,36,200
R 34,22,2048
NV 112,40,208
R 36,22,4096
CV 71,78,79
NV 120,40,212
R 38,22,6144
NV 120,44,220
R 40,22,8192
buffer_store_dwordx4 v[68:71], v23, s[48:51], s76 offen offset:1024 sc1
NV 112,44,216
R 42,22,10240
s_waitcnt lgkmcnt(6)
NV 112,48,224
R 44,22,12288
buffer_load_dwordx4 v12, s[20:23], s75 offen offset:1024 lds
NV 120,48,228
R 46,22,14336
NV 120,52,236
R 48,22,16384
s_add_u32 s74, s80, 32768
s_waitcnt vmcnt(14)
NV 112,52,232
R 50,22,18432
NV 112,56,240
R 52,22,20480
buffer_store_dword v3, v30, s[48:51], s74 offen sc1
NV 120,56,244
R 54,22,22528
NV 120,60,252
R 56,22,24576
buffer_load_dwordx4 a[12:15], v16, s[48:51], s0 offen sc1
buffer_load_dwordx4 v13, s[20:23], s75 offen offset:2048 lds
NV 112,60,248
R 58,22,26624
s_waitcnt lgkmcnt(6)
v_mfma_f32_16x16x32_bf16 v[116:119], v[32:35], v[192:195], 0
R 60,22,28672
v_mfma_f32_16x16x32_bf16 v[124:127], v[32:35], v[196:199], 0
R 62,22,30720
NV 124,36,204
R 32,19,36864
buffer_load_dwordx4 v14, s[20:23], s75 offen offset:3072 lds
NV 116,36,200
R 34,19,38912
NV 116,40,208
R 36,19,40960
NV 124,40,212
R 38,19,43008
NV 124,44,220
R 40,19,45056
s_add_u32 m0, s66, 114688
s_add_u32 s75, s63, 332544
NV 116,44,216
R 42,19,47104
s_waitcnt lgkmcnt(6)
NV 116,48,224
R 44,19,49152
buffer_load_dwordx4 v11, s[20:23], s75 offen offset:0 lds
NV 124,48,228
R 46,19,51200
s_add_u32 s0, s84, 23724032
NV 124,52,236
R 48,19,53248
buffer_load_dwordx4 a[16:19], v15, s[48:51], s0 offen sc1
NV 116,52,232
R 50,19,55296
NV 116,56,240
R 52,19,57344
CV 80,80,81
NV 124,56,244
R 54,19,59392
NV 124,60,252
R 56,19,61440
CV 81,82,83
NV 116,60,248
R 58,19,63488
CV 82,84,85
s_waitcnt lgkmcnt(6)
NV 96,32,128
R 60,3,0
CV 83,86,87
NV 104,32,132
R 62,3,2048
NV 104,36,140
R 32,20,36864
NV 96,36,136
R 34,20,38912
NV 96,40,144
R 36,20,40960
buffer_store_dwordx4 v[80:83], v23, s[48:51], s76 offen offset:2048 sc1
NV 104,40,148
R 38,20,43008
NV 104,44,156
R 40,20,45056
buffer_load_dwordx4 v12, s[20:23], s75 offen offset:1024 lds
NV 96,44,152
R 42,20,47104
s_waitcnt lgkmcnt(6)
NV 96,48,160
R 44,20,49152
NV 104,48,164
R 46,20,51200
NV 104,52,172
R 48,20,53248
NV 96,52,168
R 50,20,55296
NV 96,56,176
R 52,20,57344
buffer_load_dwordx4 v13, s[20:23], s75 offen offset:2048 lds
NV 104,56,180
R 54,20,59392
NV 104,60,188
R 56,20,61440
buffer_load_dwordx4 a[20:23], v16, s[48:51], s0 offen sc1
NV 96,60,184
R 58,20,63488
s_waitcnt lgkmcnt(6)
NV 100,32,128
R 60,2,0
buffer_load_dwordx4 v14, s[20:23], s75 offen offset:3072 lds
NV 108,32,132
R 62,2,2048
NV 108,36,140
R 32,21,36864
CV 84,88,89
NV 100,36,136
R 34,21,38912
NV 100,40,144
R 36,21,40960
CV 85,90,91
NV 108,40,148
R 38,21,43008
CV 86,92,93
NV 108,44,156
s_waitcnt vmcnt(16)
s_barrier
R 40,21,45056
NV 100,44,152
R 42,21,47104
s_add_u32 s0, s84, 23871488
s_waitcnt lgkmcnt(5)
NV 100,48,160
R 44,21,49152
buffer_load_dwordx4 a[24:27], v15, s[48:51], s0 offen sc1
NV 108,48,164
R 46,21,51200
s_add_u32 m0, s66, 0
s_add_u32 s75, s63, 896
NV 108,52,172
R 48,21,53248
buffer_load_dwordx4 v11, s[20:23], s75 offen offset:0 lds
NV 100,52,168
R 50,21,55296
NV 100,56,176
R 52,21,57344
CV 87,94,95
NV 108,56,180
R 54,21,59392
NV 108,60,188
R 56,21,61440
NV 100,60,184
R 58,21,63488
s_waitcnt lgkmcnt(6)
NV 112,32,128
R 60,4,0
buffer_load_dwordx4 v12, s[20:23], s75 offen offset:1024 lds
buffer_store_dwordx4 v[84:87], v23, s[48:51], s76 offen offset:3072 sc1
NV 120,32,132
R 62,4,2048
NV 120,36,140
R 32,22,36864
NV 112,36,136
R 34,22,38912
NV 112,40,144
R 36,22,40960
buffer_load_dwordx4 v13, s[20:23], s75 offen offset:2048 lds
NV 120,40,148
R 38,22,43008
NV 120,44,156
R 40,22,45056
buffer_load_dwordx4 v14, s[20:23], s75 offen offset:3072 lds
NV 112,44,152
R 42,22,47104
s_add_u32 m0, s66, 4096
s_add_u32 s75, s63, 37760
s_waitcnt lgkmcnt(6)
NV 112,48,160
R 44,22,49152
buffer_load_dwordx4 v11, s[20:23], s75 offen offset:0 lds
NV 120,48,164
R 46,22,51200
NV 120,52,172
R 48,22,53248
NV 112,52,168
R 50,22,55296
NV 112,56,176
R 52,22,57344
buffer_load_dwordx4 a[28:31], v16, s[48:51], s0 offen sc1
NV 120,56,180
R 54,22,59392
NV 120,60,188
R 56,22,61440
NV 112,60,184
R 58,22,63488
s_waitcnt lgkmcnt(7)
NV 116,32,128
R 60,5,0
buffer_load_dwordx4 v12, s[20:23], s75 offen offset:1024 lds
NV 124,32,132
R 62,5,2048
NV 124,36,140
R 32,3,8192
NV 116,36,136
R 34,3,10240
NV 116,40,144
R 36,3,12288
buffer_load_dwordx4 v13, s[20:23], s75 offen offset:2048 lds
NV 124,40,148
R 38,3,14336
s_waitcnt lgkmcnt(6)
NV 124,44,156
R 40,3,16384
buffer_load_dwordx4 v14, s[20:23], s75 offen offset:3072 lds
s_add_u32 m0, s79, 147456
s_add_u32 s75, s86, s79
s_add_u32 s75, s75, 0
NV 116,44,152
R 42,3,18432
NV 116,48,160
R 44,3,20480
buffer_load_dwordx4 a[96:99], v18, s[48:51], s85 offen sc1
buffer_load_dwordx4 v23, s[4:7], s75 offen lds
NV 124,48,164
R 46,3,22528
NV 124,52,172
R 48,3,24576
NV 116,52,168
R 50,3,26624
NV 116,56,176
R 52,3,28672
NV 124,56,180
R 54,3,30720
s_waitcnt lgkmcnt(6)
NV 124,60,188
R 56,3,32768
NV 116,60,184
R 58,3,34816
v_mfma_f32_16x16x32_bf16 v[64:67], v[32:35], v[192:195], 0
R 60,3,36864
s_add_u32 s85, s85, 16384
s_add_u32 m0, s79, 151552
s_add_u32 s75, s86, s79
s_add_u32 s75, s75, 4096
v_mfma_f32_16x16x32_bf16 v[72:75], v[32:35], v[196:199], 0
R 62,3,38912
NV 72,36,204
R 32,2,8192
buffer_load_dwordx4 a[100:103], v18, s[48:51], s85 offen sc1
buffer_load_dwordx4 v23, s[4:7], s75 offen lds
NV 64,36,200
R 34,2,10240
NV 64,40,208
R 36,2,12288
NV 72,40,212
R 38,2,14336
s_waitcnt lgkmcnt(6)
NV 72,44,220
R 40,2,16384
CV 96,96,97
CV 97,98,99
NV 64,44,216
R 42,2,18432
CV 98,100,101
NV 64,48,224
R 44,2,20480
CV 99,102,103
NV 72,48,228
R 46,2,22528
s_add_u32 s76, s78, 4870144
NV 72,52,236
R 48,2,24576
buffer_store_dwordx4 v[96:99], v23, s[48:51], s76 offen offset:0 sc1
NV 64,52,232
R 50,2,26624
NV 64,56,240
R 52,2,28672
s_mov_b32 m0, 155648
s_add_u32 s75, s86, 8192
NV 72,56,244
R 54,2,30720
s_waitcnt lgkmcnt(6)
NV 72,60,252
R 56,2,32768
buffer_load_dwordx4 v23, s[4:7], s75 offen lds
NV 64,60,248
R 58,2,34816
v_mfma_f32_16x16x32_bf16 v[68:71], v[32:35], v[192:195], 0
R 60,2,36864
CV 100,104,105
v_mfma_f32_16x16x32_bf16 v[76:79], v[32:35], v[196:199], 0
R 62,2,38912
NV 76,36,204
R 32,4,8192
CV 101,106,107
CV 102,108,109
NV 68,36,200
R 34,4,10240
CV 103,110,111
NV 68,40,208
R 36,4,12288
s_add_u32 s85, s85, 16384
NV 76,40,212
R 38,4,14336
s_waitcnt lgkmcnt(6)
NV 76,44,220
s_waitcnt vmcnt(17)
s_barrier
R 40,4,16384
buffer_load_dwordx4 a[104:107], v28, s[48:51], s85 offen sc1
buffer_store_dwordx4 v[100:103], v23, s[48:51], s76 offen offset:1024 sc1
NV 68,44,216
R 42,4,18432
NV 68,48,224
R 44,4,20480
s_add_u32 m0, s66, 36864
s_add_u32 s75, s63, 295808
NV 76,48,228
R 46,4,22528
NV 76,52,236
R 48,4,24576
buffer_load_dwordx4 v11, s[20:23], s75 offen offset:0 lds
NV 68,52,232
R 50,4,26624
NV 68,56,240
R 52,4,28672
NV 76,56,244
R 54,4,30720
s_waitcnt lgkmcnt(6)
NV 76,60,252
R 56,4,32768
NV 68,60,248
R 58,4,34816
v_mfma_f32_16x16x32_bf16 v[80:83], v[32:35], v[192:195], 0
R 60,4,36864
CV 112,112,113
v_mfma_f32_16x16x32_bf16 v[88:91], v[32:35], v[196:199], 0
R 62,4,38912
CV 113,114,115
NV 88,36,204
R 32,5,8192
CV 114,116,117
NV 80,36,200
R 34,5,10240
CV 115,118,119
NV 80,40,208
R 36,5,12288
NV 88,40,212
R 38,5,14336
s_waitcnt lgkmcnt(6)
NV 88,44,220
R 40,5,16384
buffer_store_dwordx4 v[112:115], v23, s[48:51], s76 offen offset:2048 sc1
NV 80,44,216
R 42,5,18432
NV 80,48,224
R 44,5,20480
buffer_load_dwordx4 v12, s[20:23], s75 offen offset:1024 lds
NV 88,48,228
R 46,5,22528
NV 88,52,236
R 48,5,24576
CV 116,120,121
NV 80,52,232
R 50,5,26624
CV 117,122,123
NV 80,56,240
R 52,5,28672
CV 118,124,125
NV 88,56,244
R 54,5,30720
CV 119,126,127
s_mov_b32 s81, 42631168
s_waitcnt lgkmcnt(6)
NV 88,60,252
R 56,5,32768
buffer_load_dword v31, v24, s[48:51], s81 offen sc1
buffer_load_dwordx4 v13, s[20:23], s75 offen offset:2048 lds
NV 80,60,248
R 58,5,34816
v_mfma_f32_16x16x32_bf16 v[84:87], v[32:35], v[192:195], 0
R 60,5,36864
v_mfma_f32_16x16x32_bf16 v[92:95], v[32:35], v[196:199], 0
LA_pad19:
s_cbranch_execz LA_cr1
R 62,5,38912
NV 92,36,204
R 32,3,45056
buffer_load_dwordx4 v14, s[20:23], s75 offen offset:3072 lds
buffer_store_dwordx4 v[116:119], v23, s[48:51], s76 offen offset:3072 sc1
NV 84,36,200
R 34,3,47104
NV 84,40,208
R 36,3,49152
NV 92,40,212
R 38,3,51200
s_waitcnt lgkmcnt(6)
NV 92,44,220
R 40,3,53248
s_add_u32 m0, s66, 40960
s_add_u32 s75, s63, 332672
NV 84,44,216
R 42,3,55296
NV 84,48,224
R 44,3,57344
buffer_load_dwordx4 v11, s[20:23], s75 offen offset:0 lds
NV 92,48,228
R 46,3,59392
NV 92,52,236
R 48,3,61440
NV 84,52,232
R 50,3,63488
NV 84,56,240
R 52,6,0
NV 92,56,244
R 54,6,2048
s_waitcnt lgkmcnt(7)
NV 92,60,252
R 56,6,4096
NV 84,60,248
R 58,6,6144
NV 64,32,128
R 60,6,8192
NV 72,32,132
R 62,6,10240
NV 72,36,140
R 32,2,45056
NV 64,36,136
R 34,2,47104
s_waitcnt lgkmcnt(6)
NV 64,40,144
R 36,2,49152
NV 72,40,148
R 38,2,51200
NV 72,44,156
R 40,2,53248
buffer_load_dwordx4 v12, s[20:23], s75 offen offset:1024 lds
NV 64,44,152
R 42,2,55296
NV 64,48,160
R 44,2,57344
NV 72,48,164
R 46,2,59392
NV 72,52,172
R 48,2,61440
NV 64,52,168
R 50,2,63488
s_waitcnt lgkmcnt(7)
NV 64,56,176
R 52,7,0
buffer_load_dwordx4 v13, s[20:23], s75 offen offset:2048 lds
NV 72,56,180
R 54,7,2048
NV 72,60,188
R 56,7,4096
NV 64,60,184
R 58,7,6144
NV 68,32,128
R 60,7,8192
buffer_load_dwordx4 v14, s[20:23], s75 offen offset:3072 lds
NV 76,32,132
R 62,7,10240
s_waitcnt lgkmcnt(6)
NV 76,36,140
R 32,4,45056
NV 68,36,136
R 34,4,47104
NV 68,40,144
R 36,4,49152
NV 76,40,148
R 38,4,51200
NV 76,44,156
s_waitcnt vmcnt(13)
s_barrier
R 40,4,53248
NV 68,44,152
R 42,4,55296
NV 68,48,160
R 44,4,57344
s_add_u32 m0, s66, 73728
s_add_u32 s75, s63, 1024
NV 76,48,164
R 46,4,59392
s_waitcnt lgkmcnt(6)
NV 76,52,172
R 48,4,61440
buffer_load_dwordx4 v11, s[20:23], s75 offen offset:0 lds
NV 68,52,168
R 50,4,63488
NV 68,56,176
R 52,8,0
NV 76,56,180
R 54,8,2048
NV 76,60,188
R 56,8,4096
s_waitcnt vmcnt(8)
v_cmp_ne_u32 vcc, 0x10000, v31
s_nop 1
s_cbranch_vccnz LA_poll3
LA_ok3:
NV 68,60,184
R 58,8,6144
NV 80,32,128
R 60,8,8192
s_add_u32 s0, s84, 4857856
NV 88,32,132
R 62,8,10240
s_waitcnt lgkmcnt(6)
NV 88,36,140
R 32,5,45056
buffer_load_dwordx4 a[32:35], v15, s[48:51], s0 offen sc1
NV 80,36,136
R 34,5,47104
NV 80,40,144
R 36,5,49152
NV 88,40,148
R 38,5,51200
NV 88,44,156
R 40,5,53248
NV 80,44,152
R 42,5,55296
NV 80,48,160
R 44,5,57344
buffer_load_dwordx4 v12, s[20:23], s75 offen offset:1024 lds
NV 88,48,164
R 46,5,59392
s_waitcnt lgkmcnt(7)
NV 88,52,172
R 48,5,61440
NV 80,52,168
R 50,5,63488
NV 80,56,176
R 52,9,0
NV 88,56,180
R 54,9,2048
NV 88,60,188
R 56,9,4096
buffer_load_dwordx4 v13, s[20:23], s75 offen offset:2048 lds
s_add_u32 s74, s80, 40960
s_waitcnt vmcnt(8)
NV 80,60,184
R 58,9,6144
s_waitcnt lgkmcnt(6)
NV 84,32,128
R 60,9,8192
buffer_store_dword v3, v30, s[48:51], s74 offen sc1
NV 92,32,132
R 62,9,10240
NV 92,36,140
R 32,19,0
buffer_load_dwordx4 v14, s[20:23], s75 offen offset:3072 lds
NV 84,36,136
R 34,19,2048
NV 84,40,144
R 36,19,4096
NV 92,40,148
R 38,19,6144
NV 92,44,156
R 40,19,8192
s_add_u32 m0, s66, 77824
s_add_u32 s75, s63, 37888
NV 84,44,152
R 42,19,10240
s_waitcnt lgkmcnt(6)
NV 84,48,160
R 44,19,12288
buffer_load_dwordx4 a[36:39], v16, s[48:51], s0 offen sc1
buffer_load_dwordx4 v11, s[20:23], s75 offen offset:0 lds
NV 92,48,164
R 46,19,14336
NV 92,52,172
R 48,19,16384
NV 84,52,168
R 50,19,18432
NV 84,56,176
R 52,19,20480
NV 92,56,180
R 54,19,22528
NV 92,60,188
R 56,19,24576
NV 84,60,184
R 58,19,26624
s_waitcnt lgkmcnt(7)
v_mfma_f32_16x16x32_bf16 v[96:99], v[32:35], v[192:195], 0
R 60,19,28672
v_mfma_f32_16x16x32_bf16 v[104:107], v[32:35], v[196:199], 0
R 62,19,30720
NV 104,36,204
R 32,20,0
s_add_u32 s0, s84, 5005312
NV 96,36,200
R 34,20,2048
NV 96,40,208
R 36,20,4096
buffer_load_dwordx4 a[40:43], v15, s[48:51], s0 offen sc1
NV 104,40,212
R 38,20,6144
s_waitcnt lgkmcnt(6)
NV 104,44,220
R 40,20,8192
buffer_load_dwordx4 v12, s[20:23], s75 offen offset:1024 lds
NV 96,44,216
R 42,20,10240
CV 64,64,65
NV 96,48,224
R 44,20,12288
CV 65,66,67
NV 104,48,228
R 46,20,14336
NV 104,52,236
R 48,20,16384
CV 66,68,69
NV 96,52,232
R 50,20,18432
NV 96,56,240
R 52,20,20480
buffer_load_dwordx4 v13, s[20:23], s75 offen offset:2048 lds
NV 104,56,244
R 54,20,22528
s_waitcnt lgkmcnt(6)
NV 104,60,252
R 56,20,24576
CV 67,70,71
NV 96,60,248
R 58,20,26624
s_add_u32 s76, s78, 4874240
v_mfma_f32_16x16x32_bf16 v[100:103], v[32:35], v[192:195], 0
R 60,20,28672
buffer_load_dwordx4 v14, s[20:23], s75 offen offset:3072 lds
buffer_store_dwordx4 v[64:67], v23, s[48:51], s76 offen offset:0 sc1
v_mfma_f32_16x16x32_bf16 v[108:111], v[32:35], v[196:199], 0
R 62,20,30720
NV 108,36,204
R 32,21,0
NV 100,36,200
R 34,21,2048
NV 100,40,208
R 36,21,4096
NV 108,40,212
R 38,21,6144
s_waitcnt lgkmcnt(6)
NV 108,44,220
s_waitcnt vmcnt(13)
s_barrier
R 40,21,8192
NV 100,44,216
R 42,21,10240
NV 100,48,224
R 44,21,12288
s_add_u32 m0, s66, 110592
s_add_u32 s75, s63, 295936
NV 108,48,228
R 46,21,14336
NV 108,52,236
R 48,21,16384
buffer_load_dwordx4 a[44:47], v16, s[48:51], s0 offen sc1
buffer_load_dwordx4 v11, s[20:23], s75 offen offset:0 lds
NV 100,52,232
R 50,21,18432
NV 100,56,240
R 52,21,20480
NV 108,56,244
R 54,21,22528
s_waitcnt lgkmcnt(6)
NV 108,60,252
R 56,21,24576
NV 100,60,248
R 58,21,26624
v_mfma_f32_16x16x32_bf16 v[112:115], v[32:35], v[192:195], 0
R 60,21,28672
CV 68,72,73
v_mfma_f32_16x16x32_bf16 v[120:123], v[32:35], v[196:199], 0
R 62,21,30720
NV 120,36,204
R 32,22,0
CV 69,74,75
NV 112,36,200
R 34,22,2048
CV 70,76,77
NV 112,40,208
R 36,22,4096
s_add_u32 s0, s84, 23732224
NV 120,40,212
R 38,22,6144
s_waitcnt lgkmcnt(6)
NV 120,44,220
R 40,22,8192
buffer_load_dwordx4 a[48:51], v15, s[48:51], s0 offen sc1
NV 112,44,216
R 42,22,10240
NV 112,48,224
R 44,22,12288
buffer_load_dwordx4 v12, s[20:23], s75 offen offset:1024 lds
NV 120,48,228
R 46,22,14336
CV 71,78,79
NV 120,52,236
R 48,22,16384
NV 112,52,232
R 50,22,18432
NV 112,56,240
R 52,22,20480
buffer_store_dwordx4 v[68:71], v23, s[48:51], s76 offen offset:1024 sc1
NV 120,56,244
R 54,22,22528
s_waitcnt lgkmcnt(6)
NV 120,60,252
R 56,22,24576
buffer_load_dwordx4 v13, s[20:23], s75 offen offset:2048 lds
NV 112,60,248
R 58,22,26624
v_mfma_f32_16x16x32_bf16 v[116:119], v[32:35], v[192:195], 0
R 60,22,28672
v_mfma_f32_16x16x32_bf16 v[124:127], v[32:35], v[196:199], 0
R 62,22,30720
NV 124,36,204
R 32,19,36864
buffer_load_dwordx4 v14, s[20:23], s75 offen offset:3072 lds
NV 116,36,200
R 34,19,38912
NV 116,40,208
R 36,19,40960
NV 124,40,212
R 38,19,43008
s_waitcnt lgkmcnt(7)
NV 124,44,220
R 40,19,45056
s_add_u32 m0, s66, 114688
s_add_u32 s75, s63, 332800
NV 116,44,216
R 42,19,47104
NV 116,48,224
R 44,19,49152
buffer_load_dwordx4 v11, s[20:23], s75 offen offset:0 lds
NV 124,48,228
R 46,19,51200
NV 124,52,236
R 48,19,53248
NV 116,52,232
R 50,19,55296
s_waitcnt lgkmcnt(6)
NV 116,56,240
R 52,19,57344
buffer_load_dwordx4 a[52:55], v16, s[48:51], s0 offen sc1
NV 124,56,244
R 54,19,59392
NV 124,60,252
R 56,19,61440
CV 80,80,81
NV 116,60,248
R 58,19,63488
NV 96,32,128
R 60,3,0
CV 81,82,83
NV 104,32,132
R 62,3,2048
NV 104,36,140
R 32,20,36864
CV 82,84,85
NV 96,36,136
R 34,20,38912
CV 83,86,87
s_waitcnt lgkmcnt(6)
NV 96,40,144
R 36,20,40960
NV 104,40,148
R 38,20,43008
NV 104,44,156
R 40,20,45056
buffer_load_dwordx4 v12, s[20:23], s75 offen offset:1024 lds
buffer_store_dwordx4 v[80:83], v23, s[48:51], s76 offen offset:2048 sc1
NV 96,44,152
R 42,20,47104
s_add_u32 s0, s84, 23879680
NV 96,48,160
R 44,20,49152
buffer_load_dwordx4 a[56:59], v15, s[48:51], s0 offen sc1
NV 104,48,164
R 46,20,51200
NV 104,52,172
R 48,20,53248
NV 96,52,168
R 50,20,55296
s_waitcnt lgkmcnt(6)
NV 96,56,176
R 52,20,57344
buffer_load_dwordx4 v13, s[20:23], s75 offen offset:2048 lds
NV 104,56,180
R 54,20,59392
NV 104,60,188
R 56,20,61440
NV 96,60,184
R 58,20,63488
NV 100,32,128
R 60,2,0
buffer_load_dwordx4 v14, s[20:23], s75 offen offset:3072 lds
NV 108,32,132
R 62,2,2048
NV 108,36,140
R 32,21,36864
NV 100,36,136
R 34,21,38912
s_waitcnt lgkmcnt(7)
NV 100,40,144
R 36,21,40960
NV 108,40,148
R 38,21,43008
NV 108,44,156
s_waitcnt vmcnt(15)
s_barrier
R 40,21,45056
NV 100,44,152
R 42,21,47104
NV 100,48,160
R 44,21,49152
CV 84,88,89
NV 108,48,164
R 46,21,51200
s_waitcnt lgkmcnt(6)
NV 108,52,172
R 48,21,53248
CV 85,90,91
NV 100,52,168
R 50,21,55296
NV 100,56,176
R 52,21,57344
CV 86,92,93
NV 108,56,180
R 54,21,59392
NV 108,60,188
R 56,21,61440
buffer_load_dwordx4 a[60:63], v16, s[48:51], s0 offen sc1
NV 100,60,184
R 58,21,63488
NV 112,32,128
R 60,4,0
CV 87,94,95
NV 120,32,132
R 62,4,2048
s_waitcnt lgkmcnt(6)
NV 120,36,140
R 32,22,36864
NV 112,36,136
R 34,22,38912
NV 112,40,144
R 36,22,40960
buffer_store_dwordx4 v[84:87], v23, s[48:51], s76 offen offset:3072 sc1
NV 120,40,148
R 38,22,43008
NV 120,44,156
R 40,22,45056
NV 112,44,152
R 42,22,47104
NV 112,48,160
R 44,22,49152
NV 120,48,164
R 46,22,51200
s_waitcnt lgkmcnt(7)
NV 120,52,172
R 48,22,53248
s_mov_b32 s81, 42639360
NV 112,52,168
R 50,22,55296
NV 112,56,176
R 52,22,57344
buffer_load_dword v31, v24, s[48:51], s81 offen sc1
NV 120,56,180
R 54,22,59392
NV 120,60,188
R 56,22,61440
NV 112,60,184
R 58,22,63488
s_waitcnt lgkmcnt(6)
NV 116,32,128
R 60,5,0
NV 124,32,132
R 62,5,2048
NV 124,36,140
R 32,3,8192
NV 116,36,136
R 34,3,10240
NV 116,40,144
R 36,3,12288
NV 124,40,148
R 38,3,14336
NV 124,44,156
R 40,3,16384
NV 116,44,152
R 42,3,18432
s_waitcnt lgkmcnt(7)
NV 116,48,160
R 44,3,20480
NV 124,48,164
R 46,3,22528
NV 124,52,172
R 48,3,24576
NV 116,52,168
R 50,3,26624
NV 116,56,176
R 52,3,28672
NV 124,56,180
R 54,3,30720
s_waitcnt lgkmcnt(6)
NV 124,60,188
R 56,3,32768
NV 116,60,184
R 58,3,34816
v_mfma_f32_16x16x32_bf16 v[64:67], v[32:35], v[192:195], 0
R 60,3,36864
v_mfma_f32_16x16x32_bf16 v[72:75], v[32:35], v[196:199], 0
R 62,3,38912
NV 72,36,204
R 32,2,8192
NV 64,36,200
R 34,2,10240
NV 64,40,208
LA_pad20:
s_cbranch_execz LA_cr1
R 36,2,12288
NV 72,40,212
R 38,2,14336
s_waitcnt lgkmcnt(7)
NV 72,44,220
R 40,2,16384
CV 96,96,97
NV 64,44,216
R 42,2,18432
CV 97,98,99
NV 64,48,224
R 44,2,20480
CV 98,100,101
NV 72,48,228
R 46,2,22528
CV 99,102,103
NV 72,52,236
R 48,2,24576
s_add_u32 s76, s78, 4878336
NV 64,52,232
R 50,2,26624
s_waitcnt lgkmcnt(6)
NV 64,56,240
R 52,2,28672
buffer_store_dwordx4 v[96:99], v23, s[48:51], s76 offen offset:0 sc1
NV 72,56,244
R 54,2,30720
NV 72,60,252
R 56,2,32768
NV 64,60,248
R 58,2,34816
v_mfma_f32_16x16x32_bf16 v[68:71], v[32:35], v[192:195], 0
R 60,2,36864
CV 100,104,105
v_mfma_f32_16x16x32_bf16 v[76:79], v[32:35], v[196:199], 0
R 62,2,38912
CV 101,106,107
NV 76,36,204
R 32,4,8192
CV 102,108,109
NV 68,36,200
R 34,4,10240
CV 103,110,111
s_waitcnt lgkmcnt(6)
NV 68,40,208
R 36,4,12288
NV 76,40,212
R 38,4,14336
NV 76,44,220
s_waitcnt vmcnt(4)
s_barrier
R 40,4,16384
buffer_store_dwordx4 v[100:103], v23, s[48:51], s76 offen offset:1024 sc1
NV 68,44,216
R 42,4,18432
NV 68,48,224
R 44,4,20480
NV 76,48,228
R 46,4,22528
NV 76,52,236
R 48,4,24576
NV 68,52,232
R 50,4,26624
s_waitcnt lgkmcnt(6)
NV 68,56,240
R 52,4,28672
s_waitcnt vmcnt(2)
v_cmp_ne_u32 vcc, 0x10000, v31
s_nop 1
s_cbranch_vccnz LA_poll4
LA_ok4:
NV 76,56,244
R 54,4,30720
NV 76,60,252
R 56,4,32768
s_add_u32 s0, s84, 4866048
NV 68,60,248
R 58,4,34816
v_mfma_f32_16x16x32_bf16 v[80:83], v[32:35], v[192:195], 0
R 60,4,36864
buffer_load_dwordx4 a[64:67], v15, s[48:51], s0 offen sc1
v_mfma_f32_16x16x32_bf16 v[88:91], v[32:35], v[196:199], 0
R 62,4,38912
CV 112,112,113
NV 88,36,204
R 32,5,8192
CV 113,114,115
NV 80,36,200
R 34,5,10240
CV 114,116,117
s_waitcnt lgkmcnt(6)
NV 80,40,208
R 36,5,12288
CV 115,118,119
NV 88,40,212
R 38,5,14336
NV 88,44,220
R 40,5,16384
buffer_store_dwordx4 v[112:115], v23, s[48:51], s76 offen offset:2048 sc1
NV 80,44,216
R 42,5,18432
NV 80,48,224
R 44,5,20480
NV 88,48,228
R 46,5,22528
NV 88,52,236
R 48,5,24576
CV 116,120,121
NV 80,52,232
R 50,5,26624
s_waitcnt lgkmcnt(6)
NV 80,56,240
R 52,5,28672
CV 117,122,123
NV 88,56,244
R 54,5,30720
CV 118,124,125
NV 88,60,252
R 56,5,32768
buffer_load_dwordx4 a[68:71], v16, s[48:51], s0 offen sc1
NV 80,60,248
R 58,5,34816
CV 119,126,127
v_mfma_f32_16x16x32_bf16 v[84:87], v[32:35], v[192:195], 0
R 60,5,36864
v_mfma_f32_16x16x32_bf16 v[92:95], v[32:35], v[196:199], 0
R 62,5,38912
NV 92,36,204
R 32,3,45056
buffer_store_dwordx4 v[116:119], v23, s[48:51], s76 offen offset:3072 sc1
NV 84,36,200
R 34,3,47104
s_add_u32 s0, s84, 5013504
s_waitcnt lgkmcnt(6)
NV 84,40,208
R 36,3,49152
buffer_load_dwordx4 a[72:75], v15, s[48:51], s0 offen sc1
NV 92,40,212
R 38,3,51200
NV 92,44,220
R 40,3,53248
NV 84,44,216
R 42,3,55296
NV 84,48,224
R 44,3,57344
NV 92,48,228
R 46,3,59392
NV 92,52,236
R 48,3,61440
NV 84,52,232
R 50,3,63488
s_waitcnt lgkmcnt(7)
NV 84,56,240
R 52,6,0
NV 92,56,244
R 54,6,2048
NV 92,60,252
R 56,6,4096
NV 84,60,248
R 58,6,6144
NV 64,32,128
R 60,6,8192
NV 72,32,132
R 62,6,10240
s_waitcnt lgkmcnt(6)
NV 72,36,140
R 32,2,45056
buffer_load_dwordx4 a[76:79], v16, s[48:51], s0 offen sc1
NV 64,36,136
R 34,2,47104
NV 64,40,144
R 36,2,49152
NV 72,40,148
R 38,2,51200
NV 72,44,156
R 40,2,53248
NV 64,44,152
R 42,2,55296
NV 64,48,160
R 44,2,57344
s_add_u32 s0, s84, 23740416
NV 72,48,164
R 46,2,59392
s_waitcnt lgkmcnt(7)
NV 72,52,172
R 48,2,61440
buffer_load_dwordx4 a[80:83], v15, s[48:51], s0 offen sc1
NV 64,52,168
R 50,2,63488
NV 64,56,176
R 52,7,0
NV 72,56,180
R 54,7,2048
NV 72,60,188
R 56,7,4096
NV 64,60,184
R 58,7,6144
s_waitcnt lgkmcnt(6)
NV 68,32,128
R 60,7,8192
NV 76,32,132
R 62,7,10240
NV 76,36,140
R 32,4,45056
NV 68,36,136
R 34,4,47104
NV 68,40,144
R 36,4,49152
NV 76,40,148
R 38,4,51200
NV 76,44,156
R 40,4,53248
NV 68,44,152
R 42,4,55296
s_waitcnt lgkmcnt(7)
NV 68,48,160
R 44,4,57344
buffer_load_dwordx4 a[84:87], v16, s[48:51], s0 offen sc1
NV 76,48,164
R 46,4,59392
NV 76,52,172
R 48,4,61440
NV 68,52,168
R 50,4,63488
NV 68,56,176
R 52,8,0
NV 76,56,180
R 54,8,2048
s_waitcnt lgkmcnt(6)
NV 76,60,188
R 56,8,4096
s_add_u32 s0, s84, 23887872
NV 68,60,184
R 58,8,6144
NV 80,32,128
R 60,8,8192
buffer_load_dwordx4 a[88:91], v15, s[48:51], s0 offen sc1
NV 88,32,132
R 62,8,10240
NV 88,36,140
R 32,5,45056
s_add_u32 s74, s80, 49152
s_waitcnt vmcnt(5)
NV 80,36,136
R 34,5,47104
NV 80,40,144
R 36,5,49152
buffer_store_dword v3, v30, s[48:51], s74 offen sc1
NV 88,40,148
R 38,5,51200
s_waitcnt lgkmcnt(6)
NV 88,44,156
R 40,5,53248
CV 64,64,65
NV 80,44,152
R 42,5,55296
CV 65,66,67
NV 80,48,160
R 44,5,57344
CV 66,68,69
NV 88,48,164
R 46,5,59392
NV 88,52,172
R 48,5,61440
CV 67,70,71
NV 80,52,168
R 50,5,63488
NV 80,56,176
R 52,9,0
s_add_u32 s76, s78, 4882432
NV 88,56,180
R 54,9,2048
s_waitcnt lgkmcnt(6)
NV 88,60,188
R 56,9,4096
buffer_load_dwordx4 a[92:95], v16, s[48:51], s0 offen sc1
buffer_store_dwordx4 v[64:67], v23, s[48:51], s76 offen offset:0 sc1
NV 80,60,184
R 58,9,6144
NV 84,32,128
R 60,9,8192
NV 92,32,132
R 62,9,10240
NV 92,36,140
NV 84,36,136
NV 84,40,144
CV 68,72,73
CV 69,74,75
NV 92,40,148
CV 70,76,77
s_waitcnt lgkmcnt(3)
NV 92,44,156
CV 71,78,79
NV 84,44,152
NV 84,48,160
buffer_store_dwordx4 v[68:71], v23, s[48:51], s76 offen offset:1024 sc1
NV 92,48,164
NV 92,52,172
NV 84,52,168
s_waitcnt lgkmcnt(0)
NV 84,56,176
NV 92,56,180
NV 92,60,188
NV 84,60,184
CV 80,80,81
CV 81,82,83
s_nop 5
CV 82,84,85
CV 83,86,87
buffer_store_dwordx4 v[80:83], v23, s[48:51], s76 offen offset:2048 sc1
CV 84,88,89
CV 85,90,91
CV 86,92,93
CV 87,94,95
buffer_store_dwordx4 v[84:87], v23, s[48:51], s76 offen offset:3072 sc1
ds_read_b64 v[48:49], v26 offset:0
ds_read_b64 v[50:51], v26 offset:256
ds_read_b64 v[52:53], v26 offset:512
ds_read_b64 v[54:55], v26 offset:768
ds_read_b64 v[56:57], v26 offset:1024
v_and_b32 v58, 1, v1
v_lshlrev_b32 v58, 4, v58
v_mov_b32 v59, 0x3f80
v_lshlrev_b32 v58, v58, v59
v_bfe_u32 v59, v1, 1, 3
v_cmp_eq_u32 vcc, 0, v59
s_nop 1
v_cndmask_b32 v32, 0, v58, vcc
v_cmp_eq_u32 vcc, 1, v59
s_nop 1
v_cndmask_b32 v33, 0, v58, vcc
v_cmp_eq_u32 vcc, 2, v59
s_nop 1
v_cndmask_b32 v34, 0, v58, vcc
v_cmp_eq_u32 vcc, 3, v59
s_nop 1
v_cndmask_b32 v35, 0, v58, vcc
v_cmp_eq_u32 vcc, 4, v59
s_nop 1
v_cndmask_b32 v36, 0, v58, vcc
v_cmp_eq_u32 vcc, 5, v59
s_nop 1
v_cndmask_b32 v37, 0, v58, vcc
v_cmp_eq_u32 vcc, 6, v59
s_nop 1
v_cndmask_b32 v38, 0, v58, vcc
v_cmp_eq_u32 vcc, 7, v59
s_nop 1
v_cndmask_b32 v39, 0, v58, vcc
v_lshrrev_b32 v59, 1, v1
v_xor_b32 v59, v59, v1
v_and_b32 v59, 8, v59
v_or_b32 v40, v32, v36
v_or_b32 v41, v33, v37
v_or_b32 v42, v34, v38
v_or_b32 v43, v35, v39
v_cmp_eq_u32 vcc, 0, v59
s_nop 1
v_cndmask_b32 v40, 0, v40, vcc
v_cndmask_b32 v41, 0, v41, vcc
v_cndmask_b32 v42, 0, v42, vcc
v_cndmask_b32 v43, 0, v43, vcc
v_cmp_gt_u32 vcc, 32, v1
s_nop 1
v_cndmask_b32 v44, v40, 0, vcc
v_cndmask_b32 v45, v41, 0, vcc
v_cndmask_b32 v46, v42, 0, vcc
v_cndmask_b32 v47, v43, 0, vcc
v_cndmask_b32 v40, 0, v40, vcc
v_cndmask_b32 v41, 0, v41, vcc
v_cndmask_b32 v42, 0, v42, vcc
v_cndmask_b32 v43, 0, v43, vcc
s_mov_b32 s81, 42647552
buffer_load_dword v31, v24, s[48:51], s81 offen sc1
v_add_u32 v27, 147456, v27
s_add_u32 s72, s79, 147456
v_add_u32 v62, s72, v23
s_cmp_eq_u32 s52, 0
s_cselect_b32 s72, 0, 2147483648
v_or_b32 v63, s72, v23
s_add_u32 s86, s86, s79
s_add_u32 s87, s86, 4096
s_add_u32 s88, s86, 8192
v_mfma_f32_16x16x32_bf16 v[180:183], v[40:43], a[96:99], 0
s_waitcnt lgkmcnt(0)
v_lshlrev_b32 v96, 16, v48
v_and_b32 v97, 0xffff0000, v48
v_lshlrev_b32 v98, 16, v49
v_and_b32 v99, 0xffff0000, v49
v_mfma_f32_16x16x32_bf16 v[184:187], v[44:47], a[96:99], 0
v_lshlrev_b32 v100, 16, v50
v_and_b32 v101, 0xffff0000, v50
v_lshlrev_b32 v102, 16, v51
v_and_b32 v103, 0xffff0000, v51
v_mfma_f32_16x16x32_bf16 v[188:191], v[40:43], a[100:103], 0
v_lshlrev_b32 v104, 16, v52
v_and_b32 v105, 0xffff0000, v52
v_lshlrev_b32 v106, 16, v53
v_and_b32 v107, 0xffff0000, v53
v_mfma_f32_16x16x32_bf16 v[192:195], v[44:47], a[100:103], 0
v_lshlrev_b32 v108, 16, v54
v_and_b32 v109, 0xffff0000, v54
v_lshlrev_b32 v110, 16, v55
v_and_b32 v111, 0xffff0000, v55
v_mfma_f32_16x16x32_bf16 v[196:199], v[40:43], a[104:107], 0
v_lshlrev_b32 v112, 16, v56
v_and_b32 v113, 0xffff0000, v56
v_lshlrev_b32 v114, 16, v57
v_and_b32 v115, 0xffff0000, v57
v_mfma_f32_16x16x32_bf16 v[160:163], v[32:35], a[0:3], 0
NA 160,36,4
NA 160,32,8
NA 160,36,12
NA 180,32,16
NA 180,36,20
NA 180,32,24
NA 180,36,28
v_mfma_f32_16x16x32_bf16 v[164:167], v[32:35], a[32:35], 0
NA 164,36,36
NA 164,32,40
NA 164,36,44
NA 184,32,48
NA 184,36,52
NA 184,32,56
NA 184,36,60
s_waitcnt vmcnt(1)
s_add_u32 s74, s80, 57344
buffer_store_dword v3, v30, s[48:51], s74 offen sc1
s_waitcnt vmcnt(1)
v_cmp_ne_u32 vcc, 0x10000, v31
s_nop 1
s_cbranch_vccnz LA_poll5
LA_ok5:
s_add_u32 s0, s84, 4874240
buffer_load_dwordx4 v[224:227], v15, s[48:51], s0 offen sc1
buffer_load_dwordx4 v[228:231], v16, s[48:51], s0 offen sc1
s_add_u32 s0, s84, 5021696
buffer_load_dwordx4 v[232:235], v15, s[48:51], s0 offen sc1
buffer_load_dwordx4 v[236:239], v16, s[48:51], s0 offen sc1
s_add_u32 s0, s84, 23748608
buffer_load_dwordx4 v[240:243], v15, s[48:51], s0 offen sc1
buffer_load_dwordx4 v[244:247], v16, s[48:51], s0 offen sc1
s_add_u32 s0, s84, 23896064
buffer_load_dwordx4 v[248:251], v15, s[48:51], s0 offen sc1
buffer_load_dwordx4 v[252:255], v16, s[48:51], s0 offen sc1
v_mfma_f32_16x16x32_bf16 v[168:171], v[32:35], a[64:67], 0
NA 168,36,68
NA 168,32,72
NA 168,36,76
NA 188,32,80
NA 188,36,84
NA 188,32,88
NA 188,36,92
v_mul_f32 v200, 0xbfb8aa3b, v180
v_mul_f32 v201, 0xbfb8aa3b, v181
v_mul_f32 v202, 0xbfb8aa3b, v182
v_mul_f32 v203, 0xbfb8aa3b, v183
v_mul_f32 v204, 0xbfb8aa3b, v184
v_mul_f32 v205, 0xbfb8aa3b, v185
v_mul_f32 v206, 0xbfb8aa3b, v186
v_mul_f32 v207, 0xbfb8aa3b, v187
v_mul_f32 v208, 0xbfb8aa3b, v188
v_mul_f32 v209, 0xbfb8aa3b, v189
v_mul_f32 v210, 0xbfb8aa3b, v190
v_mul_f32 v211, 0xbfb8aa3b, v191
v_exp_f32 v200, v200
v_exp_f32 v201, v201
v_exp_f32 v202, v202
v_exp_f32 v203, v203
v_exp_f32 v204, v204
v_exp_f32 v205, v205
v_exp_f32 v206, v206
v_exp_f32 v207, v207
v_exp_f32 v208, v208
v_exp_f32 v209, v209
v_exp_f32 v210, v210
v_exp_f32 v211, v211
v_add_f32 v200, 1.0, v200
v_add_f32 v201, 1.0, v201
v_add_f32 v202, 1.0, v202
v_add_f32 v203, 1.0, v203
v_add_f32 v204, 1.0, v204
v_add_f32 v205, 1.0, v205
v_add_f32 v206, 1.0, v206
v_add_f32 v207, 1.0, v207
v_add_f32 v208, 1.0, v208
v_add_f32 v209, 1.0, v209
v_add_f32 v210, 1.0, v210
v_add_f32 v211, 1.0, v211
v_rcp_f32 v200, v200
v_rcp_f32 v201, v201
v_rcp_f32 v202, v202
v_rcp_f32 v203, v203
v_rcp_f32 v204, v204
v_rcp_f32 v205, v205
v_rcp_f32 v206, v206
v_rcp_f32 v207, v207
v_rcp_f32 v208, v208
v_rcp_f32 v209, v209
v_rcp_f32 v210, v210
v_rcp_f32 v211, v211
v_mul_f32 v180, v180, v200
v_mul_f32 v181, v181, v201
v_mul_f32 v182, v182, v202
v_mul_f32 v183, v183, v203
v_mul_f32 v184, v184, v204
v_mul_f32 v185, v185, v205
v_mul_f32 v186, v186, v206
v_mul_f32 v187, v187, v207
v_mul_f32 v188, v188, v208
v_mul_f32 v189, v189, v209
v_mul_f32 v190, v190, v210
v_mul_f32 v191, v191, v211
v_fmac_f32 v96, v160, v180
v_fmac_f32 v97, v161, v181
v_fmac_f32 v98, v162, v182
v_fmac_f32 v99, v163, v183
v_fmac_f32 v100, v164, v184
v_fmac_f32 v101, v165, v185
v_fmac_f32 v102, v166, v186
v_fmac_f32 v103, v167, v187
v_fmac_f32 v104, v168, v188
v_fmac_f32 v105, v169, v189
v_fmac_f32 v106, v170, v190
v_fmac_f32 v107, v171, v191
CV 116,96,97
CV 117,98,99
CV 118,100,101
CV 119,102,103
CV 120,104,105
CV 121,106,107
ds_write_b64 v26, v[116:117] offset:0
ds_write_b64 v26, v[118:119] offset:256
ds_write_b64 v26, v[120:121] offset:512
s_mov_b32 s81, 42655744
buffer_load_dword v31, v24, s[48:51], s81 offen sc1
s_waitcnt vmcnt(8)
v_mfma_f32_16x16x32_bf16 v[172:175], v[32:35], v[224:227], 0
s_waitcnt vmcnt(7)
NV 172,36,228
s_waitcnt vmcnt(6)
NV 172,32,232
s_waitcnt vmcnt(5)
NV 172,36,236
s_waitcnt vmcnt(4)
NV 192,32,240
s_waitcnt vmcnt(3)
NV 192,36,244
s_waitcnt vmcnt(2)
NV 192,32,248
s_waitcnt vmcnt(1)
NV 192,36,252
s_nop 7
v_mul_f32 v212, 0xbfb8aa3b, v192
v_mul_f32 v213, 0xbfb8aa3b, v193
v_mul_f32 v214, 0xbfb8aa3b, v194
v_mul_f32 v215, 0xbfb8aa3b, v195
v_exp_f32 v212, v212
v_exp_f32 v213, v213
v_exp_f32 v214, v214
v_exp_f32 v215, v215
v_add_f32 v212, 1.0, v212
v_add_f32 v213, 1.0, v213
v_add_f32 v214, 1.0, v214
v_add_f32 v215, 1.0, v215
v_rcp_f32 v212, v212
v_rcp_f32 v213, v213
v_rcp_f32 v214, v214
v_rcp_f32 v215, v215
v_mul_f32 v192, v192, v212
v_mul_f32 v193, v193, v213
v_mul_f32 v194, v194, v214
v_mul_f32 v195, v195, v215
v_fmac_f32 v108, v172, v192
v_fmac_f32 v109, v173, v193
v_fmac_f32 v110, v174, v194
v_fmac_f32 v111, v175, v195
CV 122,108,109
CV 123,110,111
s_waitcnt vmcnt(0)
v_cmp_ne_u32 vcc, 0x10000, v31
s_nop 1
s_cbranch_vccnz LA_poll6
LA_ok6:
s_add_u32 s0, s84, 4882432
buffer_load_dwordx4 v[128:131], v15, s[48:51], s0 offen sc1
s_add_u32 s0, s84, 5029888
buffer_load_dwordx4 v[136:139], v15, s[48:51], s0 offen sc1
s_add_u32 s0, s84, 23756800
buffer_load_dwordx4 v[144:147], v15, s[48:51], s0 offen sc1
s_add_u32 s0, s84, 23904256
buffer_load_dwordx4 v[152:155], v15, s[48:51], s0 offen sc1
ds_write_b64 v26, v[122:123] offset:768
s_waitcnt vmcnt(3)
v_mfma_f32_16x16x32_bf16 v[176:179], v[32:35], v[128:131], 0
s_waitcnt vmcnt(2)
NV 176,32,136
s_waitcnt vmcnt(1)
NV 196,32,144
s_waitcnt vmcnt(0)
NV 196,32,152
s_nop 7
v_mul_f32 v216, 0xbfb8aa3b, v196
v_mul_f32 v217, 0xbfb8aa3b, v197
v_mul_f32 v218, 0xbfb8aa3b, v198
v_mul_f32 v219, 0xbfb8aa3b, v199
v_exp_f32 v216, v216
v_exp_f32 v217, v217
v_exp_f32 v218, v218
v_exp_f32 v219, v219
v_add_f32 v216, 1.0, v216
v_add_f32 v217, 1.0, v217
v_add_f32 v218, 1.0, v218
v_add_f32 v219, 1.0, v219
v_rcp_f32 v216, v216
v_rcp_f32 v217, v217
v_rcp_f32 v218, v218
v_rcp_f32 v219, v219
v_mul_f32 v196, v196, v216
v_mul_f32 v197, v197, v217
v_mul_f32 v198, v198, v218
v_mul_f32 v199, v199, v219
v_fmac_f32 v112, v176, v196
v_fmac_f32 v113, v177, v197
v_fmac_f32 v114, v178, v198
v_fmac_f32 v115, v179, v199
CV 124,112,113
CV 125,114,115
ds_write_b64 v27, v[124:125] offset:1024
s_waitcnt lgkmcnt(0)
s_barrier
ds_read_b128 v[224:227], v62 offset:0
ds_read_b128 v[228:231], v62 offset:4096
ds_read_b128 v[232:235], v62 offset:8192
s_waitcnt lgkmcnt(2)
buffer_store_dwordx4 v[224:227], v23, s[40:43], s86 offen sc1
s_waitcnt lgkmcnt(1)
buffer_store_dwordx4 v[228:231], v23, s[40:43], s87 offen sc1
s_waitcnt lgkmcnt(0)
buffer_store_dwordx4 v[232:235], v63, s[40:43], s88 offen sc1
LA_end:
s_endpgm
LA_slow0:
s_nop 15
s_mov_b32 s93, m0
v_and_b32 v176, 15, v1
v_lshlrev_b32 v176, 8, v176
v_and_b32 v177, 16, v1
v_lshl_add_u32 v176, v177, 1, v176
v_lshrrev_b32 v177, 5, v1
v_lshl_add_u32 v176, v177, 4, v176
s_add_u32 s92, s68, 147456
v_add_u32 v96, s92, v19
v_add_u32 v97, s92, v20
v_add_u32 v98, s92, v21
v_add_u32 v99, s92, v22
v_mov_b32 v177, 0xff800000
v_mov_b32 v178, 0xff800000
v_mov_b32 v179, 0xff800000
v_mov_b32 v180, 0xff800000
v_lshrrev_b32 v185, 3, v1
v_and_b32 v186, 7, v1
v_mul_u32_u24 v184, 256, v185
v_and_b32 v185, 6, v185
v_xor_b32 v186, v185, v186
v_lshl_add_u32 v184, v186, 4, v184
v_add_u32 v185, 1024, v184
v_add_u32 v186, 2048, v184
v_add_u32 v187, 3072, v184
s_lshl_b32 s94, s56, 20
s_add_u32 s94, s94, 393216
s_mov_b32 s92, 16
LA_slowa0:
s_add_u32 s95, s94, 0
buffer_load_dwordx4 v[64:67], v176, s[8:11], s95 offen offset:0
buffer_load_dwordx4 v[68:71], v176, s[8:11], s95 offen offset:64
buffer_load_dwordx4 v[72:75], v176, s[8:11], s95 offen offset:128
buffer_load_dwordx4 v[76:79], v176, s[8:11], s95 offen offset:192
s_add_u32 s95, s94, 4096
buffer_load_dwordx4 v[80:83], v176, s[8:11], s95 offen offset:0
buffer_load_dwordx4 v[84:87], v176, s[8:11], s95 offen offset:64
buffer_load_dwordx4 v[88:91], v176, s[8:11], s95 offen offset:128
buffer_load_dwordx4 v[92:95], v176, s[8:11], s95 offen offset:192
s_waitcnt vmcnt(0)
v_mfma_f32_16x16x32_bf16 v[128:131], v[64:67], a[128:131], 0
v_mfma_f32_16x16x32_bf16 v[136:139], v[64:67], a[132:135], 0
v_mfma_f32_16x16x32_bf16 v[144:147], v[64:67], a[160:163], 0
v_mfma_f32_16x16x32_bf16 v[152:155], v[64:67], a[164:167], 0
v_mfma_f32_16x16x32_bf16 v[132:135], v[80:83], a[128:131], 0
v_mfma_f32_16x16x32_bf16 v[140:143], v[80:83], a[132:135], 0
v_mfma_f32_16x16x32_bf16 v[148:151], v[80:83], a[160:163], 0
v_mfma_f32_16x16x32_bf16 v[156:159], v[80:83], a[164:167], 0
NA 128,68,136
NA 136,68,140
NA 144,68,168
NA 152,68,172
NA 132,84,136
NA 140,84,140
NA 148,84,168
NA 156,84,172
NA 128,72,144
NA 136,72,148
NA 144,72,176
NA 152,72,180
NA 132,88,144
NA 140,88,148
NA 148,88,176
NA 156,88,180
NA 128,76,152
NA 136,76,156
NA 144,76,184
NA 152,76,188
NA 132,92,152
NA 140,92,156
NA 148,92,184
NA 156,92,188
s_nop 15
v_max3_f32 v177, v177, v128, v129
v_max3_f32 v177, v177, v130, v131
v_max3_f32 v177, v177, v132, v133
v_max3_f32 v177, v177, v134, v135
v_max3_f32 v178, v178, v136, v137
v_max3_f32 v178, v178, v138, v139
v_max3_f32 v178, v178, v140, v141
v_max3_f32 v178, v178, v142, v143
v_max3_f32 v179, v179, v144, v145
v_max3_f32 v179, v179, v146, v147
v_max3_f32 v179, v179, v148, v149
v_max3_f32 v179, v179, v150, v151
v_max3_f32 v180, v180, v152, v153
v_max3_f32 v180, v180, v154, v155
v_max3_f32 v180, v180, v156, v157
v_max3_f32 v180, v180, v158, v159
s_add_u32 s94, s94, 8192
s_sub_u32 s92, s92, 1
s_cmp_lg_u32 s92, 0
s_cbranch_scc1 LA_slowa0
v_mov_b32 v188, v177
v_mov_b32 v189, v178
v_mov_b32 v190, v179
v_mov_b32 v191, v180
s_nop 1
v_permlane16_swap_b32 v177, v188
v_permlane16_swap_b32 v178, v189
v_permlane16_swap_b32 v179, v190
v_permlane16_swap_b32 v180, v191
v_max_f32 v177, v177, v188
v_max_f32 v178, v178, v189
v_max_f32 v179, v179, v190
v_max_f32 v180, v180, v191
v_mov_b32 v188, v177
v_mov_b32 v189, v178
v_mov_b32 v190, v179
v_mov_b32 v191, v180
s_nop 1
v_permlane32_swap_b32 v177, v188
v_permlane32_swap_b32 v178, v189
v_permlane32_swap_b32 v179, v190
v_permlane32_swap_b32 v180, v191
v_max_f32 v177, v177, v188
v_max_f32 v178, v178, v189
v_max_f32 v179, v179, v190
v_max_f32 v180, v180, v191
v_mov_b32 v24, 0
v_mov_b32 v25, 0
v_mov_b32 v26, 0
v_mov_b32 v27, 0
v_accvgpr_write_b32 a0, 0
v_accvgpr_write_b32 a1, 0
v_accvgpr_write_b32 a2, 0
v_accvgpr_write_b32 a3, 0
v_accvgpr_write_b32 a4, 0
v_accvgpr_write_b32 a5, 0
v_accvgpr_write_b32 a6, 0
v_accvgpr_write_b32 a7, 0
v_accvgpr_write_b32 a8, 0
v_accvgpr_write_b32 a9, 0
v_accvgpr_write_b32 a10, 0
v_accvgpr_write_b32 a11, 0
v_accvgpr_write_b32 a12, 0
v_accvgpr_write_b32 a13, 0
v_accvgpr_write_b32 a14, 0
v_accvgpr_write_b32 a15, 0
v_accvgpr_write_b32 a16, 0
v_accvgpr_write_b32 a17, 0
v_accvgpr_write_b32 a18, 0
v_accvgpr_write_b32 a19, 0
v_accvgpr_write_b32 a20, 0
v_accvgpr_write_b32 a21, 0
v_accvgpr_write_b32 a22, 0
v_accvgpr_write_b32 a23, 0
v_accvgpr_write_b32 a24, 0
v_accvgpr_write_b32 a25, 0
v_accvgpr_write_b32 a26, 0
v_accvgpr_write_b32 a27, 0
v_accvgpr_write_b32 a28, 0
v_accvgpr_write_b32 a29, 0
v_accvgpr_write_b32 a30, 0
v_accvgpr_write_b32 a31, 0
v_accvgpr_write_b32 a32, 0
v_accvgpr_write_b32 a33, 0
v_accvgpr_write_b32 a34, 0
v_accvgpr_write_b32 a35, 0
v_accvgpr_write_b32 a36, 0
v_accvgpr_write_b32 a37, 0
v_accvgpr_write_b32 a38, 0
v_accvgpr_write_b32 a39, 0
v_accvgpr_write_b32 a40, 0
v_accvgpr_write_b32 a41, 0
v_accvgpr_write_b32 a42, 0
v_accvgpr_write_b32 a43, 0
v_accvgpr_write_b32 a44, 0
v_accvgpr_write_b32 a45, 0
v_accvgpr_write_b32 a46, 0
v_accvgpr_write_b32 a47, 0
v_accvgpr_write_b32 a48, 0
v_accvgpr_write_b32 a49, 0
v_accvgpr_write_b32 a50, 0
v_accvgpr_write_b32 a51, 0
v_accvgpr_write_b32 a52, 0
v_accvgpr_write_b32 a53, 0
v_accvgpr_write_b32 a54, 0
v_accvgpr_write_b32 a55, 0
v_accvgpr_write_b32 a56, 0
v_accvgpr_write_b32 a57, 0
v_accvgpr_write_b32 a58, 0
v_accvgpr_write_b32 a59, 0
v_accvgpr_write_b32 a60, 0
v_accvgpr_write_b32 a61, 0
v_accvgpr_write_b32 a62, 0
v_accvgpr_write_b32 a63, 0
v_accvgpr_write_b32 a64, 0
v_accvgpr_write_b32 a65, 0
v_accvgpr_write_b32 a66, 0
v_accvgpr_write_b32 a67, 0
v_accvgpr_write_b32 a68, 0
v_accvgpr_write_b32 a69, 0
v_accvgpr_write_b32 a70, 0
v_accvgpr_write_b32 a71, 0
v_accvgpr_write_b32 a72, 0
v_accvgpr_write_b32 a73, 0
v_accvgpr_write_b32 a74, 0
v_accvgpr_write_b32 a75, 0
v_accvgpr_write_b32 a76, 0
v_accvgpr_write_b32 a77, 0
v_accvgpr_write_b32 a78, 0
v_accvgpr_write_b32 a79, 0
v_accvgpr_write_b32 a80, 0
v_accvgpr_write_b32 a81, 0
v_accvgpr_write_b32 a82, 0
v_accvgpr_write_b32 a83, 0
v_accvgpr_write_b32 a84, 0
v_accvgpr_write_b32 a85, 0
v_accvgpr_write_b32 a86, 0
v_accvgpr_write_b32 a87, 0
v_accvgpr_write_b32 a88, 0
v_accvgpr_write_b32 a89, 0
v_accvgpr_write_b32 a90, 0
v_accvgpr_write_b32 a91, 0
v_accvgpr_write_b32 a92, 0
v_accvgpr_write_b32 a93, 0
v_accvgpr_write_b32 a94, 0
v_accvgpr_write_b32 a95, 0
v_accvgpr_write_b32 a96, 0
v_accvgpr_write_b32 a97, 0
v_accvgpr_write_b32 a98, 0
v_accvgpr_write_b32 a99, 0
v_accvgpr_write_b32 a100, 0
v_accvgpr_write_b32 a101, 0
v_accvgpr_write_b32 a102, 0
v_accvgpr_write_b32 a103, 0
v_accvgpr_write_b32 a104, 0
v_accvgpr_write_b32 a105, 0
v_accvgpr_write_b32 a106, 0
v_accvgpr_write_b32 a107, 0
v_accvgpr_write_b32 a108, 0
v_accvgpr_write_b32 a109, 0
v_accvgpr_write_b32 a110, 0
v_accvgpr_write_b32 a111, 0
v_accvgpr_write_b32 a112, 0
v_accvgpr_write_b32 a113, 0
v_accvgpr_write_b32 a114, 0
v_accvgpr_write_b32 a115, 0
v_accvgpr_write_b32 a116, 0
v_accvgpr_write_b32 a117, 0
v_accvgpr_write_b32 a118, 0
v_accvgpr_write_b32 a119, 0
v_accvgpr_write_b32 a120, 0
v_accvgpr_write_b32 a121, 0
v_accvgpr_write_b32 a122, 0
v_accvgpr_write_b32 a123, 0
v_accvgpr_write_b32 a124, 0
v_accvgpr_write_b32 a125, 0
v_accvgpr_write_b32 a126, 0
v_accvgpr_write_b32 a127, 0
s_lshl_b32 s94, s56, 20
s_add_u32 s94, s94, 393216
s_mov_b32 s92, 16
LA_slowb0:
s_add_u32 s95, s94, 0
buffer_load_dwordx4 v[64:67], v176, s[8:11], s95 offen offset:0
buffer_load_dwordx4 v[68:71], v176, s[8:11], s95 offen offset:64
buffer_load_dwordx4 v[72:75], v176, s[8:11], s95 offen offset:128
buffer_load_dwordx4 v[76:79], v176, s[8:11], s95 offen offset:192
s_add_u32 s95, s94, 4096
buffer_load_dwordx4 v[80:83], v176, s[8:11], s95 offen offset:0
buffer_load_dwordx4 v[84:87], v176, s[8:11], s95 offen offset:64
buffer_load_dwordx4 v[88:91], v176, s[8:11], s95 offen offset:128
buffer_load_dwordx4 v[92:95], v176, s[8:11], s95 offen offset:192
s_waitcnt vmcnt(0)
v_mfma_f32_16x16x32_bf16 v[128:131], v[64:67], a[128:131], 0
v_mfma_f32_16x16x32_bf16 v[136:139], v[64:67], a[132:135], 0
v_mfma_f32_16x16x32_bf16 v[144:147], v[64:67], a[160:163], 0
v_mfma_f32_16x16x32_bf16 v[152:155], v[64:67], a[164:167], 0
v_mfma_f32_16x16x32_bf16 v[132:135], v[80:83], a[128:131], 0
v_mfma_f32_16x16x32_bf16 v[140:143], v[80:83], a[132:135], 0
v_mfma_f32_16x16x32_bf16 v[148:151], v[80:83], a[160:163], 0
v_mfma_f32_16x16x32_bf16 v[156:159], v[80:83], a[164:167], 0
NA 128,68,136
NA 136,68,140
NA 144,68,168
NA 152,68,172
NA 132,84,136
NA 140,84,140
NA 148,84,168
NA 156,84,172
NA 128,72,144
NA 136,72,148
NA 144,72,176
NA 152,72,180
NA 132,88,144
NA 140,88,148
NA 148,88,176
NA 156,88,180
NA 128,76,152
NA 136,76,156
NA 144,76,184
NA 152,76,188
NA 132,92,152
NA 140,92,156
NA 148,92,184
NA 156,92,188
s_nop 15
v_sub_f32 v128, v128, v177
v_sub_f32 v129, v129, v177
v_sub_f32 v130, v130, v177
v_sub_f32 v131, v131, v177
v_sub_f32 v132, v132, v177
v_sub_f32 v133, v133, v177
v_sub_f32 v134, v134, v177
v_sub_f32 v135, v135, v177
v_exp_f32 v128, v128
v_exp_f32 v129, v129
v_exp_f32 v130, v130
v_exp_f32 v131, v131
v_exp_f32 v132, v132
v_exp_f32 v133, v133
v_exp_f32 v134, v134
v_exp_f32 v135, v135
s_nop 0
v_add_f32 v24, v24, v128
v_add_f32 v24, v24, v129
v_add_f32 v24, v24, v130
v_add_f32 v24, v24, v131
v_add_f32 v24, v24, v132
v_add_f32 v24, v24, v133
v_add_f32 v24, v24, v134
v_add_f32 v24, v24, v135
CV 128,128,129
CV 129,130,131
CV 130,132,133
CV 131,134,135
v_sub_f32 v136, v136, v178
v_sub_f32 v137, v137, v178
v_sub_f32 v138, v138, v178
v_sub_f32 v139, v139, v178
v_sub_f32 v140, v140, v178
v_sub_f32 v141, v141, v178
v_sub_f32 v142, v142, v178
v_sub_f32 v143, v143, v178
v_exp_f32 v136, v136
v_exp_f32 v137, v137
v_exp_f32 v138, v138
v_exp_f32 v139, v139
v_exp_f32 v140, v140
v_exp_f32 v141, v141
v_exp_f32 v142, v142
v_exp_f32 v143, v143
s_nop 0
v_add_f32 v25, v25, v136
v_add_f32 v25, v25, v137
v_add_f32 v25, v25, v138
v_add_f32 v25, v25, v139
v_add_f32 v25, v25, v140
v_add_f32 v25, v25, v141
v_add_f32 v25, v25, v142
v_add_f32 v25, v25, v143
CV 136,136,137
CV 137,138,139
CV 138,140,141
CV 139,142,143
v_sub_f32 v144, v144, v179
v_sub_f32 v145, v145, v179
v_sub_f32 v146, v146, v179
v_sub_f32 v147, v147, v179
v_sub_f32 v148, v148, v179
v_sub_f32 v149, v149, v179
v_sub_f32 v150, v150, v179
v_sub_f32 v151, v151, v179
v_exp_f32 v144, v144
v_exp_f32 v145, v145
v_exp_f32 v146, v146
v_exp_f32 v147, v147
v_exp_f32 v148, v148
v_exp_f32 v149, v149
v_exp_f32 v150, v150
v_exp_f32 v151, v151
s_nop 0
v_add_f32 v26, v26, v144
v_add_f32 v26, v26, v145
v_add_f32 v26, v26, v146
v_add_f32 v26, v26, v147
v_add_f32 v26, v26, v148
v_add_f32 v26, v26, v149
v_add_f32 v26, v26, v150
v_add_f32 v26, v26, v151
CV 144,144,145
CV 145,146,147
CV 146,148,149
CV 147,150,151
v_sub_f32 v152, v152, v180
v_sub_f32 v153, v153, v180
v_sub_f32 v154, v154, v180
v_sub_f32 v155, v155, v180
v_sub_f32 v156, v156, v180
v_sub_f32 v157, v157, v180
v_sub_f32 v158, v158, v180
v_sub_f32 v159, v159, v180
v_exp_f32 v152, v152
v_exp_f32 v153, v153
v_exp_f32 v154, v154
v_exp_f32 v155, v155
v_exp_f32 v156, v156
v_exp_f32 v157, v157
v_exp_f32 v158, v158
v_exp_f32 v159, v159
s_nop 0
v_add_f32 v27, v27, v152
v_add_f32 v27, v27, v153
v_add_f32 v27, v27, v154
v_add_f32 v27, v27, v155
v_add_f32 v27, v27, v156
v_add_f32 v27, v27, v157
v_add_f32 v27, v27, v158
v_add_f32 v27, v27, v159
CV 152,152,153
CV 153,154,155
CV 154,156,157
CV 155,158,159
s_add_u32 m0, s68, 147456
s_add_u32 s95, s94, 0
buffer_load_dwordx4 v184, s[12:15], s95 offen offset:0 lds
buffer_load_dwordx4 v185, s[12:15], s95 offen offset:1024 lds
buffer_load_dwordx4 v186, s[12:15], s95 offen offset:2048 lds
buffer_load_dwordx4 v187, s[12:15], s95 offen offset:3072 lds
s_waitcnt vmcnt(0)
R 160,96,0
R 162,96,2048
R 164,97,0
R 166,97,2048
R 168,98,0
R 170,98,2048
R 172,99,0
R 174,99,2048
s_waitcnt lgkmcnt(0)
NC 0,160,128
NC 8,160,136
NC 64,160,144
NC 72,160,152
NC 4,164,128
NC 12,164,136
NC 68,164,144
NC 76,164,152
NC 16,168,128
NC 24,168,136
NC 80,168,144
NC 88,168,152
NC 20,172,128
NC 28,172,136
NC 84,172,144
NC 92,172,152
s_nop 7
s_add_u32 m0, s68, 147456
s_add_u32 s95, s94, 128
buffer_load_dwordx4 v184, s[12:15], s95 offen offset:0 lds
buffer_load_dwordx4 v185, s[12:15], s95 offen offset:1024 lds
buffer_load_dwordx4 v186, s[12:15], s95 offen offset:2048 lds
buffer_load_dwordx4 v187, s[12:15], s95 offen offset:3072 lds
s_waitcnt vmcnt(0)
R 160,96,0
R 162,96,2048
R 164,97,0
R 166,97,2048
R 168,98,0
R 170,98,2048
R 172,99,0
R 174,99,2048
s_waitcnt lgkmcnt(0)
NC 32,160,128
NC 40,160,136
NC 96,160,144
NC 104,160,152
NC 36,164,128
NC 44,164,136
NC 100,164,144
NC 108,164,152
NC 48,168,128
NC 56,168,136
NC 112,168,144
NC 120,168,152
NC 52,172,128
NC 60,172,136
NC 116,172,144
NC 124,172,152
s_nop 7
s_add_u32 s94, s94, 8192
s_sub_u32 s92, s92, 1
s_cmp_lg_u32 s92, 0
s_cbranch_scc1 LA_slowb0
v_mov_b32 v188, v24
v_mov_b32 v189, v25
v_mov_b32 v190, v26
v_mov_b32 v191, v27
s_nop 1
v_permlane16_swap_b32 v24, v188
v_permlane16_swap_b32 v25, v189
v_permlane16_swap_b32 v26, v190
v_permlane16_swap_b32 v27, v191
v_add_f32 v24, v24, v188
v_add_f32 v25, v25, v189
v_add_f32 v26, v26, v190
v_add_f32 v27, v27, v191
v_mov_b32 v188, v24
v_mov_b32 v189, v25
v_mov_b32 v190, v26
v_mov_b32 v191, v27
s_nop 1
v_permlane32_swap_b32 v24, v188
v_permlane32_swap_b32 v25, v189
v_permlane32_swap_b32 v26, v190
v_permlane32_swap_b32 v27, v191
v_add_f32 v24, v24, v188
v_add_f32 v25, v25, v189
v_add_f32 v26, v26, v190
v_add_f32 v27, v27, v191
s_mov_b32 m0, s93
s_nop 15
s_branch LA_slowret0
LA_poll0:
s_sleep 4
buffer_load_dword v31, v115, s[44:47], 0 offen sc1
s_sub_u32 s77, s77, 1
s_cmp_eq_u32 s77, 0
s_cbranch_scc1 LA_end
s_waitcnt vmcnt(0)
v_cmp_ne_u32 vcc, 0x10000, v31
s_nop 1
s_cbranch_vccnz LA_poll0
s_branch LA_ok0
LA_poll1:
s_sleep 4
buffer_load_dword v31, v115, s[48:51], s81 offen sc1
s_sub_u32 s77, s77, 1
s_cmp_eq_u32 s77, 0
s_cbranch_scc1 LA_end
s_waitcnt vmcnt(0)
v_cmp_ne_u32 vcc, 0x10000, v31
s_nop 1
s_cbranch_vccnz LA_poll1
s_branch LA_ok1
LA_slow1:
s_nop 15
s_mov_b32 s93, m0
v_and_b32 v176, 15, v1
v_lshlrev_b32 v176, 8, v176
v_and_b32 v177, 16, v1
v_lshl_add_u32 v176, v177, 1, v176
v_lshrrev_b32 v177, 5, v1
v_lshl_add_u32 v176, v177, 4, v176
s_add_u32 s92, s68, 147456
v_add_u32 v96, s92, v19
v_add_u32 v97, s92, v20
v_add_u32 v98, s92, v21
v_add_u32 v99, s92, v22
v_mov_b32 v177, 0xff800000
v_mov_b32 v178, 0xff800000
v_mov_b32 v179, 0xff800000
v_mov_b32 v180, 0xff800000
v_lshrrev_b32 v185, 3, v1
v_and_b32 v186, 7, v1
v_mul_u32_u24 v184, 256, v185
v_and_b32 v185, 6, v185
v_xor_b32 v186, v185, v186
v_lshl_add_u32 v184, v186, 4, v184
v_add_u32 v185, 1024, v184
v_add_u32 v186, 2048, v184
v_add_u32 v187, 3072, v184
s_lshl_b32 s94, s56, 20
s_add_u32 s94, s94, 917504
s_mov_b32 s92, 16
LA_slowa1:
s_add_u32 s95, s94, 0
buffer_load_dwordx4 v[64:67], v176, s[8:11], s95 offen offset:0
buffer_load_dwordx4 v[68:71], v176, s[8:11], s95 offen offset:64
buffer_load_dwordx4 v[72:75], v176, s[8:11], s95 offen offset:128
buffer_load_dwordx4 v[76:79], v176, s[8:11], s95 offen offset:192
s_add_u32 s95, s94, 4096
buffer_load_dwordx4 v[80:83], v176, s[8:11], s95 offen offset:0
buffer_load_dwordx4 v[84:87], v176, s[8:11], s95 offen offset:64
buffer_load_dwordx4 v[88:91], v176, s[8:11], s95 offen offset:128
buffer_load_dwordx4 v[92:95], v176, s[8:11], s95 offen offset:192
s_waitcnt vmcnt(0)
v_mfma_f32_16x16x32_bf16 v[128:131], v[64:67], a[192:195], 0
v_mfma_f32_16x16x32_bf16 v[136:139], v[64:67], a[196:199], 0
v_mfma_f32_16x16x32_bf16 v[144:147], v[64:67], a[224:227], 0
v_mfma_f32_16x16x32_bf16 v[152:155], v[64:67], a[228:231], 0
v_mfma_f32_16x16x32_bf16 v[132:135], v[80:83], a[192:195], 0
v_mfma_f32_16x16x32_bf16 v[140:143], v[80:83], a[196:199], 0
v_mfma_f32_16x16x32_bf16 v[148:151], v[80:83], a[224:227], 0
v_mfma_f32_16x16x32_bf16 v[156:159], v[80:83], a[228:231], 0
NA 128,68,200
NA 136,68,204
NA 144,68,232
NA 152,68,236
NA 132,84,200
NA 140,84,204
NA 148,84,232
NA 156,84,236
NA 128,72,208
NA 136,72,212
NA 144,72,240
NA 152,72,244
NA 132,88,208
NA 140,88,212
NA 148,88,240
NA 156,88,244
NA 128,76,216
NA 136,76,220
NA 144,76,248
NA 152,76,252
NA 132,92,216
NA 140,92,220
NA 148,92,248
NA 156,92,252
s_nop 15
v_max3_f32 v177, v177, v128, v129
v_max3_f32 v177, v177, v130, v131
v_max3_f32 v177, v177, v132, v133
v_max3_f32 v177, v177, v134, v135
v_max3_f32 v178, v178, v136, v137
v_max3_f32 v178, v178, v138, v139
v_max3_f32 v178, v178, v140, v141
v_max3_f32 v178, v178, v142, v143
v_max3_f32 v179, v179, v144, v145
v_max3_f32 v179, v179, v146, v147
v_max3_f32 v179, v179, v148, v149
v_max3_f32 v179, v179, v150, v151
v_max3_f32 v180, v180, v152, v153
v_max3_f32 v180, v180, v154, v155
v_max3_f32 v180, v180, v156, v157
v_max3_f32 v180, v180, v158, v159
s_add_u32 s94, s94, 8192
s_sub_u32 s92, s92, 1
s_cmp_lg_u32 s92, 0
s_cbranch_scc1 LA_slowa1
v_mov_b32 v188, v177
v_mov_b32 v189, v178
v_mov_b32 v190, v179
v_mov_b32 v191, v180
s_nop 1
v_permlane16_swap_b32 v177, v188
v_permlane16_swap_b32 v178, v189
v_permlane16_swap_b32 v179, v190
v_permlane16_swap_b32 v180, v191
v_max_f32 v177, v177, v188
v_max_f32 v178, v178, v189
v_max_f32 v179, v179, v190
v_max_f32 v180, v180, v191
v_mov_b32 v188, v177
v_mov_b32 v189, v178
v_mov_b32 v190, v179
v_mov_b32 v191, v180
s_nop 1
v_permlane32_swap_b32 v177, v188
v_permlane32_swap_b32 v178, v189
v_permlane32_swap_b32 v179, v190
v_permlane32_swap_b32 v180, v191
v_max_f32 v177, v177, v188
v_max_f32 v178, v178, v189
v_max_f32 v179, v179, v190
v_max_f32 v180, v180, v191
v_mov_b32 v24, 0
v_mov_b32 v25, 0
v_mov_b32 v26, 0
v_mov_b32 v27, 0
v_accvgpr_write_b32 a128, 0
v_accvgpr_write_b32 a129, 0
v_accvgpr_write_b32 a130, 0
v_accvgpr_write_b32 a131, 0
v_accvgpr_write_b32 a132, 0
v_accvgpr_write_b32 a133, 0
v_accvgpr_write_b32 a134, 0
v_accvgpr_write_b32 a135, 0
v_accvgpr_write_b32 a136, 0
v_accvgpr_write_b32 a137, 0
v_accvgpr_write_b32 a138, 0
v_accvgpr_write_b32 a139, 0
v_accvgpr_write_b32 a140, 0
v_accvgpr_write_b32 a141, 0
v_accvgpr_write_b32 a142, 0
v_accvgpr_write_b32 a143, 0
v_accvgpr_write_b32 a144, 0
v_accvgpr_write_b32 a145, 0
v_accvgpr_write_b32 a146, 0
v_accvgpr_write_b32 a147, 0
v_accvgpr_write_b32 a148, 0
v_accvgpr_write_b32 a149, 0
v_accvgpr_write_b32 a150, 0
v_accvgpr_write_b32 a151, 0
v_accvgpr_write_b32 a152, 0
v_accvgpr_write_b32 a153, 0
v_accvgpr_write_b32 a154, 0
v_accvgpr_write_b32 a155, 0
v_accvgpr_write_b32 a156, 0
v_accvgpr_write_b32 a157, 0
v_accvgpr_write_b32 a158, 0
v_accvgpr_write_b32 a159, 0
v_accvgpr_write_b32 a160, 0
v_accvgpr_write_b32 a161, 0
v_accvgpr_write_b32 a162, 0
v_accvgpr_write_b32 a163, 0
v_accvgpr_write_b32 a164, 0
v_accvgpr_write_b32 a165, 0
v_accvgpr_write_b32 a166, 0
v_accvgpr_write_b32 a167, 0
v_accvgpr_write_b32 a168, 0
v_accvgpr_write_b32 a169, 0
v_accvgpr_write_b32 a170, 0
v_accvgpr_write_b32 a171, 0
v_accvgpr_write_b32 a172, 0
v_accvgpr_write_b32 a173, 0
v_accvgpr_write_b32 a174, 0
v_accvgpr_write_b32 a175, 0
v_accvgpr_write_b32 a176, 0
v_accvgpr_write_b32 a177, 0
v_accvgpr_write_b32 a178, 0
v_accvgpr_write_b32 a179, 0
v_accvgpr_write_b32 a180, 0
v_accvgpr_write_b32 a181, 0
v_accvgpr_write_b32 a182, 0
v_accvgpr_write_b32 a183, 0
v_accvgpr_write_b32 a184, 0
v_accvgpr_write_b32 a185, 0
v_accvgpr_write_b32 a186, 0
v_accvgpr_write_b32 a187, 0
v_accvgpr_write_b32 a188, 0
v_accvgpr_write_b32 a189, 0
v_accvgpr_write_b32 a190, 0
v_accvgpr_write_b32 a191, 0
v_accvgpr_write_b32 a0, 0
v_accvgpr_write_b32 a1, 0
v_accvgpr_write_b32 a2, 0
v_accvgpr_write_b32 a3, 0
v_accvgpr_write_b32 a4, 0
v_accvgpr_write_b32 a5, 0
v_accvgpr_write_b32 a6, 0
v_accvgpr_write_b32 a7, 0
v_accvgpr_write_b32 a8, 0
v_accvgpr_write_b32 a9, 0
v_accvgpr_write_b32 a10, 0
v_accvgpr_write_b32 a11, 0
v_accvgpr_write_b32 a12, 0
v_accvgpr_write_b32 a13, 0
v_accvgpr_write_b32 a14, 0
v_accvgpr_write_b32 a15, 0
v_accvgpr_write_b32 a16, 0
v_accvgpr_write_b32 a17, 0
v_accvgpr_write_b32 a18, 0
v_accvgpr_write_b32 a19, 0
v_accvgpr_write_b32 a20, 0
v_accvgpr_write_b32 a21, 0
v_accvgpr_write_b32 a22, 0
v_accvgpr_write_b32 a23, 0
v_accvgpr_write_b32 a24, 0
v_accvgpr_write_b32 a25, 0
v_accvgpr_write_b32 a26, 0
v_accvgpr_write_b32 a27, 0
v_accvgpr_write_b32 a28, 0
v_accvgpr_write_b32 a29, 0
v_accvgpr_write_b32 a30, 0
v_accvgpr_write_b32 a31, 0
v_accvgpr_write_b32 a32, 0
v_accvgpr_write_b32 a33, 0
v_accvgpr_write_b32 a34, 0
v_accvgpr_write_b32 a35, 0
v_accvgpr_write_b32 a36, 0
v_accvgpr_write_b32 a37, 0
v_accvgpr_write_b32 a38, 0
v_accvgpr_write_b32 a39, 0
v_accvgpr_write_b32 a40, 0
v_accvgpr_write_b32 a41, 0
v_accvgpr_write_b32 a42, 0
v_accvgpr_write_b32 a43, 0
v_accvgpr_write_b32 a44, 0
v_accvgpr_write_b32 a45, 0
v_accvgpr_write_b32 a46, 0
v_accvgpr_write_b32 a47, 0
v_accvgpr_write_b32 a48, 0
v_accvgpr_write_b32 a49, 0
v_accvgpr_write_b32 a50, 0
v_accvgpr_write_b32 a51, 0
v_accvgpr_write_b32 a52, 0
v_accvgpr_write_b32 a53, 0
v_accvgpr_write_b32 a54, 0
v_accvgpr_write_b32 a55, 0
v_accvgpr_write_b32 a56, 0
v_accvgpr_write_b32 a57, 0
v_accvgpr_write_b32 a58, 0
v_accvgpr_write_b32 a59, 0
v_accvgpr_write_b32 a60, 0
v_accvgpr_write_b32 a61, 0
v_accvgpr_write_b32 a62, 0
v_accvgpr_write_b32 a63, 0
s_lshl_b32 s94, s56, 20
s_add_u32 s94, s94, 917504
s_mov_b32 s92, 16
LA_slowb1:
s_add_u32 s95, s94, 0
buffer_load_dwordx4 v[64:67], v176, s[8:11], s95 offen offset:0
buffer_load_dwordx4 v[68:71], v176, s[8:11], s95 offen offset:64
buffer_load_dwordx4 v[72:75], v176, s[8:11], s95 offen offset:128
buffer_load_dwordx4 v[76:79], v176, s[8:11], s95 offen offset:192
s_add_u32 s95, s94, 4096
buffer_load_dwordx4 v[80:83], v176, s[8:11], s95 offen offset:0
buffer_load_dwordx4 v[84:87], v176, s[8:11], s95 offen offset:64
buffer_load_dwordx4 v[88:91], v176, s[8:11], s95 offen offset:128
buffer_load_dwordx4 v[92:95], v176, s[8:11], s95 offen offset:192
s_waitcnt vmcnt(0)
v_mfma_f32_16x16x32_bf16 v[128:131], v[64:67], a[192:195], 0
v_mfma_f32_16x16x32_bf16 v[136:139], v[64:67], a[196:199], 0
v_mfma_f32_16x16x32_bf16 v[144:147], v[64:67], a[224:227], 0
v_mfma_f32_16x16x32_bf16 v[152:155], v[64:67], a[228:231], 0
v_mfma_f32_16x16x32_bf16 v[132:135], v[80:83], a[192:195], 0
v_mfma_f32_16x16x32_bf16 v[140:143], v[80:83], a[196:199], 0
v_mfma_f32_16x16x32_bf16 v[148:151], v[80:83], a[224:227], 0
v_mfma_f32_16x16x32_bf16 v[156:159], v[80:83], a[228:231], 0
NA 128,68,200
NA 136,68,204
NA 144,68,232
NA 152,68,236
NA 132,84,200
NA 140,84,204
NA 148,84,232
NA 156,84,236
NA 128,72,208
NA 136,72,212
NA 144,72,240
NA 152,72,244
NA 132,88,208
NA 140,88,212
NA 148,88,240
NA 156,88,244
NA 128,76,216
NA 136,76,220
NA 144,76,248
NA 152,76,252
NA 132,92,216
NA 140,92,220
NA 148,92,248
NA 156,92,252
s_nop 15
v_sub_f32 v128, v128, v177
v_sub_f32 v129, v129, v177
v_sub_f32 v130, v130, v177
v_sub_f32 v131, v131, v177
v_sub_f32 v132, v132, v177
v_sub_f32 v133, v133, v177
v_sub_f32 v134, v134, v177
v_sub_f32 v135, v135, v177
v_exp_f32 v128, v128
v_exp_f32 v129, v129
v_exp_f32 v130, v130
v_exp_f32 v131, v131
v_exp_f32 v132, v132
v_exp_f32 v133, v133
v_exp_f32 v134, v134
v_exp_f32 v135, v135
s_nop 0
v_add_f32 v24, v24, v128
v_add_f32 v24, v24, v129
v_add_f32 v24, v24, v130
v_add_f32 v24, v24, v131
v_add_f32 v24, v24, v132
v_add_f32 v24, v24, v133
v_add_f32 v24, v24, v134
v_add_f32 v24, v24, v135
CV 128,128,129
CV 129,130,131
CV 130,132,133
CV 131,134,135
v_sub_f32 v136, v136, v178
v_sub_f32 v137, v137, v178
v_sub_f32 v138, v138, v178
v_sub_f32 v139, v139, v178
v_sub_f32 v140, v140, v178
v_sub_f32 v141, v141, v178
v_sub_f32 v142, v142, v178
v_sub_f32 v143, v143, v178
v_exp_f32 v136, v136
v_exp_f32 v137, v137
v_exp_f32 v138, v138
v_exp_f32 v139, v139
v_exp_f32 v140, v140
v_exp_f32 v141, v141
v_exp_f32 v142, v142
v_exp_f32 v143, v143
s_nop 0
v_add_f32 v25, v25, v136
v_add_f32 v25, v25, v137
v_add_f32 v25, v25, v138
v_add_f32 v25, v25, v139
v_add_f32 v25, v25, v140
v_add_f32 v25, v25, v141
v_add_f32 v25, v25, v142
v_add_f32 v25, v25, v143
CV 136,136,137
CV 137,138,139
CV 138,140,141
CV 139,142,143
v_sub_f32 v144, v144, v179
v_sub_f32 v145, v145, v179
v_sub_f32 v146, v146, v179
v_sub_f32 v147, v147, v179
v_sub_f32 v148, v148, v179
v_sub_f32 v149, v149, v179
v_sub_f32 v150, v150, v179
v_sub_f32 v151, v151, v179
v_exp_f32 v144, v144
v_exp_f32 v145, v145
v_exp_f32 v146, v146
v_exp_f32 v147, v147
v_exp_f32 v148, v148
v_exp_f32 v149, v149
v_exp_f32 v150, v150
v_exp_f32 v151, v151
s_nop 0
v_add_f32 v26, v26, v144
v_add_f32 v26, v26, v145
v_add_f32 v26, v26, v146
v_add_f32 v26, v26, v147
v_add_f32 v26, v26, v148
v_add_f32 v26, v26, v149
v_add_f32 v26, v26, v150
v_add_f32 v26, v26, v151
CV 144,144,145
CV 145,146,147
CV 146,148,149
CV 147,150,151
v_sub_f32 v152, v152, v180
v_sub_f32 v153, v153, v180
v_sub_f32 v154, v154, v180
v_sub_f32 v155, v155, v180
v_sub_f32 v156, v156, v180
v_sub_f32 v157, v157, v180
v_sub_f32 v158, v158, v180
v_sub_f32 v159, v159, v180
v_exp_f32 v152, v152
v_exp_f32 v153, v153
v_exp_f32 v154, v154
v_exp_f32 v155, v155
v_exp_f32 v156, v156
v_exp_f32 v157, v157
v_exp_f32 v158, v158
v_exp_f32 v159, v159
s_nop 0
v_add_f32 v27, v27, v152
v_add_f32 v27, v27, v153
v_add_f32 v27, v27, v154
v_add_f32 v27, v27, v155
v_add_f32 v27, v27, v156
v_add_f32 v27, v27, v157
v_add_f32 v27, v27, v158
v_add_f32 v27, v27, v159
CV 152,152,153
CV 153,154,155
CV 154,156,157
CV 155,158,159
s_add_u32 m0, s68, 147456
s_add_u32 s95, s94, 0
buffer_load_dwordx4 v184, s[12:15], s95 offen offset:0 lds
buffer_load_dwordx4 v185, s[12:15], s95 offen offset:1024 lds
buffer_load_dwordx4 v186, s[12:15], s95 offen offset:2048 lds
buffer_load_dwordx4 v187, s[12:15], s95 offen offset:3072 lds
s_waitcnt vmcnt(0)
R 160,96,0
R 162,96,2048
R 164,97,0
R 166,97,2048
R 168,98,0
R 170,98,2048
R 172,99,0
R 174,99,2048
s_waitcnt lgkmcnt(0)
NC 128,160,128
NC 136,160,136
NC 0,160,144
NC 8,160,152
NC 132,164,128
NC 140,164,136
NC 4,164,144
NC 12,164,152
NC 144,168,128
NC 152,168,136
NC 16,168,144
NC 24,168,152
NC 148,172,128
NC 156,172,136
NC 20,172,144
NC 28,172,152
s_nop 7
s_add_u32 m0, s68, 147456
s_add_u32 s95, s94, 128
buffer_load_dwordx4 v184, s[12:15], s95 offen offset:0 lds
buffer_load_dwordx4 v185, s[12:15], s95 offen offset:1024 lds
buffer_load_dwordx4 v186, s[12:15], s95 offen offset:2048 lds
buffer_load_dwordx4 v187, s[12:15], s95 offen offset:3072 lds
s_waitcnt vmcnt(0)
R 160,96,0
R 162,96,2048
R 164,97,0
R 166,97,2048
R 168,98,0
R 170,98,2048
R 172,99,0
R 174,99,2048
s_waitcnt lgkmcnt(0)
NC 160,160,128
NC 168,160,136
NC 32,160,144
NC 40,160,152
NC 164,164,128
NC 172,164,136
NC 36,164,144
NC 44,164,152
NC 176,168,128
NC 184,168,136
NC 48,168,144
NC 56,168,152
NC 180,172,128
NC 188,172,136
NC 52,172,144
NC 60,172,152
s_nop 7
s_add_u32 s94, s94, 8192
s_sub_u32 s92, s92, 1
s_cmp_lg_u32 s92, 0
s_cbranch_scc1 LA_slowb1
v_mov_b32 v188, v24
v_mov_b32 v189, v25
v_mov_b32 v190, v26
v_mov_b32 v191, v27
s_nop 1
v_permlane16_swap_b32 v24, v188
v_permlane16_swap_b32 v25, v189
v_permlane16_swap_b32 v26, v190
v_permlane16_swap_b32 v27, v191
v_add_f32 v24, v24, v188
v_add_f32 v25, v25, v189
v_add_f32 v26, v26, v190
v_add_f32 v27, v27, v191
v_mov_b32 v188, v24
v_mov_b32 v189, v25
v_mov_b32 v190, v26
v_mov_b32 v191, v27
s_nop 1
v_permlane32_swap_b32 v24, v188
v_permlane32_swap_b32 v25, v189
v_permlane32_swap_b32 v26, v190
v_permlane32_swap_b32 v27, v191
v_add_f32 v24, v24, v188
v_add_f32 v25, v25, v189
v_add_f32 v26, v26, v190
v_add_f32 v27, v27, v191
s_mov_b32 m0, s93
s_nop 15
s_branch LA_slowret1
LA_poll2:
s_sleep 4
buffer_load_dword v31, v24, s[48:51], s81 offen sc1
s_sub_u32 s77, s77, 1
s_cmp_eq_u32 s77, 0
s_cbranch_scc1 LA_end
s_waitcnt vmcnt(0)
v_cmp_ne_u32 vcc, 0x10000, v31
s_nop 1
s_cbranch_vccnz LA_poll2
s_branch LA_ok2
LA_poll3:
s_sleep 4
buffer_load_dword v31, v24, s[48:51], s81 offen sc1
s_sub_u32 s77, s77, 1
s_cmp_eq_u32 s77, 0
s_cbranch_scc1 LA_end
s_waitcnt vmcnt(0)
v_cmp_ne_u32 vcc, 0x10000, v31
s_nop 1
s_cbranch_vccnz LA_poll3
s_branch LA_ok3
LA_poll4:
s_sleep 4
buffer_load_dword v31, v24, s[48:51], s81 offen sc1
s_sub_u32 s77, s77, 1
s_cmp_eq_u32 s77, 0
s_cbranch_scc1 LA_end
s_waitcnt vmcnt(0)
v_cmp_ne_u32 vcc, 0x10000, v31
s_nop 1
s_cbranch_vccnz LA_poll4
s_branch LA_ok4
LA_poll5:
s_sleep 1
buffer_load_dword v31, v24, s[48:51], s81 offen sc1
s_sub_u32 s77, s77, 1
s_cmp_eq_u32 s77, 0
s_cbranch_scc1 LA_end
s_waitcnt vmcnt(0)
v_cmp_ne_u32 vcc, 0x10000, v31
s_nop 1
s_cbranch_vccnz LA_poll5
s_branch LA_ok5
LA_poll6:
s_sleep 1
buffer_load_dword v31, v24, s[48:51], s81 offen sc1
s_sub_u32 s77, s77, 1
s_cmp_eq_u32 s77, 0
s_cbranch_scc1 LA_end
s_waitcnt vmcnt(0)
v_cmp_ne_u32 vcc, 0x10000, v31
s_nop 1
s_cbranch_vccnz LA_poll6
s_branch LA_ok6
.section .rodata,"a"
.p2align 6
.amdhsa_kernel recurrent_scan__sliding_block_cached__mixer_s_mlp__prompt_kernel
  .amdhsa_next_free_vgpr 512
  .amdhsa_next_free_sgpr 102
  .amdhsa_accum_offset 256
  .amdhsa_group_segment_fixed_size 0
  .amdhsa_kernarg_size 104
  .amdhsa_user_sgpr_count 2
  .amdhsa_user_sgpr_kernarg_segment_ptr 1
  .amdhsa_system_sgpr_workgroup_id_x 1
.end_amdhsa_kernel
```
